```python
import torch

def _softmax(x, axis=-1):
    return torch.softmax(x, dim=axis)
def _gelu(x):
    return torch.nn.functional.gelu(x, approximate="tanh")
def _silu(x):
    return torch.nn.functional.silu(x)
def _sigmoid(x):
    return torch.sigmoid(x)
def _layernorm(x, axis=-1, eps=1e-5):
    m = x.mean(dim=axis, keepdim=True)
    v = x.var(dim=axis, keepdim=True, unbiased=False)
    return (x - m) / torch.sqrt(v + eps)
def _scatter_add(tgt, idx, src, axis=0):
    return tgt.clone().index_add_(axis, idx, src)
def _segment_sum(src, seg, n):
    out = torch.zeros((n,) + src.shape[1:], dtype=src.dtype)
    return out.index_add_(0, seg, src)
def _pad(x, pw):
    flat = tuple(v for pair in reversed(pw) for v in pair)
    return torch.nn.functional.pad(x, flat)

kernel_name = 'parallel_sum__sliding_block__mixer_token_mlp__prompt'

def setup_inputs():

    _w = (lambda a: (lambda t: t.to(torch.bfloat16) if t.is_floating_point() else t)(torch.as_tensor(a)))
    def _A_setup():
        B, S, D = 1, 2048, 1024
        return {
            "x": _w((lambda *s: torch.randn(*s, dtype=torch.bfloat16) * 0.05)(B, S, D)),
            "wqkv": _w((lambda *s: torch.randn(*s, dtype=torch.bfloat16) * 0.05)(D, 3 * D)),
            "wo": _w((lambda *s: torch.randn(*s, dtype=torch.bfloat16) * 0.05)(D, D)),
        }
    _A_in = _A_setup()

    def _B_setup():
        B, S, D, F = 1, 2048, 1024, 3584
        return {
            "x": _w((lambda *s: torch.randn(*s, dtype=torch.bfloat16) * 0.05)(B, S, D)),
            "w1": _w((lambda *s: torch.randn(*s, dtype=torch.bfloat16) * 3.2)(S, F) * (S ** -0.5)),
            "b1": _w((lambda *s: torch.randn(*s, dtype=torch.bfloat16) * 3.2)(F) * 0.02),
            "w2": _w((lambda *s: torch.randn(*s, dtype=torch.bfloat16) * 0.4)(F, S) * (F ** -0.5)),
            "b2": _w((lambda *s: torch.randn(*s, dtype=torch.bfloat16) * 0.4)(S) * 0.02),
        }
    _B_in = _B_setup()

    return {
        "A_x": _A_in["x"],
        "A_wqkv": _A_in["wqkv"],
        "A_wo": _A_in["wo"],
        "B_x": _B_in["x"],
        "B_w1": _B_in["w1"],
        "B_b1": _B_in["b1"],
        "B_w2": _B_in["w2"],
        "B_b2": _B_in["b2"],
    }

def reference(A_x, A_wqkv, A_wo, B_x, B_w1, B_b1, B_w2, B_b2):
    def _A_ref(x, wqkv, wo):
        B, S, D = x.shape
        H = 32; Dh = D // H; W = 256
        qkv = (lambda x, *d: x.permute(*d))((x @ wqkv).reshape(B, S, 3, H, Dh), 2, 0, 3, 1, 4)
        q, k, v = qkv[0], qkv[1], qkv[2]
        scores = torch.einsum("bhqd,bhkd->bhqk", q, k) * (Dh ** -0.5)
        idx = torch.arange(S)
        mask = (idx[:, None] - idx[None, :] >= 0) & (idx[:, None] - idx[None, :] < W)
        scores = torch.where(mask[None, None], scores, -1e9)
        p = _softmax(scores, axis=-1)
        o = torch.einsum("bhqk,bhkd->bhqd", p, v)
        return (lambda x, *d: x.permute(*d))(o, 0, 2, 1, 3).reshape(B, S, D) @ wo

    def _B_ref(x, w1, b1, w2, b2):
        B, S, D = x.shape
        h = _layernorm(x, axis=-1)
        u = torch.einsum("bsd,sf->bdf", h, w1) + b1
        u = _gelu(u)
        y = torch.einsum("bdf,fs->bds", u, w2) + b2
        return (lambda x, *d: x.permute(*d))(y, 0, 2, 1)

    x = A_x
    xn = _layernorm(x, axis=-1)
    return x + _A_ref(xn, A_wqkv, A_wo) + _B_ref(xn, B_w1, B_b1, B_w2, B_b2)
```

```asm
; @launch kernel=ln_kernel grid=(256,1,1) block=(512,1,1) lds=33408
; @launch kernel=k2_kernel grid=(256,1,1) block=(512,1,1) lds=163840
.amdgcn_target "amdgcn-amd-amdhsa--gfx950"
.text
.globl ln_kernel
.p2align 8
.type ln_kernel,@function
ln_kernel:
    s_cmp_ge_u32 s2, 256
    s_cbranch_scc1 ln_done
    s_load_dwordx4 s[4:7], s[0:1], 0
    s_load_dwordx2 s[30:31], s[0:1], 80
    s_load_dwordx2 s[32:33], s[0:1], 32
    v_and_b32 v1, 63, v0
    v_lshrrev_b32 v2, 6, v0
    v_lshlrev_b32 v3, 4, v1
    v_readfirstlane_b32 s3, v2
    s_lshl_b32 s20, s2, 3
    s_add_u32 s20, s20, s3
    s_lshl_b32 s21, s20, 11
    s_waitcnt lgkmcnt(0)
    s_mov_b32 s8, s4
    s_mov_b32 s9, s5
    s_mov_b32 s10, 0x400000
    s_mov_b32 s11, 0x00020000
    buffer_load_dwordx4 v[8:11], v3, s[8:11], s21 offen
    buffer_load_dwordx4 v[12:15], v3, s[8:11], s21 offen offset:1024
    v_lshlrev_b32 v60, 7, v1
    s_lshl_b32 s34, s3, 8
    s_add_u32 s34, s34, s2
    s_lshl_b32 s34, s34, 13
    s_sub_u32 s35, s34, 3145728
    s_cmp_lt_u32 s34, 3145728
    s_cselect_b32 s34, s34, s35
    s_cselect_b32 s36, s6, s32
    s_cselect_b32 s37, s7, s33
    s_mov_b32 s38, 6291456
    s_mov_b32 s39, 0x00020000
    s_sub_u32 s40, 255, s2
    s_lshl_b32 s40, s40, 3
    s_add_u32 s40, s40, s3
    s_xor_b32 s40, s40, 7
    s_lshl_b32 s40, s40, 13
    s_mov_b32 s12, s30
    s_mov_b32 s13, s31
    s_mov_b32 s14, 0x400000
    s_mov_b32 s15, 0x00020000
    s_add_u32 s16, s30, 0x400000
    s_addc_u32 s17, s31, 0
    s_mov_b32 s18, 0x400000
    s_mov_b32 s19, 0x00020000
    s_add_u32 s44, s30, 0x2c00000
    s_addc_u32 s45, s31, 0
    s_mov_b32 s46, 0x200000
    s_mov_b32 s47, 0x00020000
    s_mov_b32 s22, 0xffff0000
    s_mov_b32 s23, 0x3a800000
    s_mov_b32 s24, 0x3727c5ac
    s_waitcnt vmcnt(0)
    buffer_load_dword v61, v60, s[36:39], s34 offen
    s_getpc_b64 s[48:49]
ct1:
    s_add_u32 s48, s48, k2_kernel-ct1
    s_addc_u32 s49, s49, 0
    s_mov_b32 s50, code_end-k2_kernel
    s_mov_b32 s51, 0x00020000
    buffer_load_dword v63, v60, s[48:51], s40 offen
    s_cmp_lg_u32 s3, 0
    s_cbranch_scc1 ln_noflag
    v_lshlrev_b32 v4, 2, v1
    v_mov_b32 v5, 0
    s_mul_i32 s35, s2, 4352
    buffer_store_dword v5, v4, s[44:47], s35 offen
ln_noflag:
    v_lshlrev_b32 v16, 16, v8
    v_and_b32 v17, s22, v8
    v_lshlrev_b32 v18, 16, v9
    v_and_b32 v19, s22, v9
    v_lshlrev_b32 v20, 16, v10
    v_and_b32 v21, s22, v10
    v_lshlrev_b32 v22, 16, v11
    v_and_b32 v23, s22, v11
    v_lshlrev_b32 v24, 16, v12
    v_and_b32 v25, s22, v12
    v_lshlrev_b32 v26, 16, v13
    v_and_b32 v27, s22, v13
    v_lshlrev_b32 v28, 16, v14
    v_and_b32 v29, s22, v14
    v_lshlrev_b32 v30, 16, v15
    v_and_b32 v31, s22, v15
    v_add_f32 v4, v16, v17
    v_add_f32 v5, v18, v19
    v_add_f32 v4, v4, v20
    v_add_f32 v5, v5, v21
    v_add_f32 v4, v4, v22
    v_add_f32 v5, v5, v23
    v_add_f32 v4, v4, v24
    v_add_f32 v5, v5, v25
    v_add_f32 v4, v4, v26
    v_add_f32 v5, v5, v27
    v_add_f32 v4, v4, v28
    v_add_f32 v5, v5, v29
    v_add_f32 v4, v4, v30
    v_add_f32 v5, v5, v31
    v_add_f32 v4, v4, v5
    s_nop 1
    v_add_f32_dpp v4, v4, v4 row_shr:1 row_mask:0xf bank_mask:0xf bound_ctrl:0
    s_nop 1
    v_add_f32_dpp v4, v4, v4 row_shr:2 row_mask:0xf bank_mask:0xf bound_ctrl:0
    s_nop 1
    v_add_f32_dpp v4, v4, v4 row_shr:4 row_mask:0xf bank_mask:0xf bound_ctrl:0
    s_nop 1
    v_add_f32_dpp v4, v4, v4 row_shr:8 row_mask:0xf bank_mask:0xf bound_ctrl:0
    s_nop 1
    v_add_f32_dpp v4, v4, v4 row_bcast:15 row_mask:0xa bank_mask:0xf
    s_nop 1
    v_add_f32_dpp v4, v4, v4 row_bcast:31 row_mask:0xc bank_mask:0xf
    s_nop 1
    v_readlane_b32 s25, v4, 63
    s_nop 1
    v_mov_b32 v6, s23
    v_mul_f32 v6, s25, v6
    v_sub_f32 v32, v16, v6
    v_sub_f32 v33, v17, v6
    v_sub_f32 v34, v18, v6
    v_sub_f32 v35, v19, v6
    v_sub_f32 v36, v20, v6
    v_sub_f32 v37, v21, v6
    v_sub_f32 v38, v22, v6
    v_sub_f32 v39, v23, v6
    v_sub_f32 v40, v24, v6
    v_sub_f32 v41, v25, v6
    v_sub_f32 v42, v26, v6
    v_sub_f32 v43, v27, v6
    v_sub_f32 v44, v28, v6
    v_sub_f32 v45, v29, v6
    v_sub_f32 v46, v30, v6
    v_sub_f32 v47, v31, v6
    v_mul_f32 v4, v32, v32
    v_mul_f32 v5, v33, v33
    v_fmac_f32 v4, v34, v34
    v_fmac_f32 v5, v35, v35
    v_fmac_f32 v4, v36, v36
    v_fmac_f32 v5, v37, v37
    v_fmac_f32 v4, v38, v38
    v_fmac_f32 v5, v39, v39
    v_fmac_f32 v4, v40, v40
    v_fmac_f32 v5, v41, v41
    v_fmac_f32 v4, v42, v42
    v_fmac_f32 v5, v43, v43
    v_fmac_f32 v4, v44, v44
    v_fmac_f32 v5, v45, v45
    v_fmac_f32 v4, v46, v46
    v_fmac_f32 v5, v47, v47
    v_add_f32 v4, v4, v5
    s_nop 1
    v_add_f32_dpp v4, v4, v4 row_shr:1 row_mask:0xf bank_mask:0xf bound_ctrl:0
    s_nop 1
    v_add_f32_dpp v4, v4, v4 row_shr:2 row_mask:0xf bank_mask:0xf bound_ctrl:0
    s_nop 1
    v_add_f32_dpp v4, v4, v4 row_shr:4 row_mask:0xf bank_mask:0xf bound_ctrl:0
    s_nop 1
    v_add_f32_dpp v4, v4, v4 row_shr:8 row_mask:0xf bank_mask:0xf bound_ctrl:0
    s_nop 1
    v_add_f32_dpp v4, v4, v4 row_bcast:15 row_mask:0xa bank_mask:0xf
    s_nop 1
    v_add_f32_dpp v4, v4, v4 row_bcast:31 row_mask:0xc bank_mask:0xf
    s_nop 1
    v_readlane_b32 s25, v4, 63
    v_cvt_pk_bf16_f32 v6, v6, v6
    v_lshlrev_b32 v6, 16, v6
    v_mov_b32 v7, s23
    v_mul_f32 v7, s25, v7
    v_cvt_pk_bf16_f32 v7, v7, v7
    v_lshlrev_b32 v7, 16, v7
    v_add_f32 v7, s24, v7
    v_cvt_pk_bf16_f32 v7, v7, v7
    v_lshlrev_b32 v7, 16, v7
    v_sqrt_f32 v7, v7
    s_nop 0
    v_cvt_pk_bf16_f32 v7, v7, v7
    v_lshlrev_b32 v7, 16, v7
    v_rcp_f32 v48, v7
    v_sub_f32 v32, v16, v6
    v_sub_f32 v33, v17, v6
    v_sub_f32 v34, v18, v6
    v_sub_f32 v35, v19, v6
    v_sub_f32 v36, v20, v6
    v_sub_f32 v37, v21, v6
    v_sub_f32 v38, v22, v6
    v_sub_f32 v39, v23, v6
    v_sub_f32 v40, v24, v6
    v_sub_f32 v41, v25, v6
    v_sub_f32 v42, v26, v6
    v_sub_f32 v43, v27, v6
    v_sub_f32 v44, v28, v6
    v_sub_f32 v45, v29, v6
    v_sub_f32 v46, v30, v6
    v_sub_f32 v47, v31, v6
    v_cvt_pk_bf16_f32 v8, v32, v33
    v_cvt_pk_bf16_f32 v9, v34, v35
    v_cvt_pk_bf16_f32 v10, v36, v37
    v_cvt_pk_bf16_f32 v11, v38, v39
    v_cvt_pk_bf16_f32 v12, v40, v41
    v_cvt_pk_bf16_f32 v13, v42, v43
    v_cvt_pk_bf16_f32 v14, v44, v45
    v_cvt_pk_bf16_f32 v15, v46, v47
    v_lshlrev_b32 v32, 16, v8
    v_and_b32 v33, s22, v8
    v_lshlrev_b32 v34, 16, v9
    v_and_b32 v35, s22, v9
    v_lshlrev_b32 v36, 16, v10
    v_and_b32 v37, s22, v10
    v_lshlrev_b32 v38, 16, v11
    v_and_b32 v39, s22, v11
    v_lshlrev_b32 v40, 16, v12
    v_and_b32 v41, s22, v12
    v_lshlrev_b32 v42, 16, v13
    v_and_b32 v43, s22, v13
    v_lshlrev_b32 v44, 16, v14
    v_and_b32 v45, s22, v14
    v_lshlrev_b32 v46, 16, v15
    v_and_b32 v47, s22, v15
    v_mul_f32 v16, v32, v48
    v_mul_f32 v17, v33, v48
    v_mul_f32 v18, v34, v48
    v_mul_f32 v19, v35, v48
    v_mul_f32 v20, v36, v48
    v_mul_f32 v21, v37, v48
    v_mul_f32 v22, v38, v48
    v_mul_f32 v23, v39, v48
    v_mul_f32 v24, v40, v48
    v_mul_f32 v25, v41, v48
    v_mul_f32 v26, v42, v48
    v_mul_f32 v27, v43, v48
    v_mul_f32 v28, v44, v48
    v_mul_f32 v29, v45, v48
    v_mul_f32 v30, v46, v48
    v_mul_f32 v31, v47, v48
    v_fma_f32 v32, -v16, v7, v32
    v_fma_f32 v33, -v17, v7, v33
    v_fma_f32 v34, -v18, v7, v34
    v_fma_f32 v35, -v19, v7, v35
    v_fma_f32 v36, -v20, v7, v36
    v_fma_f32 v37, -v21, v7, v37
    v_fma_f32 v38, -v22, v7, v38
    v_fma_f32 v39, -v23, v7, v39
    v_fma_f32 v40, -v24, v7, v40
    v_fma_f32 v41, -v25, v7, v41
    v_fma_f32 v42, -v26, v7, v42
    v_fma_f32 v43, -v27, v7, v43
    v_fma_f32 v44, -v28, v7, v44
    v_fma_f32 v45, -v29, v7, v45
    v_fma_f32 v46, -v30, v7, v46
    v_fma_f32 v47, -v31, v7, v47
    v_fmac_f32 v16, v32, v48
    v_fmac_f32 v17, v33, v48
    v_fmac_f32 v18, v34, v48
    v_fmac_f32 v19, v35, v48
    v_fmac_f32 v20, v36, v48
    v_fmac_f32 v21, v37, v48
    v_fmac_f32 v22, v38, v48
    v_fmac_f32 v23, v39, v48
    v_fmac_f32 v24, v40, v48
    v_fmac_f32 v25, v41, v48
    v_fmac_f32 v26, v42, v48
    v_fmac_f32 v27, v43, v48
    v_fmac_f32 v28, v44, v48
    v_fmac_f32 v29, v45, v48
    v_fmac_f32 v30, v46, v48
    v_fmac_f32 v31, v47, v48
    v_cvt_pk_bf16_f32 v8, v16, v17
    v_cvt_pk_bf16_f32 v9, v18, v19
    v_cvt_pk_bf16_f32 v10, v20, v21
    v_cvt_pk_bf16_f32 v11, v22, v23
    v_cvt_pk_bf16_f32 v12, v24, v25
    v_cvt_pk_bf16_f32 v13, v26, v27
    v_cvt_pk_bf16_f32 v14, v28, v29
    v_cvt_pk_bf16_f32 v15, v30, v31
    v_lshlrev_b32 v16, 16, v8
    v_and_b32 v17, s22, v8
    v_lshlrev_b32 v18, 16, v9
    v_and_b32 v19, s22, v9
    v_lshlrev_b32 v20, 16, v10
    v_and_b32 v21, s22, v10
    v_lshlrev_b32 v22, 16, v11
    v_and_b32 v23, s22, v11
    v_lshlrev_b32 v24, 16, v12
    v_and_b32 v25, s22, v12
    v_lshlrev_b32 v26, 16, v13
    v_and_b32 v27, s22, v13
    v_lshlrev_b32 v28, 16, v14
    v_and_b32 v29, s22, v14
    v_lshlrev_b32 v30, 16, v15
    v_and_b32 v31, s22, v15
    s_mul_i32 s26, s3, 2064
    v_add_u32 v50, s26, v3
    ds_write_b128 v50, v[8:11]
    ds_write_b128 v50, v[12:15] offset:1024
    v_add_f32 v4, v16, v17
    v_mul_f32 v5, v16, v16
    v_fmac_f32 v5, v17, v17
    v_add_f32 v4, v4, v18
    v_fmac_f32 v5, v18, v18
    v_add_f32 v4, v4, v19
    v_fmac_f32 v5, v19, v19
    v_add_f32 v4, v4, v20
    v_fmac_f32 v5, v20, v20
    v_add_f32 v4, v4, v21
    v_fmac_f32 v5, v21, v21
    v_add_f32 v4, v4, v22
    v_fmac_f32 v5, v22, v22
    v_add_f32 v4, v4, v23
    v_fmac_f32 v5, v23, v23
    v_add_f32 v4, v4, v24
    v_fmac_f32 v5, v24, v24
    v_add_f32 v4, v4, v25
    v_fmac_f32 v5, v25, v25
    v_add_f32 v4, v4, v26
    v_fmac_f32 v5, v26, v26
    v_add_f32 v4, v4, v27
    v_fmac_f32 v5, v27, v27
    v_add_f32 v4, v4, v28
    v_fmac_f32 v5, v28, v28
    v_add_f32 v4, v4, v29
    v_fmac_f32 v5, v29, v29
    v_add_f32 v4, v4, v30
    v_fmac_f32 v5, v30, v30
    v_add_f32 v4, v4, v31
    v_fmac_f32 v5, v31, v31
    s_nop 1
    v_add_f32_dpp v4, v4, v4 row_shr:1 row_mask:0xf bank_mask:0xf bound_ctrl:0
    v_add_f32_dpp v5, v5, v5 row_shr:1 row_mask:0xf bank_mask:0xf bound_ctrl:0
    s_nop 1
    v_add_f32_dpp v4, v4, v4 row_shr:2 row_mask:0xf bank_mask:0xf bound_ctrl:0
    v_add_f32_dpp v5, v5, v5 row_shr:2 row_mask:0xf bank_mask:0xf bound_ctrl:0
    s_nop 1
    v_add_f32_dpp v4, v4, v4 row_shr:4 row_mask:0xf bank_mask:0xf bound_ctrl:0
    v_add_f32_dpp v5, v5, v5 row_shr:4 row_mask:0xf bank_mask:0xf bound_ctrl:0
    s_nop 1
    v_add_f32_dpp v4, v4, v4 row_shr:8 row_mask:0xf bank_mask:0xf bound_ctrl:0
    v_add_f32_dpp v5, v5, v5 row_shr:8 row_mask:0xf bank_mask:0xf bound_ctrl:0
    s_nop 1
    v_add_f32_dpp v4, v4, v4 row_bcast:15 row_mask:0xa bank_mask:0xf
    v_add_f32_dpp v5, v5, v5 row_bcast:15 row_mask:0xa bank_mask:0xf
    s_nop 1
    v_add_f32_dpp v4, v4, v4 row_bcast:31 row_mask:0xc bank_mask:0xf
    v_add_f32_dpp v5, v5, v5 row_bcast:31 row_mask:0xc bank_mask:0xf
    s_nop 1
    v_readlane_b32 s25, v4, 63
    v_readlane_b32 s27, v5, 63
    v_mov_b32 v6, s23
    v_mov_b32 v7, s23
    v_mul_f32 v6, s25, v6
    v_mul_f32 v7, s27, v7
    v_fma_f32 v7, -v6, v6, v7
    v_max_f32 v7, 0, v7
    v_cvt_pk_bf16_f32 v6, v6, v6
    v_lshlrev_b32 v6, 16, v6
    v_cvt_pk_bf16_f32 v7, v7, v7
    v_lshlrev_b32 v7, 16, v7
    v_add_f32 v7, s24, v7
    v_cvt_pk_bf16_f32 v7, v7, v7
    v_lshlrev_b32 v7, 16, v7
    v_sqrt_f32 v7, v7
    s_nop 0
    v_cvt_pk_bf16_f32 v7, v7, v7
    v_lshlrev_b32 v7, 16, v7
    v_rcp_f32 v48, v7
    v_sub_f32 v32, v16, v6
    v_sub_f32 v33, v17, v6
    v_sub_f32 v34, v18, v6
    v_sub_f32 v35, v19, v6
    v_sub_f32 v36, v20, v6
    v_sub_f32 v37, v21, v6
    v_sub_f32 v38, v22, v6
    v_sub_f32 v39, v23, v6
    v_sub_f32 v40, v24, v6
    v_sub_f32 v41, v25, v6
    v_sub_f32 v42, v26, v6
    v_sub_f32 v43, v27, v6
    v_sub_f32 v44, v28, v6
    v_sub_f32 v45, v29, v6
    v_sub_f32 v46, v30, v6
    v_sub_f32 v47, v31, v6
    v_cvt_pk_bf16_f32 v52, v32, v33
    v_cvt_pk_bf16_f32 v53, v34, v35
    v_cvt_pk_bf16_f32 v54, v36, v37
    v_cvt_pk_bf16_f32 v55, v38, v39
    v_cvt_pk_bf16_f32 v56, v40, v41
    v_cvt_pk_bf16_f32 v57, v42, v43
    v_cvt_pk_bf16_f32 v58, v44, v45
    v_cvt_pk_bf16_f32 v59, v46, v47
    v_lshlrev_b32 v32, 16, v52
    v_and_b32 v33, s22, v52
    v_lshlrev_b32 v34, 16, v53
    v_and_b32 v35, s22, v53
    v_lshlrev_b32 v36, 16, v54
    v_and_b32 v37, s22, v54
    v_lshlrev_b32 v38, 16, v55
    v_and_b32 v39, s22, v55
    v_lshlrev_b32 v40, 16, v56
    v_and_b32 v41, s22, v56
    v_lshlrev_b32 v42, 16, v57
    v_and_b32 v43, s22, v57
    v_lshlrev_b32 v44, 16, v58
    v_and_b32 v45, s22, v58
    v_lshlrev_b32 v46, 16, v59
    v_and_b32 v47, s22, v59
    v_mul_f32 v16, v32, v48
    v_mul_f32 v17, v33, v48
    v_mul_f32 v18, v34, v48
    v_mul_f32 v19, v35, v48
    v_mul_f32 v20, v36, v48
    v_mul_f32 v21, v37, v48
    v_mul_f32 v22, v38, v48
    v_mul_f32 v23, v39, v48
    v_mul_f32 v24, v40, v48
    v_mul_f32 v25, v41, v48
    v_mul_f32 v26, v42, v48
    v_mul_f32 v27, v43, v48
    v_mul_f32 v28, v44, v48
    v_mul_f32 v29, v45, v48
    v_mul_f32 v30, v46, v48
    v_mul_f32 v31, v47, v48
    v_fma_f32 v32, -v16, v7, v32
    v_fma_f32 v33, -v17, v7, v33
    v_fma_f32 v34, -v18, v7, v34
    v_fma_f32 v35, -v19, v7, v35
    v_fma_f32 v36, -v20, v7, v36
    v_fma_f32 v37, -v21, v7, v37
    v_fma_f32 v38, -v22, v7, v38
    v_fma_f32 v39, -v23, v7, v39
    v_fma_f32 v40, -v24, v7, v40
    v_fma_f32 v41, -v25, v7, v41
    v_fma_f32 v42, -v26, v7, v42
    v_fma_f32 v43, -v27, v7, v43
    v_fma_f32 v44, -v28, v7, v44
    v_fma_f32 v45, -v29, v7, v45
    v_fma_f32 v46, -v30, v7, v46
    v_fma_f32 v47, -v31, v7, v47
    v_fmac_f32 v16, v32, v48
    v_fmac_f32 v17, v33, v48
    v_fmac_f32 v18, v34, v48
    v_fmac_f32 v19, v35, v48
    v_fmac_f32 v20, v36, v48
    v_fmac_f32 v21, v37, v48
    v_fmac_f32 v22, v38, v48
    v_fmac_f32 v23, v39, v48
    v_fmac_f32 v24, v40, v48
    v_fmac_f32 v25, v41, v48
    v_fmac_f32 v26, v42, v48
    v_fmac_f32 v27, v43, v48
    v_fmac_f32 v28, v44, v48
    v_fmac_f32 v29, v45, v48
    v_fmac_f32 v30, v46, v48
    v_fmac_f32 v31, v47, v48
    v_cvt_pk_bf16_f32 v52, v16, v17
    v_cvt_pk_bf16_f32 v53, v18, v19
    v_cvt_pk_bf16_f32 v54, v20, v21
    v_cvt_pk_bf16_f32 v55, v22, v23
    v_cvt_pk_bf16_f32 v56, v24, v25
    v_cvt_pk_bf16_f32 v57, v26, v27
    v_cvt_pk_bf16_f32 v58, v28, v29
    v_cvt_pk_bf16_f32 v59, v30, v31
    s_mul_i32 s26, s3, 2112
    s_add_u32 s26, s26, 16512
    v_add_u32 v50, s26, v3
    ds_write_b128 v50, v[52:55]
    ds_write_b128 v50, v[56:59] offset:1024
    v_and_b32 v4, 7, v0
    v_lshrrev_b32 v5, 3, v0
    v_mul_u32_u24 v6, 2064, v4
    v_lshl_add_u32 v6, v5, 4, v6
    v_lshrrev_b32 v7, 2, v5
    v_lshlrev_b32 v7, 14, v7
    v_and_b32 v5, 3, v5
    v_lshl_add_u32 v7, v5, 8, v7
    v_lshl_add_u32 v7, v4, 4, v7
    s_lshr_b32 s26, s2, 5
    s_lshl_b32 s26, s26, 19
    s_lshr_b32 s27, s2, 1
    s_and_b32 s27, s27, 15
    s_lshl_b32 s27, s27, 10
    s_add_u32 s26, s26, s27
    s_and_b32 s27, s2, 1
    s_lshl_b32 s27, s27, 7
    s_add_u32 s26, s26, s27
    s_add_u32 s27, s26, 0x40000
    v_bfe_u32 v4, v1, 2, 2
    v_mul_u32_u24 v4, 2112, v4
    v_lshrrev_b32 v5, 4, v1
    v_lshl_add_u32 v4, v5, 5, v4
    v_and_b32 v49, 3, v1
    v_lshl_add_u32 v4, v49, 3, v4
    s_lshl_b32 s28, s3, 7
    s_add_u32 s28, s28, 16512
    v_add_u32 v4, s28, v4
    v_and_b32 v49, 15, v1
    v_lshlrev_b32 v49, 4, v49
    v_lshl_add_u32 v5, v5, 10, v49
    s_lshr_b32 s28, s3, 1
    s_lshl_b32 s28, s28, 19
    s_lshr_b32 s29, s2, 2
    s_lshl_b32 s29, s29, 13
    s_add_u32 s28, s28, s29
    s_and_b32 s29, s3, 1
    s_lshl_b32 s29, s29, 12
    s_add_u32 s28, s28, s29
    s_and_b32 s29, s2, 3
    s_lshl_b32 s29, s29, 8
    s_add_u32 s28, s28, s29
    s_add_u32 s29, s28, 0x200000
    s_waitcnt lgkmcnt(0)
    s_barrier
    ds_read_b128 v[8:11], v6
    ds_read_b128 v[12:15], v6 offset:1024
    ds_read_b64_tr_b16 v[16:17], v4
    ds_read_b64_tr_b16 v[18:19], v4 offset:8448
    ds_read_b64_tr_b16 v[20:21], v4 offset:1024
    ds_read_b64_tr_b16 v[22:23], v4 offset:9472
    s_waitcnt lgkmcnt(5)
    buffer_store_dwordx4 v[8:11], v7, s[12:15], s26 offen
    s_waitcnt lgkmcnt(4)
    buffer_store_dwordx4 v[12:15], v7, s[12:15], s27 offen
    s_waitcnt lgkmcnt(2)
    buffer_store_dwordx4 v[16:19], v5, s[16:19], s28 offen
    s_waitcnt lgkmcnt(0)
    buffer_store_dwordx4 v[20:23], v5, s[16:19], s29 offen
ln_done:
    s_endpgm
.section .rodata,"a"
.p2align 6
.amdhsa_kernel ln_kernel
  .amdhsa_next_free_vgpr 64
  .amdhsa_next_free_sgpr 56
  .amdhsa_accum_offset 64
  .amdhsa_group_segment_fixed_size 0
  .amdhsa_kernarg_size 88
  .amdhsa_user_sgpr_count 2
  .amdhsa_user_sgpr_kernarg_segment_ptr 1
  .amdhsa_system_sgpr_workgroup_id_x 1
  .amdhsa_float_denorm_mode_32 3
.end_amdhsa_kernel
.text
.globl k2_kernel
.p2align 8
.type k2_kernel,@function
k2_kernel:
    s_cmp_ge_u32 s2, 256
    s_cbranch_scc1 k2_done
    s_load_dwordx2 s[4:5], s[0:1], 8
    s_load_dwordx4 s[8:11], s[0:1], 32
    s_load_dwordx2 s[6:7], s[0:1], 80
    s_load_dwordx2 s[62:63], s[0:1], 48
    v_and_b32 v1, 63, v0
    v_lshrrev_b32 v2, 6, v0
    s_and_b32 s30, s2, 7
    v_readfirstlane_b32 s3, v2
    s_lshr_b32 s31, s2, 3
    s_mov_b32 s101, s3
    s_mov_b32 s100, 0
    s_cmp_lt_u32 s30, 4
    s_cbranch_scc1 g1_entry
    s_cmp_ge_u32 s31, 28
    s_cbranch_scc1 k2_pf
    s_sub_u32 s32, s30, 4
    s_mul_i32 s32, s32, 28
    s_add_u32 s32, s32, s31
    s_and_b32 s33, s32, 7
    s_lshr_b32 s32, s32, 3
    s_cmp_ge_u32 s3, 4
    s_cbranch_scc1 g2_prod
    s_waitcnt lgkmcnt(0)
    s_mov_b32 s12, s10
    s_mov_b32 s13, s11
    s_mov_b32 s14, 0x1c00
    s_mov_b32 s15, 0x00020000
    s_add_u32 s16, s6, 0x1400000
    s_addc_u32 s17, s7, 0
    s_mov_b32 s18, 0x700000
    s_mov_b32 s19, 0x00020000
    s_and_b32 s35, s3, 1
    s_lshr_b32 s36, s3, 1
    v_lshrrev_b32 v2, 4, v1
    v_lshlrev_b32 v2, 3, v2
    s_lshl_b32 s37, s32, 9
    s_lshl_b32 s38, s35, 6
    s_add_u32 s37, s37, s38
    buffer_load_dwordx2 v[16:17], v2, s[12:15], s37 offen offset:0
    buffer_load_dwordx2 v[18:19], v2, s[12:15], s37 offen offset:32
    buffer_load_dwordx2 v[20:21], v2, s[12:15], s37 offen offset:128
    buffer_load_dwordx2 v[22:23], v2, s[12:15], s37 offen offset:160
    buffer_load_dwordx2 v[24:25], v2, s[12:15], s37 offen offset:256
    buffer_load_dwordx2 v[26:27], v2, s[12:15], s37 offen offset:288
    buffer_load_dwordx2 v[28:29], v2, s[12:15], s37 offen offset:384
    buffer_load_dwordx2 v[30:31], v2, s[12:15], s37 offen offset:416
    v_bfe_u32 v8, v1, 2, 2
    v_lshrrev_b32 v9, 4, v1
    v_lshl_add_u32 v8, v9, 3, v8
    v_lshlrev_b32 v4, 7, v8
    v_bfe_u32 v8, v1, 3, 2
    v_lshl_add_u32 v4, v8, 5, v4
    v_and_b32 v8, 3, v1
    v_lshl_add_u32 v4, v8, 3, v4
    v_xor_b32 v4, s38, v4
    v_xor_b32 v5, 32, v4
    v_xor_b32 v6, 64, v4
    v_xor_b32 v7, 96, v4
    v_lshlrev_b32 v8, 4, v1
    s_lshl_b32 s38, s36, 12
    s_add_u32 s38, s38, 16384
    v_add_u32 v8, s38, v8
    v_add_u32 v10, 73728, v4
    v_add_u32 v11, 73728, v5
    v_add_u32 v12, 73728, v6
    v_add_u32 v13, 73728, v7
    v_add_u32 v9, 73728, v8
    s_mov_b32 s39, 0xffff0000
    s_waitcnt vmcnt(0)
    v_lshlrev_b32 v128, 16, v16
    v_and_b32 v129, s39, v16
    v_lshlrev_b32 v132, 16, v16
    v_and_b32 v133, s39, v16
    v_lshlrev_b32 v136, 16, v16
    v_and_b32 v137, s39, v16
    v_lshlrev_b32 v140, 16, v16
    v_and_b32 v141, s39, v16
    v_lshlrev_b32 v130, 16, v17
    v_and_b32 v131, s39, v17
    v_lshlrev_b32 v134, 16, v17
    v_and_b32 v135, s39, v17
    v_lshlrev_b32 v138, 16, v17
    v_and_b32 v139, s39, v17
    v_lshlrev_b32 v142, 16, v17
    v_and_b32 v143, s39, v17
    v_lshlrev_b32 v144, 16, v18
    v_and_b32 v145, s39, v18
    v_lshlrev_b32 v148, 16, v18
    v_and_b32 v149, s39, v18
    v_lshlrev_b32 v152, 16, v18
    v_and_b32 v153, s39, v18
    v_lshlrev_b32 v156, 16, v18
    v_and_b32 v157, s39, v18
    v_lshlrev_b32 v146, 16, v19
    v_and_b32 v147, s39, v19
    v_lshlrev_b32 v150, 16, v19
    v_and_b32 v151, s39, v19
    v_lshlrev_b32 v154, 16, v19
    v_and_b32 v155, s39, v19
    v_lshlrev_b32 v158, 16, v19
    v_and_b32 v159, s39, v19
    v_lshlrev_b32 v160, 16, v20
    v_and_b32 v161, s39, v20
    v_lshlrev_b32 v164, 16, v20
    v_and_b32 v165, s39, v20
    v_lshlrev_b32 v168, 16, v20
    v_and_b32 v169, s39, v20
    v_lshlrev_b32 v172, 16, v20
    v_and_b32 v173, s39, v20
    v_lshlrev_b32 v162, 16, v21
    v_and_b32 v163, s39, v21
    v_lshlrev_b32 v166, 16, v21
    v_and_b32 v167, s39, v21
    v_lshlrev_b32 v170, 16, v21
    v_and_b32 v171, s39, v21
    v_lshlrev_b32 v174, 16, v21
    v_and_b32 v175, s39, v21
    v_lshlrev_b32 v176, 16, v22
    v_and_b32 v177, s39, v22
    v_lshlrev_b32 v180, 16, v22
    v_and_b32 v181, s39, v22
    v_lshlrev_b32 v184, 16, v22
    v_and_b32 v185, s39, v22
    v_lshlrev_b32 v188, 16, v22
    v_and_b32 v189, s39, v22
    v_lshlrev_b32 v178, 16, v23
    v_and_b32 v179, s39, v23
    v_lshlrev_b32 v182, 16, v23
    v_and_b32 v183, s39, v23
    v_lshlrev_b32 v186, 16, v23
    v_and_b32 v187, s39, v23
    v_lshlrev_b32 v190, 16, v23
    v_and_b32 v191, s39, v23
    v_lshlrev_b32 v192, 16, v24
    v_and_b32 v193, s39, v24
    v_lshlrev_b32 v196, 16, v24
    v_and_b32 v197, s39, v24
    v_lshlrev_b32 v200, 16, v24
    v_and_b32 v201, s39, v24
    v_lshlrev_b32 v204, 16, v24
    v_and_b32 v205, s39, v24
    v_lshlrev_b32 v194, 16, v25
    v_and_b32 v195, s39, v25
    v_lshlrev_b32 v198, 16, v25
    v_and_b32 v199, s39, v25
    v_lshlrev_b32 v202, 16, v25
    v_and_b32 v203, s39, v25
    v_lshlrev_b32 v206, 16, v25
    v_and_b32 v207, s39, v25
    v_lshlrev_b32 v208, 16, v26
    v_and_b32 v209, s39, v26
    v_lshlrev_b32 v212, 16, v26
    v_and_b32 v213, s39, v26
    v_lshlrev_b32 v216, 16, v26
    v_and_b32 v217, s39, v26
    v_lshlrev_b32 v220, 16, v26
    v_and_b32 v221, s39, v26
    v_lshlrev_b32 v210, 16, v27
    v_and_b32 v211, s39, v27
    v_lshlrev_b32 v214, 16, v27
    v_and_b32 v215, s39, v27
    v_lshlrev_b32 v218, 16, v27
    v_and_b32 v219, s39, v27
    v_lshlrev_b32 v222, 16, v27
    v_and_b32 v223, s39, v27
    v_lshlrev_b32 v224, 16, v28
    v_and_b32 v225, s39, v28
    v_lshlrev_b32 v228, 16, v28
    v_and_b32 v229, s39, v28
    v_lshlrev_b32 v232, 16, v28
    v_and_b32 v233, s39, v28
    v_lshlrev_b32 v236, 16, v28
    v_and_b32 v237, s39, v28
    v_lshlrev_b32 v226, 16, v29
    v_and_b32 v227, s39, v29
    v_lshlrev_b32 v230, 16, v29
    v_and_b32 v231, s39, v29
    v_lshlrev_b32 v234, 16, v29
    v_and_b32 v235, s39, v29
    v_lshlrev_b32 v238, 16, v29
    v_and_b32 v239, s39, v29
    v_lshlrev_b32 v240, 16, v30
    v_and_b32 v241, s39, v30
    v_lshlrev_b32 v244, 16, v30
    v_and_b32 v245, s39, v30
    v_lshlrev_b32 v248, 16, v30
    v_and_b32 v249, s39, v30
    v_lshlrev_b32 v252, 16, v30
    v_and_b32 v253, s39, v30
    v_lshlrev_b32 v242, 16, v31
    v_and_b32 v243, s39, v31
    v_lshlrev_b32 v246, 16, v31
    v_and_b32 v247, s39, v31
    v_lshlrev_b32 v250, 16, v31
    v_and_b32 v251, s39, v31
    v_lshlrev_b32 v254, 16, v31
    v_and_b32 v255, s39, v31
    s_barrier
    ds_read_b64_tr_b16 v[16:17], v4 offset:0
    ds_read_b64_tr_b16 v[18:19], v4 offset:512
    ds_read_b128 v[48:51], v8 offset:0
    ds_read_b64_tr_b16 v[20:21], v5 offset:0
    ds_read_b64_tr_b16 v[22:23], v5 offset:512
    ds_read_b64_tr_b16 v[24:25], v4 offset:4096
    ds_read_b64_tr_b16 v[26:27], v4 offset:4608
    ds_read_b64_tr_b16 v[28:29], v5 offset:4096
    ds_read_b64_tr_b16 v[30:31], v5 offset:4608
    ds_read_b128 v[52:55], v8 offset:1024
    ds_read_b128 v[56:59], v8 offset:2048
    ds_read_b128 v[60:63], v8 offset:3072
    ds_read_b64_tr_b16 v[32:33], v4 offset:8192
    ds_read_b64_tr_b16 v[34:35], v4 offset:8704
    ds_read_b64_tr_b16 v[36:37], v5 offset:8192
    ds_read_b64_tr_b16 v[38:39], v5 offset:8704
    ds_read_b64_tr_b16 v[40:41], v4 offset:12288
    ds_read_b64_tr_b16 v[42:43], v4 offset:12800
    ds_read_b64_tr_b16 v[44:45], v5 offset:12288
    ds_read_b64_tr_b16 v[46:47], v5 offset:12800
    s_waitcnt lgkmcnt(15)
    v_mfma_f32_16x16x32_bf16 v[128:131], v[16:19], v[48:51], v[128:131]
    v_mfma_f32_16x16x32_bf16 v[144:147], v[20:23], v[48:51], v[144:147]
    s_waitcnt lgkmcnt(13)
    v_mfma_f32_16x16x32_bf16 v[160:163], v[24:27], v[48:51], v[160:163]
    s_waitcnt lgkmcnt(11)
    v_mfma_f32_16x16x32_bf16 v[176:179], v[28:31], v[48:51], v[176:179]
    s_waitcnt lgkmcnt(10)
    v_mfma_f32_16x16x32_bf16 v[132:135], v[16:19], v[52:55], v[132:135]
    v_mfma_f32_16x16x32_bf16 v[148:151], v[20:23], v[52:55], v[148:151]
    v_mfma_f32_16x16x32_bf16 v[164:167], v[24:27], v[52:55], v[164:167]
    v_mfma_f32_16x16x32_bf16 v[180:183], v[28:31], v[52:55], v[180:183]
    s_waitcnt lgkmcnt(9)
    v_mfma_f32_16x16x32_bf16 v[136:139], v[16:19], v[56:59], v[136:139]
    v_mfma_f32_16x16x32_bf16 v[152:155], v[20:23], v[56:59], v[152:155]
    v_mfma_f32_16x16x32_bf16 v[168:171], v[24:27], v[56:59], v[168:171]
    v_mfma_f32_16x16x32_bf16 v[184:187], v[28:31], v[56:59], v[184:187]
    s_waitcnt lgkmcnt(8)
    v_mfma_f32_16x16x32_bf16 v[140:143], v[16:19], v[60:63], v[140:143]
    v_mfma_f32_16x16x32_bf16 v[156:159], v[20:23], v[60:63], v[156:159]
    v_mfma_f32_16x16x32_bf16 v[172:175], v[24:27], v[60:63], v[172:175]
    v_mfma_f32_16x16x32_bf16 v[188:191], v[28:31], v[60:63], v[188:191]
    s_waitcnt lgkmcnt(6)
    v_mfma_f32_16x16x32_bf16 v[192:195], v[32:35], v[48:51], v[192:195]
    s_barrier
    s_waitcnt lgkmcnt(4)
    v_mfma_f32_16x16x32_bf16 v[208:211], v[36:39], v[48:51], v[208:211]
    ds_read_b64_tr_b16 v[16:17], v4 offset:24576
    s_waitcnt lgkmcnt(3)
    v_mfma_f32_16x16x32_bf16 v[224:227], v[40:43], v[48:51], v[224:227]
    ds_read_b64_tr_b16 v[18:19], v4 offset:25088
    s_waitcnt lgkmcnt(2)
    v_mfma_f32_16x16x32_bf16 v[240:243], v[44:47], v[48:51], v[240:243]
    ds_read_b128 v[48:51], v8 offset:24576
    v_mfma_f32_16x16x32_bf16 v[196:199], v[32:35], v[52:55], v[196:199]
    ds_read_b64_tr_b16 v[20:21], v5 offset:24576
    v_mfma_f32_16x16x32_bf16 v[212:215], v[36:39], v[52:55], v[212:215]
    s_mov_b32 s44, 10
g2c_l0:
    v_mfma_f32_16x16x32_bf16 v[228:231], v[40:43], v[52:55], v[228:231]
    ds_read_b64_tr_b16 v[22:23], v5 offset:25088
    v_mfma_f32_16x16x32_bf16 v[244:247], v[44:47], v[52:55], v[244:247]
    ds_read_b64_tr_b16 v[24:25], v4 offset:28672
    v_mfma_f32_16x16x32_bf16 v[200:203], v[32:35], v[56:59], v[200:203]
    ds_read_b64_tr_b16 v[26:27], v4 offset:29184
    v_mfma_f32_16x16x32_bf16 v[216:219], v[36:39], v[56:59], v[216:219]
    ds_read_b64_tr_b16 v[28:29], v5 offset:28672
    v_mfma_f32_16x16x32_bf16 v[232:235], v[40:43], v[56:59], v[232:235]
    ds_read_b64_tr_b16 v[30:31], v5 offset:29184
    v_mfma_f32_16x16x32_bf16 v[248:251], v[44:47], v[56:59], v[248:251]
    ds_read_b128 v[52:55], v8 offset:25600
    v_mfma_f32_16x16x32_bf16 v[204:207], v[32:35], v[60:63], v[204:207]
    ds_read_b128 v[56:59], v8 offset:26624
    v_mfma_f32_16x16x32_bf16 v[220:223], v[36:39], v[60:63], v[220:223]
    ds_read_b64_tr_b16 v[32:33], v4 offset:32768
    v_mfma_f32_16x16x32_bf16 v[236:239], v[40:43], v[60:63], v[236:239]
    ds_read_b64_tr_b16 v[34:35], v4 offset:33280
    v_mfma_f32_16x16x32_bf16 v[252:255], v[44:47], v[60:63], v[252:255]
    ds_read_b128 v[60:63], v8 offset:27648
    s_waitcnt lgkmcnt(11)
    v_mfma_f32_16x16x32_bf16 v[128:131], v[16:19], v[48:51], v[128:131]
    ds_read_b64_tr_b16 v[36:37], v5 offset:32768
    s_waitcnt lgkmcnt(10)
    v_mfma_f32_16x16x32_bf16 v[144:147], v[20:23], v[48:51], v[144:147]
    ds_read_b64_tr_b16 v[38:39], v5 offset:33280
    s_waitcnt lgkmcnt(9)
    v_mfma_f32_16x16x32_bf16 v[160:163], v[24:27], v[48:51], v[160:163]
    ds_read_b64_tr_b16 v[40:41], v4 offset:36864
    s_waitcnt lgkmcnt(8)
    v_mfma_f32_16x16x32_bf16 v[176:179], v[28:31], v[48:51], v[176:179]
    ds_read_b64_tr_b16 v[42:43], v4 offset:37376
    s_waitcnt lgkmcnt(8)
    v_mfma_f32_16x16x32_bf16 v[132:135], v[16:19], v[52:55], v[132:135]
    ds_read_b64_tr_b16 v[44:45], v5 offset:36864
    v_mfma_f32_16x16x32_bf16 v[148:151], v[20:23], v[52:55], v[148:151]
    ds_read_b64_tr_b16 v[46:47], v5 offset:37376
    v_mfma_f32_16x16x32_bf16 v[164:167], v[24:27], v[52:55], v[164:167]
    v_mfma_f32_16x16x32_bf16 v[180:183], v[28:31], v[52:55], v[180:183]
    s_waitcnt lgkmcnt(9)
    v_mfma_f32_16x16x32_bf16 v[136:139], v[16:19], v[56:59], v[136:139]
    v_mfma_f32_16x16x32_bf16 v[152:155], v[20:23], v[56:59], v[152:155]
    v_mfma_f32_16x16x32_bf16 v[168:171], v[24:27], v[56:59], v[168:171]
    v_mfma_f32_16x16x32_bf16 v[184:187], v[28:31], v[56:59], v[184:187]
    s_waitcnt lgkmcnt(6)
    v_mfma_f32_16x16x32_bf16 v[140:143], v[16:19], v[60:63], v[140:143]
    v_mfma_f32_16x16x32_bf16 v[156:159], v[20:23], v[60:63], v[156:159]
    v_mfma_f32_16x16x32_bf16 v[172:175], v[24:27], v[60:63], v[172:175]
    v_mfma_f32_16x16x32_bf16 v[188:191], v[28:31], v[60:63], v[188:191]
    v_mfma_f32_16x16x32_bf16 v[192:195], v[32:35], v[48:51], v[192:195]
    s_barrier
    s_waitcnt lgkmcnt(4)
    v_mfma_f32_16x16x32_bf16 v[208:211], v[36:39], v[48:51], v[208:211]
    ds_read_b64_tr_b16 v[16:17], v4 offset:49152
    s_waitcnt lgkmcnt(3)
    v_mfma_f32_16x16x32_bf16 v[224:227], v[40:43], v[48:51], v[224:227]
    ds_read_b64_tr_b16 v[18:19], v4 offset:49664
    s_waitcnt lgkmcnt(2)
    v_mfma_f32_16x16x32_bf16 v[240:243], v[44:47], v[48:51], v[240:243]
    ds_read_b128 v[48:51], v8 offset:49152
    v_mfma_f32_16x16x32_bf16 v[196:199], v[32:35], v[52:55], v[196:199]
    ds_read_b64_tr_b16 v[20:21], v5 offset:49152
    v_mfma_f32_16x16x32_bf16 v[212:215], v[36:39], v[52:55], v[212:215]
    v_mfma_f32_16x16x32_bf16 v[228:231], v[40:43], v[52:55], v[228:231]
    ds_read_b64_tr_b16 v[22:23], v5 offset:49664
    v_mfma_f32_16x16x32_bf16 v[244:247], v[44:47], v[52:55], v[244:247]
    ds_read_b64_tr_b16 v[24:25], v4 offset:53248
    v_mfma_f32_16x16x32_bf16 v[200:203], v[32:35], v[56:59], v[200:203]
    ds_read_b64_tr_b16 v[26:27], v4 offset:53760
    v_mfma_f32_16x16x32_bf16 v[216:219], v[36:39], v[56:59], v[216:219]
    ds_read_b64_tr_b16 v[28:29], v5 offset:53248
    v_mfma_f32_16x16x32_bf16 v[232:235], v[40:43], v[56:59], v[232:235]
    ds_read_b64_tr_b16 v[30:31], v5 offset:53760
    v_mfma_f32_16x16x32_bf16 v[248:251], v[44:47], v[56:59], v[248:251]
    ds_read_b128 v[52:55], v8 offset:50176
    v_mfma_f32_16x16x32_bf16 v[204:207], v[32:35], v[60:63], v[204:207]
    ds_read_b128 v[56:59], v8 offset:51200
    v_mfma_f32_16x16x32_bf16 v[220:223], v[36:39], v[60:63], v[220:223]
    ds_read_b64_tr_b16 v[32:33], v4 offset:57344
    v_mfma_f32_16x16x32_bf16 v[236:239], v[40:43], v[60:63], v[236:239]
    ds_read_b64_tr_b16 v[34:35], v4 offset:57856
    v_mfma_f32_16x16x32_bf16 v[252:255], v[44:47], v[60:63], v[252:255]
    ds_read_b128 v[60:63], v8 offset:52224
    s_waitcnt lgkmcnt(11)
    v_mfma_f32_16x16x32_bf16 v[128:131], v[16:19], v[48:51], v[128:131]
    ds_read_b64_tr_b16 v[36:37], v5 offset:57344
    s_waitcnt lgkmcnt(10)
    v_mfma_f32_16x16x32_bf16 v[144:147], v[20:23], v[48:51], v[144:147]
    ds_read_b64_tr_b16 v[38:39], v5 offset:57856
    s_waitcnt lgkmcnt(9)
    v_mfma_f32_16x16x32_bf16 v[160:163], v[24:27], v[48:51], v[160:163]
    ds_read_b64_tr_b16 v[40:41], v4 offset:61440
    s_waitcnt lgkmcnt(8)
    v_mfma_f32_16x16x32_bf16 v[176:179], v[28:31], v[48:51], v[176:179]
    ds_read_b64_tr_b16 v[42:43], v4 offset:61952
    s_waitcnt lgkmcnt(8)
    v_mfma_f32_16x16x32_bf16 v[132:135], v[16:19], v[52:55], v[132:135]
    ds_read_b64_tr_b16 v[44:45], v5 offset:61440
    v_mfma_f32_16x16x32_bf16 v[148:151], v[20:23], v[52:55], v[148:151]
    ds_read_b64_tr_b16 v[46:47], v5 offset:61952
    v_mfma_f32_16x16x32_bf16 v[164:167], v[24:27], v[52:55], v[164:167]
    v_mfma_f32_16x16x32_bf16 v[180:183], v[28:31], v[52:55], v[180:183]
    s_waitcnt lgkmcnt(9)
    v_mfma_f32_16x16x32_bf16 v[136:139], v[16:19], v[56:59], v[136:139]
    v_mfma_f32_16x16x32_bf16 v[152:155], v[20:23], v[56:59], v[152:155]
    v_mfma_f32_16x16x32_bf16 v[168:171], v[24:27], v[56:59], v[168:171]
    v_mfma_f32_16x16x32_bf16 v[184:187], v[28:31], v[56:59], v[184:187]
    s_waitcnt lgkmcnt(6)
    v_mfma_f32_16x16x32_bf16 v[140:143], v[16:19], v[60:63], v[140:143]
    v_mfma_f32_16x16x32_bf16 v[156:159], v[20:23], v[60:63], v[156:159]
    v_mfma_f32_16x16x32_bf16 v[172:175], v[24:27], v[60:63], v[172:175]
    v_mfma_f32_16x16x32_bf16 v[188:191], v[28:31], v[60:63], v[188:191]
    v_mfma_f32_16x16x32_bf16 v[192:195], v[32:35], v[48:51], v[192:195]
    s_barrier
    s_waitcnt lgkmcnt(4)
    v_mfma_f32_16x16x32_bf16 v[208:211], v[36:39], v[48:51], v[208:211]
    ds_read_b64_tr_b16 v[16:17], v10 offset:0
    s_waitcnt lgkmcnt(3)
    v_mfma_f32_16x16x32_bf16 v[224:227], v[40:43], v[48:51], v[224:227]
    ds_read_b64_tr_b16 v[18:19], v10 offset:512
    s_waitcnt lgkmcnt(2)
    v_mfma_f32_16x16x32_bf16 v[240:243], v[44:47], v[48:51], v[240:243]
    ds_read_b128 v[48:51], v9 offset:0
    v_mfma_f32_16x16x32_bf16 v[196:199], v[32:35], v[52:55], v[196:199]
    ds_read_b64_tr_b16 v[20:21], v11 offset:0
    v_mfma_f32_16x16x32_bf16 v[212:215], v[36:39], v[52:55], v[212:215]
    v_mfma_f32_16x16x32_bf16 v[228:231], v[40:43], v[52:55], v[228:231]
    ds_read_b64_tr_b16 v[22:23], v11 offset:512
    v_mfma_f32_16x16x32_bf16 v[244:247], v[44:47], v[52:55], v[244:247]
    ds_read_b64_tr_b16 v[24:25], v10 offset:4096
    v_mfma_f32_16x16x32_bf16 v[200:203], v[32:35], v[56:59], v[200:203]
    ds_read_b64_tr_b16 v[26:27], v10 offset:4608
    v_mfma_f32_16x16x32_bf16 v[216:219], v[36:39], v[56:59], v[216:219]
    ds_read_b64_tr_b16 v[28:29], v11 offset:4096
    v_mfma_f32_16x16x32_bf16 v[232:235], v[40:43], v[56:59], v[232:235]
    ds_read_b64_tr_b16 v[30:31], v11 offset:4608
    v_mfma_f32_16x16x32_bf16 v[248:251], v[44:47], v[56:59], v[248:251]
    ds_read_b128 v[52:55], v9 offset:1024
    v_mfma_f32_16x16x32_bf16 v[204:207], v[32:35], v[60:63], v[204:207]
    ds_read_b128 v[56:59], v9 offset:2048
    v_mfma_f32_16x16x32_bf16 v[220:223], v[36:39], v[60:63], v[220:223]
    ds_read_b64_tr_b16 v[32:33], v10 offset:8192
    v_mfma_f32_16x16x32_bf16 v[236:239], v[40:43], v[60:63], v[236:239]
    ds_read_b64_tr_b16 v[34:35], v10 offset:8704
    v_mfma_f32_16x16x32_bf16 v[252:255], v[44:47], v[60:63], v[252:255]
    ds_read_b128 v[60:63], v9 offset:3072
    s_waitcnt lgkmcnt(11)
    v_mfma_f32_16x16x32_bf16 v[128:131], v[16:19], v[48:51], v[128:131]
    ds_read_b64_tr_b16 v[36:37], v11 offset:8192
    s_waitcnt lgkmcnt(10)
    v_mfma_f32_16x16x32_bf16 v[144:147], v[20:23], v[48:51], v[144:147]
    ds_read_b64_tr_b16 v[38:39], v11 offset:8704
    s_waitcnt lgkmcnt(9)
    v_mfma_f32_16x16x32_bf16 v[160:163], v[24:27], v[48:51], v[160:163]
    ds_read_b64_tr_b16 v[40:41], v10 offset:12288
    s_waitcnt lgkmcnt(8)
    v_mfma_f32_16x16x32_bf16 v[176:179], v[28:31], v[48:51], v[176:179]
    ds_read_b64_tr_b16 v[42:43], v10 offset:12800
    s_waitcnt lgkmcnt(8)
    v_mfma_f32_16x16x32_bf16 v[132:135], v[16:19], v[52:55], v[132:135]
    ds_read_b64_tr_b16 v[44:45], v11 offset:12288
    v_mfma_f32_16x16x32_bf16 v[148:151], v[20:23], v[52:55], v[148:151]
    ds_read_b64_tr_b16 v[46:47], v11 offset:12800
    v_mfma_f32_16x16x32_bf16 v[164:167], v[24:27], v[52:55], v[164:167]
    v_mfma_f32_16x16x32_bf16 v[180:183], v[28:31], v[52:55], v[180:183]
    s_waitcnt lgkmcnt(9)
    v_mfma_f32_16x16x32_bf16 v[136:139], v[16:19], v[56:59], v[136:139]
    v_mfma_f32_16x16x32_bf16 v[152:155], v[20:23], v[56:59], v[152:155]
    v_mfma_f32_16x16x32_bf16 v[168:171], v[24:27], v[56:59], v[168:171]
    v_mfma_f32_16x16x32_bf16 v[184:187], v[28:31], v[56:59], v[184:187]
    s_waitcnt lgkmcnt(6)
    v_mfma_f32_16x16x32_bf16 v[140:143], v[16:19], v[60:63], v[140:143]
    v_mfma_f32_16x16x32_bf16 v[156:159], v[20:23], v[60:63], v[156:159]
    v_mfma_f32_16x16x32_bf16 v[172:175], v[24:27], v[60:63], v[172:175]
    v_mfma_f32_16x16x32_bf16 v[188:191], v[28:31], v[60:63], v[188:191]
    v_mfma_f32_16x16x32_bf16 v[192:195], v[32:35], v[48:51], v[192:195]
    s_barrier
    s_waitcnt lgkmcnt(4)
    v_mfma_f32_16x16x32_bf16 v[208:211], v[36:39], v[48:51], v[208:211]
    ds_read_b64_tr_b16 v[16:17], v10 offset:24576
    s_waitcnt lgkmcnt(3)
    v_mfma_f32_16x16x32_bf16 v[224:227], v[40:43], v[48:51], v[224:227]
    ds_read_b64_tr_b16 v[18:19], v10 offset:25088
    s_waitcnt lgkmcnt(2)
    v_mfma_f32_16x16x32_bf16 v[240:243], v[44:47], v[48:51], v[240:243]
    ds_read_b128 v[48:51], v9 offset:24576
    v_mfma_f32_16x16x32_bf16 v[196:199], v[32:35], v[52:55], v[196:199]
    ds_read_b64_tr_b16 v[20:21], v11 offset:24576
    v_mfma_f32_16x16x32_bf16 v[212:215], v[36:39], v[52:55], v[212:215]
    v_mfma_f32_16x16x32_bf16 v[228:231], v[40:43], v[52:55], v[228:231]
    ds_read_b64_tr_b16 v[22:23], v11 offset:25088
    v_mfma_f32_16x16x32_bf16 v[244:247], v[44:47], v[52:55], v[244:247]
    ds_read_b64_tr_b16 v[24:25], v10 offset:28672
    v_mfma_f32_16x16x32_bf16 v[200:203], v[32:35], v[56:59], v[200:203]
    ds_read_b64_tr_b16 v[26:27], v10 offset:29184
    v_mfma_f32_16x16x32_bf16 v[216:219], v[36:39], v[56:59], v[216:219]
    ds_read_b64_tr_b16 v[28:29], v11 offset:28672
    v_mfma_f32_16x16x32_bf16 v[232:235], v[40:43], v[56:59], v[232:235]
    ds_read_b64_tr_b16 v[30:31], v11 offset:29184
    v_mfma_f32_16x16x32_bf16 v[248:251], v[44:47], v[56:59], v[248:251]
    ds_read_b128 v[52:55], v9 offset:25600
    v_mfma_f32_16x16x32_bf16 v[204:207], v[32:35], v[60:63], v[204:207]
    ds_read_b128 v[56:59], v9 offset:26624
    v_mfma_f32_16x16x32_bf16 v[220:223], v[36:39], v[60:63], v[220:223]
    ds_read_b64_tr_b16 v[32:33], v10 offset:32768
    v_mfma_f32_16x16x32_bf16 v[236:239], v[40:43], v[60:63], v[236:239]
    ds_read_b64_tr_b16 v[34:35], v10 offset:33280
    v_mfma_f32_16x16x32_bf16 v[252:255], v[44:47], v[60:63], v[252:255]
    ds_read_b128 v[60:63], v9 offset:27648
    s_waitcnt lgkmcnt(11)
    v_mfma_f32_16x16x32_bf16 v[128:131], v[16:19], v[48:51], v[128:131]
    ds_read_b64_tr_b16 v[36:37], v11 offset:32768
    s_waitcnt lgkmcnt(10)
    v_mfma_f32_16x16x32_bf16 v[144:147], v[20:23], v[48:51], v[144:147]
    ds_read_b64_tr_b16 v[38:39], v11 offset:33280
    s_waitcnt lgkmcnt(9)
    v_mfma_f32_16x16x32_bf16 v[160:163], v[24:27], v[48:51], v[160:163]
    ds_read_b64_tr_b16 v[40:41], v10 offset:36864
    s_waitcnt lgkmcnt(8)
    v_mfma_f32_16x16x32_bf16 v[176:179], v[28:31], v[48:51], v[176:179]
    ds_read_b64_tr_b16 v[42:43], v10 offset:37376
    s_waitcnt lgkmcnt(8)
    v_mfma_f32_16x16x32_bf16 v[132:135], v[16:19], v[52:55], v[132:135]
    ds_read_b64_tr_b16 v[44:45], v11 offset:36864
    v_mfma_f32_16x16x32_bf16 v[148:151], v[20:23], v[52:55], v[148:151]
    ds_read_b64_tr_b16 v[46:47], v11 offset:37376
    v_mfma_f32_16x16x32_bf16 v[164:167], v[24:27], v[52:55], v[164:167]
    v_mfma_f32_16x16x32_bf16 v[180:183], v[28:31], v[52:55], v[180:183]
    s_waitcnt lgkmcnt(9)
    v_mfma_f32_16x16x32_bf16 v[136:139], v[16:19], v[56:59], v[136:139]
    v_mfma_f32_16x16x32_bf16 v[152:155], v[20:23], v[56:59], v[152:155]
    v_mfma_f32_16x16x32_bf16 v[168:171], v[24:27], v[56:59], v[168:171]
    v_mfma_f32_16x16x32_bf16 v[184:187], v[28:31], v[56:59], v[184:187]
    s_waitcnt lgkmcnt(6)
    v_mfma_f32_16x16x32_bf16 v[140:143], v[16:19], v[60:63], v[140:143]
    v_mfma_f32_16x16x32_bf16 v[156:159], v[20:23], v[60:63], v[156:159]
    v_mfma_f32_16x16x32_bf16 v[172:175], v[24:27], v[60:63], v[172:175]
    v_mfma_f32_16x16x32_bf16 v[188:191], v[28:31], v[60:63], v[188:191]
    v_mfma_f32_16x16x32_bf16 v[192:195], v[32:35], v[48:51], v[192:195]
    s_barrier
    s_waitcnt lgkmcnt(4)
    v_mfma_f32_16x16x32_bf16 v[208:211], v[36:39], v[48:51], v[208:211]
    ds_read_b64_tr_b16 v[16:17], v10 offset:49152
    s_waitcnt lgkmcnt(3)
    v_mfma_f32_16x16x32_bf16 v[224:227], v[40:43], v[48:51], v[224:227]
    ds_read_b64_tr_b16 v[18:19], v10 offset:49664
    s_waitcnt lgkmcnt(2)
    v_mfma_f32_16x16x32_bf16 v[240:243], v[44:47], v[48:51], v[240:243]
    ds_read_b128 v[48:51], v9 offset:49152
    v_mfma_f32_16x16x32_bf16 v[196:199], v[32:35], v[52:55], v[196:199]
    ds_read_b64_tr_b16 v[20:21], v11 offset:49152
    v_mfma_f32_16x16x32_bf16 v[212:215], v[36:39], v[52:55], v[212:215]
    v_mfma_f32_16x16x32_bf16 v[228:231], v[40:43], v[52:55], v[228:231]
    ds_read_b64_tr_b16 v[22:23], v11 offset:49664
    v_mfma_f32_16x16x32_bf16 v[244:247], v[44:47], v[52:55], v[244:247]
    ds_read_b64_tr_b16 v[24:25], v10 offset:53248
    v_mfma_f32_16x16x32_bf16 v[200:203], v[32:35], v[56:59], v[200:203]
    ds_read_b64_tr_b16 v[26:27], v10 offset:53760
    v_mfma_f32_16x16x32_bf16 v[216:219], v[36:39], v[56:59], v[216:219]
    ds_read_b64_tr_b16 v[28:29], v11 offset:53248
    v_mfma_f32_16x16x32_bf16 v[232:235], v[40:43], v[56:59], v[232:235]
    ds_read_b64_tr_b16 v[30:31], v11 offset:53760
    v_mfma_f32_16x16x32_bf16 v[248:251], v[44:47], v[56:59], v[248:251]
    ds_read_b128 v[52:55], v9 offset:50176
    v_mfma_f32_16x16x32_bf16 v[204:207], v[32:35], v[60:63], v[204:207]
    ds_read_b128 v[56:59], v9 offset:51200
    v_mfma_f32_16x16x32_bf16 v[220:223], v[36:39], v[60:63], v[220:223]
    ds_read_b64_tr_b16 v[32:33], v10 offset:57344
    v_mfma_f32_16x16x32_bf16 v[236:239], v[40:43], v[60:63], v[236:239]
    ds_read_b64_tr_b16 v[34:35], v10 offset:57856
    v_mfma_f32_16x16x32_bf16 v[252:255], v[44:47], v[60:63], v[252:255]
    ds_read_b128 v[60:63], v9 offset:52224
    s_waitcnt lgkmcnt(11)
    v_mfma_f32_16x16x32_bf16 v[128:131], v[16:19], v[48:51], v[128:131]
    ds_read_b64_tr_b16 v[36:37], v11 offset:57344
    s_waitcnt lgkmcnt(10)
    v_mfma_f32_16x16x32_bf16 v[144:147], v[20:23], v[48:51], v[144:147]
    ds_read_b64_tr_b16 v[38:39], v11 offset:57856
    s_waitcnt lgkmcnt(9)
    v_mfma_f32_16x16x32_bf16 v[160:163], v[24:27], v[48:51], v[160:163]
    ds_read_b64_tr_b16 v[40:41], v10 offset:61440
    s_waitcnt lgkmcnt(8)
    v_mfma_f32_16x16x32_bf16 v[176:179], v[28:31], v[48:51], v[176:179]
    ds_read_b64_tr_b16 v[42:43], v10 offset:61952
    s_waitcnt lgkmcnt(8)
    v_mfma_f32_16x16x32_bf16 v[132:135], v[16:19], v[52:55], v[132:135]
    ds_read_b64_tr_b16 v[44:45], v11 offset:61440
    v_mfma_f32_16x16x32_bf16 v[148:151], v[20:23], v[52:55], v[148:151]
    ds_read_b64_tr_b16 v[46:47], v11 offset:61952
    v_mfma_f32_16x16x32_bf16 v[164:167], v[24:27], v[52:55], v[164:167]
    v_mfma_f32_16x16x32_bf16 v[180:183], v[28:31], v[52:55], v[180:183]
    s_waitcnt lgkmcnt(9)
    v_mfma_f32_16x16x32_bf16 v[136:139], v[16:19], v[56:59], v[136:139]
    v_mfma_f32_16x16x32_bf16 v[152:155], v[20:23], v[56:59], v[152:155]
    v_mfma_f32_16x16x32_bf16 v[168:171], v[24:27], v[56:59], v[168:171]
    v_mfma_f32_16x16x32_bf16 v[184:187], v[28:31], v[56:59], v[184:187]
    s_waitcnt lgkmcnt(6)
    v_mfma_f32_16x16x32_bf16 v[140:143], v[16:19], v[60:63], v[140:143]
    v_mfma_f32_16x16x32_bf16 v[156:159], v[20:23], v[60:63], v[156:159]
    v_mfma_f32_16x16x32_bf16 v[172:175], v[24:27], v[60:63], v[172:175]
    v_mfma_f32_16x16x32_bf16 v[188:191], v[28:31], v[60:63], v[188:191]
    v_mfma_f32_16x16x32_bf16 v[192:195], v[32:35], v[48:51], v[192:195]
    s_barrier
    s_waitcnt lgkmcnt(4)
    v_mfma_f32_16x16x32_bf16 v[208:211], v[36:39], v[48:51], v[208:211]
    ds_read_b64_tr_b16 v[16:17], v4 offset:0
    s_waitcnt lgkmcnt(3)
    v_mfma_f32_16x16x32_bf16 v[224:227], v[40:43], v[48:51], v[224:227]
    ds_read_b64_tr_b16 v[18:19], v4 offset:512
    s_waitcnt lgkmcnt(2)
    v_mfma_f32_16x16x32_bf16 v[240:243], v[44:47], v[48:51], v[240:243]
    ds_read_b128 v[48:51], v8 offset:0
    v_mfma_f32_16x16x32_bf16 v[196:199], v[32:35], v[52:55], v[196:199]
    ds_read_b64_tr_b16 v[20:21], v5 offset:0
    v_mfma_f32_16x16x32_bf16 v[212:215], v[36:39], v[52:55], v[212:215]
    v_mfma_f32_16x16x32_bf16 v[228:231], v[40:43], v[52:55], v[228:231]
    ds_read_b64_tr_b16 v[22:23], v5 offset:512
    v_mfma_f32_16x16x32_bf16 v[244:247], v[44:47], v[52:55], v[244:247]
    ds_read_b64_tr_b16 v[24:25], v4 offset:4096
    v_mfma_f32_16x16x32_bf16 v[200:203], v[32:35], v[56:59], v[200:203]
    ds_read_b64_tr_b16 v[26:27], v4 offset:4608
    v_mfma_f32_16x16x32_bf16 v[216:219], v[36:39], v[56:59], v[216:219]
    ds_read_b64_tr_b16 v[28:29], v5 offset:4096
    v_mfma_f32_16x16x32_bf16 v[232:235], v[40:43], v[56:59], v[232:235]
    ds_read_b64_tr_b16 v[30:31], v5 offset:4608
    v_mfma_f32_16x16x32_bf16 v[248:251], v[44:47], v[56:59], v[248:251]
    ds_read_b128 v[52:55], v8 offset:1024
    v_mfma_f32_16x16x32_bf16 v[204:207], v[32:35], v[60:63], v[204:207]
    ds_read_b128 v[56:59], v8 offset:2048
    v_mfma_f32_16x16x32_bf16 v[220:223], v[36:39], v[60:63], v[220:223]
    ds_read_b64_tr_b16 v[32:33], v4 offset:8192
    v_mfma_f32_16x16x32_bf16 v[236:239], v[40:43], v[60:63], v[236:239]
    ds_read_b64_tr_b16 v[34:35], v4 offset:8704
    v_mfma_f32_16x16x32_bf16 v[252:255], v[44:47], v[60:63], v[252:255]
    ds_read_b128 v[60:63], v8 offset:3072
    s_waitcnt lgkmcnt(11)
    v_mfma_f32_16x16x32_bf16 v[128:131], v[16:19], v[48:51], v[128:131]
    ds_read_b64_tr_b16 v[36:37], v5 offset:8192
    s_waitcnt lgkmcnt(10)
    v_mfma_f32_16x16x32_bf16 v[144:147], v[20:23], v[48:51], v[144:147]
    ds_read_b64_tr_b16 v[38:39], v5 offset:8704
    s_waitcnt lgkmcnt(9)
    v_mfma_f32_16x16x32_bf16 v[160:163], v[24:27], v[48:51], v[160:163]
    ds_read_b64_tr_b16 v[40:41], v4 offset:12288
    s_waitcnt lgkmcnt(8)
    v_mfma_f32_16x16x32_bf16 v[176:179], v[28:31], v[48:51], v[176:179]
    ds_read_b64_tr_b16 v[42:43], v4 offset:12800
    s_waitcnt lgkmcnt(8)
    v_mfma_f32_16x16x32_bf16 v[132:135], v[16:19], v[52:55], v[132:135]
    ds_read_b64_tr_b16 v[44:45], v5 offset:12288
    v_mfma_f32_16x16x32_bf16 v[148:151], v[20:23], v[52:55], v[148:151]
    ds_read_b64_tr_b16 v[46:47], v5 offset:12800
    v_mfma_f32_16x16x32_bf16 v[164:167], v[24:27], v[52:55], v[164:167]
    v_mfma_f32_16x16x32_bf16 v[180:183], v[28:31], v[52:55], v[180:183]
    s_waitcnt lgkmcnt(9)
    v_mfma_f32_16x16x32_bf16 v[136:139], v[16:19], v[56:59], v[136:139]
    v_mfma_f32_16x16x32_bf16 v[152:155], v[20:23], v[56:59], v[152:155]
    v_mfma_f32_16x16x32_bf16 v[168:171], v[24:27], v[56:59], v[168:171]
    v_mfma_f32_16x16x32_bf16 v[184:187], v[28:31], v[56:59], v[184:187]
    s_waitcnt lgkmcnt(6)
    v_mfma_f32_16x16x32_bf16 v[140:143], v[16:19], v[60:63], v[140:143]
    v_mfma_f32_16x16x32_bf16 v[156:159], v[20:23], v[60:63], v[156:159]
    v_mfma_f32_16x16x32_bf16 v[172:175], v[24:27], v[60:63], v[172:175]
    v_mfma_f32_16x16x32_bf16 v[188:191], v[28:31], v[60:63], v[188:191]
    v_mfma_f32_16x16x32_bf16 v[192:195], v[32:35], v[48:51], v[192:195]
    s_barrier
    s_waitcnt lgkmcnt(4)
    v_mfma_f32_16x16x32_bf16 v[208:211], v[36:39], v[48:51], v[208:211]
    ds_read_b64_tr_b16 v[16:17], v4 offset:24576
    s_waitcnt lgkmcnt(3)
    v_mfma_f32_16x16x32_bf16 v[224:227], v[40:43], v[48:51], v[224:227]
    ds_read_b64_tr_b16 v[18:19], v4 offset:25088
    s_waitcnt lgkmcnt(2)
    v_mfma_f32_16x16x32_bf16 v[240:243], v[44:47], v[48:51], v[240:243]
    ds_read_b128 v[48:51], v8 offset:24576
    s_sub_u32 s44, s44, 1
    v_mfma_f32_16x16x32_bf16 v[196:199], v[32:35], v[52:55], v[196:199]
    ds_read_b64_tr_b16 v[20:21], v5 offset:24576
    s_cmp_lg_u32 s44, 0
    v_mfma_f32_16x16x32_bf16 v[212:215], v[36:39], v[52:55], v[212:215]
    s_cbranch_scc1 g2c_l0
    v_mfma_f32_16x16x32_bf16 v[228:231], v[40:43], v[52:55], v[228:231]
    ds_read_b64_tr_b16 v[22:23], v5 offset:25088
    v_mfma_f32_16x16x32_bf16 v[244:247], v[44:47], v[52:55], v[244:247]
    ds_read_b64_tr_b16 v[24:25], v4 offset:28672
    v_mfma_f32_16x16x32_bf16 v[200:203], v[32:35], v[56:59], v[200:203]
    ds_read_b64_tr_b16 v[26:27], v4 offset:29184
    v_mfma_f32_16x16x32_bf16 v[216:219], v[36:39], v[56:59], v[216:219]
    ds_read_b64_tr_b16 v[28:29], v5 offset:28672
    v_mfma_f32_16x16x32_bf16 v[232:235], v[40:43], v[56:59], v[232:235]
    ds_read_b64_tr_b16 v[30:31], v5 offset:29184
    v_mfma_f32_16x16x32_bf16 v[248:251], v[44:47], v[56:59], v[248:251]
    ds_read_b128 v[52:55], v8 offset:25600
    v_mfma_f32_16x16x32_bf16 v[204:207], v[32:35], v[60:63], v[204:207]
    ds_read_b128 v[56:59], v8 offset:26624
    v_mfma_f32_16x16x32_bf16 v[220:223], v[36:39], v[60:63], v[220:223]
    ds_read_b64_tr_b16 v[32:33], v4 offset:32768
    v_mfma_f32_16x16x32_bf16 v[236:239], v[40:43], v[60:63], v[236:239]
    ds_read_b64_tr_b16 v[34:35], v4 offset:33280
    v_mfma_f32_16x16x32_bf16 v[252:255], v[44:47], v[60:63], v[252:255]
    ds_read_b128 v[60:63], v8 offset:27648
    s_waitcnt lgkmcnt(11)
    v_mfma_f32_16x16x32_bf16 v[128:131], v[16:19], v[48:51], v[128:131]
    ds_read_b64_tr_b16 v[36:37], v5 offset:32768
    s_waitcnt lgkmcnt(10)
    v_mfma_f32_16x16x32_bf16 v[144:147], v[20:23], v[48:51], v[144:147]
    ds_read_b64_tr_b16 v[38:39], v5 offset:33280
    s_waitcnt lgkmcnt(9)
    v_mfma_f32_16x16x32_bf16 v[160:163], v[24:27], v[48:51], v[160:163]
    ds_read_b64_tr_b16 v[40:41], v4 offset:36864
    s_waitcnt lgkmcnt(8)
    v_mfma_f32_16x16x32_bf16 v[176:179], v[28:31], v[48:51], v[176:179]
    ds_read_b64_tr_b16 v[42:43], v4 offset:37376
    s_waitcnt lgkmcnt(8)
    v_mfma_f32_16x16x32_bf16 v[132:135], v[16:19], v[52:55], v[132:135]
    ds_read_b64_tr_b16 v[44:45], v5 offset:36864
    v_mfma_f32_16x16x32_bf16 v[148:151], v[20:23], v[52:55], v[148:151]
    ds_read_b64_tr_b16 v[46:47], v5 offset:37376
    v_mfma_f32_16x16x32_bf16 v[164:167], v[24:27], v[52:55], v[164:167]
    v_mfma_f32_16x16x32_bf16 v[180:183], v[28:31], v[52:55], v[180:183]
    s_waitcnt lgkmcnt(9)
    v_mfma_f32_16x16x32_bf16 v[136:139], v[16:19], v[56:59], v[136:139]
    v_mfma_f32_16x16x32_bf16 v[152:155], v[20:23], v[56:59], v[152:155]
    v_mfma_f32_16x16x32_bf16 v[168:171], v[24:27], v[56:59], v[168:171]
    v_mfma_f32_16x16x32_bf16 v[184:187], v[28:31], v[56:59], v[184:187]
    s_waitcnt lgkmcnt(6)
    v_mfma_f32_16x16x32_bf16 v[140:143], v[16:19], v[60:63], v[140:143]
    v_mfma_f32_16x16x32_bf16 v[156:159], v[20:23], v[60:63], v[156:159]
    v_mfma_f32_16x16x32_bf16 v[172:175], v[24:27], v[60:63], v[172:175]
    v_mfma_f32_16x16x32_bf16 v[188:191], v[28:31], v[60:63], v[188:191]
    v_mfma_f32_16x16x32_bf16 v[192:195], v[32:35], v[48:51], v[192:195]
    s_barrier
    s_waitcnt lgkmcnt(4)
    v_mfma_f32_16x16x32_bf16 v[208:211], v[36:39], v[48:51], v[208:211]
    ds_read_b64_tr_b16 v[16:17], v4 offset:49152
    s_waitcnt lgkmcnt(3)
    v_mfma_f32_16x16x32_bf16 v[224:227], v[40:43], v[48:51], v[224:227]
    ds_read_b64_tr_b16 v[18:19], v4 offset:49664
    s_waitcnt lgkmcnt(2)
    v_mfma_f32_16x16x32_bf16 v[240:243], v[44:47], v[48:51], v[240:243]
    ds_read_b128 v[48:51], v8 offset:49152
    v_mfma_f32_16x16x32_bf16 v[196:199], v[32:35], v[52:55], v[196:199]
    ds_read_b64_tr_b16 v[20:21], v5 offset:49152
    v_mfma_f32_16x16x32_bf16 v[212:215], v[36:39], v[52:55], v[212:215]
    v_mfma_f32_16x16x32_bf16 v[228:231], v[40:43], v[52:55], v[228:231]
    ds_read_b64_tr_b16 v[22:23], v5 offset:49664
    v_mfma_f32_16x16x32_bf16 v[244:247], v[44:47], v[52:55], v[244:247]
    ds_read_b64_tr_b16 v[24:25], v4 offset:53248
    v_mfma_f32_16x16x32_bf16 v[200:203], v[32:35], v[56:59], v[200:203]
    ds_read_b64_tr_b16 v[26:27], v4 offset:53760
    v_mfma_f32_16x16x32_bf16 v[216:219], v[36:39], v[56:59], v[216:219]
    ds_read_b64_tr_b16 v[28:29], v5 offset:53248
    v_mfma_f32_16x16x32_bf16 v[232:235], v[40:43], v[56:59], v[232:235]
    ds_read_b64_tr_b16 v[30:31], v5 offset:53760
    v_mfma_f32_16x16x32_bf16 v[248:251], v[44:47], v[56:59], v[248:251]
    ds_read_b128 v[52:55], v8 offset:50176
    v_mfma_f32_16x16x32_bf16 v[204:207], v[32:35], v[60:63], v[204:207]
    ds_read_b128 v[56:59], v8 offset:51200
    v_mfma_f32_16x16x32_bf16 v[220:223], v[36:39], v[60:63], v[220:223]
    ds_read_b64_tr_b16 v[32:33], v4 offset:57344
    v_mfma_f32_16x16x32_bf16 v[236:239], v[40:43], v[60:63], v[236:239]
    ds_read_b64_tr_b16 v[34:35], v4 offset:57856
    v_mfma_f32_16x16x32_bf16 v[252:255], v[44:47], v[60:63], v[252:255]
    ds_read_b128 v[60:63], v8 offset:52224
    s_waitcnt lgkmcnt(11)
    v_mfma_f32_16x16x32_bf16 v[128:131], v[16:19], v[48:51], v[128:131]
    ds_read_b64_tr_b16 v[36:37], v5 offset:57344
    s_waitcnt lgkmcnt(10)
    v_mfma_f32_16x16x32_bf16 v[144:147], v[20:23], v[48:51], v[144:147]
    ds_read_b64_tr_b16 v[38:39], v5 offset:57856
    s_waitcnt lgkmcnt(9)
    v_mfma_f32_16x16x32_bf16 v[160:163], v[24:27], v[48:51], v[160:163]
    ds_read_b64_tr_b16 v[40:41], v4 offset:61440
    s_waitcnt lgkmcnt(8)
    v_mfma_f32_16x16x32_bf16 v[176:179], v[28:31], v[48:51], v[176:179]
    ds_read_b64_tr_b16 v[42:43], v4 offset:61952
    s_waitcnt lgkmcnt(8)
    v_mfma_f32_16x16x32_bf16 v[132:135], v[16:19], v[52:55], v[132:135]
    ds_read_b64_tr_b16 v[44:45], v5 offset:61440
    v_mfma_f32_16x16x32_bf16 v[148:151], v[20:23], v[52:55], v[148:151]
    ds_read_b64_tr_b16 v[46:47], v5 offset:61952
    v_mfma_f32_16x16x32_bf16 v[164:167], v[24:27], v[52:55], v[164:167]
    v_mfma_f32_16x16x32_bf16 v[180:183], v[28:31], v[52:55], v[180:183]
    s_waitcnt lgkmcnt(9)
    v_mfma_f32_16x16x32_bf16 v[136:139], v[16:19], v[56:59], v[136:139]
    v_mfma_f32_16x16x32_bf16 v[152:155], v[20:23], v[56:59], v[152:155]
    v_mfma_f32_16x16x32_bf16 v[168:171], v[24:27], v[56:59], v[168:171]
    v_mfma_f32_16x16x32_bf16 v[184:187], v[28:31], v[56:59], v[184:187]
    s_waitcnt lgkmcnt(6)
    v_mfma_f32_16x16x32_bf16 v[140:143], v[16:19], v[60:63], v[140:143]
    v_mfma_f32_16x16x32_bf16 v[156:159], v[20:23], v[60:63], v[156:159]
    v_mfma_f32_16x16x32_bf16 v[172:175], v[24:27], v[60:63], v[172:175]
    v_mfma_f32_16x16x32_bf16 v[188:191], v[28:31], v[60:63], v[188:191]
    v_mfma_f32_16x16x32_bf16 v[192:195], v[32:35], v[48:51], v[192:195]
    s_barrier
    s_waitcnt lgkmcnt(4)
    v_mfma_f32_16x16x32_bf16 v[208:211], v[36:39], v[48:51], v[208:211]
    ds_read_b64_tr_b16 v[16:17], v10 offset:0
    s_waitcnt lgkmcnt(3)
    v_mfma_f32_16x16x32_bf16 v[224:227], v[40:43], v[48:51], v[224:227]
    ds_read_b64_tr_b16 v[18:19], v10 offset:512
    s_waitcnt lgkmcnt(2)
    v_mfma_f32_16x16x32_bf16 v[240:243], v[44:47], v[48:51], v[240:243]
    ds_read_b128 v[48:51], v9 offset:0
    v_mfma_f32_16x16x32_bf16 v[196:199], v[32:35], v[52:55], v[196:199]
    ds_read_b64_tr_b16 v[20:21], v11 offset:0
    v_mfma_f32_16x16x32_bf16 v[212:215], v[36:39], v[52:55], v[212:215]
    v_mfma_f32_16x16x32_bf16 v[228:231], v[40:43], v[52:55], v[228:231]
    ds_read_b64_tr_b16 v[22:23], v11 offset:512
    v_mfma_f32_16x16x32_bf16 v[244:247], v[44:47], v[52:55], v[244:247]
    ds_read_b64_tr_b16 v[24:25], v10 offset:4096
    v_mfma_f32_16x16x32_bf16 v[200:203], v[32:35], v[56:59], v[200:203]
    ds_read_b64_tr_b16 v[26:27], v10 offset:4608
    v_mfma_f32_16x16x32_bf16 v[216:219], v[36:39], v[56:59], v[216:219]
    ds_read_b64_tr_b16 v[28:29], v11 offset:4096
    v_mfma_f32_16x16x32_bf16 v[232:235], v[40:43], v[56:59], v[232:235]
    ds_read_b64_tr_b16 v[30:31], v11 offset:4608
    v_mfma_f32_16x16x32_bf16 v[248:251], v[44:47], v[56:59], v[248:251]
    ds_read_b128 v[52:55], v9 offset:1024
    v_mfma_f32_16x16x32_bf16 v[204:207], v[32:35], v[60:63], v[204:207]
    ds_read_b128 v[56:59], v9 offset:2048
    v_mfma_f32_16x16x32_bf16 v[220:223], v[36:39], v[60:63], v[220:223]
    ds_read_b64_tr_b16 v[32:33], v10 offset:8192
    v_mfma_f32_16x16x32_bf16 v[236:239], v[40:43], v[60:63], v[236:239]
    ds_read_b64_tr_b16 v[34:35], v10 offset:8704
    v_mfma_f32_16x16x32_bf16 v[252:255], v[44:47], v[60:63], v[252:255]
    ds_read_b128 v[60:63], v9 offset:3072
    s_waitcnt lgkmcnt(11)
    v_mfma_f32_16x16x32_bf16 v[128:131], v[16:19], v[48:51], v[128:131]
    ds_read_b64_tr_b16 v[36:37], v11 offset:8192
    s_waitcnt lgkmcnt(10)
    v_mfma_f32_16x16x32_bf16 v[144:147], v[20:23], v[48:51], v[144:147]
    ds_read_b64_tr_b16 v[38:39], v11 offset:8704
    s_waitcnt lgkmcnt(9)
    v_mfma_f32_16x16x32_bf16 v[160:163], v[24:27], v[48:51], v[160:163]
    ds_read_b64_tr_b16 v[40:41], v10 offset:12288
    s_waitcnt lgkmcnt(8)
    v_mfma_f32_16x16x32_bf16 v[176:179], v[28:31], v[48:51], v[176:179]
    ds_read_b64_tr_b16 v[42:43], v10 offset:12800
    s_waitcnt lgkmcnt(8)
    v_mfma_f32_16x16x32_bf16 v[132:135], v[16:19], v[52:55], v[132:135]
    ds_read_b64_tr_b16 v[44:45], v11 offset:12288
    v_mfma_f32_16x16x32_bf16 v[148:151], v[20:23], v[52:55], v[148:151]
    ds_read_b64_tr_b16 v[46:47], v11 offset:12800
    v_mfma_f32_16x16x32_bf16 v[164:167], v[24:27], v[52:55], v[164:167]
    v_mfma_f32_16x16x32_bf16 v[180:183], v[28:31], v[52:55], v[180:183]
    s_waitcnt lgkmcnt(9)
    v_mfma_f32_16x16x32_bf16 v[136:139], v[16:19], v[56:59], v[136:139]
    v_mfma_f32_16x16x32_bf16 v[152:155], v[20:23], v[56:59], v[152:155]
    v_mfma_f32_16x16x32_bf16 v[168:171], v[24:27], v[56:59], v[168:171]
    v_mfma_f32_16x16x32_bf16 v[184:187], v[28:31], v[56:59], v[184:187]
    s_waitcnt lgkmcnt(6)
    v_mfma_f32_16x16x32_bf16 v[140:143], v[16:19], v[60:63], v[140:143]
    v_mfma_f32_16x16x32_bf16 v[156:159], v[20:23], v[60:63], v[156:159]
    v_mfma_f32_16x16x32_bf16 v[172:175], v[24:27], v[60:63], v[172:175]
    v_mfma_f32_16x16x32_bf16 v[188:191], v[28:31], v[60:63], v[188:191]
    v_mfma_f32_16x16x32_bf16 v[192:195], v[32:35], v[48:51], v[192:195]
    s_waitcnt lgkmcnt(4)
    v_mfma_f32_16x16x32_bf16 v[208:211], v[36:39], v[48:51], v[208:211]
    s_waitcnt lgkmcnt(2)
    v_mfma_f32_16x16x32_bf16 v[224:227], v[40:43], v[48:51], v[224:227]
    s_waitcnt lgkmcnt(0)
    v_mfma_f32_16x16x32_bf16 v[240:243], v[44:47], v[48:51], v[240:243]
    v_mfma_f32_16x16x32_bf16 v[196:199], v[32:35], v[52:55], v[196:199]
    v_mfma_f32_16x16x32_bf16 v[212:215], v[36:39], v[52:55], v[212:215]
    v_mfma_f32_16x16x32_bf16 v[228:231], v[40:43], v[52:55], v[228:231]
    v_mfma_f32_16x16x32_bf16 v[244:247], v[44:47], v[52:55], v[244:247]
    v_mfma_f32_16x16x32_bf16 v[200:203], v[32:35], v[56:59], v[200:203]
    v_mfma_f32_16x16x32_bf16 v[216:219], v[36:39], v[56:59], v[216:219]
    v_mfma_f32_16x16x32_bf16 v[232:235], v[40:43], v[56:59], v[232:235]
    v_mfma_f32_16x16x32_bf16 v[248:251], v[44:47], v[56:59], v[248:251]
    v_mfma_f32_16x16x32_bf16 v[204:207], v[32:35], v[60:63], v[204:207]
    v_mfma_f32_16x16x32_bf16 v[220:223], v[36:39], v[60:63], v[220:223]
    v_mfma_f32_16x16x32_bf16 v[236:239], v[40:43], v[60:63], v[236:239]
    v_mfma_f32_16x16x32_bf16 v[252:255], v[44:47], v[60:63], v[252:255]
    s_barrier
    s_mov_b32 s46, 0xc0135761
    s_mov_b32 s48, 0xbdd2d3e8
    s_mov_b32 s49, 0xbdd2d3e8
    s_mul_i32 s37, s33, 112
    s_lshl_b32 s38, s32, 3
    s_add_u32 s37, s37, s38
    s_add_u32 s37, s37, s35
    s_lshl_b32 s37, s37, 13
    s_lshl_b32 s38, s36, 12
    s_add_u32 s37, s37, s38
    s_add_u32 s20, s6, 0x2c00000
    s_addc_u32 s21, s7, 0
    s_mov_b32 s22, 0x200000
    s_mov_b32 s23, 0x00020000
    s_lshl_b32 s40, s33, 1
    s_lshr_b32 s41, s32, 3
    s_add_u32 s40, s40, s41
    s_mul_i32 s40, s40, 4352
    s_and_b32 s41, s32, 7
    s_lshl_b32 s41, s41, 2
    s_add_u32 s41, s41, s3
    s_lshl_b32 s41, s41, 2
    s_add_u32 s40, s40, s41
    s_add_u32 s40, s40, 626816
    v_mov_b32 v6, 1
    v_mov_b32 v7, 0
    v_lshlrev_b32 v2, 4, v1
    v_mov_b32 v4, s46
    v_mov_b32 v5, s46
    s_nop 7
    v_pk_mul_f32 v[16:17], v[128:129], v[128:129]
    v_pk_mul_f32 v[18:19], v[130:131], v[130:131]
    v_pk_mul_f32 v[20:21], v[144:145], v[144:145]
    v_pk_mul_f32 v[22:23], v[146:147], v[146:147]
    v_pk_fma_f32 v[16:17], v[16:17], s[48:49], v[4:5]
    v_pk_fma_f32 v[18:19], v[18:19], s[48:49], v[4:5]
    v_pk_fma_f32 v[20:21], v[20:21], s[48:49], v[4:5]
    v_pk_fma_f32 v[22:23], v[22:23], s[48:49], v[4:5]
    v_pk_mul_f32 v[16:17], v[16:17], v[128:129]
    v_pk_mul_f32 v[18:19], v[18:19], v[130:131]
    v_pk_mul_f32 v[20:21], v[20:21], v[144:145]
    v_pk_mul_f32 v[22:23], v[22:23], v[146:147]
    v_exp_f32 v16, v16
    v_exp_f32 v17, v17
    v_exp_f32 v18, v18
    v_exp_f32 v19, v19
    v_exp_f32 v20, v20
    v_exp_f32 v21, v21
    v_exp_f32 v22, v22
    v_exp_f32 v23, v23
    v_pk_add_f32 v[16:17], v[16:17], 1.0 op_sel_hi:[1,0]
    v_pk_add_f32 v[18:19], v[18:19], 1.0 op_sel_hi:[1,0]
    v_pk_add_f32 v[20:21], v[20:21], 1.0 op_sel_hi:[1,0]
    v_pk_add_f32 v[22:23], v[22:23], 1.0 op_sel_hi:[1,0]
    v_rcp_f32 v16, v16
    v_rcp_f32 v17, v17
    v_rcp_f32 v18, v18
    v_rcp_f32 v19, v19
    v_rcp_f32 v20, v20
    v_rcp_f32 v21, v21
    v_rcp_f32 v22, v22
    v_rcp_f32 v23, v23
    v_pk_mul_f32 v[16:17], v[16:17], v[128:129]
    v_pk_mul_f32 v[18:19], v[18:19], v[130:131]
    v_pk_mul_f32 v[20:21], v[20:21], v[144:145]
    v_pk_mul_f32 v[22:23], v[22:23], v[146:147]
    v_cvt_pk_bf16_f32 v24, v16, v17
    v_cvt_pk_bf16_f32 v25, v18, v19
    v_cvt_pk_bf16_f32 v26, v20, v21
    v_cvt_pk_bf16_f32 v27, v22, v23
    s_add_u32 s38, s37, 0
    buffer_store_dwordx4 v[24:27], v2, s[16:19], s38 offen offset:0 sc1
    v_pk_mul_f32 v[32:33], v[132:133], v[132:133]
    v_pk_mul_f32 v[34:35], v[134:135], v[134:135]
    v_pk_mul_f32 v[36:37], v[148:149], v[148:149]
    v_pk_mul_f32 v[38:39], v[150:151], v[150:151]
    v_pk_fma_f32 v[32:33], v[32:33], s[48:49], v[4:5]
    v_pk_fma_f32 v[34:35], v[34:35], s[48:49], v[4:5]
    v_pk_fma_f32 v[36:37], v[36:37], s[48:49], v[4:5]
    v_pk_fma_f32 v[38:39], v[38:39], s[48:49], v[4:5]
    v_pk_mul_f32 v[32:33], v[32:33], v[132:133]
    v_pk_mul_f32 v[34:35], v[34:35], v[134:135]
    v_pk_mul_f32 v[36:37], v[36:37], v[148:149]
    v_pk_mul_f32 v[38:39], v[38:39], v[150:151]
    v_exp_f32 v32, v32
    v_exp_f32 v33, v33
    v_exp_f32 v34, v34
    v_exp_f32 v35, v35
    v_exp_f32 v36, v36
    v_exp_f32 v37, v37
    v_exp_f32 v38, v38
    v_exp_f32 v39, v39
    v_pk_add_f32 v[32:33], v[32:33], 1.0 op_sel_hi:[1,0]
    v_pk_add_f32 v[34:35], v[34:35], 1.0 op_sel_hi:[1,0]
    v_pk_add_f32 v[36:37], v[36:37], 1.0 op_sel_hi:[1,0]
    v_pk_add_f32 v[38:39], v[38:39], 1.0 op_sel_hi:[1,0]
    v_rcp_f32 v32, v32
    v_rcp_f32 v33, v33
    v_rcp_f32 v34, v34
    v_rcp_f32 v35, v35
    v_rcp_f32 v36, v36
    v_rcp_f32 v37, v37
    v_rcp_f32 v38, v38
    v_rcp_f32 v39, v39
    v_pk_mul_f32 v[32:33], v[32:33], v[132:133]
    v_pk_mul_f32 v[34:35], v[34:35], v[134:135]
    v_pk_mul_f32 v[36:37], v[36:37], v[148:149]
    v_pk_mul_f32 v[38:39], v[38:39], v[150:151]
    v_cvt_pk_bf16_f32 v40, v32, v33
    v_cvt_pk_bf16_f32 v41, v34, v35
    v_cvt_pk_bf16_f32 v42, v36, v37
    v_cvt_pk_bf16_f32 v43, v38, v39
    buffer_store_dwordx4 v[40:43], v2, s[16:19], s38 offen offset:1024 sc1
    v_pk_mul_f32 v[16:17], v[136:137], v[136:137]
    v_pk_mul_f32 v[18:19], v[138:139], v[138:139]
    v_pk_mul_f32 v[20:21], v[152:153], v[152:153]
    v_pk_mul_f32 v[22:23], v[154:155], v[154:155]
    v_pk_fma_f32 v[16:17], v[16:17], s[48:49], v[4:5]
    v_pk_fma_f32 v[18:19], v[18:19], s[48:49], v[4:5]
    v_pk_fma_f32 v[20:21], v[20:21], s[48:49], v[4:5]
    v_pk_fma_f32 v[22:23], v[22:23], s[48:49], v[4:5]
    v_pk_mul_f32 v[16:17], v[16:17], v[136:137]
    v_pk_mul_f32 v[18:19], v[18:19], v[138:139]
    v_pk_mul_f32 v[20:21], v[20:21], v[152:153]
    v_pk_mul_f32 v[22:23], v[22:23], v[154:155]
    v_exp_f32 v16, v16
    v_exp_f32 v17, v17
    v_exp_f32 v18, v18
    v_exp_f32 v19, v19
    v_exp_f32 v20, v20
    v_exp_f32 v21, v21
    v_exp_f32 v22, v22
    v_exp_f32 v23, v23
    v_pk_add_f32 v[16:17], v[16:17], 1.0 op_sel_hi:[1,0]
    v_pk_add_f32 v[18:19], v[18:19], 1.0 op_sel_hi:[1,0]
    v_pk_add_f32 v[20:21], v[20:21], 1.0 op_sel_hi:[1,0]
    v_pk_add_f32 v[22:23], v[22:23], 1.0 op_sel_hi:[1,0]
    v_rcp_f32 v16, v16
    v_rcp_f32 v17, v17
    v_rcp_f32 v18, v18
    v_rcp_f32 v19, v19
    v_rcp_f32 v20, v20
    v_rcp_f32 v21, v21
    v_rcp_f32 v22, v22
    v_rcp_f32 v23, v23
    v_pk_mul_f32 v[16:17], v[16:17], v[136:137]
    v_pk_mul_f32 v[18:19], v[18:19], v[138:139]
    v_pk_mul_f32 v[20:21], v[20:21], v[152:153]
    v_pk_mul_f32 v[22:23], v[22:23], v[154:155]
    v_cvt_pk_bf16_f32 v24, v16, v17
    v_cvt_pk_bf16_f32 v25, v18, v19
    v_cvt_pk_bf16_f32 v26, v20, v21
    v_cvt_pk_bf16_f32 v27, v22, v23
    buffer_store_dwordx4 v[24:27], v2, s[16:19], s38 offen offset:2048 sc1
    v_pk_mul_f32 v[32:33], v[140:141], v[140:141]
    v_pk_mul_f32 v[34:35], v[142:143], v[142:143]
    v_pk_mul_f32 v[36:37], v[156:157], v[156:157]
    v_pk_mul_f32 v[38:39], v[158:159], v[158:159]
    v_pk_fma_f32 v[32:33], v[32:33], s[48:49], v[4:5]
    v_pk_fma_f32 v[34:35], v[34:35], s[48:49], v[4:5]
    v_pk_fma_f32 v[36:37], v[36:37], s[48:49], v[4:5]
    v_pk_fma_f32 v[38:39], v[38:39], s[48:49], v[4:5]
    v_pk_mul_f32 v[32:33], v[32:33], v[140:141]
    v_pk_mul_f32 v[34:35], v[34:35], v[142:143]
    v_pk_mul_f32 v[36:37], v[36:37], v[156:157]
    v_pk_mul_f32 v[38:39], v[38:39], v[158:159]
    v_exp_f32 v32, v32
    v_exp_f32 v33, v33
    v_exp_f32 v34, v34
    v_exp_f32 v35, v35
    v_exp_f32 v36, v36
    v_exp_f32 v37, v37
    v_exp_f32 v38, v38
    v_exp_f32 v39, v39
    v_pk_add_f32 v[32:33], v[32:33], 1.0 op_sel_hi:[1,0]
    v_pk_add_f32 v[34:35], v[34:35], 1.0 op_sel_hi:[1,0]
    v_pk_add_f32 v[36:37], v[36:37], 1.0 op_sel_hi:[1,0]
    v_pk_add_f32 v[38:39], v[38:39], 1.0 op_sel_hi:[1,0]
    v_rcp_f32 v32, v32
    v_rcp_f32 v33, v33
    v_rcp_f32 v34, v34
    v_rcp_f32 v35, v35
    v_rcp_f32 v36, v36
    v_rcp_f32 v37, v37
    v_rcp_f32 v38, v38
    v_rcp_f32 v39, v39
    v_pk_mul_f32 v[32:33], v[32:33], v[140:141]
    v_pk_mul_f32 v[34:35], v[34:35], v[142:143]
    v_pk_mul_f32 v[36:37], v[36:37], v[156:157]
    v_pk_mul_f32 v[38:39], v[38:39], v[158:159]
    v_cvt_pk_bf16_f32 v40, v32, v33
    v_cvt_pk_bf16_f32 v41, v34, v35
    v_cvt_pk_bf16_f32 v42, v36, v37
    v_cvt_pk_bf16_f32 v43, v38, v39
    buffer_store_dwordx4 v[40:43], v2, s[16:19], s38 offen offset:3072 sc1
    v_pk_mul_f32 v[16:17], v[160:161], v[160:161]
    v_pk_mul_f32 v[18:19], v[162:163], v[162:163]
    v_pk_mul_f32 v[20:21], v[176:177], v[176:177]
    v_pk_mul_f32 v[22:23], v[178:179], v[178:179]
    v_pk_fma_f32 v[16:17], v[16:17], s[48:49], v[4:5]
    v_pk_fma_f32 v[18:19], v[18:19], s[48:49], v[4:5]
    v_pk_fma_f32 v[20:21], v[20:21], s[48:49], v[4:5]
    v_pk_fma_f32 v[22:23], v[22:23], s[48:49], v[4:5]
    v_pk_mul_f32 v[16:17], v[16:17], v[160:161]
    v_pk_mul_f32 v[18:19], v[18:19], v[162:163]
    v_pk_mul_f32 v[20:21], v[20:21], v[176:177]
    v_pk_mul_f32 v[22:23], v[22:23], v[178:179]
    v_exp_f32 v16, v16
    v_exp_f32 v17, v17
    v_exp_f32 v18, v18
    v_exp_f32 v19, v19
    v_exp_f32 v20, v20
    v_exp_f32 v21, v21
    v_exp_f32 v22, v22
    v_exp_f32 v23, v23
    v_pk_add_f32 v[16:17], v[16:17], 1.0 op_sel_hi:[1,0]
    v_pk_add_f32 v[18:19], v[18:19], 1.0 op_sel_hi:[1,0]
    v_pk_add_f32 v[20:21], v[20:21], 1.0 op_sel_hi:[1,0]
    v_pk_add_f32 v[22:23], v[22:23], 1.0 op_sel_hi:[1,0]
    v_rcp_f32 v16, v16
    v_rcp_f32 v17, v17
    v_rcp_f32 v18, v18
    v_rcp_f32 v19, v19
    v_rcp_f32 v20, v20
    v_rcp_f32 v21, v21
    v_rcp_f32 v22, v22
    v_rcp_f32 v23, v23
    v_pk_mul_f32 v[16:17], v[16:17], v[160:161]
    v_pk_mul_f32 v[18:19], v[18:19], v[162:163]
    v_pk_mul_f32 v[20:21], v[20:21], v[176:177]
    v_pk_mul_f32 v[22:23], v[22:23], v[178:179]
    v_cvt_pk_bf16_f32 v24, v16, v17
    v_cvt_pk_bf16_f32 v25, v18, v19
    v_cvt_pk_bf16_f32 v26, v20, v21
    v_cvt_pk_bf16_f32 v27, v22, v23
    s_add_u32 s38, s37, 16384
    buffer_store_dwordx4 v[24:27], v2, s[16:19], s38 offen offset:0 sc1
    v_pk_mul_f32 v[32:33], v[164:165], v[164:165]
    v_pk_mul_f32 v[34:35], v[166:167], v[166:167]
    v_pk_mul_f32 v[36:37], v[180:181], v[180:181]
    v_pk_mul_f32 v[38:39], v[182:183], v[182:183]
    v_pk_fma_f32 v[32:33], v[32:33], s[48:49], v[4:5]
    v_pk_fma_f32 v[34:35], v[34:35], s[48:49], v[4:5]
    v_pk_fma_f32 v[36:37], v[36:37], s[48:49], v[4:5]
    v_pk_fma_f32 v[38:39], v[38:39], s[48:49], v[4:5]
    v_pk_mul_f32 v[32:33], v[32:33], v[164:165]
    v_pk_mul_f32 v[34:35], v[34:35], v[166:167]
    v_pk_mul_f32 v[36:37], v[36:37], v[180:181]
    v_pk_mul_f32 v[38:39], v[38:39], v[182:183]
    v_exp_f32 v32, v32
    v_exp_f32 v33, v33
    v_exp_f32 v34, v34
    v_exp_f32 v35, v35
    v_exp_f32 v36, v36
    v_exp_f32 v37, v37
    v_exp_f32 v38, v38
    v_exp_f32 v39, v39
    v_pk_add_f32 v[32:33], v[32:33], 1.0 op_sel_hi:[1,0]
    v_pk_add_f32 v[34:35], v[34:35], 1.0 op_sel_hi:[1,0]
    v_pk_add_f32 v[36:37], v[36:37], 1.0 op_sel_hi:[1,0]
    v_pk_add_f32 v[38:39], v[38:39], 1.0 op_sel_hi:[1,0]
    v_rcp_f32 v32, v32
    v_rcp_f32 v33, v33
    v_rcp_f32 v34, v34
    v_rcp_f32 v35, v35
    v_rcp_f32 v36, v36
    v_rcp_f32 v37, v37
    v_rcp_f32 v38, v38
    v_rcp_f32 v39, v39
    v_pk_mul_f32 v[32:33], v[32:33], v[164:165]
    v_pk_mul_f32 v[34:35], v[34:35], v[166:167]
    v_pk_mul_f32 v[36:37], v[36:37], v[180:181]
    v_pk_mul_f32 v[38:39], v[38:39], v[182:183]
    v_cvt_pk_bf16_f32 v40, v32, v33
    v_cvt_pk_bf16_f32 v41, v34, v35
    v_cvt_pk_bf16_f32 v42, v36, v37
    v_cvt_pk_bf16_f32 v43, v38, v39
    buffer_store_dwordx4 v[40:43], v2, s[16:19], s38 offen offset:1024 sc1
    v_pk_mul_f32 v[16:17], v[168:169], v[168:169]
    v_pk_mul_f32 v[18:19], v[170:171], v[170:171]
    v_pk_mul_f32 v[20:21], v[184:185], v[184:185]
    v_pk_mul_f32 v[22:23], v[186:187], v[186:187]
    v_pk_fma_f32 v[16:17], v[16:17], s[48:49], v[4:5]
    v_pk_fma_f32 v[18:19], v[18:19], s[48:49], v[4:5]
    v_pk_fma_f32 v[20:21], v[20:21], s[48:49], v[4:5]
    v_pk_fma_f32 v[22:23], v[22:23], s[48:49], v[4:5]
    v_pk_mul_f32 v[16:17], v[16:17], v[168:169]
    v_pk_mul_f32 v[18:19], v[18:19], v[170:171]
    v_pk_mul_f32 v[20:21], v[20:21], v[184:185]
    v_pk_mul_f32 v[22:23], v[22:23], v[186:187]
    v_exp_f32 v16, v16
    v_exp_f32 v17, v17
    v_exp_f32 v18, v18
    v_exp_f32 v19, v19
    v_exp_f32 v20, v20
    v_exp_f32 v21, v21
    v_exp_f32 v22, v22
    v_exp_f32 v23, v23
    v_pk_add_f32 v[16:17], v[16:17], 1.0 op_sel_hi:[1,0]
    v_pk_add_f32 v[18:19], v[18:19], 1.0 op_sel_hi:[1,0]
    v_pk_add_f32 v[20:21], v[20:21], 1.0 op_sel_hi:[1,0]
    v_pk_add_f32 v[22:23], v[22:23], 1.0 op_sel_hi:[1,0]
    v_rcp_f32 v16, v16
    v_rcp_f32 v17, v17
    v_rcp_f32 v18, v18
    v_rcp_f32 v19, v19
    v_rcp_f32 v20, v20
    v_rcp_f32 v21, v21
    v_rcp_f32 v22, v22
    v_rcp_f32 v23, v23
    v_pk_mul_f32 v[16:17], v[16:17], v[168:169]
    v_pk_mul_f32 v[18:19], v[18:19], v[170:171]
    v_pk_mul_f32 v[20:21], v[20:21], v[184:185]
    v_pk_mul_f32 v[22:23], v[22:23], v[186:187]
    v_cvt_pk_bf16_f32 v24, v16, v17
    v_cvt_pk_bf16_f32 v25, v18, v19
    v_cvt_pk_bf16_f32 v26, v20, v21
    v_cvt_pk_bf16_f32 v27, v22, v23
    buffer_store_dwordx4 v[24:27], v2, s[16:19], s38 offen offset:2048 sc1
    v_pk_mul_f32 v[32:33], v[172:173], v[172:173]
    v_pk_mul_f32 v[34:35], v[174:175], v[174:175]
    v_pk_mul_f32 v[36:37], v[188:189], v[188:189]
    v_pk_mul_f32 v[38:39], v[190:191], v[190:191]
    v_pk_fma_f32 v[32:33], v[32:33], s[48:49], v[4:5]
    v_pk_fma_f32 v[34:35], v[34:35], s[48:49], v[4:5]
    v_pk_fma_f32 v[36:37], v[36:37], s[48:49], v[4:5]
    v_pk_fma_f32 v[38:39], v[38:39], s[48:49], v[4:5]
    v_pk_mul_f32 v[32:33], v[32:33], v[172:173]
    v_pk_mul_f32 v[34:35], v[34:35], v[174:175]
    v_pk_mul_f32 v[36:37], v[36:37], v[188:189]
    v_pk_mul_f32 v[38:39], v[38:39], v[190:191]
    v_exp_f32 v32, v32
    v_exp_f32 v33, v33
    v_exp_f32 v34, v34
    v_exp_f32 v35, v35
    v_exp_f32 v36, v36
    v_exp_f32 v37, v37
    v_exp_f32 v38, v38
    v_exp_f32 v39, v39
    v_pk_add_f32 v[32:33], v[32:33], 1.0 op_sel_hi:[1,0]
    v_pk_add_f32 v[34:35], v[34:35], 1.0 op_sel_hi:[1,0]
    v_pk_add_f32 v[36:37], v[36:37], 1.0 op_sel_hi:[1,0]
    v_pk_add_f32 v[38:39], v[38:39], 1.0 op_sel_hi:[1,0]
    v_rcp_f32 v32, v32
    v_rcp_f32 v33, v33
    v_rcp_f32 v34, v34
    v_rcp_f32 v35, v35
    v_rcp_f32 v36, v36
    v_rcp_f32 v37, v37
    v_rcp_f32 v38, v38
    v_rcp_f32 v39, v39
    v_pk_mul_f32 v[32:33], v[32:33], v[172:173]
    v_pk_mul_f32 v[34:35], v[34:35], v[174:175]
    v_pk_mul_f32 v[36:37], v[36:37], v[188:189]
    v_pk_mul_f32 v[38:39], v[38:39], v[190:191]
    v_cvt_pk_bf16_f32 v40, v32, v33
    v_cvt_pk_bf16_f32 v41, v34, v35
    v_cvt_pk_bf16_f32 v42, v36, v37
    v_cvt_pk_bf16_f32 v43, v38, v39
    buffer_store_dwordx4 v[40:43], v2, s[16:19], s38 offen offset:3072 sc1
    v_pk_mul_f32 v[16:17], v[192:193], v[192:193]
    v_pk_mul_f32 v[18:19], v[194:195], v[194:195]
    v_pk_mul_f32 v[20:21], v[208:209], v[208:209]
    v_pk_mul_f32 v[22:23], v[210:211], v[210:211]
    v_pk_fma_f32 v[16:17], v[16:17], s[48:49], v[4:5]
    v_pk_fma_f32 v[18:19], v[18:19], s[48:49], v[4:5]
    v_pk_fma_f32 v[20:21], v[20:21], s[48:49], v[4:5]
    v_pk_fma_f32 v[22:23], v[22:23], s[48:49], v[4:5]
    v_pk_mul_f32 v[16:17], v[16:17], v[192:193]
    v_pk_mul_f32 v[18:19], v[18:19], v[194:195]
    v_pk_mul_f32 v[20:21], v[20:21], v[208:209]
    v_pk_mul_f32 v[22:23], v[22:23], v[210:211]
    v_exp_f32 v16, v16
    v_exp_f32 v17, v17
    v_exp_f32 v18, v18
    v_exp_f32 v19, v19
    v_exp_f32 v20, v20
    v_exp_f32 v21, v21
    v_exp_f32 v22, v22
    v_exp_f32 v23, v23
    v_pk_add_f32 v[16:17], v[16:17], 1.0 op_sel_hi:[1,0]
    v_pk_add_f32 v[18:19], v[18:19], 1.0 op_sel_hi:[1,0]
    v_pk_add_f32 v[20:21], v[20:21], 1.0 op_sel_hi:[1,0]
    v_pk_add_f32 v[22:23], v[22:23], 1.0 op_sel_hi:[1,0]
    v_rcp_f32 v16, v16
    v_rcp_f32 v17, v17
    v_rcp_f32 v18, v18
    v_rcp_f32 v19, v19
    v_rcp_f32 v20, v20
    v_rcp_f32 v21, v21
    v_rcp_f32 v22, v22
    v_rcp_f32 v23, v23
    v_pk_mul_f32 v[16:17], v[16:17], v[192:193]
    v_pk_mul_f32 v[18:19], v[18:19], v[194:195]
    v_pk_mul_f32 v[20:21], v[20:21], v[208:209]
    v_pk_mul_f32 v[22:23], v[22:23], v[210:211]
    v_cvt_pk_bf16_f32 v24, v16, v17
    v_cvt_pk_bf16_f32 v25, v18, v19
    v_cvt_pk_bf16_f32 v26, v20, v21
    v_cvt_pk_bf16_f32 v27, v22, v23
    s_add_u32 s38, s37, 32768
    s_waitcnt vmcnt(0)
    buffer_store_dword v6, v7, s[20:23], s40 offen sc1
    buffer_store_dwordx4 v[24:27], v2, s[16:19], s38 offen offset:0 sc1
    v_pk_mul_f32 v[32:33], v[196:197], v[196:197]
    v_pk_mul_f32 v[34:35], v[198:199], v[198:199]
    v_pk_mul_f32 v[36:37], v[212:213], v[212:213]
    v_pk_mul_f32 v[38:39], v[214:215], v[214:215]
    v_pk_fma_f32 v[32:33], v[32:33], s[48:49], v[4:5]
    v_pk_fma_f32 v[34:35], v[34:35], s[48:49], v[4:5]
    v_pk_fma_f32 v[36:37], v[36:37], s[48:49], v[4:5]
    v_pk_fma_f32 v[38:39], v[38:39], s[48:49], v[4:5]
    v_pk_mul_f32 v[32:33], v[32:33], v[196:197]
    v_pk_mul_f32 v[34:35], v[34:35], v[198:199]
    v_pk_mul_f32 v[36:37], v[36:37], v[212:213]
    v_pk_mul_f32 v[38:39], v[38:39], v[214:215]
    v_exp_f32 v32, v32
    v_exp_f32 v33, v33
    v_exp_f32 v34, v34
    v_exp_f32 v35, v35
    v_exp_f32 v36, v36
    v_exp_f32 v37, v37
    v_exp_f32 v38, v38
    v_exp_f32 v39, v39
    v_pk_add_f32 v[32:33], v[32:33], 1.0 op_sel_hi:[1,0]
    v_pk_add_f32 v[34:35], v[34:35], 1.0 op_sel_hi:[1,0]
    v_pk_add_f32 v[36:37], v[36:37], 1.0 op_sel_hi:[1,0]
    v_pk_add_f32 v[38:39], v[38:39], 1.0 op_sel_hi:[1,0]
    v_rcp_f32 v32, v32
    v_rcp_f32 v33, v33
    v_rcp_f32 v34, v34
    v_rcp_f32 v35, v35
    v_rcp_f32 v36, v36
    v_rcp_f32 v37, v37
    v_rcp_f32 v38, v38
    v_rcp_f32 v39, v39
    v_pk_mul_f32 v[32:33], v[32:33], v[196:197]
    v_pk_mul_f32 v[34:35], v[34:35], v[198:199]
    v_pk_mul_f32 v[36:37], v[36:37], v[212:213]
    v_pk_mul_f32 v[38:39], v[38:39], v[214:215]
    v_cvt_pk_bf16_f32 v40, v32, v33
    v_cvt_pk_bf16_f32 v41, v34, v35
    v_cvt_pk_bf16_f32 v42, v36, v37
    v_cvt_pk_bf16_f32 v43, v38, v39
    buffer_store_dwordx4 v[40:43], v2, s[16:19], s38 offen offset:1024 sc1
    v_pk_mul_f32 v[16:17], v[200:201], v[200:201]
    v_pk_mul_f32 v[18:19], v[202:203], v[202:203]
    v_pk_mul_f32 v[20:21], v[216:217], v[216:217]
    v_pk_mul_f32 v[22:23], v[218:219], v[218:219]
    v_pk_fma_f32 v[16:17], v[16:17], s[48:49], v[4:5]
    v_pk_fma_f32 v[18:19], v[18:19], s[48:49], v[4:5]
    v_pk_fma_f32 v[20:21], v[20:21], s[48:49], v[4:5]
    v_pk_fma_f32 v[22:23], v[22:23], s[48:49], v[4:5]
    v_pk_mul_f32 v[16:17], v[16:17], v[200:201]
    v_pk_mul_f32 v[18:19], v[18:19], v[202:203]
    v_pk_mul_f32 v[20:21], v[20:21], v[216:217]
    v_pk_mul_f32 v[22:23], v[22:23], v[218:219]
    v_exp_f32 v16, v16
    v_exp_f32 v17, v17
    v_exp_f32 v18, v18
    v_exp_f32 v19, v19
    v_exp_f32 v20, v20
    v_exp_f32 v21, v21
    v_exp_f32 v22, v22
    v_exp_f32 v23, v23
    v_pk_add_f32 v[16:17], v[16:17], 1.0 op_sel_hi:[1,0]
    v_pk_add_f32 v[18:19], v[18:19], 1.0 op_sel_hi:[1,0]
    v_pk_add_f32 v[20:21], v[20:21], 1.0 op_sel_hi:[1,0]
    v_pk_add_f32 v[22:23], v[22:23], 1.0 op_sel_hi:[1,0]
    v_rcp_f32 v16, v16
    v_rcp_f32 v17, v17
    v_rcp_f32 v18, v18
    v_rcp_f32 v19, v19
    v_rcp_f32 v20, v20
    v_rcp_f32 v21, v21
    v_rcp_f32 v22, v22
    v_rcp_f32 v23, v23
    v_pk_mul_f32 v[16:17], v[16:17], v[200:201]
    v_pk_mul_f32 v[18:19], v[18:19], v[202:203]
    v_pk_mul_f32 v[20:21], v[20:21], v[216:217]
    v_pk_mul_f32 v[22:23], v[22:23], v[218:219]
    v_cvt_pk_bf16_f32 v24, v16, v17
    v_cvt_pk_bf16_f32 v25, v18, v19
    v_cvt_pk_bf16_f32 v26, v20, v21
    v_cvt_pk_bf16_f32 v27, v22, v23
    buffer_store_dwordx4 v[24:27], v2, s[16:19], s38 offen offset:2048 sc1
    v_pk_mul_f32 v[32:33], v[204:205], v[204:205]
    v_pk_mul_f32 v[34:35], v[206:207], v[206:207]
    v_pk_mul_f32 v[36:37], v[220:221], v[220:221]
    v_pk_mul_f32 v[38:39], v[222:223], v[222:223]
    v_pk_fma_f32 v[32:33], v[32:33], s[48:49], v[4:5]
    v_pk_fma_f32 v[34:35], v[34:35], s[48:49], v[4:5]
    v_pk_fma_f32 v[36:37], v[36:37], s[48:49], v[4:5]
    v_pk_fma_f32 v[38:39], v[38:39], s[48:49], v[4:5]
    v_pk_mul_f32 v[32:33], v[32:33], v[204:205]
    v_pk_mul_f32 v[34:35], v[34:35], v[206:207]
    v_pk_mul_f32 v[36:37], v[36:37], v[220:221]
    v_pk_mul_f32 v[38:39], v[38:39], v[222:223]
    v_exp_f32 v32, v32
    v_exp_f32 v33, v33
    v_exp_f32 v34, v34
    v_exp_f32 v35, v35
    v_exp_f32 v36, v36
    v_exp_f32 v37, v37
    v_exp_f32 v38, v38
    v_exp_f32 v39, v39
    v_pk_add_f32 v[32:33], v[32:33], 1.0 op_sel_hi:[1,0]
    v_pk_add_f32 v[34:35], v[34:35], 1.0 op_sel_hi:[1,0]
    v_pk_add_f32 v[36:37], v[36:37], 1.0 op_sel_hi:[1,0]
    v_pk_add_f32 v[38:39], v[38:39], 1.0 op_sel_hi:[1,0]
    v_rcp_f32 v32, v32
    v_rcp_f32 v33, v33
    v_rcp_f32 v34, v34
    v_rcp_f32 v35, v35
    v_rcp_f32 v36, v36
    v_rcp_f32 v37, v37
    v_rcp_f32 v38, v38
    v_rcp_f32 v39, v39
    v_pk_mul_f32 v[32:33], v[32:33], v[204:205]
    v_pk_mul_f32 v[34:35], v[34:35], v[206:207]
    v_pk_mul_f32 v[36:37], v[36:37], v[220:221]
    v_pk_mul_f32 v[38:39], v[38:39], v[222:223]
    v_cvt_pk_bf16_f32 v40, v32, v33
    v_cvt_pk_bf16_f32 v41, v34, v35
    v_cvt_pk_bf16_f32 v42, v36, v37
    v_cvt_pk_bf16_f32 v43, v38, v39
    buffer_store_dwordx4 v[40:43], v2, s[16:19], s38 offen offset:3072 sc1
    v_pk_mul_f32 v[16:17], v[224:225], v[224:225]
    v_pk_mul_f32 v[18:19], v[226:227], v[226:227]
    v_pk_mul_f32 v[20:21], v[240:241], v[240:241]
    v_pk_mul_f32 v[22:23], v[242:243], v[242:243]
    v_pk_fma_f32 v[16:17], v[16:17], s[48:49], v[4:5]
    v_pk_fma_f32 v[18:19], v[18:19], s[48:49], v[4:5]
    v_pk_fma_f32 v[20:21], v[20:21], s[48:49], v[4:5]
    v_pk_fma_f32 v[22:23], v[22:23], s[48:49], v[4:5]
    v_pk_mul_f32 v[16:17], v[16:17], v[224:225]
    v_pk_mul_f32 v[18:19], v[18:19], v[226:227]
    v_pk_mul_f32 v[20:21], v[20:21], v[240:241]
    v_pk_mul_f32 v[22:23], v[22:23], v[242:243]
    v_exp_f32 v16, v16
    v_exp_f32 v17, v17
    v_exp_f32 v18, v18
    v_exp_f32 v19, v19
    v_exp_f32 v20, v20
    v_exp_f32 v21, v21
    v_exp_f32 v22, v22
    v_exp_f32 v23, v23
    v_pk_add_f32 v[16:17], v[16:17], 1.0 op_sel_hi:[1,0]
    v_pk_add_f32 v[18:19], v[18:19], 1.0 op_sel_hi:[1,0]
    v_pk_add_f32 v[20:21], v[20:21], 1.0 op_sel_hi:[1,0]
    v_pk_add_f32 v[22:23], v[22:23], 1.0 op_sel_hi:[1,0]
    v_rcp_f32 v16, v16
    v_rcp_f32 v17, v17
    v_rcp_f32 v18, v18
    v_rcp_f32 v19, v19
    v_rcp_f32 v20, v20
    v_rcp_f32 v21, v21
    v_rcp_f32 v22, v22
    v_rcp_f32 v23, v23
    v_pk_mul_f32 v[16:17], v[16:17], v[224:225]
    v_pk_mul_f32 v[18:19], v[18:19], v[226:227]
    v_pk_mul_f32 v[20:21], v[20:21], v[240:241]
    v_pk_mul_f32 v[22:23], v[22:23], v[242:243]
    v_cvt_pk_bf16_f32 v24, v16, v17
    v_cvt_pk_bf16_f32 v25, v18, v19
    v_cvt_pk_bf16_f32 v26, v20, v21
    v_cvt_pk_bf16_f32 v27, v22, v23
    s_add_u32 s38, s37, 49152
    buffer_store_dwordx4 v[24:27], v2, s[16:19], s38 offen offset:0 sc1
    v_pk_mul_f32 v[32:33], v[228:229], v[228:229]
    v_pk_mul_f32 v[34:35], v[230:231], v[230:231]
    v_pk_mul_f32 v[36:37], v[244:245], v[244:245]
    v_pk_mul_f32 v[38:39], v[246:247], v[246:247]
    v_pk_fma_f32 v[32:33], v[32:33], s[48:49], v[4:5]
    v_pk_fma_f32 v[34:35], v[34:35], s[48:49], v[4:5]
    v_pk_fma_f32 v[36:37], v[36:37], s[48:49], v[4:5]
    v_pk_fma_f32 v[38:39], v[38:39], s[48:49], v[4:5]
    v_pk_mul_f32 v[32:33], v[32:33], v[228:229]
    v_pk_mul_f32 v[34:35], v[34:35], v[230:231]
    v_pk_mul_f32 v[36:37], v[36:37], v[244:245]
    v_pk_mul_f32 v[38:39], v[38:39], v[246:247]
    v_exp_f32 v32, v32
    v_exp_f32 v33, v33
    v_exp_f32 v34, v34
    v_exp_f32 v35, v35
    v_exp_f32 v36, v36
    v_exp_f32 v37, v37
    v_exp_f32 v38, v38
    v_exp_f32 v39, v39
    v_pk_add_f32 v[32:33], v[32:33], 1.0 op_sel_hi:[1,0]
    v_pk_add_f32 v[34:35], v[34:35], 1.0 op_sel_hi:[1,0]
    v_pk_add_f32 v[36:37], v[36:37], 1.0 op_sel_hi:[1,0]
    v_pk_add_f32 v[38:39], v[38:39], 1.0 op_sel_hi:[1,0]
    v_rcp_f32 v32, v32
    v_rcp_f32 v33, v33
    v_rcp_f32 v34, v34
    v_rcp_f32 v35, v35
    v_rcp_f32 v36, v36
    v_rcp_f32 v37, v37
    v_rcp_f32 v38, v38
    v_rcp_f32 v39, v39
    v_pk_mul_f32 v[32:33], v[32:33], v[228:229]
    v_pk_mul_f32 v[34:35], v[34:35], v[230:231]
    v_pk_mul_f32 v[36:37], v[36:37], v[244:245]
    v_pk_mul_f32 v[38:39], v[38:39], v[246:247]
    v_cvt_pk_bf16_f32 v40, v32, v33
    v_cvt_pk_bf16_f32 v41, v34, v35
    v_cvt_pk_bf16_f32 v42, v36, v37
    v_cvt_pk_bf16_f32 v43, v38, v39
    buffer_store_dwordx4 v[40:43], v2, s[16:19], s38 offen offset:1024 sc1
    v_pk_mul_f32 v[16:17], v[232:233], v[232:233]
    v_pk_mul_f32 v[18:19], v[234:235], v[234:235]
    v_pk_mul_f32 v[20:21], v[248:249], v[248:249]
    v_pk_mul_f32 v[22:23], v[250:251], v[250:251]
    v_pk_fma_f32 v[16:17], v[16:17], s[48:49], v[4:5]
    v_pk_fma_f32 v[18:19], v[18:19], s[48:49], v[4:5]
    v_pk_fma_f32 v[20:21], v[20:21], s[48:49], v[4:5]
    v_pk_fma_f32 v[22:23], v[22:23], s[48:49], v[4:5]
    v_pk_mul_f32 v[16:17], v[16:17], v[232:233]
    v_pk_mul_f32 v[18:19], v[18:19], v[234:235]
    v_pk_mul_f32 v[20:21], v[20:21], v[248:249]
    v_pk_mul_f32 v[22:23], v[22:23], v[250:251]
    v_exp_f32 v16, v16
    v_exp_f32 v17, v17
    v_exp_f32 v18, v18
    v_exp_f32 v19, v19
    v_exp_f32 v20, v20
    v_exp_f32 v21, v21
    v_exp_f32 v22, v22
    v_exp_f32 v23, v23
    v_pk_add_f32 v[16:17], v[16:17], 1.0 op_sel_hi:[1,0]
    v_pk_add_f32 v[18:19], v[18:19], 1.0 op_sel_hi:[1,0]
    v_pk_add_f32 v[20:21], v[20:21], 1.0 op_sel_hi:[1,0]
    v_pk_add_f32 v[22:23], v[22:23], 1.0 op_sel_hi:[1,0]
    v_rcp_f32 v16, v16
    v_rcp_f32 v17, v17
    v_rcp_f32 v18, v18
    v_rcp_f32 v19, v19
    v_rcp_f32 v20, v20
    v_rcp_f32 v21, v21
    v_rcp_f32 v22, v22
    v_rcp_f32 v23, v23
    v_pk_mul_f32 v[16:17], v[16:17], v[232:233]
    v_pk_mul_f32 v[18:19], v[18:19], v[234:235]
    v_pk_mul_f32 v[20:21], v[20:21], v[248:249]
    v_pk_mul_f32 v[22:23], v[22:23], v[250:251]
    v_cvt_pk_bf16_f32 v24, v16, v17
    v_cvt_pk_bf16_f32 v25, v18, v19
    v_cvt_pk_bf16_f32 v26, v20, v21
    v_cvt_pk_bf16_f32 v27, v22, v23
    buffer_store_dwordx4 v[24:27], v2, s[16:19], s38 offen offset:2048 sc1
    v_pk_mul_f32 v[32:33], v[236:237], v[236:237]
    v_pk_mul_f32 v[34:35], v[238:239], v[238:239]
    v_pk_mul_f32 v[36:37], v[252:253], v[252:253]
    v_pk_mul_f32 v[38:39], v[254:255], v[254:255]
    v_pk_fma_f32 v[32:33], v[32:33], s[48:49], v[4:5]
    v_pk_fma_f32 v[34:35], v[34:35], s[48:49], v[4:5]
    v_pk_fma_f32 v[36:37], v[36:37], s[48:49], v[4:5]
    v_pk_fma_f32 v[38:39], v[38:39], s[48:49], v[4:5]
    v_pk_mul_f32 v[32:33], v[32:33], v[236:237]
    v_pk_mul_f32 v[34:35], v[34:35], v[238:239]
    v_pk_mul_f32 v[36:37], v[36:37], v[252:253]
    v_pk_mul_f32 v[38:39], v[38:39], v[254:255]
    v_exp_f32 v32, v32
    v_exp_f32 v33, v33
    v_exp_f32 v34, v34
    v_exp_f32 v35, v35
    v_exp_f32 v36, v36
    v_exp_f32 v37, v37
    v_exp_f32 v38, v38
    v_exp_f32 v39, v39
    v_pk_add_f32 v[32:33], v[32:33], 1.0 op_sel_hi:[1,0]
    v_pk_add_f32 v[34:35], v[34:35], 1.0 op_sel_hi:[1,0]
    v_pk_add_f32 v[36:37], v[36:37], 1.0 op_sel_hi:[1,0]
    v_pk_add_f32 v[38:39], v[38:39], 1.0 op_sel_hi:[1,0]
    v_rcp_f32 v32, v32
    v_rcp_f32 v33, v33
    v_rcp_f32 v34, v34
    v_rcp_f32 v35, v35
    v_rcp_f32 v36, v36
    v_rcp_f32 v37, v37
    v_rcp_f32 v38, v38
    v_rcp_f32 v39, v39
    v_pk_mul_f32 v[32:33], v[32:33], v[236:237]
    v_pk_mul_f32 v[34:35], v[34:35], v[238:239]
    v_pk_mul_f32 v[36:37], v[36:37], v[252:253]
    v_pk_mul_f32 v[38:39], v[38:39], v[254:255]
    v_cvt_pk_bf16_f32 v40, v32, v33
    v_cvt_pk_bf16_f32 v41, v34, v35
    v_cvt_pk_bf16_f32 v42, v36, v37
    v_cvt_pk_bf16_f32 v43, v38, v39
    buffer_store_dwordx4 v[40:43], v2, s[16:19], s38 offen offset:3072 sc1
    s_waitcnt vmcnt(0)
    s_branch g2_end
g2_prod:
    s_sub_u32 s3, s3, 4
    s_and_b32 s45, s3, 1
    s_lshl_b32 s45, s45, 1
    v_lshrrev_b32 v2, 3, v1
    v_mul_u32_u24 v4, 7168, v2
    v_bfe_u32 v2, v1, 4, 1
    v_or_b32 v2, s45, v2
    v_lshlrev_b32 v2, 1, v2
    v_and_b32 v3, 7, v1
    v_xor_b32 v2, v2, v3
    v_lshl_add_u32 v4, v2, 4, v4
    v_add_u32 v5, 128, v4
    v_add_u32 v6, 256, v4
    v_add_u32 v7, 384, v4
    v_lshlrev_b32 v8, 4, v1
    s_mul_i32 s35, s3, 57344
    s_lshl_b32 s36, s32, 9
    s_add_u32 s35, s35, s36
    s_lshl_b32 s36, s33, 19
    s_lshl_b32 s37, s3, 11
    s_add_u32 s36, s36, s37
    s_lshl_b32 s38, s3, 10
    s_add_u32 s39, s37, 16384
    s_mov_b32 s40, 0
    s_waitcnt lgkmcnt(0)
    s_mov_b32 s12, s8
    s_mov_b32 s13, s9
    s_mov_b32 s14, 0xe00000
    s_mov_b32 s15, 0x00020000
    s_add_u32 s16, s6, 0x400000
    s_addc_u32 s17, s7, 0
    s_mov_b32 s18, 0x400000
    s_mov_b32 s19, 0x00020000
    s_mov_b32 s56, s62
    s_mov_b32 s57, s63
    s_mov_b32 s58, 0xe00000
    s_mov_b32 s59, 0x00020000
    s_lshl_b32 s61, s32, 3
    s_add_u32 s61, s61, s33
    s_lshl_b32 s61, s61, 2
    s_add_u32 s61, s61, s3
    s_mul_i32 s55, s61, 0
    s_add_u32 s55, s55, 10485760
    s_add_u32 m0, s40, s38
    s_nop 0
    buffer_load_dwordx4 v4, s[12:15], s35 offen lds
    s_add_u32 m0, m0, 4096
    s_nop 0
    buffer_load_dwordx4 v5, s[12:15], s35 offen lds
    s_add_u32 m0, m0, 4096
    s_nop 0
    buffer_load_dwordx4 v6, s[12:15], s35 offen lds
    s_add_u32 m0, m0, 4096
    s_nop 0
    buffer_load_dwordx4 v7, s[12:15], s35 offen lds
    s_add_u32 s35, s35, 229376
    s_add_u32 m0, s40, s39
    s_nop 0
    buffer_load_dwordx4 v8, s[16:19], s36 offen lds
    buffer_load_dwordx4 v8, s[16:19], s36 offen offset:1024 lds
    s_add_u32 s36, s36, 8192
    s_add_u32 s40, s40, 24576
    s_cmp_eq_u32 s40, 147456
    s_cselect_b32 s40, 0, s40
    s_add_u32 m0, s40, s38
    s_nop 0
    buffer_load_dwordx4 v4, s[12:15], s35 offen lds
    s_add_u32 m0, m0, 4096
    s_nop 0
    buffer_load_dwordx4 v5, s[12:15], s35 offen lds
    s_add_u32 m0, m0, 4096
    s_nop 0
    buffer_load_dwordx4 v6, s[12:15], s35 offen lds
    s_add_u32 m0, m0, 4096
    s_nop 0
    buffer_load_dwordx4 v7, s[12:15], s35 offen lds
    s_add_u32 s35, s35, 229376
    s_add_u32 m0, s40, s39
    s_nop 0
    buffer_load_dwordx4 v8, s[16:19], s36 offen lds
    buffer_load_dwordx4 v8, s[16:19], s36 offen offset:1024 lds
    s_add_u32 s36, s36, 8192
    s_add_u32 s40, s40, 24576
    s_cmp_eq_u32 s40, 147456
    s_cselect_b32 s40, 0, s40
    s_waitcnt vmcnt(6)
    s_barrier
    s_add_u32 m0, s40, s38
    s_nop 0
    buffer_load_dwordx4 v4, s[12:15], s35 offen lds
    s_add_u32 m0, m0, 4096
    s_nop 0
    buffer_load_dwordx4 v5, s[12:15], s35 offen lds
    s_add_u32 m0, m0, 4096
    s_nop 0
    buffer_load_dwordx4 v6, s[12:15], s35 offen lds
    s_add_u32 m0, m0, 4096
    s_nop 0
    buffer_load_dwordx4 v7, s[12:15], s35 offen lds
    s_add_u32 s35, s35, 229376
    s_add_u32 m0, s40, s39
    s_nop 0
    buffer_load_dwordx4 v8, s[16:19], s36 offen lds
    buffer_load_dwordx4 v8, s[16:19], s36 offen offset:1024 lds
    s_add_u32 s36, s36, 8192
    s_add_u32 s40, s40, 24576
    s_cmp_eq_u32 s40, 147456
    s_cselect_b32 s40, 0, s40
    s_add_u32 m0, s40, s38
    s_nop 0
    buffer_load_dwordx4 v4, s[12:15], s35 offen lds
    s_add_u32 m0, m0, 4096
    s_nop 0
    buffer_load_dwordx4 v5, s[12:15], s35 offen lds
    s_add_u32 m0, m0, 4096
    s_nop 0
    buffer_load_dwordx4 v6, s[12:15], s35 offen lds
    s_add_u32 m0, m0, 4096
    s_nop 0
    buffer_load_dwordx4 v7, s[12:15], s35 offen lds
    s_add_u32 s35, s35, 229376
    s_add_u32 m0, s40, s39
    s_nop 0
    buffer_load_dwordx4 v8, s[16:19], s36 offen lds
    buffer_load_dwordx4 v8, s[16:19], s36 offen offset:1024 lds
    s_add_u32 s36, s36, 8192
    s_add_u32 s40, s40, 24576
    s_cmp_eq_u32 s40, 147456
    s_cselect_b32 s40, 0, s40
    s_waitcnt vmcnt(12)
    s_barrier
    s_add_u32 m0, s40, s38
    s_nop 0
    buffer_load_dwordx4 v4, s[12:15], s35 offen lds
    s_add_u32 m0, m0, 4096
    s_nop 0
    buffer_load_dwordx4 v5, s[12:15], s35 offen lds
    s_add_u32 m0, m0, 4096
    s_nop 0
    buffer_load_dwordx4 v6, s[12:15], s35 offen lds
    s_add_u32 m0, m0, 4096
    s_nop 0
    buffer_load_dwordx4 v7, s[12:15], s35 offen lds
    s_add_u32 s35, s35, 229376
    s_add_u32 m0, s40, s39
    s_nop 0
    buffer_load_dwordx4 v8, s[16:19], s36 offen lds
    buffer_load_dwordx4 v8, s[16:19], s36 offen offset:1024 lds
    s_add_u32 s36, s36, 8192
    s_add_u32 s40, s40, 24576
    s_cmp_eq_u32 s40, 147456
    s_cselect_b32 s40, 0, s40
    s_add_u32 m0, s40, s38
    s_nop 0
    buffer_load_dwordx4 v4, s[12:15], s35 offen lds
    s_add_u32 m0, m0, 4096
    s_nop 0
    buffer_load_dwordx4 v5, s[12:15], s35 offen lds
    s_add_u32 m0, m0, 4096
    s_nop 0
    buffer_load_dwordx4 v6, s[12:15], s35 offen lds
    s_add_u32 m0, m0, 4096
    s_nop 0
    buffer_load_dwordx4 v7, s[12:15], s35 offen lds
    s_add_u32 s35, s35, 229376
    s_add_u32 m0, s40, s39
    s_nop 0
    buffer_load_dwordx4 v8, s[16:19], s36 offen lds
    buffer_load_dwordx4 v8, s[16:19], s36 offen offset:1024 lds
    s_add_u32 s36, s36, 8192
    s_add_u32 s40, s40, 24576
    s_cmp_eq_u32 s40, 147456
    s_cselect_b32 s40, 0, s40
    s_mov_b32 s44, 58
g2_ploop0:
    s_waitcnt vmcnt(18)
    s_barrier
    s_add_u32 m0, s40, s38
    s_nop 0
    buffer_load_dwordx4 v4, s[12:15], s35 offen lds
    s_add_u32 m0, m0, 4096
    s_nop 0
    buffer_load_dwordx4 v5, s[12:15], s35 offen lds
    s_add_u32 m0, m0, 4096
    s_nop 0
    buffer_load_dwordx4 v6, s[12:15], s35 offen lds
    s_add_u32 m0, m0, 4096
    s_nop 0
    buffer_load_dwordx4 v7, s[12:15], s35 offen lds
    s_add_u32 s35, s35, 229376
    s_add_u32 m0, s40, s39
    s_nop 0
    buffer_load_dwordx4 v8, s[16:19], s36 offen lds
    buffer_load_dwordx4 v8, s[16:19], s36 offen offset:1024 lds
    s_add_u32 s36, s36, 8192
    s_add_u32 s40, s40, 24576
    s_cmp_eq_u32 s40, 147456
    s_cselect_b32 s40, 0, s40
    s_sub_u32 s44, s44, 1
    s_cmp_lg_u32 s44, 0
    s_cbranch_scc1 g2_ploop0
    v_lshlrev_b32 v9, 7, v1
    s_lshl_b32 s61, s32, 3
    s_add_u32 s61, s61, s33
    s_lshl_b32 s61, s61, 2
    s_add_u32 s61, s61, s3
    s_lshl_b32 s61, s61, 13
    s_add_u32 s61, s61, 4194304
    s_waitcnt vmcnt(18)
    s_barrier
    s_waitcnt vmcnt(12)
    s_barrier
    s_waitcnt vmcnt(6)
    s_barrier
    s_waitcnt vmcnt(0)
    s_barrier
    s_waitcnt vmcnt(0) lgkmcnt(0)
    s_barrier
    s_mov_b32 s29, 0
    s_mov_b32 s28, 1
    s_branch k3_entry2
g2_end:
    s_mul_i32 s34, s33, 4352
    s_lshl_b32 s35, s32, 2
    s_add_u32 s34, s34, s35
    s_add_u32 s34, s34, 557184
    s_mov_b32 s29, 0
    s_branch k23_flag
g1_entry:
    s_and_b32 s32, s30, 1
    s_lshl_b32 s32, s32, 3
    s_and_b32 s33, s31, 7
    s_add_u32 s32, s32, s33
    s_lshr_b32 s33, s30, 1
    s_lshl_b32 s33, s33, 2
    s_lshr_b32 s34, s31, 3
    s_add_u32 s33, s33, s34
    s_cmp_ge_u32 s3, 4
    s_cbranch_scc1 g1_prod
    s_waitcnt lgkmcnt(0)
    s_and_b32 s35, s3, 1
    s_lshr_b32 s36, s3, 1
    v_bfe_u32 v6, v1, 2, 2
    v_lshrrev_b32 v7, 4, v1
    v_lshl_add_u32 v6, v7, 3, v6
    v_lshlrev_b32 v4, 7, v6
    v_bfe_u32 v6, v1, 3, 2
    v_lshl_add_u32 v4, v6, 5, v4
    v_and_b32 v6, 3, v1
    v_lshl_add_u32 v4, v6, 3, v4
    s_lshl_b32 s38, s35, 6
    v_xor_b32 v4, s38, v4
    v_xor_b32 v5, 32, v4
    v_lshlrev_b32 v6, 4, v1
    s_lshl_b32 s38, s36, 13
    s_add_u32 s38, s38, 12288
    v_add_u32 v6, s38, v6
    v_add_u32 v2, 57344, v4
    v_add_u32 v3, 57344, v5
    v_add_u32 v0, 114688, v4
    v_add_u32 v1, 114688, v5
    v_add_u32 v7, 86016, v6
    s_barrier
    ds_read_b64_tr_b16 v[8:9], v4 offset:0
    ds_read_b64_tr_b16 v[10:11], v4 offset:512
    ds_read_b128 v[32:35], v6 offset:0
    ds_read_b128 v[36:39], v6 offset:1024
    ds_read_b64_tr_b16 v[12:13], v5 offset:0
    ds_read_b64_tr_b16 v[14:15], v5 offset:512
    ds_read_b64_tr_b16 v[16:17], v4 offset:4096
    ds_read_b64_tr_b16 v[18:19], v4 offset:4608
    ds_read_b64_tr_b16 v[20:21], v5 offset:4096
    ds_read_b64_tr_b16 v[22:23], v5 offset:4608
    ds_read_b64_tr_b16 v[24:25], v4 offset:8192
    ds_read_b64_tr_b16 v[26:27], v4 offset:8704
    ds_read_b64_tr_b16 v[28:29], v5 offset:8192
    ds_read_b64_tr_b16 v[30:31], v5 offset:8704
    ds_read_b128 v[40:43], v6 offset:2048
    ds_read_b128 v[44:47], v6 offset:3072
    ds_read_b128 v[48:51], v6 offset:4096
    ds_read_b128 v[52:55], v6 offset:5120
    ds_read_b128 v[56:59], v6 offset:6144
    ds_read_b128 v[60:63], v6 offset:7168
    s_waitcnt lgkmcnt(15)
    v_mfma_f32_16x16x32_bf16 v[64:67], v[8:11], v[32:35], 0
    v_mfma_f32_16x16x32_bf16 v[68:71], v[8:11], v[36:39], 0
    s_waitcnt lgkmcnt(14)
    v_mfma_f32_16x16x32_bf16 v[96:99], v[12:15], v[32:35], 0
    v_mfma_f32_16x16x32_bf16 v[100:103], v[12:15], v[36:39], 0
    s_waitcnt lgkmcnt(12)
    v_mfma_f32_16x16x32_bf16 v[128:131], v[16:19], v[32:35], 0
    v_mfma_f32_16x16x32_bf16 v[132:135], v[16:19], v[36:39], 0
    s_waitcnt lgkmcnt(10)
    v_mfma_f32_16x16x32_bf16 v[160:163], v[20:23], v[32:35], 0
    v_mfma_f32_16x16x32_bf16 v[164:167], v[20:23], v[36:39], 0
    s_waitcnt lgkmcnt(8)
    v_mfma_f32_16x16x32_bf16 v[192:195], v[32:35], v[24:27], 0
    v_mfma_f32_16x16x32_bf16 v[196:199], v[36:39], v[24:27], 0
    s_waitcnt lgkmcnt(6)
    v_mfma_f32_16x16x32_bf16 v[224:227], v[32:35], v[28:31], 0
    v_mfma_f32_16x16x32_bf16 v[228:231], v[36:39], v[28:31], 0
    s_waitcnt lgkmcnt(5)
    v_mfma_f32_16x16x32_bf16 v[72:75], v[8:11], v[40:43], 0
    s_waitcnt lgkmcnt(4)
    v_mfma_f32_16x16x32_bf16 v[76:79], v[8:11], v[44:47], 0
    v_mfma_f32_16x16x32_bf16 v[104:107], v[12:15], v[40:43], 0
    v_mfma_f32_16x16x32_bf16 v[108:111], v[12:15], v[44:47], 0
    v_mfma_f32_16x16x32_bf16 v[136:139], v[16:19], v[40:43], 0
    v_mfma_f32_16x16x32_bf16 v[140:143], v[16:19], v[44:47], 0
    v_mfma_f32_16x16x32_bf16 v[168:171], v[20:23], v[40:43], 0
    v_mfma_f32_16x16x32_bf16 v[172:175], v[20:23], v[44:47], 0
    v_mfma_f32_16x16x32_bf16 v[200:203], v[40:43], v[24:27], 0
    v_mfma_f32_16x16x32_bf16 v[204:207], v[44:47], v[24:27], 0
    v_mfma_f32_16x16x32_bf16 v[232:235], v[40:43], v[28:31], 0
    v_mfma_f32_16x16x32_bf16 v[236:239], v[44:47], v[28:31], 0
    s_waitcnt lgkmcnt(3)
    v_mfma_f32_16x16x32_bf16 v[80:83], v[8:11], v[48:51], 0
    s_waitcnt lgkmcnt(2)
    v_mfma_f32_16x16x32_bf16 v[84:87], v[8:11], v[52:55], 0
    v_mfma_f32_16x16x32_bf16 v[112:115], v[12:15], v[48:51], 0
    v_mfma_f32_16x16x32_bf16 v[116:119], v[12:15], v[52:55], 0
    v_mfma_f32_16x16x32_bf16 v[144:147], v[16:19], v[48:51], 0
    v_mfma_f32_16x16x32_bf16 v[148:151], v[16:19], v[52:55], 0
    v_mfma_f32_16x16x32_bf16 v[176:179], v[20:23], v[48:51], 0
    v_mfma_f32_16x16x32_bf16 v[180:183], v[20:23], v[52:55], 0
    v_mfma_f32_16x16x32_bf16 v[208:211], v[48:51], v[24:27], 0
    s_barrier
    v_mfma_f32_16x16x32_bf16 v[212:215], v[52:55], v[24:27], 0
    ds_read_b128 v[32:35], v6 offset:28672
    v_mfma_f32_16x16x32_bf16 v[240:243], v[48:51], v[28:31], 0
    ds_read_b128 v[36:39], v6 offset:29696
    v_mfma_f32_16x16x32_bf16 v[244:247], v[52:55], v[28:31], 0
    ds_read_b128 v[40:43], v6 offset:30720
    s_waitcnt lgkmcnt(4)
    v_mfma_f32_16x16x32_bf16 v[88:91], v[8:11], v[56:59], 0
    ds_read_b128 v[44:47], v6 offset:31744
    s_waitcnt lgkmcnt(4)
    v_mfma_f32_16x16x32_bf16 v[92:95], v[8:11], v[60:63], 0
    v_mfma_f32_16x16x32_bf16 v[120:123], v[12:15], v[56:59], 0
    ds_read_b64_tr_b16 v[8:9], v4 offset:28672
    v_mfma_f32_16x16x32_bf16 v[124:127], v[12:15], v[60:63], 0
    ds_read_b64_tr_b16 v[10:11], v4 offset:29184
    v_mfma_f32_16x16x32_bf16 v[152:155], v[16:19], v[56:59], 0
    ds_read_b64_tr_b16 v[12:13], v5 offset:28672
    v_mfma_f32_16x16x32_bf16 v[156:159], v[16:19], v[60:63], 0
    ds_read_b64_tr_b16 v[14:15], v5 offset:29184
    v_mfma_f32_16x16x32_bf16 v[184:187], v[20:23], v[56:59], 0
    ds_read_b64_tr_b16 v[16:17], v4 offset:32768
    v_mfma_f32_16x16x32_bf16 v[188:191], v[20:23], v[60:63], 0
    ds_read_b64_tr_b16 v[18:19], v4 offset:33280
    v_mfma_f32_16x16x32_bf16 v[216:219], v[56:59], v[24:27], 0
    ds_read_b64_tr_b16 v[20:21], v5 offset:32768
    v_mfma_f32_16x16x32_bf16 v[220:223], v[60:63], v[24:27], 0
    ds_read_b64_tr_b16 v[22:23], v5 offset:33280
    v_mfma_f32_16x16x32_bf16 v[248:251], v[56:59], v[28:31], 0
    ds_read_b64_tr_b16 v[24:25], v4 offset:36864
    v_mfma_f32_16x16x32_bf16 v[252:255], v[60:63], v[28:31], 0
    ds_read_b64_tr_b16 v[26:27], v4 offset:37376
    s_waitcnt lgkmcnt(8)
    v_mfma_f32_16x16x32_bf16 v[64:67], v[8:11], v[32:35], v[64:67]
    ds_read_b64_tr_b16 v[28:29], v5 offset:36864
    v_mfma_f32_16x16x32_bf16 v[68:71], v[8:11], v[36:39], v[68:71]
    ds_read_b64_tr_b16 v[30:31], v5 offset:37376
    s_waitcnt lgkmcnt(8)
    v_mfma_f32_16x16x32_bf16 v[96:99], v[12:15], v[32:35], v[96:99]
    ds_read_b128 v[48:51], v6 offset:32768
    v_mfma_f32_16x16x32_bf16 v[100:103], v[12:15], v[36:39], v[100:103]
    ds_read_b128 v[52:55], v6 offset:33792
    s_waitcnt lgkmcnt(8)
    v_mfma_f32_16x16x32_bf16 v[128:131], v[16:19], v[32:35], v[128:131]
    ds_read_b128 v[56:59], v6 offset:34816
    v_mfma_f32_16x16x32_bf16 v[132:135], v[16:19], v[36:39], v[132:135]
    ds_read_b128 v[60:63], v6 offset:35840
    s_waitcnt lgkmcnt(8)
    v_mfma_f32_16x16x32_bf16 v[160:163], v[20:23], v[32:35], v[160:163]
    v_mfma_f32_16x16x32_bf16 v[164:167], v[20:23], v[36:39], v[164:167]
    s_waitcnt lgkmcnt(6)
    v_mfma_f32_16x16x32_bf16 v[192:195], v[32:35], v[24:27], v[192:195]
    v_mfma_f32_16x16x32_bf16 v[196:199], v[36:39], v[24:27], v[196:199]
    s_waitcnt lgkmcnt(4)
    v_mfma_f32_16x16x32_bf16 v[224:227], v[32:35], v[28:31], v[224:227]
    v_mfma_f32_16x16x32_bf16 v[228:231], v[36:39], v[28:31], v[228:231]
    v_mfma_f32_16x16x32_bf16 v[72:75], v[8:11], v[40:43], v[72:75]
    v_mfma_f32_16x16x32_bf16 v[76:79], v[8:11], v[44:47], v[76:79]
    v_mfma_f32_16x16x32_bf16 v[104:107], v[12:15], v[40:43], v[104:107]
    v_mfma_f32_16x16x32_bf16 v[108:111], v[12:15], v[44:47], v[108:111]
    v_mfma_f32_16x16x32_bf16 v[136:139], v[16:19], v[40:43], v[136:139]
    v_mfma_f32_16x16x32_bf16 v[140:143], v[16:19], v[44:47], v[140:143]
    v_mfma_f32_16x16x32_bf16 v[168:171], v[20:23], v[40:43], v[168:171]
    v_mfma_f32_16x16x32_bf16 v[172:175], v[20:23], v[44:47], v[172:175]
    v_mfma_f32_16x16x32_bf16 v[200:203], v[40:43], v[24:27], v[200:203]
    v_mfma_f32_16x16x32_bf16 v[204:207], v[44:47], v[24:27], v[204:207]
    v_mfma_f32_16x16x32_bf16 v[232:235], v[40:43], v[28:31], v[232:235]
    v_mfma_f32_16x16x32_bf16 v[236:239], v[44:47], v[28:31], v[236:239]
    s_waitcnt lgkmcnt(3)
    v_mfma_f32_16x16x32_bf16 v[80:83], v[8:11], v[48:51], v[80:83]
    s_waitcnt lgkmcnt(2)
    v_mfma_f32_16x16x32_bf16 v[84:87], v[8:11], v[52:55], v[84:87]
    v_mfma_f32_16x16x32_bf16 v[112:115], v[12:15], v[48:51], v[112:115]
    v_mfma_f32_16x16x32_bf16 v[116:119], v[12:15], v[52:55], v[116:119]
    v_mfma_f32_16x16x32_bf16 v[144:147], v[16:19], v[48:51], v[144:147]
    v_mfma_f32_16x16x32_bf16 v[148:151], v[16:19], v[52:55], v[148:151]
    v_mfma_f32_16x16x32_bf16 v[176:179], v[20:23], v[48:51], v[176:179]
    v_mfma_f32_16x16x32_bf16 v[180:183], v[20:23], v[52:55], v[180:183]
    v_mfma_f32_16x16x32_bf16 v[208:211], v[48:51], v[24:27], v[208:211]
    s_barrier
    v_mfma_f32_16x16x32_bf16 v[212:215], v[52:55], v[24:27], v[212:215]
    ds_read_b128 v[32:35], v6 offset:57344
    v_mfma_f32_16x16x32_bf16 v[240:243], v[48:51], v[28:31], v[240:243]
    ds_read_b128 v[36:39], v6 offset:58368
    v_mfma_f32_16x16x32_bf16 v[244:247], v[52:55], v[28:31], v[244:247]
    ds_read_b128 v[40:43], v6 offset:59392
    s_waitcnt lgkmcnt(4)
    v_mfma_f32_16x16x32_bf16 v[88:91], v[8:11], v[56:59], v[88:91]
    ds_read_b128 v[44:47], v6 offset:60416
    s_waitcnt lgkmcnt(4)
    v_mfma_f32_16x16x32_bf16 v[92:95], v[8:11], v[60:63], v[92:95]
    s_mov_b32 s44, 5
g1c_l0:
    v_mfma_f32_16x16x32_bf16 v[120:123], v[12:15], v[56:59], v[120:123]
    ds_read_b64_tr_b16 v[8:9], v2 offset:0
    v_mfma_f32_16x16x32_bf16 v[124:127], v[12:15], v[60:63], v[124:127]
    ds_read_b64_tr_b16 v[10:11], v2 offset:512
    v_mfma_f32_16x16x32_bf16 v[152:155], v[16:19], v[56:59], v[152:155]
    ds_read_b64_tr_b16 v[12:13], v3 offset:0
    v_mfma_f32_16x16x32_bf16 v[156:159], v[16:19], v[60:63], v[156:159]
    ds_read_b64_tr_b16 v[14:15], v3 offset:512
    v_mfma_f32_16x16x32_bf16 v[184:187], v[20:23], v[56:59], v[184:187]
    ds_read_b64_tr_b16 v[16:17], v2 offset:4096
    v_mfma_f32_16x16x32_bf16 v[188:191], v[20:23], v[60:63], v[188:191]
    ds_read_b64_tr_b16 v[18:19], v2 offset:4608
    v_mfma_f32_16x16x32_bf16 v[216:219], v[56:59], v[24:27], v[216:219]
    ds_read_b64_tr_b16 v[20:21], v3 offset:4096
    v_mfma_f32_16x16x32_bf16 v[220:223], v[60:63], v[24:27], v[220:223]
    ds_read_b64_tr_b16 v[22:23], v3 offset:4608
    v_mfma_f32_16x16x32_bf16 v[248:251], v[56:59], v[28:31], v[248:251]
    ds_read_b64_tr_b16 v[24:25], v2 offset:8192
    v_mfma_f32_16x16x32_bf16 v[252:255], v[60:63], v[28:31], v[252:255]
    ds_read_b64_tr_b16 v[26:27], v2 offset:8704
    s_waitcnt lgkmcnt(8)
    v_mfma_f32_16x16x32_bf16 v[64:67], v[8:11], v[32:35], v[64:67]
    ds_read_b64_tr_b16 v[28:29], v3 offset:8192
    v_mfma_f32_16x16x32_bf16 v[68:71], v[8:11], v[36:39], v[68:71]
    ds_read_b64_tr_b16 v[30:31], v3 offset:8704
    s_waitcnt lgkmcnt(8)
    v_mfma_f32_16x16x32_bf16 v[96:99], v[12:15], v[32:35], v[96:99]
    ds_read_b128 v[48:51], v6 offset:61440
    v_mfma_f32_16x16x32_bf16 v[100:103], v[12:15], v[36:39], v[100:103]
    ds_read_b128 v[52:55], v6 offset:62464
    s_waitcnt lgkmcnt(8)
    v_mfma_f32_16x16x32_bf16 v[128:131], v[16:19], v[32:35], v[128:131]
    ds_read_b128 v[56:59], v6 offset:63488
    v_mfma_f32_16x16x32_bf16 v[132:135], v[16:19], v[36:39], v[132:135]
    ds_read_b128 v[60:63], v6 offset:64512
    s_waitcnt lgkmcnt(8)
    v_mfma_f32_16x16x32_bf16 v[160:163], v[20:23], v[32:35], v[160:163]
    v_mfma_f32_16x16x32_bf16 v[164:167], v[20:23], v[36:39], v[164:167]
    s_waitcnt lgkmcnt(6)
    v_mfma_f32_16x16x32_bf16 v[192:195], v[32:35], v[24:27], v[192:195]
    v_mfma_f32_16x16x32_bf16 v[196:199], v[36:39], v[24:27], v[196:199]
    s_waitcnt lgkmcnt(4)
    v_mfma_f32_16x16x32_bf16 v[224:227], v[32:35], v[28:31], v[224:227]
    v_mfma_f32_16x16x32_bf16 v[228:231], v[36:39], v[28:31], v[228:231]
    v_mfma_f32_16x16x32_bf16 v[72:75], v[8:11], v[40:43], v[72:75]
    v_mfma_f32_16x16x32_bf16 v[76:79], v[8:11], v[44:47], v[76:79]
    v_mfma_f32_16x16x32_bf16 v[104:107], v[12:15], v[40:43], v[104:107]
    v_mfma_f32_16x16x32_bf16 v[108:111], v[12:15], v[44:47], v[108:111]
    v_mfma_f32_16x16x32_bf16 v[136:139], v[16:19], v[40:43], v[136:139]
    v_mfma_f32_16x16x32_bf16 v[140:143], v[16:19], v[44:47], v[140:143]
    v_mfma_f32_16x16x32_bf16 v[168:171], v[20:23], v[40:43], v[168:171]
    v_mfma_f32_16x16x32_bf16 v[172:175], v[20:23], v[44:47], v[172:175]
    v_mfma_f32_16x16x32_bf16 v[200:203], v[40:43], v[24:27], v[200:203]
    v_mfma_f32_16x16x32_bf16 v[204:207], v[44:47], v[24:27], v[204:207]
    v_mfma_f32_16x16x32_bf16 v[232:235], v[40:43], v[28:31], v[232:235]
    v_mfma_f32_16x16x32_bf16 v[236:239], v[44:47], v[28:31], v[236:239]
    s_waitcnt lgkmcnt(3)
    v_mfma_f32_16x16x32_bf16 v[80:83], v[8:11], v[48:51], v[80:83]
    s_waitcnt lgkmcnt(2)
    v_mfma_f32_16x16x32_bf16 v[84:87], v[8:11], v[52:55], v[84:87]
    v_mfma_f32_16x16x32_bf16 v[112:115], v[12:15], v[48:51], v[112:115]
    v_mfma_f32_16x16x32_bf16 v[116:119], v[12:15], v[52:55], v[116:119]
    v_mfma_f32_16x16x32_bf16 v[144:147], v[16:19], v[48:51], v[144:147]
    v_mfma_f32_16x16x32_bf16 v[148:151], v[16:19], v[52:55], v[148:151]
    v_mfma_f32_16x16x32_bf16 v[176:179], v[20:23], v[48:51], v[176:179]
    v_mfma_f32_16x16x32_bf16 v[180:183], v[20:23], v[52:55], v[180:183]
    v_mfma_f32_16x16x32_bf16 v[208:211], v[48:51], v[24:27], v[208:211]
    s_barrier
    v_mfma_f32_16x16x32_bf16 v[212:215], v[52:55], v[24:27], v[212:215]
    ds_read_b128 v[32:35], v7 offset:0
    v_mfma_f32_16x16x32_bf16 v[240:243], v[48:51], v[28:31], v[240:243]
    ds_read_b128 v[36:39], v7 offset:1024
    v_mfma_f32_16x16x32_bf16 v[244:247], v[52:55], v[28:31], v[244:247]
    ds_read_b128 v[40:43], v7 offset:2048
    s_waitcnt lgkmcnt(4)
    v_mfma_f32_16x16x32_bf16 v[88:91], v[8:11], v[56:59], v[88:91]
    ds_read_b128 v[44:47], v7 offset:3072
    s_waitcnt lgkmcnt(4)
    v_mfma_f32_16x16x32_bf16 v[92:95], v[8:11], v[60:63], v[92:95]
    v_mfma_f32_16x16x32_bf16 v[120:123], v[12:15], v[56:59], v[120:123]
    ds_read_b64_tr_b16 v[8:9], v2 offset:28672
    v_mfma_f32_16x16x32_bf16 v[124:127], v[12:15], v[60:63], v[124:127]
    ds_read_b64_tr_b16 v[10:11], v2 offset:29184
    v_mfma_f32_16x16x32_bf16 v[152:155], v[16:19], v[56:59], v[152:155]
    ds_read_b64_tr_b16 v[12:13], v3 offset:28672
    v_mfma_f32_16x16x32_bf16 v[156:159], v[16:19], v[60:63], v[156:159]
    ds_read_b64_tr_b16 v[14:15], v3 offset:29184
    v_mfma_f32_16x16x32_bf16 v[184:187], v[20:23], v[56:59], v[184:187]
    ds_read_b64_tr_b16 v[16:17], v2 offset:32768
    v_mfma_f32_16x16x32_bf16 v[188:191], v[20:23], v[60:63], v[188:191]
    ds_read_b64_tr_b16 v[18:19], v2 offset:33280
    v_mfma_f32_16x16x32_bf16 v[216:219], v[56:59], v[24:27], v[216:219]
    ds_read_b64_tr_b16 v[20:21], v3 offset:32768
    v_mfma_f32_16x16x32_bf16 v[220:223], v[60:63], v[24:27], v[220:223]
    ds_read_b64_tr_b16 v[22:23], v3 offset:33280
    v_mfma_f32_16x16x32_bf16 v[248:251], v[56:59], v[28:31], v[248:251]
    ds_read_b64_tr_b16 v[24:25], v2 offset:36864
    v_mfma_f32_16x16x32_bf16 v[252:255], v[60:63], v[28:31], v[252:255]
    ds_read_b64_tr_b16 v[26:27], v2 offset:37376
    s_waitcnt lgkmcnt(8)
    v_mfma_f32_16x16x32_bf16 v[64:67], v[8:11], v[32:35], v[64:67]
    ds_read_b64_tr_b16 v[28:29], v3 offset:36864
    v_mfma_f32_16x16x32_bf16 v[68:71], v[8:11], v[36:39], v[68:71]
    ds_read_b64_tr_b16 v[30:31], v3 offset:37376
    s_waitcnt lgkmcnt(8)
    v_mfma_f32_16x16x32_bf16 v[96:99], v[12:15], v[32:35], v[96:99]
    ds_read_b128 v[48:51], v7 offset:4096
    v_mfma_f32_16x16x32_bf16 v[100:103], v[12:15], v[36:39], v[100:103]
    ds_read_b128 v[52:55], v7 offset:5120
    s_waitcnt lgkmcnt(8)
    v_mfma_f32_16x16x32_bf16 v[128:131], v[16:19], v[32:35], v[128:131]
    ds_read_b128 v[56:59], v7 offset:6144
    v_mfma_f32_16x16x32_bf16 v[132:135], v[16:19], v[36:39], v[132:135]
    ds_read_b128 v[60:63], v7 offset:7168
    s_waitcnt lgkmcnt(8)
    v_mfma_f32_16x16x32_bf16 v[160:163], v[20:23], v[32:35], v[160:163]
    v_mfma_f32_16x16x32_bf16 v[164:167], v[20:23], v[36:39], v[164:167]
    s_waitcnt lgkmcnt(6)
    v_mfma_f32_16x16x32_bf16 v[192:195], v[32:35], v[24:27], v[192:195]
    v_mfma_f32_16x16x32_bf16 v[196:199], v[36:39], v[24:27], v[196:199]
    s_waitcnt lgkmcnt(4)
    v_mfma_f32_16x16x32_bf16 v[224:227], v[32:35], v[28:31], v[224:227]
    v_mfma_f32_16x16x32_bf16 v[228:231], v[36:39], v[28:31], v[228:231]
    v_mfma_f32_16x16x32_bf16 v[72:75], v[8:11], v[40:43], v[72:75]
    v_mfma_f32_16x16x32_bf16 v[76:79], v[8:11], v[44:47], v[76:79]
    v_mfma_f32_16x16x32_bf16 v[104:107], v[12:15], v[40:43], v[104:107]
    v_mfma_f32_16x16x32_bf16 v[108:111], v[12:15], v[44:47], v[108:111]
    v_mfma_f32_16x16x32_bf16 v[136:139], v[16:19], v[40:43], v[136:139]
    v_mfma_f32_16x16x32_bf16 v[140:143], v[16:19], v[44:47], v[140:143]
    v_mfma_f32_16x16x32_bf16 v[168:171], v[20:23], v[40:43], v[168:171]
    v_mfma_f32_16x16x32_bf16 v[172:175], v[20:23], v[44:47], v[172:175]
    v_mfma_f32_16x16x32_bf16 v[200:203], v[40:43], v[24:27], v[200:203]
    v_mfma_f32_16x16x32_bf16 v[204:207], v[44:47], v[24:27], v[204:207]
    v_mfma_f32_16x16x32_bf16 v[232:235], v[40:43], v[28:31], v[232:235]
    v_mfma_f32_16x16x32_bf16 v[236:239], v[44:47], v[28:31], v[236:239]
    s_waitcnt lgkmcnt(3)
    v_mfma_f32_16x16x32_bf16 v[80:83], v[8:11], v[48:51], v[80:83]
    s_waitcnt lgkmcnt(2)
    v_mfma_f32_16x16x32_bf16 v[84:87], v[8:11], v[52:55], v[84:87]
    v_mfma_f32_16x16x32_bf16 v[112:115], v[12:15], v[48:51], v[112:115]
    v_mfma_f32_16x16x32_bf16 v[116:119], v[12:15], v[52:55], v[116:119]
    v_mfma_f32_16x16x32_bf16 v[144:147], v[16:19], v[48:51], v[144:147]
    v_mfma_f32_16x16x32_bf16 v[148:151], v[16:19], v[52:55], v[148:151]
    v_mfma_f32_16x16x32_bf16 v[176:179], v[20:23], v[48:51], v[176:179]
    v_mfma_f32_16x16x32_bf16 v[180:183], v[20:23], v[52:55], v[180:183]
    v_mfma_f32_16x16x32_bf16 v[208:211], v[48:51], v[24:27], v[208:211]
    s_barrier
    v_mfma_f32_16x16x32_bf16 v[212:215], v[52:55], v[24:27], v[212:215]
    ds_read_b128 v[32:35], v7 offset:28672
    v_mfma_f32_16x16x32_bf16 v[240:243], v[48:51], v[28:31], v[240:243]
    ds_read_b128 v[36:39], v7 offset:29696
    v_mfma_f32_16x16x32_bf16 v[244:247], v[52:55], v[28:31], v[244:247]
    ds_read_b128 v[40:43], v7 offset:30720
    s_waitcnt lgkmcnt(4)
    v_mfma_f32_16x16x32_bf16 v[88:91], v[8:11], v[56:59], v[88:91]
    ds_read_b128 v[44:47], v7 offset:31744
    s_waitcnt lgkmcnt(4)
    v_mfma_f32_16x16x32_bf16 v[92:95], v[8:11], v[60:63], v[92:95]
    v_mfma_f32_16x16x32_bf16 v[120:123], v[12:15], v[56:59], v[120:123]
    ds_read_b64_tr_b16 v[8:9], v0 offset:0
    v_mfma_f32_16x16x32_bf16 v[124:127], v[12:15], v[60:63], v[124:127]
    ds_read_b64_tr_b16 v[10:11], v0 offset:512
    v_mfma_f32_16x16x32_bf16 v[152:155], v[16:19], v[56:59], v[152:155]
    ds_read_b64_tr_b16 v[12:13], v1 offset:0
    v_mfma_f32_16x16x32_bf16 v[156:159], v[16:19], v[60:63], v[156:159]
    ds_read_b64_tr_b16 v[14:15], v1 offset:512
    v_mfma_f32_16x16x32_bf16 v[184:187], v[20:23], v[56:59], v[184:187]
    ds_read_b64_tr_b16 v[16:17], v0 offset:4096
    v_mfma_f32_16x16x32_bf16 v[188:191], v[20:23], v[60:63], v[188:191]
    ds_read_b64_tr_b16 v[18:19], v0 offset:4608
    v_mfma_f32_16x16x32_bf16 v[216:219], v[56:59], v[24:27], v[216:219]
    ds_read_b64_tr_b16 v[20:21], v1 offset:4096
    v_mfma_f32_16x16x32_bf16 v[220:223], v[60:63], v[24:27], v[220:223]
    ds_read_b64_tr_b16 v[22:23], v1 offset:4608
    v_mfma_f32_16x16x32_bf16 v[248:251], v[56:59], v[28:31], v[248:251]
    ds_read_b64_tr_b16 v[24:25], v0 offset:8192
    v_mfma_f32_16x16x32_bf16 v[252:255], v[60:63], v[28:31], v[252:255]
    ds_read_b64_tr_b16 v[26:27], v0 offset:8704
    s_waitcnt lgkmcnt(8)
    v_mfma_f32_16x16x32_bf16 v[64:67], v[8:11], v[32:35], v[64:67]
    ds_read_b64_tr_b16 v[28:29], v1 offset:8192
    v_mfma_f32_16x16x32_bf16 v[68:71], v[8:11], v[36:39], v[68:71]
    ds_read_b64_tr_b16 v[30:31], v1 offset:8704
    s_waitcnt lgkmcnt(8)
    v_mfma_f32_16x16x32_bf16 v[96:99], v[12:15], v[32:35], v[96:99]
    ds_read_b128 v[48:51], v7 offset:32768
    v_mfma_f32_16x16x32_bf16 v[100:103], v[12:15], v[36:39], v[100:103]
    ds_read_b128 v[52:55], v7 offset:33792
    s_waitcnt lgkmcnt(8)
    v_mfma_f32_16x16x32_bf16 v[128:131], v[16:19], v[32:35], v[128:131]
    ds_read_b128 v[56:59], v7 offset:34816
    v_mfma_f32_16x16x32_bf16 v[132:135], v[16:19], v[36:39], v[132:135]
    ds_read_b128 v[60:63], v7 offset:35840
    s_waitcnt lgkmcnt(8)
    v_mfma_f32_16x16x32_bf16 v[160:163], v[20:23], v[32:35], v[160:163]
    v_mfma_f32_16x16x32_bf16 v[164:167], v[20:23], v[36:39], v[164:167]
    s_waitcnt lgkmcnt(6)
    v_mfma_f32_16x16x32_bf16 v[192:195], v[32:35], v[24:27], v[192:195]
    v_mfma_f32_16x16x32_bf16 v[196:199], v[36:39], v[24:27], v[196:199]
    s_waitcnt lgkmcnt(4)
    v_mfma_f32_16x16x32_bf16 v[224:227], v[32:35], v[28:31], v[224:227]
    v_mfma_f32_16x16x32_bf16 v[228:231], v[36:39], v[28:31], v[228:231]
    v_mfma_f32_16x16x32_bf16 v[72:75], v[8:11], v[40:43], v[72:75]
    v_mfma_f32_16x16x32_bf16 v[76:79], v[8:11], v[44:47], v[76:79]
    v_mfma_f32_16x16x32_bf16 v[104:107], v[12:15], v[40:43], v[104:107]
    v_mfma_f32_16x16x32_bf16 v[108:111], v[12:15], v[44:47], v[108:111]
    v_mfma_f32_16x16x32_bf16 v[136:139], v[16:19], v[40:43], v[136:139]
    v_mfma_f32_16x16x32_bf16 v[140:143], v[16:19], v[44:47], v[140:143]
    v_mfma_f32_16x16x32_bf16 v[168:171], v[20:23], v[40:43], v[168:171]
    v_mfma_f32_16x16x32_bf16 v[172:175], v[20:23], v[44:47], v[172:175]
    v_mfma_f32_16x16x32_bf16 v[200:203], v[40:43], v[24:27], v[200:203]
    v_mfma_f32_16x16x32_bf16 v[204:207], v[44:47], v[24:27], v[204:207]
    v_mfma_f32_16x16x32_bf16 v[232:235], v[40:43], v[28:31], v[232:235]
    v_mfma_f32_16x16x32_bf16 v[236:239], v[44:47], v[28:31], v[236:239]
    s_waitcnt lgkmcnt(3)
    v_mfma_f32_16x16x32_bf16 v[80:83], v[8:11], v[48:51], v[80:83]
    s_waitcnt lgkmcnt(2)
    v_mfma_f32_16x16x32_bf16 v[84:87], v[8:11], v[52:55], v[84:87]
    v_mfma_f32_16x16x32_bf16 v[112:115], v[12:15], v[48:51], v[112:115]
    v_mfma_f32_16x16x32_bf16 v[116:119], v[12:15], v[52:55], v[116:119]
    v_mfma_f32_16x16x32_bf16 v[144:147], v[16:19], v[48:51], v[144:147]
    v_mfma_f32_16x16x32_bf16 v[148:151], v[16:19], v[52:55], v[148:151]
    v_mfma_f32_16x16x32_bf16 v[176:179], v[20:23], v[48:51], v[176:179]
    v_mfma_f32_16x16x32_bf16 v[180:183], v[20:23], v[52:55], v[180:183]
    v_mfma_f32_16x16x32_bf16 v[208:211], v[48:51], v[24:27], v[208:211]
    s_barrier
    v_mfma_f32_16x16x32_bf16 v[212:215], v[52:55], v[24:27], v[212:215]
    ds_read_b128 v[32:35], v6 offset:0
    v_mfma_f32_16x16x32_bf16 v[240:243], v[48:51], v[28:31], v[240:243]
    ds_read_b128 v[36:39], v6 offset:1024
    v_mfma_f32_16x16x32_bf16 v[244:247], v[52:55], v[28:31], v[244:247]
    ds_read_b128 v[40:43], v6 offset:2048
    s_waitcnt lgkmcnt(4)
    v_mfma_f32_16x16x32_bf16 v[88:91], v[8:11], v[56:59], v[88:91]
    ds_read_b128 v[44:47], v6 offset:3072
    s_waitcnt lgkmcnt(4)
    v_mfma_f32_16x16x32_bf16 v[92:95], v[8:11], v[60:63], v[92:95]
    v_mfma_f32_16x16x32_bf16 v[120:123], v[12:15], v[56:59], v[120:123]
    ds_read_b64_tr_b16 v[8:9], v4 offset:0
    v_mfma_f32_16x16x32_bf16 v[124:127], v[12:15], v[60:63], v[124:127]
    ds_read_b64_tr_b16 v[10:11], v4 offset:512
    v_mfma_f32_16x16x32_bf16 v[152:155], v[16:19], v[56:59], v[152:155]
    ds_read_b64_tr_b16 v[12:13], v5 offset:0
    v_mfma_f32_16x16x32_bf16 v[156:159], v[16:19], v[60:63], v[156:159]
    ds_read_b64_tr_b16 v[14:15], v5 offset:512
    v_mfma_f32_16x16x32_bf16 v[184:187], v[20:23], v[56:59], v[184:187]
    ds_read_b64_tr_b16 v[16:17], v4 offset:4096
    v_mfma_f32_16x16x32_bf16 v[188:191], v[20:23], v[60:63], v[188:191]
    ds_read_b64_tr_b16 v[18:19], v4 offset:4608
    v_mfma_f32_16x16x32_bf16 v[216:219], v[56:59], v[24:27], v[216:219]
    ds_read_b64_tr_b16 v[20:21], v5 offset:4096
    v_mfma_f32_16x16x32_bf16 v[220:223], v[60:63], v[24:27], v[220:223]
    ds_read_b64_tr_b16 v[22:23], v5 offset:4608
    v_mfma_f32_16x16x32_bf16 v[248:251], v[56:59], v[28:31], v[248:251]
    ds_read_b64_tr_b16 v[24:25], v4 offset:8192
    v_mfma_f32_16x16x32_bf16 v[252:255], v[60:63], v[28:31], v[252:255]
    ds_read_b64_tr_b16 v[26:27], v4 offset:8704
    s_waitcnt lgkmcnt(8)
    v_mfma_f32_16x16x32_bf16 v[64:67], v[8:11], v[32:35], v[64:67]
    ds_read_b64_tr_b16 v[28:29], v5 offset:8192
    v_mfma_f32_16x16x32_bf16 v[68:71], v[8:11], v[36:39], v[68:71]
    ds_read_b64_tr_b16 v[30:31], v5 offset:8704
    s_waitcnt lgkmcnt(8)
    v_mfma_f32_16x16x32_bf16 v[96:99], v[12:15], v[32:35], v[96:99]
    ds_read_b128 v[48:51], v6 offset:4096
    v_mfma_f32_16x16x32_bf16 v[100:103], v[12:15], v[36:39], v[100:103]
    ds_read_b128 v[52:55], v6 offset:5120
    s_waitcnt lgkmcnt(8)
    v_mfma_f32_16x16x32_bf16 v[128:131], v[16:19], v[32:35], v[128:131]
    ds_read_b128 v[56:59], v6 offset:6144
    v_mfma_f32_16x16x32_bf16 v[132:135], v[16:19], v[36:39], v[132:135]
    ds_read_b128 v[60:63], v6 offset:7168
    s_waitcnt lgkmcnt(8)
    v_mfma_f32_16x16x32_bf16 v[160:163], v[20:23], v[32:35], v[160:163]
    v_mfma_f32_16x16x32_bf16 v[164:167], v[20:23], v[36:39], v[164:167]
    s_waitcnt lgkmcnt(6)
    v_mfma_f32_16x16x32_bf16 v[192:195], v[32:35], v[24:27], v[192:195]
    v_mfma_f32_16x16x32_bf16 v[196:199], v[36:39], v[24:27], v[196:199]
    s_waitcnt lgkmcnt(4)
    v_mfma_f32_16x16x32_bf16 v[224:227], v[32:35], v[28:31], v[224:227]
    v_mfma_f32_16x16x32_bf16 v[228:231], v[36:39], v[28:31], v[228:231]
    v_mfma_f32_16x16x32_bf16 v[72:75], v[8:11], v[40:43], v[72:75]
    v_mfma_f32_16x16x32_bf16 v[76:79], v[8:11], v[44:47], v[76:79]
    v_mfma_f32_16x16x32_bf16 v[104:107], v[12:15], v[40:43], v[104:107]
    v_mfma_f32_16x16x32_bf16 v[108:111], v[12:15], v[44:47], v[108:111]
    v_mfma_f32_16x16x32_bf16 v[136:139], v[16:19], v[40:43], v[136:139]
    v_mfma_f32_16x16x32_bf16 v[140:143], v[16:19], v[44:47], v[140:143]
    v_mfma_f32_16x16x32_bf16 v[168:171], v[20:23], v[40:43], v[168:171]
    v_mfma_f32_16x16x32_bf16 v[172:175], v[20:23], v[44:47], v[172:175]
    v_mfma_f32_16x16x32_bf16 v[200:203], v[40:43], v[24:27], v[200:203]
    v_mfma_f32_16x16x32_bf16 v[204:207], v[44:47], v[24:27], v[204:207]
    v_mfma_f32_16x16x32_bf16 v[232:235], v[40:43], v[28:31], v[232:235]
    v_mfma_f32_16x16x32_bf16 v[236:239], v[44:47], v[28:31], v[236:239]
    s_waitcnt lgkmcnt(3)
    v_mfma_f32_16x16x32_bf16 v[80:83], v[8:11], v[48:51], v[80:83]
    s_waitcnt lgkmcnt(2)
    v_mfma_f32_16x16x32_bf16 v[84:87], v[8:11], v[52:55], v[84:87]
    v_mfma_f32_16x16x32_bf16 v[112:115], v[12:15], v[48:51], v[112:115]
    v_mfma_f32_16x16x32_bf16 v[116:119], v[12:15], v[52:55], v[116:119]
    v_mfma_f32_16x16x32_bf16 v[144:147], v[16:19], v[48:51], v[144:147]
    v_mfma_f32_16x16x32_bf16 v[148:151], v[16:19], v[52:55], v[148:151]
    v_mfma_f32_16x16x32_bf16 v[176:179], v[20:23], v[48:51], v[176:179]
    v_mfma_f32_16x16x32_bf16 v[180:183], v[20:23], v[52:55], v[180:183]
    v_mfma_f32_16x16x32_bf16 v[208:211], v[48:51], v[24:27], v[208:211]
    s_barrier
    v_mfma_f32_16x16x32_bf16 v[212:215], v[52:55], v[24:27], v[212:215]
    ds_read_b128 v[32:35], v6 offset:28672
    v_mfma_f32_16x16x32_bf16 v[240:243], v[48:51], v[28:31], v[240:243]
    ds_read_b128 v[36:39], v6 offset:29696
    v_mfma_f32_16x16x32_bf16 v[244:247], v[52:55], v[28:31], v[244:247]
    ds_read_b128 v[40:43], v6 offset:30720
    s_waitcnt lgkmcnt(4)
    v_mfma_f32_16x16x32_bf16 v[88:91], v[8:11], v[56:59], v[88:91]
    ds_read_b128 v[44:47], v6 offset:31744
    s_waitcnt lgkmcnt(4)
    v_mfma_f32_16x16x32_bf16 v[92:95], v[8:11], v[60:63], v[92:95]
    v_mfma_f32_16x16x32_bf16 v[120:123], v[12:15], v[56:59], v[120:123]
    ds_read_b64_tr_b16 v[8:9], v4 offset:28672
    v_mfma_f32_16x16x32_bf16 v[124:127], v[12:15], v[60:63], v[124:127]
    ds_read_b64_tr_b16 v[10:11], v4 offset:29184
    v_mfma_f32_16x16x32_bf16 v[152:155], v[16:19], v[56:59], v[152:155]
    ds_read_b64_tr_b16 v[12:13], v5 offset:28672
    v_mfma_f32_16x16x32_bf16 v[156:159], v[16:19], v[60:63], v[156:159]
    ds_read_b64_tr_b16 v[14:15], v5 offset:29184
    v_mfma_f32_16x16x32_bf16 v[184:187], v[20:23], v[56:59], v[184:187]
    ds_read_b64_tr_b16 v[16:17], v4 offset:32768
    v_mfma_f32_16x16x32_bf16 v[188:191], v[20:23], v[60:63], v[188:191]
    ds_read_b64_tr_b16 v[18:19], v4 offset:33280
    v_mfma_f32_16x16x32_bf16 v[216:219], v[56:59], v[24:27], v[216:219]
    ds_read_b64_tr_b16 v[20:21], v5 offset:32768
    v_mfma_f32_16x16x32_bf16 v[220:223], v[60:63], v[24:27], v[220:223]
    ds_read_b64_tr_b16 v[22:23], v5 offset:33280
    v_mfma_f32_16x16x32_bf16 v[248:251], v[56:59], v[28:31], v[248:251]
    ds_read_b64_tr_b16 v[24:25], v4 offset:36864
    v_mfma_f32_16x16x32_bf16 v[252:255], v[60:63], v[28:31], v[252:255]
    ds_read_b64_tr_b16 v[26:27], v4 offset:37376
    s_waitcnt lgkmcnt(8)
    v_mfma_f32_16x16x32_bf16 v[64:67], v[8:11], v[32:35], v[64:67]
    ds_read_b64_tr_b16 v[28:29], v5 offset:36864
    v_mfma_f32_16x16x32_bf16 v[68:71], v[8:11], v[36:39], v[68:71]
    ds_read_b64_tr_b16 v[30:31], v5 offset:37376
    s_waitcnt lgkmcnt(8)
    v_mfma_f32_16x16x32_bf16 v[96:99], v[12:15], v[32:35], v[96:99]
    ds_read_b128 v[48:51], v6 offset:32768
    v_mfma_f32_16x16x32_bf16 v[100:103], v[12:15], v[36:39], v[100:103]
    ds_read_b128 v[52:55], v6 offset:33792
    s_waitcnt lgkmcnt(8)
    v_mfma_f32_16x16x32_bf16 v[128:131], v[16:19], v[32:35], v[128:131]
    ds_read_b128 v[56:59], v6 offset:34816
    v_mfma_f32_16x16x32_bf16 v[132:135], v[16:19], v[36:39], v[132:135]
    ds_read_b128 v[60:63], v6 offset:35840
    s_waitcnt lgkmcnt(8)
    v_mfma_f32_16x16x32_bf16 v[160:163], v[20:23], v[32:35], v[160:163]
    v_mfma_f32_16x16x32_bf16 v[164:167], v[20:23], v[36:39], v[164:167]
    s_waitcnt lgkmcnt(6)
    v_mfma_f32_16x16x32_bf16 v[192:195], v[32:35], v[24:27], v[192:195]
    v_mfma_f32_16x16x32_bf16 v[196:199], v[36:39], v[24:27], v[196:199]
    s_waitcnt lgkmcnt(4)
    v_mfma_f32_16x16x32_bf16 v[224:227], v[32:35], v[28:31], v[224:227]
    v_mfma_f32_16x16x32_bf16 v[228:231], v[36:39], v[28:31], v[228:231]
    v_mfma_f32_16x16x32_bf16 v[72:75], v[8:11], v[40:43], v[72:75]
    v_mfma_f32_16x16x32_bf16 v[76:79], v[8:11], v[44:47], v[76:79]
    v_mfma_f32_16x16x32_bf16 v[104:107], v[12:15], v[40:43], v[104:107]
    v_mfma_f32_16x16x32_bf16 v[108:111], v[12:15], v[44:47], v[108:111]
    v_mfma_f32_16x16x32_bf16 v[136:139], v[16:19], v[40:43], v[136:139]
    v_mfma_f32_16x16x32_bf16 v[140:143], v[16:19], v[44:47], v[140:143]
    v_mfma_f32_16x16x32_bf16 v[168:171], v[20:23], v[40:43], v[168:171]
    v_mfma_f32_16x16x32_bf16 v[172:175], v[20:23], v[44:47], v[172:175]
    v_mfma_f32_16x16x32_bf16 v[200:203], v[40:43], v[24:27], v[200:203]
    v_mfma_f32_16x16x32_bf16 v[204:207], v[44:47], v[24:27], v[204:207]
    v_mfma_f32_16x16x32_bf16 v[232:235], v[40:43], v[28:31], v[232:235]
    v_mfma_f32_16x16x32_bf16 v[236:239], v[44:47], v[28:31], v[236:239]
    s_waitcnt lgkmcnt(3)
    v_mfma_f32_16x16x32_bf16 v[80:83], v[8:11], v[48:51], v[80:83]
    s_waitcnt lgkmcnt(2)
    v_mfma_f32_16x16x32_bf16 v[84:87], v[8:11], v[52:55], v[84:87]
    v_mfma_f32_16x16x32_bf16 v[112:115], v[12:15], v[48:51], v[112:115]
    v_mfma_f32_16x16x32_bf16 v[116:119], v[12:15], v[52:55], v[116:119]
    v_mfma_f32_16x16x32_bf16 v[144:147], v[16:19], v[48:51], v[144:147]
    v_mfma_f32_16x16x32_bf16 v[148:151], v[16:19], v[52:55], v[148:151]
    v_mfma_f32_16x16x32_bf16 v[176:179], v[20:23], v[48:51], v[176:179]
    v_mfma_f32_16x16x32_bf16 v[180:183], v[20:23], v[52:55], v[180:183]
    v_mfma_f32_16x16x32_bf16 v[208:211], v[48:51], v[24:27], v[208:211]
    s_barrier
    v_mfma_f32_16x16x32_bf16 v[212:215], v[52:55], v[24:27], v[212:215]
    ds_read_b128 v[32:35], v6 offset:57344
    v_mfma_f32_16x16x32_bf16 v[240:243], v[48:51], v[28:31], v[240:243]
    ds_read_b128 v[36:39], v6 offset:58368
    v_mfma_f32_16x16x32_bf16 v[244:247], v[52:55], v[28:31], v[244:247]
    ds_read_b128 v[40:43], v6 offset:59392
    s_waitcnt lgkmcnt(4)
    s_sub_u32 s44, s44, 1
    v_mfma_f32_16x16x32_bf16 v[88:91], v[8:11], v[56:59], v[88:91]
    ds_read_b128 v[44:47], v6 offset:60416
    s_waitcnt lgkmcnt(4)
    s_cmp_lg_u32 s44, 0
    v_mfma_f32_16x16x32_bf16 v[92:95], v[8:11], v[60:63], v[92:95]
    s_cbranch_scc1 g1c_l0
    v_mfma_f32_16x16x32_bf16 v[120:123], v[12:15], v[56:59], v[120:123]
    ds_read_b64_tr_b16 v[8:9], v2 offset:0
    v_mfma_f32_16x16x32_bf16 v[124:127], v[12:15], v[60:63], v[124:127]
    ds_read_b64_tr_b16 v[10:11], v2 offset:512
    v_mfma_f32_16x16x32_bf16 v[152:155], v[16:19], v[56:59], v[152:155]
    ds_read_b64_tr_b16 v[12:13], v3 offset:0
    v_mfma_f32_16x16x32_bf16 v[156:159], v[16:19], v[60:63], v[156:159]
    ds_read_b64_tr_b16 v[14:15], v3 offset:512
    v_mfma_f32_16x16x32_bf16 v[184:187], v[20:23], v[56:59], v[184:187]
    ds_read_b64_tr_b16 v[16:17], v2 offset:4096
    v_mfma_f32_16x16x32_bf16 v[188:191], v[20:23], v[60:63], v[188:191]
    ds_read_b64_tr_b16 v[18:19], v2 offset:4608
    v_mfma_f32_16x16x32_bf16 v[216:219], v[56:59], v[24:27], v[216:219]
    ds_read_b64_tr_b16 v[20:21], v3 offset:4096
    v_mfma_f32_16x16x32_bf16 v[220:223], v[60:63], v[24:27], v[220:223]
    ds_read_b64_tr_b16 v[22:23], v3 offset:4608
    v_mfma_f32_16x16x32_bf16 v[248:251], v[56:59], v[28:31], v[248:251]
    ds_read_b64_tr_b16 v[24:25], v2 offset:8192
    v_mfma_f32_16x16x32_bf16 v[252:255], v[60:63], v[28:31], v[252:255]
    ds_read_b64_tr_b16 v[26:27], v2 offset:8704
    s_waitcnt lgkmcnt(8)
    v_mfma_f32_16x16x32_bf16 v[64:67], v[8:11], v[32:35], v[64:67]
    ds_read_b64_tr_b16 v[28:29], v3 offset:8192
    v_mfma_f32_16x16x32_bf16 v[68:71], v[8:11], v[36:39], v[68:71]
    ds_read_b64_tr_b16 v[30:31], v3 offset:8704
    s_waitcnt lgkmcnt(8)
    v_mfma_f32_16x16x32_bf16 v[96:99], v[12:15], v[32:35], v[96:99]
    ds_read_b128 v[48:51], v6 offset:61440
    v_mfma_f32_16x16x32_bf16 v[100:103], v[12:15], v[36:39], v[100:103]
    ds_read_b128 v[52:55], v6 offset:62464
    s_waitcnt lgkmcnt(8)
    v_mfma_f32_16x16x32_bf16 v[128:131], v[16:19], v[32:35], v[128:131]
    ds_read_b128 v[56:59], v6 offset:63488
    v_mfma_f32_16x16x32_bf16 v[132:135], v[16:19], v[36:39], v[132:135]
    ds_read_b128 v[60:63], v6 offset:64512
    s_waitcnt lgkmcnt(8)
    v_mfma_f32_16x16x32_bf16 v[160:163], v[20:23], v[32:35], v[160:163]
    v_mfma_f32_16x16x32_bf16 v[164:167], v[20:23], v[36:39], v[164:167]
    s_waitcnt lgkmcnt(6)
    v_mfma_f32_16x16x32_bf16 v[192:195], v[32:35], v[24:27], v[192:195]
    v_mfma_f32_16x16x32_bf16 v[196:199], v[36:39], v[24:27], v[196:199]
    s_waitcnt lgkmcnt(4)
    v_mfma_f32_16x16x32_bf16 v[224:227], v[32:35], v[28:31], v[224:227]
    v_mfma_f32_16x16x32_bf16 v[228:231], v[36:39], v[28:31], v[228:231]
    v_mfma_f32_16x16x32_bf16 v[72:75], v[8:11], v[40:43], v[72:75]
    v_mfma_f32_16x16x32_bf16 v[76:79], v[8:11], v[44:47], v[76:79]
    v_mfma_f32_16x16x32_bf16 v[104:107], v[12:15], v[40:43], v[104:107]
    v_mfma_f32_16x16x32_bf16 v[108:111], v[12:15], v[44:47], v[108:111]
    v_mfma_f32_16x16x32_bf16 v[136:139], v[16:19], v[40:43], v[136:139]
    v_mfma_f32_16x16x32_bf16 v[140:143], v[16:19], v[44:47], v[140:143]
    v_mfma_f32_16x16x32_bf16 v[168:171], v[20:23], v[40:43], v[168:171]
    v_mfma_f32_16x16x32_bf16 v[172:175], v[20:23], v[44:47], v[172:175]
    v_mfma_f32_16x16x32_bf16 v[200:203], v[40:43], v[24:27], v[200:203]
    v_mfma_f32_16x16x32_bf16 v[204:207], v[44:47], v[24:27], v[204:207]
    v_mfma_f32_16x16x32_bf16 v[232:235], v[40:43], v[28:31], v[232:235]
    v_mfma_f32_16x16x32_bf16 v[236:239], v[44:47], v[28:31], v[236:239]
    s_waitcnt lgkmcnt(3)
    v_mfma_f32_16x16x32_bf16 v[80:83], v[8:11], v[48:51], v[80:83]
    s_waitcnt lgkmcnt(2)
    v_mfma_f32_16x16x32_bf16 v[84:87], v[8:11], v[52:55], v[84:87]
    v_mfma_f32_16x16x32_bf16 v[112:115], v[12:15], v[48:51], v[112:115]
    v_mfma_f32_16x16x32_bf16 v[116:119], v[12:15], v[52:55], v[116:119]
    v_mfma_f32_16x16x32_bf16 v[144:147], v[16:19], v[48:51], v[144:147]
    v_mfma_f32_16x16x32_bf16 v[148:151], v[16:19], v[52:55], v[148:151]
    v_mfma_f32_16x16x32_bf16 v[176:179], v[20:23], v[48:51], v[176:179]
    v_mfma_f32_16x16x32_bf16 v[180:183], v[20:23], v[52:55], v[180:183]
    v_mfma_f32_16x16x32_bf16 v[208:211], v[48:51], v[24:27], v[208:211]
    s_barrier
    v_mfma_f32_16x16x32_bf16 v[212:215], v[52:55], v[24:27], v[212:215]
    ds_read_b128 v[32:35], v7 offset:0
    v_mfma_f32_16x16x32_bf16 v[240:243], v[48:51], v[28:31], v[240:243]
    ds_read_b128 v[36:39], v7 offset:1024
    v_mfma_f32_16x16x32_bf16 v[244:247], v[52:55], v[28:31], v[244:247]
    ds_read_b128 v[40:43], v7 offset:2048
    s_waitcnt lgkmcnt(4)
    v_mfma_f32_16x16x32_bf16 v[88:91], v[8:11], v[56:59], v[88:91]
    ds_read_b128 v[44:47], v7 offset:3072
    s_waitcnt lgkmcnt(4)
    v_mfma_f32_16x16x32_bf16 v[92:95], v[8:11], v[60:63], v[92:95]
    v_mfma_f32_16x16x32_bf16 v[120:123], v[12:15], v[56:59], v[120:123]
    ds_read_b64_tr_b16 v[8:9], v2 offset:28672
    v_mfma_f32_16x16x32_bf16 v[124:127], v[12:15], v[60:63], v[124:127]
    ds_read_b64_tr_b16 v[10:11], v2 offset:29184
    v_mfma_f32_16x16x32_bf16 v[152:155], v[16:19], v[56:59], v[152:155]
    ds_read_b64_tr_b16 v[12:13], v3 offset:28672
    v_mfma_f32_16x16x32_bf16 v[156:159], v[16:19], v[60:63], v[156:159]
    ds_read_b64_tr_b16 v[14:15], v3 offset:29184
    v_mfma_f32_16x16x32_bf16 v[184:187], v[20:23], v[56:59], v[184:187]
    ds_read_b64_tr_b16 v[16:17], v2 offset:32768
    v_mfma_f32_16x16x32_bf16 v[188:191], v[20:23], v[60:63], v[188:191]
    ds_read_b64_tr_b16 v[18:19], v2 offset:33280
    v_mfma_f32_16x16x32_bf16 v[216:219], v[56:59], v[24:27], v[216:219]
    ds_read_b64_tr_b16 v[20:21], v3 offset:32768
    v_mfma_f32_16x16x32_bf16 v[220:223], v[60:63], v[24:27], v[220:223]
    ds_read_b64_tr_b16 v[22:23], v3 offset:33280
    v_mfma_f32_16x16x32_bf16 v[248:251], v[56:59], v[28:31], v[248:251]
    ds_read_b64_tr_b16 v[24:25], v2 offset:36864
    v_mfma_f32_16x16x32_bf16 v[252:255], v[60:63], v[28:31], v[252:255]
    ds_read_b64_tr_b16 v[26:27], v2 offset:37376
    s_waitcnt lgkmcnt(8)
    v_mfma_f32_16x16x32_bf16 v[64:67], v[8:11], v[32:35], v[64:67]
    ds_read_b64_tr_b16 v[28:29], v3 offset:36864
    v_mfma_f32_16x16x32_bf16 v[68:71], v[8:11], v[36:39], v[68:71]
    ds_read_b64_tr_b16 v[30:31], v3 offset:37376
    s_waitcnt lgkmcnt(8)
    v_mfma_f32_16x16x32_bf16 v[96:99], v[12:15], v[32:35], v[96:99]
    ds_read_b128 v[48:51], v7 offset:4096
    v_mfma_f32_16x16x32_bf16 v[100:103], v[12:15], v[36:39], v[100:103]
    ds_read_b128 v[52:55], v7 offset:5120
    s_waitcnt lgkmcnt(8)
    v_mfma_f32_16x16x32_bf16 v[128:131], v[16:19], v[32:35], v[128:131]
    ds_read_b128 v[56:59], v7 offset:6144
    v_mfma_f32_16x16x32_bf16 v[132:135], v[16:19], v[36:39], v[132:135]
    ds_read_b128 v[60:63], v7 offset:7168
    s_waitcnt lgkmcnt(8)
    v_mfma_f32_16x16x32_bf16 v[160:163], v[20:23], v[32:35], v[160:163]
    v_mfma_f32_16x16x32_bf16 v[164:167], v[20:23], v[36:39], v[164:167]
    s_waitcnt lgkmcnt(6)
    v_mfma_f32_16x16x32_bf16 v[192:195], v[32:35], v[24:27], v[192:195]
    v_mfma_f32_16x16x32_bf16 v[196:199], v[36:39], v[24:27], v[196:199]
    s_waitcnt lgkmcnt(4)
    v_mfma_f32_16x16x32_bf16 v[224:227], v[32:35], v[28:31], v[224:227]
    v_mfma_f32_16x16x32_bf16 v[228:231], v[36:39], v[28:31], v[228:231]
    v_mfma_f32_16x16x32_bf16 v[72:75], v[8:11], v[40:43], v[72:75]
    v_mfma_f32_16x16x32_bf16 v[76:79], v[8:11], v[44:47], v[76:79]
    v_mfma_f32_16x16x32_bf16 v[104:107], v[12:15], v[40:43], v[104:107]
    v_mfma_f32_16x16x32_bf16 v[108:111], v[12:15], v[44:47], v[108:111]
    v_mfma_f32_16x16x32_bf16 v[136:139], v[16:19], v[40:43], v[136:139]
    v_mfma_f32_16x16x32_bf16 v[140:143], v[16:19], v[44:47], v[140:143]
    v_mfma_f32_16x16x32_bf16 v[168:171], v[20:23], v[40:43], v[168:171]
    v_mfma_f32_16x16x32_bf16 v[172:175], v[20:23], v[44:47], v[172:175]
    v_mfma_f32_16x16x32_bf16 v[200:203], v[40:43], v[24:27], v[200:203]
    v_mfma_f32_16x16x32_bf16 v[204:207], v[44:47], v[24:27], v[204:207]
    v_mfma_f32_16x16x32_bf16 v[232:235], v[40:43], v[28:31], v[232:235]
    v_mfma_f32_16x16x32_bf16 v[236:239], v[44:47], v[28:31], v[236:239]
    s_waitcnt lgkmcnt(3)
    v_mfma_f32_16x16x32_bf16 v[80:83], v[8:11], v[48:51], v[80:83]
    s_waitcnt lgkmcnt(2)
    v_mfma_f32_16x16x32_bf16 v[84:87], v[8:11], v[52:55], v[84:87]
    v_mfma_f32_16x16x32_bf16 v[112:115], v[12:15], v[48:51], v[112:115]
    v_mfma_f32_16x16x32_bf16 v[116:119], v[12:15], v[52:55], v[116:119]
    v_mfma_f32_16x16x32_bf16 v[144:147], v[16:19], v[48:51], v[144:147]
    v_mfma_f32_16x16x32_bf16 v[148:151], v[16:19], v[52:55], v[148:151]
    v_mfma_f32_16x16x32_bf16 v[176:179], v[20:23], v[48:51], v[176:179]
    v_mfma_f32_16x16x32_bf16 v[180:183], v[20:23], v[52:55], v[180:183]
    v_mfma_f32_16x16x32_bf16 v[208:211], v[48:51], v[24:27], v[208:211]
    s_barrier
    v_mfma_f32_16x16x32_bf16 v[212:215], v[52:55], v[24:27], v[212:215]
    ds_read_b128 v[32:35], v7 offset:28672
    v_mfma_f32_16x16x32_bf16 v[240:243], v[48:51], v[28:31], v[240:243]
    ds_read_b128 v[36:39], v7 offset:29696
    v_mfma_f32_16x16x32_bf16 v[244:247], v[52:55], v[28:31], v[244:247]
    ds_read_b128 v[40:43], v7 offset:30720
    s_waitcnt lgkmcnt(4)
    v_mfma_f32_16x16x32_bf16 v[88:91], v[8:11], v[56:59], v[88:91]
    ds_read_b128 v[44:47], v7 offset:31744
    s_waitcnt lgkmcnt(4)
    v_mfma_f32_16x16x32_bf16 v[92:95], v[8:11], v[60:63], v[92:95]
    v_mfma_f32_16x16x32_bf16 v[120:123], v[12:15], v[56:59], v[120:123]
    ds_read_b64_tr_b16 v[8:9], v0 offset:0
    v_mfma_f32_16x16x32_bf16 v[124:127], v[12:15], v[60:63], v[124:127]
    ds_read_b64_tr_b16 v[10:11], v0 offset:512
    v_mfma_f32_16x16x32_bf16 v[152:155], v[16:19], v[56:59], v[152:155]
    ds_read_b64_tr_b16 v[12:13], v1 offset:0
    v_mfma_f32_16x16x32_bf16 v[156:159], v[16:19], v[60:63], v[156:159]
    ds_read_b64_tr_b16 v[14:15], v1 offset:512
    v_mfma_f32_16x16x32_bf16 v[184:187], v[20:23], v[56:59], v[184:187]
    ds_read_b64_tr_b16 v[16:17], v0 offset:4096
    v_mfma_f32_16x16x32_bf16 v[188:191], v[20:23], v[60:63], v[188:191]
    ds_read_b64_tr_b16 v[18:19], v0 offset:4608
    v_mfma_f32_16x16x32_bf16 v[216:219], v[56:59], v[24:27], v[216:219]
    ds_read_b64_tr_b16 v[20:21], v1 offset:4096
    v_mfma_f32_16x16x32_bf16 v[220:223], v[60:63], v[24:27], v[220:223]
    ds_read_b64_tr_b16 v[22:23], v1 offset:4608
    v_mfma_f32_16x16x32_bf16 v[248:251], v[56:59], v[28:31], v[248:251]
    ds_read_b64_tr_b16 v[24:25], v0 offset:8192
    v_mfma_f32_16x16x32_bf16 v[252:255], v[60:63], v[28:31], v[252:255]
    ds_read_b64_tr_b16 v[26:27], v0 offset:8704
    s_waitcnt lgkmcnt(8)
    v_mfma_f32_16x16x32_bf16 v[64:67], v[8:11], v[32:35], v[64:67]
    ds_read_b64_tr_b16 v[28:29], v1 offset:8192
    v_mfma_f32_16x16x32_bf16 v[68:71], v[8:11], v[36:39], v[68:71]
    ds_read_b64_tr_b16 v[30:31], v1 offset:8704
    s_waitcnt lgkmcnt(8)
    v_mfma_f32_16x16x32_bf16 v[96:99], v[12:15], v[32:35], v[96:99]
    ds_read_b128 v[48:51], v7 offset:32768
    v_mfma_f32_16x16x32_bf16 v[100:103], v[12:15], v[36:39], v[100:103]
    ds_read_b128 v[52:55], v7 offset:33792
    s_waitcnt lgkmcnt(8)
    v_mfma_f32_16x16x32_bf16 v[128:131], v[16:19], v[32:35], v[128:131]
    ds_read_b128 v[56:59], v7 offset:34816
    v_mfma_f32_16x16x32_bf16 v[132:135], v[16:19], v[36:39], v[132:135]
    ds_read_b128 v[60:63], v7 offset:35840
    s_waitcnt lgkmcnt(8)
    v_mfma_f32_16x16x32_bf16 v[160:163], v[20:23], v[32:35], v[160:163]
    v_mfma_f32_16x16x32_bf16 v[164:167], v[20:23], v[36:39], v[164:167]
    s_waitcnt lgkmcnt(6)
    v_mfma_f32_16x16x32_bf16 v[192:195], v[32:35], v[24:27], v[192:195]
    v_mfma_f32_16x16x32_bf16 v[196:199], v[36:39], v[24:27], v[196:199]
    s_waitcnt lgkmcnt(4)
    v_mfma_f32_16x16x32_bf16 v[224:227], v[32:35], v[28:31], v[224:227]
    v_mfma_f32_16x16x32_bf16 v[228:231], v[36:39], v[28:31], v[228:231]
    v_mfma_f32_16x16x32_bf16 v[72:75], v[8:11], v[40:43], v[72:75]
    v_mfma_f32_16x16x32_bf16 v[76:79], v[8:11], v[44:47], v[76:79]
    v_mfma_f32_16x16x32_bf16 v[104:107], v[12:15], v[40:43], v[104:107]
    v_mfma_f32_16x16x32_bf16 v[108:111], v[12:15], v[44:47], v[108:111]
    v_mfma_f32_16x16x32_bf16 v[136:139], v[16:19], v[40:43], v[136:139]
    v_mfma_f32_16x16x32_bf16 v[140:143], v[16:19], v[44:47], v[140:143]
    v_mfma_f32_16x16x32_bf16 v[168:171], v[20:23], v[40:43], v[168:171]
    v_mfma_f32_16x16x32_bf16 v[172:175], v[20:23], v[44:47], v[172:175]
    v_mfma_f32_16x16x32_bf16 v[200:203], v[40:43], v[24:27], v[200:203]
    v_mfma_f32_16x16x32_bf16 v[204:207], v[44:47], v[24:27], v[204:207]
    v_mfma_f32_16x16x32_bf16 v[232:235], v[40:43], v[28:31], v[232:235]
    v_mfma_f32_16x16x32_bf16 v[236:239], v[44:47], v[28:31], v[236:239]
    s_waitcnt lgkmcnt(3)
    v_mfma_f32_16x16x32_bf16 v[80:83], v[8:11], v[48:51], v[80:83]
    s_waitcnt lgkmcnt(2)
    v_mfma_f32_16x16x32_bf16 v[84:87], v[8:11], v[52:55], v[84:87]
    v_mfma_f32_16x16x32_bf16 v[112:115], v[12:15], v[48:51], v[112:115]
    v_mfma_f32_16x16x32_bf16 v[116:119], v[12:15], v[52:55], v[116:119]
    v_mfma_f32_16x16x32_bf16 v[144:147], v[16:19], v[48:51], v[144:147]
    v_mfma_f32_16x16x32_bf16 v[148:151], v[16:19], v[52:55], v[148:151]
    v_mfma_f32_16x16x32_bf16 v[176:179], v[20:23], v[48:51], v[176:179]
    v_mfma_f32_16x16x32_bf16 v[180:183], v[20:23], v[52:55], v[180:183]
    v_mfma_f32_16x16x32_bf16 v[208:211], v[48:51], v[24:27], v[208:211]
    s_barrier
    v_mfma_f32_16x16x32_bf16 v[212:215], v[52:55], v[24:27], v[212:215]
    ds_read_b128 v[32:35], v6 offset:0
    v_mfma_f32_16x16x32_bf16 v[240:243], v[48:51], v[28:31], v[240:243]
    ds_read_b128 v[36:39], v6 offset:1024
    v_mfma_f32_16x16x32_bf16 v[244:247], v[52:55], v[28:31], v[244:247]
    ds_read_b128 v[40:43], v6 offset:2048
    s_waitcnt lgkmcnt(4)
    v_mfma_f32_16x16x32_bf16 v[88:91], v[8:11], v[56:59], v[88:91]
    ds_read_b128 v[44:47], v6 offset:3072
    s_waitcnt lgkmcnt(4)
    v_mfma_f32_16x16x32_bf16 v[92:95], v[8:11], v[60:63], v[92:95]
    v_mfma_f32_16x16x32_bf16 v[120:123], v[12:15], v[56:59], v[120:123]
    ds_read_b64_tr_b16 v[8:9], v4 offset:0
    v_mfma_f32_16x16x32_bf16 v[124:127], v[12:15], v[60:63], v[124:127]
    ds_read_b64_tr_b16 v[10:11], v4 offset:512
    v_mfma_f32_16x16x32_bf16 v[152:155], v[16:19], v[56:59], v[152:155]
    ds_read_b64_tr_b16 v[12:13], v5 offset:0
    v_mfma_f32_16x16x32_bf16 v[156:159], v[16:19], v[60:63], v[156:159]
    ds_read_b64_tr_b16 v[14:15], v5 offset:512
    v_mfma_f32_16x16x32_bf16 v[184:187], v[20:23], v[56:59], v[184:187]
    ds_read_b64_tr_b16 v[16:17], v4 offset:4096
    v_mfma_f32_16x16x32_bf16 v[188:191], v[20:23], v[60:63], v[188:191]
    ds_read_b64_tr_b16 v[18:19], v4 offset:4608
    v_mfma_f32_16x16x32_bf16 v[216:219], v[56:59], v[24:27], v[216:219]
    ds_read_b64_tr_b16 v[20:21], v5 offset:4096
    v_mfma_f32_16x16x32_bf16 v[220:223], v[60:63], v[24:27], v[220:223]
    ds_read_b64_tr_b16 v[22:23], v5 offset:4608
    v_mfma_f32_16x16x32_bf16 v[248:251], v[56:59], v[28:31], v[248:251]
    ds_read_b64_tr_b16 v[24:25], v4 offset:8192
    v_mfma_f32_16x16x32_bf16 v[252:255], v[60:63], v[28:31], v[252:255]
    ds_read_b64_tr_b16 v[26:27], v4 offset:8704
    s_waitcnt lgkmcnt(8)
    v_mfma_f32_16x16x32_bf16 v[64:67], v[8:11], v[32:35], v[64:67]
    ds_read_b64_tr_b16 v[28:29], v5 offset:8192
    v_mfma_f32_16x16x32_bf16 v[68:71], v[8:11], v[36:39], v[68:71]
    ds_read_b64_tr_b16 v[30:31], v5 offset:8704
    s_waitcnt lgkmcnt(8)
    v_mfma_f32_16x16x32_bf16 v[96:99], v[12:15], v[32:35], v[96:99]
    ds_read_b128 v[48:51], v6 offset:4096
    v_mfma_f32_16x16x32_bf16 v[100:103], v[12:15], v[36:39], v[100:103]
    ds_read_b128 v[52:55], v6 offset:5120
    s_waitcnt lgkmcnt(8)
    v_mfma_f32_16x16x32_bf16 v[128:131], v[16:19], v[32:35], v[128:131]
    ds_read_b128 v[56:59], v6 offset:6144
    v_mfma_f32_16x16x32_bf16 v[132:135], v[16:19], v[36:39], v[132:135]
    ds_read_b128 v[60:63], v6 offset:7168
    s_waitcnt lgkmcnt(8)
    v_mfma_f32_16x16x32_bf16 v[160:163], v[20:23], v[32:35], v[160:163]
    v_mfma_f32_16x16x32_bf16 v[164:167], v[20:23], v[36:39], v[164:167]
    s_waitcnt lgkmcnt(6)
    v_mfma_f32_16x16x32_bf16 v[192:195], v[32:35], v[24:27], v[192:195]
    v_mfma_f32_16x16x32_bf16 v[196:199], v[36:39], v[24:27], v[196:199]
    s_waitcnt lgkmcnt(4)
    v_mfma_f32_16x16x32_bf16 v[224:227], v[32:35], v[28:31], v[224:227]
    v_mfma_f32_16x16x32_bf16 v[228:231], v[36:39], v[28:31], v[228:231]
    v_mfma_f32_16x16x32_bf16 v[72:75], v[8:11], v[40:43], v[72:75]
    v_mfma_f32_16x16x32_bf16 v[76:79], v[8:11], v[44:47], v[76:79]
    v_mfma_f32_16x16x32_bf16 v[104:107], v[12:15], v[40:43], v[104:107]
    v_mfma_f32_16x16x32_bf16 v[108:111], v[12:15], v[44:47], v[108:111]
    v_mfma_f32_16x16x32_bf16 v[136:139], v[16:19], v[40:43], v[136:139]
    v_mfma_f32_16x16x32_bf16 v[140:143], v[16:19], v[44:47], v[140:143]
    v_mfma_f32_16x16x32_bf16 v[168:171], v[20:23], v[40:43], v[168:171]
    v_mfma_f32_16x16x32_bf16 v[172:175], v[20:23], v[44:47], v[172:175]
    v_mfma_f32_16x16x32_bf16 v[200:203], v[40:43], v[24:27], v[200:203]
    v_mfma_f32_16x16x32_bf16 v[204:207], v[44:47], v[24:27], v[204:207]
    v_mfma_f32_16x16x32_bf16 v[232:235], v[40:43], v[28:31], v[232:235]
    v_mfma_f32_16x16x32_bf16 v[236:239], v[44:47], v[28:31], v[236:239]
    s_waitcnt lgkmcnt(3)
    v_mfma_f32_16x16x32_bf16 v[80:83], v[8:11], v[48:51], v[80:83]
    s_waitcnt lgkmcnt(2)
    v_mfma_f32_16x16x32_bf16 v[84:87], v[8:11], v[52:55], v[84:87]
    v_mfma_f32_16x16x32_bf16 v[112:115], v[12:15], v[48:51], v[112:115]
    v_mfma_f32_16x16x32_bf16 v[116:119], v[12:15], v[52:55], v[116:119]
    v_mfma_f32_16x16x32_bf16 v[144:147], v[16:19], v[48:51], v[144:147]
    v_mfma_f32_16x16x32_bf16 v[148:151], v[16:19], v[52:55], v[148:151]
    v_mfma_f32_16x16x32_bf16 v[176:179], v[20:23], v[48:51], v[176:179]
    v_mfma_f32_16x16x32_bf16 v[180:183], v[20:23], v[52:55], v[180:183]
    v_mfma_f32_16x16x32_bf16 v[208:211], v[48:51], v[24:27], v[208:211]
    s_barrier
    v_mfma_f32_16x16x32_bf16 v[212:215], v[52:55], v[24:27], v[212:215]
    ds_read_b128 v[32:35], v6 offset:28672
    v_mfma_f32_16x16x32_bf16 v[240:243], v[48:51], v[28:31], v[240:243]
    ds_read_b128 v[36:39], v6 offset:29696
    v_mfma_f32_16x16x32_bf16 v[244:247], v[52:55], v[28:31], v[244:247]
    ds_read_b128 v[40:43], v6 offset:30720
    s_waitcnt lgkmcnt(4)
    v_mfma_f32_16x16x32_bf16 v[88:91], v[8:11], v[56:59], v[88:91]
    ds_read_b128 v[44:47], v6 offset:31744
    s_waitcnt lgkmcnt(4)
    v_mfma_f32_16x16x32_bf16 v[92:95], v[8:11], v[60:63], v[92:95]
    v_mfma_f32_16x16x32_bf16 v[120:123], v[12:15], v[56:59], v[120:123]
    ds_read_b64_tr_b16 v[8:9], v4 offset:28672
    v_mfma_f32_16x16x32_bf16 v[124:127], v[12:15], v[60:63], v[124:127]
    ds_read_b64_tr_b16 v[10:11], v4 offset:29184
    v_mfma_f32_16x16x32_bf16 v[152:155], v[16:19], v[56:59], v[152:155]
    ds_read_b64_tr_b16 v[12:13], v5 offset:28672
    v_mfma_f32_16x16x32_bf16 v[156:159], v[16:19], v[60:63], v[156:159]
    ds_read_b64_tr_b16 v[14:15], v5 offset:29184
    v_mfma_f32_16x16x32_bf16 v[184:187], v[20:23], v[56:59], v[184:187]
    ds_read_b64_tr_b16 v[16:17], v4 offset:32768
    v_mfma_f32_16x16x32_bf16 v[188:191], v[20:23], v[60:63], v[188:191]
    ds_read_b64_tr_b16 v[18:19], v4 offset:33280
    v_mfma_f32_16x16x32_bf16 v[216:219], v[56:59], v[24:27], v[216:219]
    ds_read_b64_tr_b16 v[20:21], v5 offset:32768
    v_mfma_f32_16x16x32_bf16 v[220:223], v[60:63], v[24:27], v[220:223]
    ds_read_b64_tr_b16 v[22:23], v5 offset:33280
    v_mfma_f32_16x16x32_bf16 v[248:251], v[56:59], v[28:31], v[248:251]
    ds_read_b64_tr_b16 v[24:25], v4 offset:36864
    v_mfma_f32_16x16x32_bf16 v[252:255], v[60:63], v[28:31], v[252:255]
    ds_read_b64_tr_b16 v[26:27], v4 offset:37376
    s_waitcnt lgkmcnt(8)
    v_mfma_f32_16x16x32_bf16 v[64:67], v[8:11], v[32:35], v[64:67]
    ds_read_b64_tr_b16 v[28:29], v5 offset:36864
    v_mfma_f32_16x16x32_bf16 v[68:71], v[8:11], v[36:39], v[68:71]
    ds_read_b64_tr_b16 v[30:31], v5 offset:37376
    s_waitcnt lgkmcnt(8)
    v_mfma_f32_16x16x32_bf16 v[96:99], v[12:15], v[32:35], v[96:99]
    ds_read_b128 v[48:51], v6 offset:32768
    v_mfma_f32_16x16x32_bf16 v[100:103], v[12:15], v[36:39], v[100:103]
    ds_read_b128 v[52:55], v6 offset:33792
    s_waitcnt lgkmcnt(8)
    v_mfma_f32_16x16x32_bf16 v[128:131], v[16:19], v[32:35], v[128:131]
    ds_read_b128 v[56:59], v6 offset:34816
    v_mfma_f32_16x16x32_bf16 v[132:135], v[16:19], v[36:39], v[132:135]
    ds_read_b128 v[60:63], v6 offset:35840
    s_waitcnt lgkmcnt(8)
    v_mfma_f32_16x16x32_bf16 v[160:163], v[20:23], v[32:35], v[160:163]
    v_mfma_f32_16x16x32_bf16 v[164:167], v[20:23], v[36:39], v[164:167]
    s_waitcnt lgkmcnt(6)
    v_mfma_f32_16x16x32_bf16 v[192:195], v[32:35], v[24:27], v[192:195]
    v_mfma_f32_16x16x32_bf16 v[196:199], v[36:39], v[24:27], v[196:199]
    s_waitcnt lgkmcnt(4)
    v_mfma_f32_16x16x32_bf16 v[224:227], v[32:35], v[28:31], v[224:227]
    v_mfma_f32_16x16x32_bf16 v[228:231], v[36:39], v[28:31], v[228:231]
    v_mfma_f32_16x16x32_bf16 v[72:75], v[8:11], v[40:43], v[72:75]
    v_mfma_f32_16x16x32_bf16 v[76:79], v[8:11], v[44:47], v[76:79]
    v_mfma_f32_16x16x32_bf16 v[104:107], v[12:15], v[40:43], v[104:107]
    v_mfma_f32_16x16x32_bf16 v[108:111], v[12:15], v[44:47], v[108:111]
    v_mfma_f32_16x16x32_bf16 v[136:139], v[16:19], v[40:43], v[136:139]
    v_mfma_f32_16x16x32_bf16 v[140:143], v[16:19], v[44:47], v[140:143]
    v_mfma_f32_16x16x32_bf16 v[168:171], v[20:23], v[40:43], v[168:171]
    v_mfma_f32_16x16x32_bf16 v[172:175], v[20:23], v[44:47], v[172:175]
    v_mfma_f32_16x16x32_bf16 v[200:203], v[40:43], v[24:27], v[200:203]
    v_mfma_f32_16x16x32_bf16 v[204:207], v[44:47], v[24:27], v[204:207]
    v_mfma_f32_16x16x32_bf16 v[232:235], v[40:43], v[28:31], v[232:235]
    v_mfma_f32_16x16x32_bf16 v[236:239], v[44:47], v[28:31], v[236:239]
    s_waitcnt lgkmcnt(3)
    v_mfma_f32_16x16x32_bf16 v[80:83], v[8:11], v[48:51], v[80:83]
    s_waitcnt lgkmcnt(2)
    v_mfma_f32_16x16x32_bf16 v[84:87], v[8:11], v[52:55], v[84:87]
    v_mfma_f32_16x16x32_bf16 v[112:115], v[12:15], v[48:51], v[112:115]
    v_mfma_f32_16x16x32_bf16 v[116:119], v[12:15], v[52:55], v[116:119]
    v_mfma_f32_16x16x32_bf16 v[144:147], v[16:19], v[48:51], v[144:147]
    v_mfma_f32_16x16x32_bf16 v[148:151], v[16:19], v[52:55], v[148:151]
    v_mfma_f32_16x16x32_bf16 v[176:179], v[20:23], v[48:51], v[176:179]
    v_mfma_f32_16x16x32_bf16 v[180:183], v[20:23], v[52:55], v[180:183]
    v_mfma_f32_16x16x32_bf16 v[208:211], v[48:51], v[24:27], v[208:211]
    v_mfma_f32_16x16x32_bf16 v[212:215], v[52:55], v[24:27], v[212:215]
    v_mfma_f32_16x16x32_bf16 v[240:243], v[48:51], v[28:31], v[240:243]
    v_mfma_f32_16x16x32_bf16 v[244:247], v[52:55], v[28:31], v[244:247]
    s_waitcnt lgkmcnt(1)
    v_mfma_f32_16x16x32_bf16 v[88:91], v[8:11], v[56:59], v[88:91]
    s_waitcnt lgkmcnt(0)
    v_mfma_f32_16x16x32_bf16 v[92:95], v[8:11], v[60:63], v[92:95]
    v_mfma_f32_16x16x32_bf16 v[120:123], v[12:15], v[56:59], v[120:123]
    v_mfma_f32_16x16x32_bf16 v[124:127], v[12:15], v[60:63], v[124:127]
    v_mfma_f32_16x16x32_bf16 v[152:155], v[16:19], v[56:59], v[152:155]
    v_mfma_f32_16x16x32_bf16 v[156:159], v[16:19], v[60:63], v[156:159]
    v_mfma_f32_16x16x32_bf16 v[184:187], v[20:23], v[56:59], v[184:187]
    v_mfma_f32_16x16x32_bf16 v[188:191], v[20:23], v[60:63], v[188:191]
    v_mfma_f32_16x16x32_bf16 v[216:219], v[56:59], v[24:27], v[216:219]
    v_mfma_f32_16x16x32_bf16 v[220:223], v[60:63], v[24:27], v[220:223]
    v_mfma_f32_16x16x32_bf16 v[248:251], v[56:59], v[28:31], v[248:251]
    v_mfma_f32_16x16x32_bf16 v[252:255], v[60:63], v[28:31], v[252:255]
    v_mbcnt_lo_u32_b32 v1, -1, 0
    v_mbcnt_hi_u32_b32 v1, -1, v1
    s_barrier
    s_mov_b32 s46, 0x3e8293ee
    s_mov_b32 s47, 0x3e8293ee
    v_lshrrev_b32 v2, 4, v1
    v_and_b32 v3, 15, v1
    v_lshlrev_b32 v3, 4, v3
    v_lshl_add_u32 v4, v2, 9, v3
    v_and_b32 v5, 1, v2
    v_lshl_add_u32 v5, v5, 9, v3
    v_lshrrev_b32 v2, 1, v2
    v_lshl_add_u32 v5, v2, 8, v5
    s_lshl_b32 s38, s35, 16
    s_lshl_b32 s39, s36, 13
    s_add_u32 s38, s38, s39
    s_add_u32 s38, s38, 16384
    v_add_u32 v6, s38, v4
    s_add_u32 s38, s38, 32768
    v_add_u32 v7, s38, v5
    s_lshl_b32 s38, s35, 14
    s_add_u32 s38, s38, s39
    s_add_u32 s38, s38, 131072
    v_add_u32 v0, s38, v4
    v_cvt_pk_bf16_f32 v8, v192, v193
    v_cvt_pk_bf16_f32 v9, v194, v195
    v_cvt_pk_bf16_f32 v10, v224, v225
    v_cvt_pk_bf16_f32 v11, v226, v227
    v_cvt_pk_bf16_f32 v12, v128, v129
    v_cvt_pk_bf16_f32 v13, v130, v131
    v_cvt_pk_bf16_f32 v14, v160, v161
    v_cvt_pk_bf16_f32 v15, v162, v163
    v_permlane32_swap_b32 v8, v10
    v_permlane32_swap_b32 v9, v11
    ds_write_b128 v6, v[12:15] offset:0
    v_pk_mul_f32 v[64:65], v[64:65], s[46:47]
    v_pk_mul_f32 v[66:67], v[66:67], s[46:47]
    v_pk_mul_f32 v[96:97], v[96:97], s[46:47]
    v_pk_mul_f32 v[98:99], v[98:99], s[46:47]
    ds_write_b128 v7, v[8:11] offset:0
    v_cvt_pk_bf16_f32 v16, v64, v65
    v_cvt_pk_bf16_f32 v17, v66, v67
    v_cvt_pk_bf16_f32 v18, v96, v97
    v_cvt_pk_bf16_f32 v19, v98, v99
    ds_write_b128 v0, v[16:19] offset:0
    v_cvt_pk_bf16_f32 v20, v196, v197
    v_cvt_pk_bf16_f32 v21, v198, v199
    v_cvt_pk_bf16_f32 v22, v228, v229
    v_cvt_pk_bf16_f32 v23, v230, v231
    v_cvt_pk_bf16_f32 v24, v132, v133
    v_cvt_pk_bf16_f32 v25, v134, v135
    v_cvt_pk_bf16_f32 v26, v164, v165
    v_cvt_pk_bf16_f32 v27, v166, v167
    v_permlane32_swap_b32 v20, v22
    v_permlane32_swap_b32 v21, v23
    ds_write_b128 v6, v[24:27] offset:256
    v_pk_mul_f32 v[68:69], v[68:69], s[46:47]
    v_pk_mul_f32 v[70:71], v[70:71], s[46:47]
    v_pk_mul_f32 v[100:101], v[100:101], s[46:47]
    v_pk_mul_f32 v[102:103], v[102:103], s[46:47]
    ds_write_b128 v7, v[20:23] offset:1024
    v_cvt_pk_bf16_f32 v28, v68, v69
    v_cvt_pk_bf16_f32 v29, v70, v71
    v_cvt_pk_bf16_f32 v30, v100, v101
    v_cvt_pk_bf16_f32 v31, v102, v103
    ds_write_b128 v0, v[28:31] offset:256
    v_cvt_pk_bf16_f32 v32, v200, v201
    v_cvt_pk_bf16_f32 v33, v202, v203
    v_cvt_pk_bf16_f32 v34, v232, v233
    v_cvt_pk_bf16_f32 v35, v234, v235
    v_cvt_pk_bf16_f32 v36, v136, v137
    v_cvt_pk_bf16_f32 v37, v138, v139
    v_cvt_pk_bf16_f32 v38, v168, v169
    v_cvt_pk_bf16_f32 v39, v170, v171
    v_permlane32_swap_b32 v32, v34
    v_permlane32_swap_b32 v33, v35
    ds_write_b128 v6, v[36:39] offset:2048
    v_pk_mul_f32 v[72:73], v[72:73], s[46:47]
    v_pk_mul_f32 v[74:75], v[74:75], s[46:47]
    v_pk_mul_f32 v[104:105], v[104:105], s[46:47]
    v_pk_mul_f32 v[106:107], v[106:107], s[46:47]
    ds_write_b128 v7, v[32:35] offset:2048
    v_cvt_pk_bf16_f32 v40, v72, v73
    v_cvt_pk_bf16_f32 v41, v74, v75
    v_cvt_pk_bf16_f32 v42, v104, v105
    v_cvt_pk_bf16_f32 v43, v106, v107
    ds_write_b128 v0, v[40:43] offset:2048
    v_cvt_pk_bf16_f32 v44, v204, v205
    v_cvt_pk_bf16_f32 v45, v206, v207
    v_cvt_pk_bf16_f32 v46, v236, v237
    v_cvt_pk_bf16_f32 v47, v238, v239
    v_cvt_pk_bf16_f32 v48, v140, v141
    v_cvt_pk_bf16_f32 v49, v142, v143
    v_cvt_pk_bf16_f32 v50, v172, v173
    v_cvt_pk_bf16_f32 v51, v174, v175
    v_permlane32_swap_b32 v44, v46
    v_permlane32_swap_b32 v45, v47
    ds_write_b128 v6, v[48:51] offset:2304
    v_pk_mul_f32 v[76:77], v[76:77], s[46:47]
    v_pk_mul_f32 v[78:79], v[78:79], s[46:47]
    v_pk_mul_f32 v[108:109], v[108:109], s[46:47]
    v_pk_mul_f32 v[110:111], v[110:111], s[46:47]
    ds_write_b128 v7, v[44:47] offset:3072
    v_cvt_pk_bf16_f32 v52, v76, v77
    v_cvt_pk_bf16_f32 v53, v78, v79
    v_cvt_pk_bf16_f32 v54, v108, v109
    v_cvt_pk_bf16_f32 v55, v110, v111
    ds_write_b128 v0, v[52:55] offset:2304
    v_cvt_pk_bf16_f32 v8, v208, v209
    v_cvt_pk_bf16_f32 v9, v210, v211
    v_cvt_pk_bf16_f32 v10, v240, v241
    v_cvt_pk_bf16_f32 v11, v242, v243
    v_cvt_pk_bf16_f32 v12, v144, v145
    v_cvt_pk_bf16_f32 v13, v146, v147
    v_cvt_pk_bf16_f32 v14, v176, v177
    v_cvt_pk_bf16_f32 v15, v178, v179
    v_permlane32_swap_b32 v8, v10
    v_permlane32_swap_b32 v9, v11
    ds_write_b128 v6, v[12:15] offset:4096
    v_pk_mul_f32 v[80:81], v[80:81], s[46:47]
    v_pk_mul_f32 v[82:83], v[82:83], s[46:47]
    v_pk_mul_f32 v[112:113], v[112:113], s[46:47]
    v_pk_mul_f32 v[114:115], v[114:115], s[46:47]
    ds_write_b128 v7, v[8:11] offset:4096
    v_cvt_pk_bf16_f32 v16, v80, v81
    v_cvt_pk_bf16_f32 v17, v82, v83
    v_cvt_pk_bf16_f32 v18, v112, v113
    v_cvt_pk_bf16_f32 v19, v114, v115
    ds_write_b128 v0, v[16:19] offset:4096
    v_cvt_pk_bf16_f32 v20, v212, v213
    v_cvt_pk_bf16_f32 v21, v214, v215
    v_cvt_pk_bf16_f32 v22, v244, v245
    v_cvt_pk_bf16_f32 v23, v246, v247
    v_cvt_pk_bf16_f32 v24, v148, v149
    v_cvt_pk_bf16_f32 v25, v150, v151
    v_cvt_pk_bf16_f32 v26, v180, v181
    v_cvt_pk_bf16_f32 v27, v182, v183
    v_permlane32_swap_b32 v20, v22
    v_permlane32_swap_b32 v21, v23
    ds_write_b128 v6, v[24:27] offset:4352
    v_pk_mul_f32 v[84:85], v[84:85], s[46:47]
    v_pk_mul_f32 v[86:87], v[86:87], s[46:47]
    v_pk_mul_f32 v[116:117], v[116:117], s[46:47]
    v_pk_mul_f32 v[118:119], v[118:119], s[46:47]
    ds_write_b128 v7, v[20:23] offset:5120
    v_cvt_pk_bf16_f32 v28, v84, v85
    v_cvt_pk_bf16_f32 v29, v86, v87
    v_cvt_pk_bf16_f32 v30, v116, v117
    v_cvt_pk_bf16_f32 v31, v118, v119
    ds_write_b128 v0, v[28:31] offset:4352
    v_cvt_pk_bf16_f32 v32, v216, v217
    v_cvt_pk_bf16_f32 v33, v218, v219
    v_cvt_pk_bf16_f32 v34, v248, v249
    v_cvt_pk_bf16_f32 v35, v250, v251
    v_cvt_pk_bf16_f32 v36, v152, v153
    v_cvt_pk_bf16_f32 v37, v154, v155
    v_cvt_pk_bf16_f32 v38, v184, v185
    v_cvt_pk_bf16_f32 v39, v186, v187
    v_permlane32_swap_b32 v32, v34
    v_permlane32_swap_b32 v33, v35
    ds_write_b128 v6, v[36:39] offset:6144
    v_pk_mul_f32 v[88:89], v[88:89], s[46:47]
    v_pk_mul_f32 v[90:91], v[90:91], s[46:47]
    v_pk_mul_f32 v[120:121], v[120:121], s[46:47]
    v_pk_mul_f32 v[122:123], v[122:123], s[46:47]
    ds_write_b128 v7, v[32:35] offset:6144
    v_cvt_pk_bf16_f32 v40, v88, v89
    v_cvt_pk_bf16_f32 v41, v90, v91
    v_cvt_pk_bf16_f32 v42, v120, v121
    v_cvt_pk_bf16_f32 v43, v122, v123
    ds_write_b128 v0, v[40:43] offset:6144
    v_cvt_pk_bf16_f32 v44, v220, v221
    v_cvt_pk_bf16_f32 v45, v222, v223
    v_cvt_pk_bf16_f32 v46, v252, v253
    v_cvt_pk_bf16_f32 v47, v254, v255
    v_cvt_pk_bf16_f32 v48, v156, v157
    v_cvt_pk_bf16_f32 v49, v158, v159
    v_cvt_pk_bf16_f32 v50, v188, v189
    v_cvt_pk_bf16_f32 v51, v190, v191
    v_permlane32_swap_b32 v44, v46
    v_permlane32_swap_b32 v45, v47
    ds_write_b128 v6, v[48:51] offset:6400
    v_pk_mul_f32 v[92:93], v[92:93], s[46:47]
    v_pk_mul_f32 v[94:95], v[94:95], s[46:47]
    v_pk_mul_f32 v[124:125], v[124:125], s[46:47]
    v_pk_mul_f32 v[126:127], v[126:127], s[46:47]
    ds_write_b128 v7, v[44:47] offset:7168
    v_cvt_pk_bf16_f32 v52, v92, v93
    v_cvt_pk_bf16_f32 v53, v94, v95
    v_cvt_pk_bf16_f32 v54, v124, v125
    v_cvt_pk_bf16_f32 v55, v126, v127
    ds_write_b128 v0, v[52:55] offset:6400
    s_branch g1_att
g1_prod:
    s_sub_u32 s45, s3, 4
    s_and_b32 s46, s3, 1
    s_lshl_b32 s46, s46, 1
    v_lshrrev_b32 v2, 3, v1
    v_mul_u32_u24 v4, 6144, v2
    v_bfe_u32 v2, v1, 4, 1
    v_or_b32 v2, s46, v2
    v_lshlrev_b32 v2, 1, v2
    v_and_b32 v3, 7, v1
    v_xor_b32 v2, v2, v3
    v_lshl_add_u32 v4, v2, 4, v4
    v_add_u32 v5, 2048, v4
    v_add_u32 v6, 4096, v4
    v_lshlrev_b32 v8, 4, v1
    s_mul_i32 s35, s45, 49152
    s_lshl_b32 s36, s32, 7
    s_add_u32 s35, s35, s36
    s_lshl_b32 s36, s33, 19
    s_lshl_b32 s37, s45, 12
    s_add_u32 s36, s36, s37
    s_lshl_b32 s38, s45, 10
    s_add_u32 s39, s37, 12288
    s_mov_b32 s40, 0
    s_waitcnt lgkmcnt(0)
    s_mov_b32 s12, s4
    s_mov_b32 s13, s5
    s_mov_b32 s14, 0x600000
    s_mov_b32 s15, 0x00020000
    s_mov_b32 s16, s6
    s_mov_b32 s17, s7
    s_mov_b32 s18, 0x400000
    s_mov_b32 s19, 0x00020000
    s_mov_b32 s56, s62
    s_mov_b32 s57, s63
    s_mov_b32 s58, 0xe00000
    s_mov_b32 s59, 0x00020000
    s_lshl_b32 s61, s32, 3
    s_add_u32 s61, s61, s33
    s_lshl_b32 s61, s61, 2
    s_add_u32 s61, s61, s45
    s_mul_i32 s55, s61, 0
    s_mul_i32 s61, s61, 4096
    s_add_u32 s61, s61, 10485760
    v_min_u32 v11, 31, v1
    v_lshlrev_b32 v11, 7, v11
    s_mov_b32 s60, 8
    s_add_u32 m0, s40, s38
    s_nop 0
    buffer_load_dwordx4 v4, s[12:15], s35 offen lds
    s_add_u32 m0, m0, 4096
    s_nop 0
    buffer_load_dwordx4 v5, s[12:15], s35 offen lds
    s_add_u32 m0, m0, 4096
    s_nop 0
    buffer_load_dwordx4 v6, s[12:15], s35 offen lds
    s_add_u32 s35, s35, 196608
    s_add_u32 m0, s40, s39
    s_nop 0
    buffer_load_dwordx4 v8, s[16:19], s36 offen offset:0 lds
    buffer_load_dwordx4 v8, s[16:19], s36 offen offset:1024 lds
    buffer_load_dwordx4 v8, s[16:19], s36 offen offset:2048 lds
    buffer_load_dwordx4 v8, s[16:19], s36 offen offset:3072 lds
    s_add_u32 s36, s36, 16384
    s_sub_u32 s60, s60, 1
    s_cmp_lg_u32 s60, 0
    s_cbranch_scc1 g1t3
    buffer_load_dword v10, v11, s[56:59], s61 offen
    s_add_u32 s61, s61, 2097152
    s_sub_u32 s60, s61, 14680064
    s_cmp_ge_u32 s61, 14680064
    s_cselect_b32 s61, s60, s61
    s_mov_b32 s60, 6
g1t3:
    s_add_u32 s40, s40, 28672
    s_cmp_eq_u32 s40, 143360
    s_cselect_b32 s40, 0, s40
    s_add_u32 m0, s40, s38
    s_nop 0
    buffer_load_dwordx4 v4, s[12:15], s35 offen lds
    s_add_u32 m0, m0, 4096
    s_nop 0
    buffer_load_dwordx4 v5, s[12:15], s35 offen lds
    s_add_u32 m0, m0, 4096
    s_nop 0
    buffer_load_dwordx4 v6, s[12:15], s35 offen lds
    s_add_u32 s35, s35, 196608
    s_add_u32 m0, s40, s39
    s_nop 0
    buffer_load_dwordx4 v8, s[16:19], s36 offen offset:0 lds
    buffer_load_dwordx4 v8, s[16:19], s36 offen offset:1024 lds
    buffer_load_dwordx4 v8, s[16:19], s36 offen offset:2048 lds
    buffer_load_dwordx4 v8, s[16:19], s36 offen offset:3072 lds
    s_add_u32 s36, s36, 16384
    s_sub_u32 s60, s60, 1
    s_cmp_lg_u32 s60, 0
    s_cbranch_scc1 g1t4
    buffer_load_dword v10, v11, s[56:59], s61 offen
    s_add_u32 s61, s61, 2097152
    s_sub_u32 s60, s61, 14680064
    s_cmp_ge_u32 s61, 14680064
    s_cselect_b32 s61, s60, s61
    s_mov_b32 s60, 6
g1t4:
    s_add_u32 s40, s40, 28672
    s_cmp_eq_u32 s40, 143360
    s_cselect_b32 s40, 0, s40
    s_waitcnt vmcnt(7)
    s_barrier
    s_add_u32 m0, s40, s38
    s_nop 0
    buffer_load_dwordx4 v4, s[12:15], s35 offen lds
    s_add_u32 m0, m0, 4096
    s_nop 0
    buffer_load_dwordx4 v5, s[12:15], s35 offen lds
    s_add_u32 m0, m0, 4096
    s_nop 0
    buffer_load_dwordx4 v6, s[12:15], s35 offen lds
    s_add_u32 s35, s35, 196608
    s_add_u32 m0, s40, s39
    s_nop 0
    buffer_load_dwordx4 v8, s[16:19], s36 offen offset:0 lds
    buffer_load_dwordx4 v8, s[16:19], s36 offen offset:1024 lds
    buffer_load_dwordx4 v8, s[16:19], s36 offen offset:2048 lds
    buffer_load_dwordx4 v8, s[16:19], s36 offen offset:3072 lds
    s_add_u32 s36, s36, 16384
    s_sub_u32 s60, s60, 1
    s_cmp_lg_u32 s60, 0
    s_cbranch_scc1 g1t5
    buffer_load_dword v10, v11, s[56:59], s61 offen
    s_add_u32 s61, s61, 2097152
    s_sub_u32 s60, s61, 14680064
    s_cmp_ge_u32 s61, 14680064
    s_cselect_b32 s61, s60, s61
    s_mov_b32 s60, 6
g1t5:
    s_add_u32 s40, s40, 28672
    s_cmp_eq_u32 s40, 143360
    s_cselect_b32 s40, 0, s40
    s_add_u32 m0, s40, s38
    s_nop 0
    buffer_load_dwordx4 v4, s[12:15], s35 offen lds
    s_add_u32 m0, m0, 4096
    s_nop 0
    buffer_load_dwordx4 v5, s[12:15], s35 offen lds
    s_add_u32 m0, m0, 4096
    s_nop 0
    buffer_load_dwordx4 v6, s[12:15], s35 offen lds
    s_add_u32 s35, s35, 196608
    s_add_u32 m0, s40, s39
    s_nop 0
    buffer_load_dwordx4 v8, s[16:19], s36 offen offset:0 lds
    buffer_load_dwordx4 v8, s[16:19], s36 offen offset:1024 lds
    buffer_load_dwordx4 v8, s[16:19], s36 offen offset:2048 lds
    buffer_load_dwordx4 v8, s[16:19], s36 offen offset:3072 lds
    s_add_u32 s36, s36, 16384
    s_sub_u32 s60, s60, 1
    s_cmp_lg_u32 s60, 0
    s_cbranch_scc1 g1t6
    buffer_load_dword v10, v11, s[56:59], s61 offen
    s_add_u32 s61, s61, 2097152
    s_sub_u32 s60, s61, 14680064
    s_cmp_ge_u32 s61, 14680064
    s_cselect_b32 s61, s60, s61
    s_mov_b32 s60, 6
g1t6:
    s_add_u32 s40, s40, 28672
    s_cmp_eq_u32 s40, 143360
    s_cselect_b32 s40, 0, s40
    s_waitcnt vmcnt(14)
    s_barrier
    s_add_u32 m0, s40, s38
    s_nop 0
    buffer_load_dwordx4 v4, s[12:15], s35 offen lds
    s_add_u32 m0, m0, 4096
    s_nop 0
    buffer_load_dwordx4 v5, s[12:15], s35 offen lds
    s_add_u32 m0, m0, 4096
    s_nop 0
    buffer_load_dwordx4 v6, s[12:15], s35 offen lds
    s_add_u32 s35, s35, 196608
    s_add_u32 m0, s40, s39
    s_nop 0
    buffer_load_dwordx4 v8, s[16:19], s36 offen offset:0 lds
    buffer_load_dwordx4 v8, s[16:19], s36 offen offset:1024 lds
    buffer_load_dwordx4 v8, s[16:19], s36 offen offset:2048 lds
    buffer_load_dwordx4 v8, s[16:19], s36 offen offset:3072 lds
    s_add_u32 s36, s36, 16384
    s_sub_u32 s60, s60, 1
    s_cmp_lg_u32 s60, 0
    s_cbranch_scc1 g1t7
    buffer_load_dword v10, v11, s[56:59], s61 offen
    s_add_u32 s61, s61, 2097152
    s_sub_u32 s60, s61, 14680064
    s_cmp_ge_u32 s61, 14680064
    s_cselect_b32 s61, s60, s61
    s_mov_b32 s60, 6
g1t7:
    s_add_u32 s40, s40, 28672
    s_cmp_eq_u32 s40, 143360
    s_cselect_b32 s40, 0, s40
    s_mov_b32 s44, 27
g1_ploop0:
    s_waitcnt vmcnt(14)
    s_barrier
    s_add_u32 m0, s40, s38
    s_nop 0
    buffer_load_dwordx4 v4, s[12:15], s35 offen lds
    s_add_u32 m0, m0, 4096
    s_nop 0
    buffer_load_dwordx4 v5, s[12:15], s35 offen lds
    s_add_u32 m0, m0, 4096
    s_nop 0
    buffer_load_dwordx4 v6, s[12:15], s35 offen lds
    s_add_u32 s35, s35, 196608
    s_add_u32 m0, s40, s39
    s_nop 0
    buffer_load_dwordx4 v8, s[16:19], s36 offen offset:0 lds
    buffer_load_dwordx4 v8, s[16:19], s36 offen offset:1024 lds
    buffer_load_dwordx4 v8, s[16:19], s36 offen offset:2048 lds
    buffer_load_dwordx4 v8, s[16:19], s36 offen offset:3072 lds
    s_add_u32 s36, s36, 16384
    s_sub_u32 s60, s60, 1
    s_cmp_lg_u32 s60, 0
    s_cbranch_scc1 g1t8
    buffer_load_dword v10, v11, s[56:59], s61 offen
    s_add_u32 s61, s61, 2097152
    s_sub_u32 s60, s61, 14680064
    s_cmp_ge_u32 s61, 14680064
    s_cselect_b32 s61, s60, s61
    s_mov_b32 s60, 6
g1t8:
    s_add_u32 s40, s40, 28672
    s_cmp_eq_u32 s40, 143360
    s_cselect_b32 s40, 0, s40
    s_sub_u32 s44, s44, 1
    s_cmp_lg_u32 s44, 0
    s_cbranch_scc1 g1_ploop0
    v_lshlrev_b32 v9, 7, v1
    s_lshl_b32 s61, s45, 13
    s_getpc_b64 s[48:49]
    ct2:
    s_add_u32 s48, s48, g1_att-ct2
    s_addc_u32 s49, s49, 0
    s_mov_b32 s50, k2_pf-g1_att
    s_mov_b32 s51, 0x00020000
    buffer_load_dword v10, v9, s[48:51], s61 offen
    s_waitcnt vmcnt(15)
    s_barrier
    s_waitcnt vmcnt(8)
    s_barrier
    s_waitcnt vmcnt(1)
    s_barrier
    s_barrier
    s_waitcnt vmcnt(0) lgkmcnt(0)
g1_att:
    s_add_u32 s12, s6, 0x800000
    s_addc_u32 s13, s7, 0
    s_mov_b32 s14, 0x800000
    s_mov_b32 s15, 0x00020000
    s_add_u32 s16, s6, 0x2c00000
    s_addc_u32 s17, s7, 0
    s_mov_b32 s18, 0x200000
    s_mov_b32 s19, 0x00020000
    s_add_u32 s20, s6, 0x1c00000
    s_addc_u32 s21, s7, 0
    s_mov_b32 s22, 0x400000
    s_mov_b32 s23, 0x00020000
    v_lshlrev_b32 v3, 4, v1
    s_and_b32 s34, s3, 1
    s_lshr_b32 s35, s3, 1
    s_sub_u32 s36, 7, s35
    s_lshl_b32 s37, s32, 3
    s_add_u32 s37, s37, s33
    s_mul_i32 s39, s37, 4352
    s_lshl_b32 s40, s3, 2
    s_add_u32 s39, s39, s40
    s_add_u32 s39, s39, 128
    s_sub_u32 s40, s39, 4352
    s_lshr_b32 s41, s3, 1
    s_lshl_b32 s41, s41, 15
    s_lshl_b32 s42, s34, 13
    s_add_u32 s41, s41, s42
    s_lshl_b32 s42, s37, 16
    s_lshl_b32 s43, s3, 13
    s_add_u32 s42, s42, s43
    s_add_u32 s43, s41, 16384
    v_add_u32 v0, s43, v3
    v_and_b32 v5, 31, v1
    v_lshrrev_b32 v6, 5, v1
    v_lshlrev_b32 v6, 2, v6
    v_sub_u32 v5, v5, v6
    s_lshl_b32 s43, s34, 16
    v_add_u32 v4, s43, v3
    v_and_b32 v2, 15, v1
    v_lshlrev_b32 v2, 4, v2
    v_bfe_u32 v57, v1, 4, 1
    v_lshl_add_u32 v2, v57, 10, v2
    v_lshrrev_b32 v57, 5, v1
    v_lshl_add_u32 v2, v57, 8, v2
    s_lshl_b32 s43, s34, 14
    s_add_u32 s43, s43, 131072
    s_lshl_b32 s44, s35, 11
    s_add_u32 s44, s44, s43
    v_add_u32 v56, s44, v3
    s_lshl_b32 s44, s36, 11
    s_add_u32 s44, s44, s43
    v_add_u32 v57, s44, v3
    v_mov_b32 v208, 0
    v_mov_b32 v209, 0
    v_mov_b32 v210, 0
    v_mov_b32 v211, 0
    v_mov_b32 v212, 0
    v_mov_b32 v213, 0
    v_mov_b32 v214, 0
    v_mov_b32 v215, 0
    v_mov_b32 v216, 0
    v_mov_b32 v217, 0
    v_mov_b32 v218, 0
    v_mov_b32 v219, 0
    v_mov_b32 v220, 0
    v_mov_b32 v221, 0
    v_mov_b32 v222, 0
    v_mov_b32 v223, 0
    v_mov_b32 v62, 0
    v_mov_b32 v63, 0
    v_mov_b32 v58, 0xff800000
    v_mov_b32 v224, 0
    v_mov_b32 v225, 0
    v_mov_b32 v226, 0
    v_mov_b32 v227, 0
    v_mov_b32 v228, 0
    v_mov_b32 v229, 0
    v_mov_b32 v230, 0
    v_mov_b32 v231, 0
    v_mov_b32 v232, 0
    v_mov_b32 v233, 0
    v_mov_b32 v234, 0
    v_mov_b32 v235, 0
    v_mov_b32 v236, 0
    v_mov_b32 v237, 0
    v_mov_b32 v238, 0
    v_mov_b32 v239, 0
    v_mov_b32 v6, 0
    v_mov_b32 v7, 0
    v_mov_b32 v60, 0xff800000
    v_mov_b32 v1, 0
    s_mov_b32 s38, 0
    s_add_u32 s43, s42, 4096
    s_waitcnt lgkmcnt(0)
    s_barrier
    ds_read_b128 v[160:163], v0 offset:0
    ds_read_b128 v[164:167], v0 offset:1024
    ds_read_b128 v[168:171], v0 offset:2048
    ds_read_b128 v[172:175], v0 offset:3072
    ds_read_b128 v[176:179], v0 offset:4096
    ds_read_b128 v[180:183], v0 offset:5120
    ds_read_b128 v[184:187], v0 offset:6144
    ds_read_b128 v[188:191], v0 offset:7168
    ds_read_b128 v[8:11], v56
    ds_read_b128 v[12:15], v56 offset:1024
    ds_read_b128 v[16:19], v57
    ds_read_b128 v[20:23], v57 offset:1024
    s_add_u32 s24, s6, 0x800000
    s_addc_u32 s25, s7, 0
    s_mov_b32 s26, 0x800000
    s_mov_b32 s27, 0x00020000
    s_cmp_eq_u32 s33, 7
    s_cselect_b32 s26, 0, s26
    s_mov_b32 s56, s62
    s_mov_b32 s57, s63
    s_mov_b32 s58, 0xe00000
    s_mov_b32 s59, 0x00020000
    v_lshlrev_b32 v0, 3, v3
    s_mov_b32 s60, 557184
    s_lshl_b32 s61, s37, 3
    s_add_u32 s61, s61, s3
    s_lshl_b32 s61, s61, 13
    s_add_u32 s61, s61, 4194304
att_part:
    s_cmp_eq_u32 s38, 0
    s_add_u32 s44, s35, 1
    s_sub_u32 s45, 8, s35
    s_cmp_eq_u32 s38, 0
    s_cselect_b32 s44, s44, s45
    s_cselect_b32 s46, 8, 0
    s_add_u32 s46, s46, s35
    s_cmp_eq_u32 s38, 0
    s_cselect_b32 s47, 0, 8
    s_add_u32 s47, s47, s36
    s_cmp_eq_u32 s38, 0
    s_cselect_b32 s48, -1, 1
    s_cselect_b32 s50, 0, 0xff800000
    s_cselect_b32 s51, 0xff800000, 0
    s_lshl_b32 s46, s46, 11
    s_lshl_b32 s47, s47, 11
    s_lshl_b32 s48, s48, 11
    s_cmp_gt_u32 s44, 0
    s_cselect_b32 s49, s46, s47
    v_add_u32 v48, s49, v4
    s_add_u32 s46, s46, s48
    s_sub_u32 s47, s47, s48
    ds_read_b128 v[24:27], v48
    ds_read_b128 v[28:31], v48 offset:1024
    s_cmp_gt_u32 s44, 1
    s_cselect_b32 s49, s46, s47
    v_add_u32 v49, s49, v4
    s_add_u32 s46, s46, s48
    s_sub_u32 s47, s47, s48
    ds_read_b128 v[32:35], v49
    ds_read_b128 v[36:39], v49 offset:1024
    s_cmp_gt_u32 s44, 2
    s_cselect_b32 s49, s46, s47
    v_add_u32 v50, s49, v4
    s_add_u32 s46, s46, s48
    s_sub_u32 s47, s47, s48
    s_cmp_gt_u32 s44, 3
    s_cselect_b32 s49, s46, s47
    v_add_u32 v51, s49, v4
    s_add_u32 s46, s46, s48
    s_sub_u32 s47, s47, s48
    s_cmp_gt_u32 s44, 4
    s_cselect_b32 s49, s46, s47
    v_add_u32 v52, s49, v4
    s_add_u32 s46, s46, s48
    s_sub_u32 s47, s47, s48
    s_cmp_gt_u32 s44, 5
    s_cselect_b32 s49, s46, s47
    v_add_u32 v53, s49, v4
    s_add_u32 s46, s46, s48
    s_sub_u32 s47, s47, s48
    s_cmp_gt_u32 s44, 6
    s_cselect_b32 s49, s46, s47
    v_add_u32 v54, s49, v4
    s_add_u32 s46, s46, s48
    s_sub_u32 s47, s47, s48
    s_cmp_gt_u32 s44, 7
    s_cselect_b32 s49, s46, s47
    v_add_u32 v55, s49, v4
    s_add_u32 s46, s46, s48
    s_sub_u32 s47, s47, s48
    s_cmp_gt_u32 s44, 8
    s_cselect_b32 s49, s46, s47
    v_add_u32 v56, s49, v4
    s_add_u32 s46, s46, s48
    s_sub_u32 s47, s47, s48
    v_mov_b32 v240, s50
    v_mov_b32 v241, s51
    v_cmp_gt_i32 s[52:53], 0, v5
    v_cmp_gt_i32 s[54:55], 1, v5
    s_nop 0
    v_cndmask_b32 v64, v240, v241, s[52:53]
    v_cndmask_b32 v192, v240, v241, s[52:53]
    v_cndmask_b32 v65, v240, v241, s[54:55]
    v_cndmask_b32 v193, v240, v241, s[54:55]
    v_cmp_gt_i32 s[52:53], 2, v5
    v_cmp_gt_i32 s[54:55], 3, v5
    s_nop 0
    v_cndmask_b32 v66, v240, v241, s[52:53]
    v_cndmask_b32 v194, v240, v241, s[52:53]
    v_cndmask_b32 v67, v240, v241, s[54:55]
    v_cndmask_b32 v195, v240, v241, s[54:55]
    v_cmp_gt_i32 s[52:53], 8, v5
    v_cmp_gt_i32 s[54:55], 9, v5
    s_nop 0
    v_cndmask_b32 v68, v240, v241, s[52:53]
    v_cndmask_b32 v196, v240, v241, s[52:53]
    v_cndmask_b32 v69, v240, v241, s[54:55]
    v_cndmask_b32 v197, v240, v241, s[54:55]
    v_cmp_gt_i32 s[52:53], 10, v5
    v_cmp_gt_i32 s[54:55], 11, v5
    s_nop 0
    v_cndmask_b32 v70, v240, v241, s[52:53]
    v_cndmask_b32 v198, v240, v241, s[52:53]
    v_cndmask_b32 v71, v240, v241, s[54:55]
    v_cndmask_b32 v199, v240, v241, s[54:55]
    v_cmp_gt_i32 s[52:53], 16, v5
    v_cmp_gt_i32 s[54:55], 17, v5
    s_nop 0
    v_cndmask_b32 v72, v240, v241, s[52:53]
    v_cndmask_b32 v200, v240, v241, s[52:53]
    v_cndmask_b32 v73, v240, v241, s[54:55]
    v_cndmask_b32 v201, v240, v241, s[54:55]
    v_cmp_gt_i32 s[52:53], 18, v5
    v_cmp_gt_i32 s[54:55], 19, v5
    s_nop 0
    v_cndmask_b32 v74, v240, v241, s[52:53]
    v_cndmask_b32 v202, v240, v241, s[52:53]
    v_cndmask_b32 v75, v240, v241, s[54:55]
    v_cndmask_b32 v203, v240, v241, s[54:55]
    v_cmp_gt_i32 s[52:53], 24, v5
    v_cmp_gt_i32 s[54:55], 25, v5
    s_nop 0
    v_cndmask_b32 v76, v240, v241, s[52:53]
    v_cndmask_b32 v204, v240, v241, s[52:53]
    v_cndmask_b32 v77, v240, v241, s[54:55]
    v_cndmask_b32 v205, v240, v241, s[54:55]
    v_cmp_gt_i32 s[52:53], 26, v5
    v_cmp_gt_i32 s[54:55], 27, v5
    s_nop 0
    v_cndmask_b32 v78, v240, v241, s[52:53]
    v_cndmask_b32 v206, v240, v241, s[52:53]
    v_cndmask_b32 v79, v240, v241, s[54:55]
    v_cndmask_b32 v207, v240, v241, s[54:55]
    ds_read_b128 v[40:43], v50
    ds_read_b128 v[44:47], v50 offset:1024
    s_waitcnt lgkmcnt(4)
    v_mfma_f32_32x32x16_bf16 v[64:79], v[24:27], v[8:11], v[64:79]
    v_mfma_f32_32x32x16_bf16 v[64:79], v[28:31], v[12:15], v[64:79]
    buffer_store_dwordx4 v[160:163], v3, s[24:27], s42 offen offset:0 sc1
    s_cmp_eq_u32 s44, 1
    s_cbranch_scc1 aqk_b1
    ds_read_b128 v[24:27], v51
    ds_read_b128 v[28:31], v51 offset:1024
    s_waitcnt lgkmcnt(4)
    v_mfma_f32_32x32x16_bf16 v[80:95], v[32:35], v[8:11], 0
    v_mfma_f32_32x32x16_bf16 v[80:95], v[36:39], v[12:15], v[80:95]
    buffer_store_dwordx4 v[164:167], v3, s[24:27], s42 offen offset:1024 sc1
    buffer_store_dwordx4 v[168:171], v3, s[24:27], s42 offen offset:2048 sc1
    s_cmp_eq_u32 s44, 2
    s_cbranch_scc1 aqk_b2
    ds_read_b128 v[32:35], v52
    ds_read_b128 v[36:39], v52 offset:1024
    s_waitcnt lgkmcnt(4)
    v_mfma_f32_32x32x16_bf16 v[96:111], v[40:43], v[8:11], 0
    v_mfma_f32_32x32x16_bf16 v[96:111], v[44:47], v[12:15], v[96:111]
    buffer_store_dwordx4 v[172:175], v3, s[24:27], s42 offen offset:3072 sc1
    v_max3_f32 v242, v64, v65, v66
    v_max3_f32 v240, v67, v68, v69
    v_max3_f32 v242, v242, v70, v71
    v_max3_f32 v240, v240, v72, v73
    v_max3_f32 v242, v242, v74, v75
    v_max3_f32 v240, v240, v76, v77
    v_max3_f32 v242, v242, v78, v79
    v_max_f32 v242, v242, v240
    s_cmp_eq_u32 s44, 3
    s_cbranch_scc1 aqk_b3
    ds_read_b128 v[40:43], v53
    ds_read_b128 v[44:47], v53 offset:1024
    s_waitcnt lgkmcnt(4)
    v_mfma_f32_32x32x16_bf16 v[112:127], v[24:27], v[8:11], 0
    v_mfma_f32_32x32x16_bf16 v[112:127], v[28:31], v[12:15], v[112:127]
    buffer_store_dwordx4 v[176:179], v3, s[24:27], s43 offen offset:0 sc1
    buffer_store_dwordx4 v[180:183], v3, s[24:27], s43 offen offset:1024 sc1
    v_max3_f32 v243, v80, v81, v82
    v_max3_f32 v240, v83, v84, v85
    v_max3_f32 v243, v243, v86, v87
    v_max3_f32 v240, v240, v88, v89
    v_max3_f32 v243, v243, v90, v91
    v_max3_f32 v240, v240, v92, v93
    v_max3_f32 v243, v243, v94, v95
    v_max_f32 v243, v243, v240
    s_cmp_eq_u32 s44, 4
    s_cbranch_scc1 aqk_b4
    ds_read_b128 v[24:27], v54
    ds_read_b128 v[28:31], v54 offset:1024
    s_waitcnt lgkmcnt(4)
    v_mfma_f32_32x32x16_bf16 v[128:143], v[32:35], v[8:11], 0
    v_mfma_f32_32x32x16_bf16 v[128:143], v[36:39], v[12:15], v[128:143]
    buffer_store_dwordx4 v[184:187], v3, s[24:27], s43 offen offset:2048 sc1
    v_max3_f32 v244, v96, v97, v98
    v_max3_f32 v240, v99, v100, v101
    v_max3_f32 v244, v244, v102, v103
    v_max3_f32 v240, v240, v104, v105
    v_max3_f32 v244, v244, v106, v107
    v_max3_f32 v240, v240, v108, v109
    v_max3_f32 v244, v244, v110, v111
    v_max_f32 v244, v244, v240
    s_cmp_eq_u32 s44, 5
    s_cbranch_scc1 aqk_b5
    ds_read_b128 v[32:35], v55
    ds_read_b128 v[36:39], v55 offset:1024
    s_waitcnt lgkmcnt(4)
    v_mfma_f32_32x32x16_bf16 v[144:159], v[40:43], v[8:11], 0
    v_mfma_f32_32x32x16_bf16 v[144:159], v[44:47], v[12:15], v[144:159]
    buffer_store_dwordx4 v[188:191], v3, s[24:27], s43 offen offset:3072 sc1
    v_max3_f32 v245, v112, v113, v114
    v_max3_f32 v240, v115, v116, v117
    v_max3_f32 v245, v245, v118, v119
    v_max3_f32 v240, v240, v120, v121
    v_max3_f32 v245, v245, v122, v123
    v_max3_f32 v240, v240, v124, v125
    v_max3_f32 v245, v245, v126, v127
    v_max_f32 v245, v245, v240
    s_cmp_eq_u32 s44, 6
    s_cbranch_scc1 aqk_b6
    ds_read_b128 v[40:43], v56
    ds_read_b128 v[44:47], v56 offset:1024
    s_waitcnt lgkmcnt(4)
    v_mfma_f32_32x32x16_bf16 v[160:175], v[24:27], v[8:11], 0
    v_mfma_f32_32x32x16_bf16 v[160:175], v[28:31], v[12:15], v[160:175]
    v_max3_f32 v246, v128, v129, v130
    v_max3_f32 v240, v131, v132, v133
    v_max3_f32 v246, v246, v134, v135
    v_max3_f32 v240, v240, v136, v137
    v_max3_f32 v246, v246, v138, v139
    v_max3_f32 v240, v240, v140, v141
    v_max3_f32 v246, v246, v142, v143
    v_max_f32 v246, v246, v240
    s_cmp_eq_u32 s44, 7
    s_cbranch_scc1 aqk_b7
    s_waitcnt lgkmcnt(2)
    v_mfma_f32_32x32x16_bf16 v[176:191], v[32:35], v[8:11], 0
    v_mfma_f32_32x32x16_bf16 v[176:191], v[36:39], v[12:15], v[176:191]
    v_max3_f32 v247, v144, v145, v146
    v_max3_f32 v240, v147, v148, v149
    v_max3_f32 v247, v247, v150, v151
    v_max3_f32 v240, v240, v152, v153
    v_max3_f32 v247, v247, v154, v155
    v_max3_f32 v240, v240, v156, v157
    v_max3_f32 v247, v247, v158, v159
    v_max_f32 v247, v247, v240
    s_branch aqk_b8
aqk_b1:
    ds_read_b128 v[24:27], v51
    ds_read_b128 v[28:31], v51 offset:1024
    s_waitcnt lgkmcnt(4)
    v_mfma_f32_32x32x16_bf16 v[80:95], v[32:35], v[16:19], 0
    v_mfma_f32_32x32x16_bf16 v[80:95], v[36:39], v[20:23], v[80:95]
    buffer_store_dwordx4 v[164:167], v3, s[24:27], s42 offen offset:1024 sc1
    buffer_store_dwordx4 v[168:171], v3, s[24:27], s42 offen offset:2048 sc1
aqk_b2:
    ds_read_b128 v[32:35], v52
    ds_read_b128 v[36:39], v52 offset:1024
    s_waitcnt lgkmcnt(4)
    v_mfma_f32_32x32x16_bf16 v[96:111], v[40:43], v[16:19], 0
    v_mfma_f32_32x32x16_bf16 v[96:111], v[44:47], v[20:23], v[96:111]
    buffer_store_dwordx4 v[172:175], v3, s[24:27], s42 offen offset:3072 sc1
    v_max3_f32 v242, v64, v65, v66
    v_max3_f32 v240, v67, v68, v69
    v_max3_f32 v242, v242, v70, v71
    v_max3_f32 v240, v240, v72, v73
    v_max3_f32 v242, v242, v74, v75
    v_max3_f32 v240, v240, v76, v77
    v_max3_f32 v242, v242, v78, v79
    v_max_f32 v242, v242, v240
aqk_b3:
    ds_read_b128 v[40:43], v53
    ds_read_b128 v[44:47], v53 offset:1024
    s_waitcnt lgkmcnt(4)
    v_mfma_f32_32x32x16_bf16 v[112:127], v[24:27], v[16:19], 0
    v_mfma_f32_32x32x16_bf16 v[112:127], v[28:31], v[20:23], v[112:127]
    buffer_store_dwordx4 v[176:179], v3, s[24:27], s43 offen offset:0 sc1
    buffer_store_dwordx4 v[180:183], v3, s[24:27], s43 offen offset:1024 sc1
    v_max3_f32 v243, v80, v81, v82
    v_max3_f32 v240, v83, v84, v85
    v_max3_f32 v243, v243, v86, v87
    v_max3_f32 v240, v240, v88, v89
    v_max3_f32 v243, v243, v90, v91
    v_max3_f32 v240, v240, v92, v93
    v_max3_f32 v243, v243, v94, v95
    v_max_f32 v243, v243, v240
aqk_b4:
    ds_read_b128 v[24:27], v54
    ds_read_b128 v[28:31], v54 offset:1024
    s_waitcnt lgkmcnt(4)
    v_mfma_f32_32x32x16_bf16 v[128:143], v[32:35], v[16:19], 0
    v_mfma_f32_32x32x16_bf16 v[128:143], v[36:39], v[20:23], v[128:143]
    buffer_store_dwordx4 v[184:187], v3, s[24:27], s43 offen offset:2048 sc1
    v_max3_f32 v244, v96, v97, v98
    v_max3_f32 v240, v99, v100, v101
    v_max3_f32 v244, v244, v102, v103
    v_max3_f32 v240, v240, v104, v105
    v_max3_f32 v244, v244, v106, v107
    v_max3_f32 v240, v240, v108, v109
    v_max3_f32 v244, v244, v110, v111
    v_max_f32 v244, v244, v240
aqk_b5:
    ds_read_b128 v[32:35], v55
    ds_read_b128 v[36:39], v55 offset:1024
    s_waitcnt lgkmcnt(4)
    v_mfma_f32_32x32x16_bf16 v[144:159], v[40:43], v[16:19], 0
    v_mfma_f32_32x32x16_bf16 v[144:159], v[44:47], v[20:23], v[144:159]
    buffer_store_dwordx4 v[188:191], v3, s[24:27], s43 offen offset:3072 sc1
    v_max3_f32 v245, v112, v113, v114
    v_max3_f32 v240, v115, v116, v117
    v_max3_f32 v245, v245, v118, v119
    v_max3_f32 v240, v240, v120, v121
    v_max3_f32 v245, v245, v122, v123
    v_max3_f32 v240, v240, v124, v125
    v_max3_f32 v245, v245, v126, v127
    v_max_f32 v245, v245, v240
aqk_b6:
    ds_read_b128 v[40:43], v56
    ds_read_b128 v[44:47], v56 offset:1024
    s_waitcnt lgkmcnt(4)
    v_mfma_f32_32x32x16_bf16 v[160:175], v[24:27], v[16:19], 0
    v_mfma_f32_32x32x16_bf16 v[160:175], v[28:31], v[20:23], v[160:175]
    v_max3_f32 v246, v128, v129, v130
    v_max3_f32 v240, v131, v132, v133
    v_max3_f32 v246, v246, v134, v135
    v_max3_f32 v240, v240, v136, v137
    v_max3_f32 v246, v246, v138, v139
    v_max3_f32 v240, v240, v140, v141
    v_max3_f32 v246, v246, v142, v143
    v_max_f32 v246, v246, v240
aqk_b7:
    s_waitcnt lgkmcnt(2)
    v_mfma_f32_32x32x16_bf16 v[176:191], v[32:35], v[16:19], 0
    v_mfma_f32_32x32x16_bf16 v[176:191], v[36:39], v[20:23], v[176:191]
    v_max3_f32 v247, v144, v145, v146
    v_max3_f32 v240, v147, v148, v149
    v_max3_f32 v247, v247, v150, v151
    v_max3_f32 v240, v240, v152, v153
    v_max3_f32 v247, v247, v154, v155
    v_max3_f32 v240, v240, v156, v157
    v_max3_f32 v247, v247, v158, v159
    v_max_f32 v247, v247, v240
aqk_b8:
    s_waitcnt lgkmcnt(0)
    v_mfma_f32_32x32x16_bf16 v[192:207], v[40:43], v[16:19], v[192:207]
    v_mfma_f32_32x32x16_bf16 v[192:207], v[44:47], v[20:23], v[192:207]
    v_max3_f32 v248, v160, v161, v162
    v_max3_f32 v240, v163, v164, v165
    v_max3_f32 v248, v248, v166, v167
    v_max3_f32 v240, v240, v168, v169
    v_max3_f32 v248, v248, v170, v171
    v_max3_f32 v240, v240, v172, v173
    v_max3_f32 v248, v248, v174, v175
    v_max_f32 v248, v248, v240
    v_max3_f32 v249, v176, v177, v178
    v_max3_f32 v240, v179, v180, v181
    v_max3_f32 v249, v249, v182, v183
    v_max3_f32 v240, v240, v184, v185
    v_max3_f32 v249, v249, v186, v187
    v_max3_f32 v240, v240, v188, v189
    v_max3_f32 v249, v249, v190, v191
    v_max_f32 v249, v249, v240
    ds_read_b128 v[24:27], v48 offset:32768
    ds_read_b128 v[28:31], v48 offset:33792
    ds_read_b128 v[32:35], v49 offset:32768
    ds_read_b128 v[36:39], v49 offset:33792
    v_max3_f32 v250, v192, v193, v194
    v_max3_f32 v240, v195, v196, v197
    v_max3_f32 v250, v250, v198, v199
    v_max3_f32 v240, v240, v200, v201
    v_max3_f32 v250, v250, v202, v203
    v_max3_f32 v240, v240, v204, v205
    v_max3_f32 v250, v250, v206, v207
    v_max_f32 v250, v250, v240
    ds_read_b128 v[40:43], v50 offset:32768
    ds_read_b128 v[44:47], v50 offset:33792
    v_mov_b32 v252, v58
    v_mov_b32 v254, v60
    v_max_f32 v252, v252, v242
    s_cmp_eq_u32 s44, 1
    s_cbranch_scc1 amx_b1
    v_max_f32 v252, v252, v243
    s_cmp_eq_u32 s44, 2
    s_cbranch_scc1 amx_b2
    v_max_f32 v252, v252, v244
    s_cmp_eq_u32 s44, 3
    s_cbranch_scc1 amx_b3
    v_max_f32 v252, v252, v245
    s_cmp_eq_u32 s44, 4
    s_cbranch_scc1 amx_b4
    v_max_f32 v252, v252, v246
    s_cmp_eq_u32 s44, 5
    s_cbranch_scc1 amx_b5
    v_max_f32 v252, v252, v247
    s_cmp_eq_u32 s44, 6
    s_cbranch_scc1 amx_b6
    v_max_f32 v252, v252, v248
    s_cmp_eq_u32 s44, 7
    s_cbranch_scc1 amx_b7
    v_max_f32 v252, v252, v249
    s_branch amx_b8
amx_b1:
    v_max_f32 v254, v254, v243
amx_b2:
    v_max_f32 v254, v254, v244
amx_b3:
    v_max_f32 v254, v254, v245
amx_b4:
    v_max_f32 v254, v254, v246
amx_b5:
    v_max_f32 v254, v254, v247
amx_b6:
    v_max_f32 v254, v254, v248
amx_b7:
    v_max_f32 v254, v254, v249
amx_b8:
    v_max_f32 v254, v254, v250
    v_mov_b32 v253, v252
    v_mov_b32 v255, v254
    s_nop 1
    v_permlane32_swap_b32 v252, v253
    v_permlane32_swap_b32 v254, v255
    s_nop 1
    v_max_f32 v252, v252, v253
    v_sub_f32 v253, v58, v252
    v_exp_f32 v253, v253
    v_mov_b32 v58, v252
    v_max_f32 v254, v254, v255
    v_sub_f32 v255, v60, v254
    v_exp_f32 v255, v255
    v_mov_b32 v60, v254
    s_cmp_eq_u32 s38, 0
    s_cbranch_scc1 att_sp1
    v_pk_mul_f32 v[208:209], v[208:209], v[252:253] op_sel:[0,1] op_sel_hi:[1,1]
    v_pk_mul_f32 v[210:211], v[210:211], v[252:253] op_sel:[0,1] op_sel_hi:[1,1]
    v_pk_mul_f32 v[212:213], v[212:213], v[252:253] op_sel:[0,1] op_sel_hi:[1,1]
    v_pk_mul_f32 v[214:215], v[214:215], v[252:253] op_sel:[0,1] op_sel_hi:[1,1]
    v_pk_mul_f32 v[216:217], v[216:217], v[252:253] op_sel:[0,1] op_sel_hi:[1,1]
    v_pk_mul_f32 v[218:219], v[218:219], v[252:253] op_sel:[0,1] op_sel_hi:[1,1]
    v_pk_mul_f32 v[220:221], v[220:221], v[252:253] op_sel:[0,1] op_sel_hi:[1,1]
    v_pk_mul_f32 v[222:223], v[222:223], v[252:253] op_sel:[0,1] op_sel_hi:[1,1]
    v_pk_mul_f32 v[62:63], v[62:63], v[252:253] op_sel:[0,1] op_sel_hi:[1,1]
    v_pk_mul_f32 v[224:225], v[224:225], v[254:255] op_sel:[0,1] op_sel_hi:[1,1]
    v_pk_mul_f32 v[226:227], v[226:227], v[254:255] op_sel:[0,1] op_sel_hi:[1,1]
    v_pk_mul_f32 v[228:229], v[228:229], v[254:255] op_sel:[0,1] op_sel_hi:[1,1]
    v_pk_mul_f32 v[230:231], v[230:231], v[254:255] op_sel:[0,1] op_sel_hi:[1,1]
    v_pk_mul_f32 v[232:233], v[232:233], v[254:255] op_sel:[0,1] op_sel_hi:[1,1]
    v_pk_mul_f32 v[234:235], v[234:235], v[254:255] op_sel:[0,1] op_sel_hi:[1,1]
    v_pk_mul_f32 v[236:237], v[236:237], v[254:255] op_sel:[0,1] op_sel_hi:[1,1]
    v_pk_mul_f32 v[238:239], v[238:239], v[254:255] op_sel:[0,1] op_sel_hi:[1,1]
    v_pk_mul_f32 v[6:7], v[6:7], v[254:255] op_sel:[0,1] op_sel_hi:[1,1]
    s_branch att_sp1x
att_sp1:
att_sp1x:
    v_pk_add_f32 v[64:65], v[64:65], v[58:59] op_sel_hi:[1,0] neg_lo:[0,1] neg_hi:[0,1]
    v_pk_add_f32 v[66:67], v[66:67], v[58:59] op_sel_hi:[1,0] neg_lo:[0,1] neg_hi:[0,1]
    v_pk_add_f32 v[68:69], v[68:69], v[58:59] op_sel_hi:[1,0] neg_lo:[0,1] neg_hi:[0,1]
    v_pk_add_f32 v[70:71], v[70:71], v[58:59] op_sel_hi:[1,0] neg_lo:[0,1] neg_hi:[0,1]
    v_pk_add_f32 v[72:73], v[72:73], v[58:59] op_sel_hi:[1,0] neg_lo:[0,1] neg_hi:[0,1]
    v_pk_add_f32 v[74:75], v[74:75], v[58:59] op_sel_hi:[1,0] neg_lo:[0,1] neg_hi:[0,1]
    v_pk_add_f32 v[76:77], v[76:77], v[58:59] op_sel_hi:[1,0] neg_lo:[0,1] neg_hi:[0,1]
    v_pk_add_f32 v[78:79], v[78:79], v[58:59] op_sel_hi:[1,0] neg_lo:[0,1] neg_hi:[0,1]
    v_exp_f32 v64, v64
    v_exp_f32 v65, v65
    v_exp_f32 v66, v66
    v_exp_f32 v67, v67
    v_exp_f32 v68, v68
    v_exp_f32 v69, v69
    v_exp_f32 v70, v70
    v_exp_f32 v71, v71
    v_exp_f32 v72, v72
    v_exp_f32 v73, v73
    v_exp_f32 v74, v74
    v_exp_f32 v75, v75
    v_exp_f32 v76, v76
    v_exp_f32 v77, v77
    v_exp_f32 v78, v78
    v_exp_f32 v79, v79
    v_cvt_pk_bf16_f32 v240, v64, v65
    v_cvt_pk_bf16_f32 v241, v66, v67
    v_cvt_pk_bf16_f32 v242, v68, v69
    v_cvt_pk_bf16_f32 v243, v70, v71
    v_cvt_pk_bf16_f32 v244, v72, v73
    v_cvt_pk_bf16_f32 v245, v74, v75
    v_cvt_pk_bf16_f32 v246, v76, v77
    v_cvt_pk_bf16_f32 v247, v78, v79
    v_pk_add_f32 v[62:63], v[62:63], v[64:65]
    v_pk_add_f32 v[62:63], v[62:63], v[66:67]
    v_pk_add_f32 v[62:63], v[62:63], v[68:69]
    v_pk_add_f32 v[62:63], v[62:63], v[70:71]
    v_pk_add_f32 v[62:63], v[62:63], v[72:73]
    v_pk_add_f32 v[62:63], v[62:63], v[74:75]
    v_pk_add_f32 v[62:63], v[62:63], v[76:77]
    v_pk_add_f32 v[62:63], v[62:63], v[78:79]
    s_waitcnt lgkmcnt(4)
    v_mfma_f32_32x32x16_bf16 v[208:223], v[24:27], v[240:243], v[208:223]
    v_mfma_f32_32x32x16_bf16 v[208:223], v[28:31], v[244:247], v[208:223]
    ds_read_b128 v[24:27], v51 offset:32768
    ds_read_b128 v[28:31], v51 offset:33792
    s_cmp_eq_u32 s44, 1
    s_cbranch_scc1 aex_b1
    s_or_b32 s49, s38, 0
    s_cbranch_scc1 att_sp1ya
    v_mov_b32 v57, 1
    s_waitcnt vmcnt(0)
    buffer_store_dword v57, v1, s[16:19], s39 offen sc1
att_sp1ya:
    v_pk_add_f32 v[80:81], v[80:81], v[58:59] op_sel_hi:[1,0] neg_lo:[0,1] neg_hi:[0,1]
    v_pk_add_f32 v[82:83], v[82:83], v[58:59] op_sel_hi:[1,0] neg_lo:[0,1] neg_hi:[0,1]
    v_pk_add_f32 v[84:85], v[84:85], v[58:59] op_sel_hi:[1,0] neg_lo:[0,1] neg_hi:[0,1]
    v_pk_add_f32 v[86:87], v[86:87], v[58:59] op_sel_hi:[1,0] neg_lo:[0,1] neg_hi:[0,1]
    v_pk_add_f32 v[88:89], v[88:89], v[58:59] op_sel_hi:[1,0] neg_lo:[0,1] neg_hi:[0,1]
    v_pk_add_f32 v[90:91], v[90:91], v[58:59] op_sel_hi:[1,0] neg_lo:[0,1] neg_hi:[0,1]
    v_pk_add_f32 v[92:93], v[92:93], v[58:59] op_sel_hi:[1,0] neg_lo:[0,1] neg_hi:[0,1]
    v_pk_add_f32 v[94:95], v[94:95], v[58:59] op_sel_hi:[1,0] neg_lo:[0,1] neg_hi:[0,1]
    v_exp_f32 v80, v80
    v_exp_f32 v81, v81
    v_exp_f32 v82, v82
    v_exp_f32 v83, v83
    v_exp_f32 v84, v84
    v_exp_f32 v85, v85
    v_exp_f32 v86, v86
    v_exp_f32 v87, v87
    v_exp_f32 v88, v88
    v_exp_f32 v89, v89
    v_exp_f32 v90, v90
    v_exp_f32 v91, v91
    v_exp_f32 v92, v92
    v_exp_f32 v93, v93
    v_exp_f32 v94, v94
    v_exp_f32 v95, v95
    v_cvt_pk_bf16_f32 v248, v80, v81
    v_cvt_pk_bf16_f32 v249, v82, v83
    v_cvt_pk_bf16_f32 v250, v84, v85
    v_cvt_pk_bf16_f32 v251, v86, v87
    v_cvt_pk_bf16_f32 v252, v88, v89
    v_cvt_pk_bf16_f32 v253, v90, v91
    v_cvt_pk_bf16_f32 v254, v92, v93
    v_cvt_pk_bf16_f32 v255, v94, v95
    v_pk_add_f32 v[62:63], v[62:63], v[80:81]
    v_pk_add_f32 v[62:63], v[62:63], v[82:83]
    v_pk_add_f32 v[62:63], v[62:63], v[84:85]
    v_pk_add_f32 v[62:63], v[62:63], v[86:87]
    v_pk_add_f32 v[62:63], v[62:63], v[88:89]
    v_pk_add_f32 v[62:63], v[62:63], v[90:91]
    v_pk_add_f32 v[62:63], v[62:63], v[92:93]
    v_pk_add_f32 v[62:63], v[62:63], v[94:95]
    s_waitcnt lgkmcnt(4)
    v_mfma_f32_32x32x16_bf16 v[208:223], v[32:35], v[248:251], v[208:223]
    v_mfma_f32_32x32x16_bf16 v[208:223], v[36:39], v[252:255], v[208:223]
    ds_read_b128 v[32:35], v52 offset:32768
    ds_read_b128 v[36:39], v52 offset:33792
    s_cmp_eq_u32 s44, 2
    s_cbranch_scc1 aex_b2
    v_pk_add_f32 v[96:97], v[96:97], v[58:59] op_sel_hi:[1,0] neg_lo:[0,1] neg_hi:[0,1]
    v_pk_add_f32 v[98:99], v[98:99], v[58:59] op_sel_hi:[1,0] neg_lo:[0,1] neg_hi:[0,1]
    v_pk_add_f32 v[100:101], v[100:101], v[58:59] op_sel_hi:[1,0] neg_lo:[0,1] neg_hi:[0,1]
    v_pk_add_f32 v[102:103], v[102:103], v[58:59] op_sel_hi:[1,0] neg_lo:[0,1] neg_hi:[0,1]
    v_pk_add_f32 v[104:105], v[104:105], v[58:59] op_sel_hi:[1,0] neg_lo:[0,1] neg_hi:[0,1]
    v_pk_add_f32 v[106:107], v[106:107], v[58:59] op_sel_hi:[1,0] neg_lo:[0,1] neg_hi:[0,1]
    v_pk_add_f32 v[108:109], v[108:109], v[58:59] op_sel_hi:[1,0] neg_lo:[0,1] neg_hi:[0,1]
    v_pk_add_f32 v[110:111], v[110:111], v[58:59] op_sel_hi:[1,0] neg_lo:[0,1] neg_hi:[0,1]
    v_exp_f32 v96, v96
    v_exp_f32 v97, v97
    v_exp_f32 v98, v98
    v_exp_f32 v99, v99
    v_exp_f32 v100, v100
    v_exp_f32 v101, v101
    v_exp_f32 v102, v102
    v_exp_f32 v103, v103
    v_exp_f32 v104, v104
    v_exp_f32 v105, v105
    v_exp_f32 v106, v106
    v_exp_f32 v107, v107
    v_exp_f32 v108, v108
    v_exp_f32 v109, v109
    v_exp_f32 v110, v110
    v_exp_f32 v111, v111
    v_cvt_pk_bf16_f32 v240, v96, v97
    v_cvt_pk_bf16_f32 v241, v98, v99
    v_cvt_pk_bf16_f32 v242, v100, v101
    v_cvt_pk_bf16_f32 v243, v102, v103
    v_cvt_pk_bf16_f32 v244, v104, v105
    v_cvt_pk_bf16_f32 v245, v106, v107
    v_cvt_pk_bf16_f32 v246, v108, v109
    v_cvt_pk_bf16_f32 v247, v110, v111
    v_pk_add_f32 v[62:63], v[62:63], v[96:97]
    v_pk_add_f32 v[62:63], v[62:63], v[98:99]
    v_pk_add_f32 v[62:63], v[62:63], v[100:101]
    v_pk_add_f32 v[62:63], v[62:63], v[102:103]
    v_pk_add_f32 v[62:63], v[62:63], v[104:105]
    v_pk_add_f32 v[62:63], v[62:63], v[106:107]
    v_pk_add_f32 v[62:63], v[62:63], v[108:109]
    v_pk_add_f32 v[62:63], v[62:63], v[110:111]
    s_waitcnt lgkmcnt(4)
    v_mfma_f32_32x32x16_bf16 v[208:223], v[40:43], v[240:243], v[208:223]
    v_mfma_f32_32x32x16_bf16 v[208:223], v[44:47], v[244:247], v[208:223]
    ds_read_b128 v[40:43], v53 offset:32768
    ds_read_b128 v[44:47], v53 offset:33792
    s_cmp_eq_u32 s44, 3
    s_cbranch_scc1 aex_b3
    v_pk_add_f32 v[112:113], v[112:113], v[58:59] op_sel_hi:[1,0] neg_lo:[0,1] neg_hi:[0,1]
    v_pk_add_f32 v[114:115], v[114:115], v[58:59] op_sel_hi:[1,0] neg_lo:[0,1] neg_hi:[0,1]
    v_pk_add_f32 v[116:117], v[116:117], v[58:59] op_sel_hi:[1,0] neg_lo:[0,1] neg_hi:[0,1]
    v_pk_add_f32 v[118:119], v[118:119], v[58:59] op_sel_hi:[1,0] neg_lo:[0,1] neg_hi:[0,1]
    v_pk_add_f32 v[120:121], v[120:121], v[58:59] op_sel_hi:[1,0] neg_lo:[0,1] neg_hi:[0,1]
    v_pk_add_f32 v[122:123], v[122:123], v[58:59] op_sel_hi:[1,0] neg_lo:[0,1] neg_hi:[0,1]
    v_pk_add_f32 v[124:125], v[124:125], v[58:59] op_sel_hi:[1,0] neg_lo:[0,1] neg_hi:[0,1]
    v_pk_add_f32 v[126:127], v[126:127], v[58:59] op_sel_hi:[1,0] neg_lo:[0,1] neg_hi:[0,1]
    v_exp_f32 v112, v112
    v_exp_f32 v113, v113
    v_exp_f32 v114, v114
    v_exp_f32 v115, v115
    v_exp_f32 v116, v116
    v_exp_f32 v117, v117
    v_exp_f32 v118, v118
    v_exp_f32 v119, v119
    v_exp_f32 v120, v120
    v_exp_f32 v121, v121
    v_exp_f32 v122, v122
    v_exp_f32 v123, v123
    v_exp_f32 v124, v124
    v_exp_f32 v125, v125
    v_exp_f32 v126, v126
    v_exp_f32 v127, v127
    v_cvt_pk_bf16_f32 v248, v112, v113
    v_cvt_pk_bf16_f32 v249, v114, v115
    v_cvt_pk_bf16_f32 v250, v116, v117
    v_cvt_pk_bf16_f32 v251, v118, v119
    v_cvt_pk_bf16_f32 v252, v120, v121
    v_cvt_pk_bf16_f32 v253, v122, v123
    v_cvt_pk_bf16_f32 v254, v124, v125
    v_cvt_pk_bf16_f32 v255, v126, v127
    v_pk_add_f32 v[62:63], v[62:63], v[112:113]
    v_pk_add_f32 v[62:63], v[62:63], v[114:115]
    v_pk_add_f32 v[62:63], v[62:63], v[116:117]
    v_pk_add_f32 v[62:63], v[62:63], v[118:119]
    v_pk_add_f32 v[62:63], v[62:63], v[120:121]
    v_pk_add_f32 v[62:63], v[62:63], v[122:123]
    v_pk_add_f32 v[62:63], v[62:63], v[124:125]
    v_pk_add_f32 v[62:63], v[62:63], v[126:127]
    s_waitcnt lgkmcnt(4)
    v_mfma_f32_32x32x16_bf16 v[208:223], v[24:27], v[248:251], v[208:223]
    v_mfma_f32_32x32x16_bf16 v[208:223], v[28:31], v[252:255], v[208:223]
    ds_read_b128 v[24:27], v54 offset:32768
    ds_read_b128 v[28:31], v54 offset:33792
    s_cmp_eq_u32 s44, 4
    s_cbranch_scc1 aex_b4
    v_pk_add_f32 v[128:129], v[128:129], v[58:59] op_sel_hi:[1,0] neg_lo:[0,1] neg_hi:[0,1]
    v_pk_add_f32 v[130:131], v[130:131], v[58:59] op_sel_hi:[1,0] neg_lo:[0,1] neg_hi:[0,1]
    v_pk_add_f32 v[132:133], v[132:133], v[58:59] op_sel_hi:[1,0] neg_lo:[0,1] neg_hi:[0,1]
    v_pk_add_f32 v[134:135], v[134:135], v[58:59] op_sel_hi:[1,0] neg_lo:[0,1] neg_hi:[0,1]
    v_pk_add_f32 v[136:137], v[136:137], v[58:59] op_sel_hi:[1,0] neg_lo:[0,1] neg_hi:[0,1]
    v_pk_add_f32 v[138:139], v[138:139], v[58:59] op_sel_hi:[1,0] neg_lo:[0,1] neg_hi:[0,1]
    v_pk_add_f32 v[140:141], v[140:141], v[58:59] op_sel_hi:[1,0] neg_lo:[0,1] neg_hi:[0,1]
    v_pk_add_f32 v[142:143], v[142:143], v[58:59] op_sel_hi:[1,0] neg_lo:[0,1] neg_hi:[0,1]
    v_exp_f32 v128, v128
    v_exp_f32 v129, v129
    v_exp_f32 v130, v130
    v_exp_f32 v131, v131
    v_exp_f32 v132, v132
    v_exp_f32 v133, v133
    v_exp_f32 v134, v134
    v_exp_f32 v135, v135
    v_exp_f32 v136, v136
    v_exp_f32 v137, v137
    v_exp_f32 v138, v138
    v_exp_f32 v139, v139
    v_exp_f32 v140, v140
    v_exp_f32 v141, v141
    v_exp_f32 v142, v142
    v_exp_f32 v143, v143
    v_cvt_pk_bf16_f32 v240, v128, v129
    v_cvt_pk_bf16_f32 v241, v130, v131
    v_cvt_pk_bf16_f32 v242, v132, v133
    v_cvt_pk_bf16_f32 v243, v134, v135
    v_cvt_pk_bf16_f32 v244, v136, v137
    v_cvt_pk_bf16_f32 v245, v138, v139
    v_cvt_pk_bf16_f32 v246, v140, v141
    v_cvt_pk_bf16_f32 v247, v142, v143
    v_pk_add_f32 v[62:63], v[62:63], v[128:129]
    v_pk_add_f32 v[62:63], v[62:63], v[130:131]
    v_pk_add_f32 v[62:63], v[62:63], v[132:133]
    v_pk_add_f32 v[62:63], v[62:63], v[134:135]
    v_pk_add_f32 v[62:63], v[62:63], v[136:137]
    v_pk_add_f32 v[62:63], v[62:63], v[138:139]
    v_pk_add_f32 v[62:63], v[62:63], v[140:141]
    v_pk_add_f32 v[62:63], v[62:63], v[142:143]
    s_waitcnt lgkmcnt(4)
    v_mfma_f32_32x32x16_bf16 v[208:223], v[32:35], v[240:243], v[208:223]
    v_mfma_f32_32x32x16_bf16 v[208:223], v[36:39], v[244:247], v[208:223]
    ds_read_b128 v[32:35], v55 offset:32768
    ds_read_b128 v[36:39], v55 offset:33792
    s_cmp_eq_u32 s44, 5
    s_cbranch_scc1 aex_b5
    s_or_b32 s49, s38, 0
    s_cbranch_scc1 att_sp2xa
    s_cmp_eq_u32 s33, 0
    s_cbranch_scc1 att_sp2ta
    s_mov_b32 s49, 0
att_polla:
    buffer_load_dword v57, v1, s[16:19], s40 offen sc1
    s_waitcnt vmcnt(0)
    v_cmp_ne_u32 vcc, 0, v57
    s_cbranch_vccnz att_gota
    s_sleep 1
    s_add_u32 s49, s49, 1
    s_cmp_lt_u32 s49, 200000
    s_cbranch_scc1 att_polla
att_gota:
    s_add_u32 m0, s41, 0
    s_sub_u32 s49, s42, 65536
    buffer_load_dwordx4 v3, s[12:15], s49 offen offset:0 sc1 lds
    buffer_load_dwordx4 v3, s[12:15], s49 offen offset:1024 sc1 lds
    buffer_load_dwordx4 v3, s[12:15], s49 offen offset:2048 sc1 lds
    buffer_load_dwordx4 v3, s[12:15], s49 offen offset:3072 sc1 lds
    s_add_u32 m0, s41, 4096
    s_sub_u32 s49, s42, 61440
    buffer_load_dwordx4 v3, s[12:15], s49 offen offset:0 sc1 lds
    buffer_load_dwordx4 v3, s[12:15], s49 offen offset:1024 sc1 lds
    buffer_load_dwordx4 v3, s[12:15], s49 offen offset:2048 sc1 lds
    buffer_load_dwordx4 v3, s[12:15], s49 offen offset:3072 sc1 lds
att_sp2ta:
att_sp2xa:
    v_pk_add_f32 v[144:145], v[144:145], v[58:59] op_sel_hi:[1,0] neg_lo:[0,1] neg_hi:[0,1]
    v_pk_add_f32 v[146:147], v[146:147], v[58:59] op_sel_hi:[1,0] neg_lo:[0,1] neg_hi:[0,1]
    v_pk_add_f32 v[148:149], v[148:149], v[58:59] op_sel_hi:[1,0] neg_lo:[0,1] neg_hi:[0,1]
    v_pk_add_f32 v[150:151], v[150:151], v[58:59] op_sel_hi:[1,0] neg_lo:[0,1] neg_hi:[0,1]
    v_pk_add_f32 v[152:153], v[152:153], v[58:59] op_sel_hi:[1,0] neg_lo:[0,1] neg_hi:[0,1]
    v_pk_add_f32 v[154:155], v[154:155], v[58:59] op_sel_hi:[1,0] neg_lo:[0,1] neg_hi:[0,1]
    v_pk_add_f32 v[156:157], v[156:157], v[58:59] op_sel_hi:[1,0] neg_lo:[0,1] neg_hi:[0,1]
    v_pk_add_f32 v[158:159], v[158:159], v[58:59] op_sel_hi:[1,0] neg_lo:[0,1] neg_hi:[0,1]
    v_exp_f32 v144, v144
    v_exp_f32 v145, v145
    v_exp_f32 v146, v146
    v_exp_f32 v147, v147
    v_exp_f32 v148, v148
    v_exp_f32 v149, v149
    v_exp_f32 v150, v150
    v_exp_f32 v151, v151
    v_exp_f32 v152, v152
    v_exp_f32 v153, v153
    v_exp_f32 v154, v154
    v_exp_f32 v155, v155
    v_exp_f32 v156, v156
    v_exp_f32 v157, v157
    v_exp_f32 v158, v158
    v_exp_f32 v159, v159
    v_cvt_pk_bf16_f32 v248, v144, v145
    v_cvt_pk_bf16_f32 v249, v146, v147
    v_cvt_pk_bf16_f32 v250, v148, v149
    v_cvt_pk_bf16_f32 v251, v150, v151
    v_cvt_pk_bf16_f32 v252, v152, v153
    v_cvt_pk_bf16_f32 v253, v154, v155
    v_cvt_pk_bf16_f32 v254, v156, v157
    v_cvt_pk_bf16_f32 v255, v158, v159
    v_pk_add_f32 v[62:63], v[62:63], v[144:145]
    v_pk_add_f32 v[62:63], v[62:63], v[146:147]
    v_pk_add_f32 v[62:63], v[62:63], v[148:149]
    v_pk_add_f32 v[62:63], v[62:63], v[150:151]
    v_pk_add_f32 v[62:63], v[62:63], v[152:153]
    v_pk_add_f32 v[62:63], v[62:63], v[154:155]
    v_pk_add_f32 v[62:63], v[62:63], v[156:157]
    v_pk_add_f32 v[62:63], v[62:63], v[158:159]
    s_waitcnt lgkmcnt(4)
    v_mfma_f32_32x32x16_bf16 v[208:223], v[40:43], v[248:251], v[208:223]
    v_mfma_f32_32x32x16_bf16 v[208:223], v[44:47], v[252:255], v[208:223]
    ds_read_b128 v[40:43], v56 offset:32768
    ds_read_b128 v[44:47], v56 offset:33792
    s_cmp_eq_u32 s44, 6
    s_cbranch_scc1 aex_b6
    v_pk_add_f32 v[160:161], v[160:161], v[58:59] op_sel_hi:[1,0] neg_lo:[0,1] neg_hi:[0,1]
    v_pk_add_f32 v[162:163], v[162:163], v[58:59] op_sel_hi:[1,0] neg_lo:[0,1] neg_hi:[0,1]
    v_pk_add_f32 v[164:165], v[164:165], v[58:59] op_sel_hi:[1,0] neg_lo:[0,1] neg_hi:[0,1]
    v_pk_add_f32 v[166:167], v[166:167], v[58:59] op_sel_hi:[1,0] neg_lo:[0,1] neg_hi:[0,1]
    v_pk_add_f32 v[168:169], v[168:169], v[58:59] op_sel_hi:[1,0] neg_lo:[0,1] neg_hi:[0,1]
    v_pk_add_f32 v[170:171], v[170:171], v[58:59] op_sel_hi:[1,0] neg_lo:[0,1] neg_hi:[0,1]
    v_pk_add_f32 v[172:173], v[172:173], v[58:59] op_sel_hi:[1,0] neg_lo:[0,1] neg_hi:[0,1]
    v_pk_add_f32 v[174:175], v[174:175], v[58:59] op_sel_hi:[1,0] neg_lo:[0,1] neg_hi:[0,1]
    v_exp_f32 v160, v160
    v_exp_f32 v161, v161
    v_exp_f32 v162, v162
    v_exp_f32 v163, v163
    v_exp_f32 v164, v164
    v_exp_f32 v165, v165
    v_exp_f32 v166, v166
    v_exp_f32 v167, v167
    v_exp_f32 v168, v168
    v_exp_f32 v169, v169
    v_exp_f32 v170, v170
    v_exp_f32 v171, v171
    v_exp_f32 v172, v172
    v_exp_f32 v173, v173
    v_exp_f32 v174, v174
    v_exp_f32 v175, v175
    v_cvt_pk_bf16_f32 v240, v160, v161
    v_cvt_pk_bf16_f32 v241, v162, v163
    v_cvt_pk_bf16_f32 v242, v164, v165
    v_cvt_pk_bf16_f32 v243, v166, v167
    v_cvt_pk_bf16_f32 v244, v168, v169
    v_cvt_pk_bf16_f32 v245, v170, v171
    v_cvt_pk_bf16_f32 v246, v172, v173
    v_cvt_pk_bf16_f32 v247, v174, v175
    v_pk_add_f32 v[62:63], v[62:63], v[160:161]
    v_pk_add_f32 v[62:63], v[62:63], v[162:163]
    v_pk_add_f32 v[62:63], v[62:63], v[164:165]
    v_pk_add_f32 v[62:63], v[62:63], v[166:167]
    v_pk_add_f32 v[62:63], v[62:63], v[168:169]
    v_pk_add_f32 v[62:63], v[62:63], v[170:171]
    v_pk_add_f32 v[62:63], v[62:63], v[172:173]
    v_pk_add_f32 v[62:63], v[62:63], v[174:175]
    s_waitcnt lgkmcnt(4)
    v_mfma_f32_32x32x16_bf16 v[208:223], v[24:27], v[240:243], v[208:223]
    v_mfma_f32_32x32x16_bf16 v[208:223], v[28:31], v[244:247], v[208:223]
    s_cmp_eq_u32 s44, 7
    s_cbranch_scc1 aex_b7
    v_pk_add_f32 v[176:177], v[176:177], v[58:59] op_sel_hi:[1,0] neg_lo:[0,1] neg_hi:[0,1]
    v_pk_add_f32 v[178:179], v[178:179], v[58:59] op_sel_hi:[1,0] neg_lo:[0,1] neg_hi:[0,1]
    v_pk_add_f32 v[180:181], v[180:181], v[58:59] op_sel_hi:[1,0] neg_lo:[0,1] neg_hi:[0,1]
    v_pk_add_f32 v[182:183], v[182:183], v[58:59] op_sel_hi:[1,0] neg_lo:[0,1] neg_hi:[0,1]
    v_pk_add_f32 v[184:185], v[184:185], v[58:59] op_sel_hi:[1,0] neg_lo:[0,1] neg_hi:[0,1]
    v_pk_add_f32 v[186:187], v[186:187], v[58:59] op_sel_hi:[1,0] neg_lo:[0,1] neg_hi:[0,1]
    v_pk_add_f32 v[188:189], v[188:189], v[58:59] op_sel_hi:[1,0] neg_lo:[0,1] neg_hi:[0,1]
    v_pk_add_f32 v[190:191], v[190:191], v[58:59] op_sel_hi:[1,0] neg_lo:[0,1] neg_hi:[0,1]
    v_exp_f32 v176, v176
    v_exp_f32 v177, v177
    v_exp_f32 v178, v178
    v_exp_f32 v179, v179
    v_exp_f32 v180, v180
    v_exp_f32 v181, v181
    v_exp_f32 v182, v182
    v_exp_f32 v183, v183
    v_exp_f32 v184, v184
    v_exp_f32 v185, v185
    v_exp_f32 v186, v186
    v_exp_f32 v187, v187
    v_exp_f32 v188, v188
    v_exp_f32 v189, v189
    v_exp_f32 v190, v190
    v_exp_f32 v191, v191
    v_cvt_pk_bf16_f32 v248, v176, v177
    v_cvt_pk_bf16_f32 v249, v178, v179
    v_cvt_pk_bf16_f32 v250, v180, v181
    v_cvt_pk_bf16_f32 v251, v182, v183
    v_cvt_pk_bf16_f32 v252, v184, v185
    v_cvt_pk_bf16_f32 v253, v186, v187
    v_cvt_pk_bf16_f32 v254, v188, v189
    v_cvt_pk_bf16_f32 v255, v190, v191
    v_pk_add_f32 v[62:63], v[62:63], v[176:177]
    v_pk_add_f32 v[62:63], v[62:63], v[178:179]
    v_pk_add_f32 v[62:63], v[62:63], v[180:181]
    v_pk_add_f32 v[62:63], v[62:63], v[182:183]
    v_pk_add_f32 v[62:63], v[62:63], v[184:185]
    v_pk_add_f32 v[62:63], v[62:63], v[186:187]
    v_pk_add_f32 v[62:63], v[62:63], v[188:189]
    v_pk_add_f32 v[62:63], v[62:63], v[190:191]
    s_waitcnt lgkmcnt(2)
    v_mfma_f32_32x32x16_bf16 v[208:223], v[32:35], v[248:251], v[208:223]
    v_mfma_f32_32x32x16_bf16 v[208:223], v[36:39], v[252:255], v[208:223]
    s_branch aex_b8
aex_b1:
    s_or_b32 s49, s38, 0
    s_cbranch_scc1 att_sp1yb
    v_mov_b32 v57, 1
    s_waitcnt vmcnt(0)
    buffer_store_dword v57, v1, s[16:19], s39 offen sc1
att_sp1yb:
    v_pk_add_f32 v[80:81], v[80:81], v[60:61] op_sel_hi:[1,0] neg_lo:[0,1] neg_hi:[0,1]
    v_pk_add_f32 v[82:83], v[82:83], v[60:61] op_sel_hi:[1,0] neg_lo:[0,1] neg_hi:[0,1]
    v_pk_add_f32 v[84:85], v[84:85], v[60:61] op_sel_hi:[1,0] neg_lo:[0,1] neg_hi:[0,1]
    v_pk_add_f32 v[86:87], v[86:87], v[60:61] op_sel_hi:[1,0] neg_lo:[0,1] neg_hi:[0,1]
    v_pk_add_f32 v[88:89], v[88:89], v[60:61] op_sel_hi:[1,0] neg_lo:[0,1] neg_hi:[0,1]
    v_pk_add_f32 v[90:91], v[90:91], v[60:61] op_sel_hi:[1,0] neg_lo:[0,1] neg_hi:[0,1]
    v_pk_add_f32 v[92:93], v[92:93], v[60:61] op_sel_hi:[1,0] neg_lo:[0,1] neg_hi:[0,1]
    v_pk_add_f32 v[94:95], v[94:95], v[60:61] op_sel_hi:[1,0] neg_lo:[0,1] neg_hi:[0,1]
    v_exp_f32 v80, v80
    v_exp_f32 v81, v81
    v_exp_f32 v82, v82
    v_exp_f32 v83, v83
    v_exp_f32 v84, v84
    v_exp_f32 v85, v85
    v_exp_f32 v86, v86
    v_exp_f32 v87, v87
    v_exp_f32 v88, v88
    v_exp_f32 v89, v89
    v_exp_f32 v90, v90
    v_exp_f32 v91, v91
    v_exp_f32 v92, v92
    v_exp_f32 v93, v93
    v_exp_f32 v94, v94
    v_exp_f32 v95, v95
    v_cvt_pk_bf16_f32 v248, v80, v81
    v_cvt_pk_bf16_f32 v249, v82, v83
    v_cvt_pk_bf16_f32 v250, v84, v85
    v_cvt_pk_bf16_f32 v251, v86, v87
    v_cvt_pk_bf16_f32 v252, v88, v89
    v_cvt_pk_bf16_f32 v253, v90, v91
    v_cvt_pk_bf16_f32 v254, v92, v93
    v_cvt_pk_bf16_f32 v255, v94, v95
    v_pk_add_f32 v[6:7], v[6:7], v[80:81]
    v_pk_add_f32 v[6:7], v[6:7], v[82:83]
    v_pk_add_f32 v[6:7], v[6:7], v[84:85]
    v_pk_add_f32 v[6:7], v[6:7], v[86:87]
    v_pk_add_f32 v[6:7], v[6:7], v[88:89]
    v_pk_add_f32 v[6:7], v[6:7], v[90:91]
    v_pk_add_f32 v[6:7], v[6:7], v[92:93]
    v_pk_add_f32 v[6:7], v[6:7], v[94:95]
    s_waitcnt lgkmcnt(4)
    v_mfma_f32_32x32x16_bf16 v[224:239], v[32:35], v[248:251], v[224:239]
    v_mfma_f32_32x32x16_bf16 v[224:239], v[36:39], v[252:255], v[224:239]
    ds_read_b128 v[32:35], v52 offset:32768
    ds_read_b128 v[36:39], v52 offset:33792
aex_b2:
    v_pk_add_f32 v[96:97], v[96:97], v[60:61] op_sel_hi:[1,0] neg_lo:[0,1] neg_hi:[0,1]
    v_pk_add_f32 v[98:99], v[98:99], v[60:61] op_sel_hi:[1,0] neg_lo:[0,1] neg_hi:[0,1]
    v_pk_add_f32 v[100:101], v[100:101], v[60:61] op_sel_hi:[1,0] neg_lo:[0,1] neg_hi:[0,1]
    v_pk_add_f32 v[102:103], v[102:103], v[60:61] op_sel_hi:[1,0] neg_lo:[0,1] neg_hi:[0,1]
    v_pk_add_f32 v[104:105], v[104:105], v[60:61] op_sel_hi:[1,0] neg_lo:[0,1] neg_hi:[0,1]
    v_pk_add_f32 v[106:107], v[106:107], v[60:61] op_sel_hi:[1,0] neg_lo:[0,1] neg_hi:[0,1]
    v_pk_add_f32 v[108:109], v[108:109], v[60:61] op_sel_hi:[1,0] neg_lo:[0,1] neg_hi:[0,1]
    v_pk_add_f32 v[110:111], v[110:111], v[60:61] op_sel_hi:[1,0] neg_lo:[0,1] neg_hi:[0,1]
    v_exp_f32 v96, v96
    v_exp_f32 v97, v97
    v_exp_f32 v98, v98
    v_exp_f32 v99, v99
    v_exp_f32 v100, v100
    v_exp_f32 v101, v101
    v_exp_f32 v102, v102
    v_exp_f32 v103, v103
    v_exp_f32 v104, v104
    v_exp_f32 v105, v105
    v_exp_f32 v106, v106
    v_exp_f32 v107, v107
    v_exp_f32 v108, v108
    v_exp_f32 v109, v109
    v_exp_f32 v110, v110
    v_exp_f32 v111, v111
    v_cvt_pk_bf16_f32 v240, v96, v97
    v_cvt_pk_bf16_f32 v241, v98, v99
    v_cvt_pk_bf16_f32 v242, v100, v101
    v_cvt_pk_bf16_f32 v243, v102, v103
    v_cvt_pk_bf16_f32 v244, v104, v105
    v_cvt_pk_bf16_f32 v245, v106, v107
    v_cvt_pk_bf16_f32 v246, v108, v109
    v_cvt_pk_bf16_f32 v247, v110, v111
    v_pk_add_f32 v[6:7], v[6:7], v[96:97]
    v_pk_add_f32 v[6:7], v[6:7], v[98:99]
    v_pk_add_f32 v[6:7], v[6:7], v[100:101]
    v_pk_add_f32 v[6:7], v[6:7], v[102:103]
    v_pk_add_f32 v[6:7], v[6:7], v[104:105]
    v_pk_add_f32 v[6:7], v[6:7], v[106:107]
    v_pk_add_f32 v[6:7], v[6:7], v[108:109]
    v_pk_add_f32 v[6:7], v[6:7], v[110:111]
    s_waitcnt lgkmcnt(4)
    v_mfma_f32_32x32x16_bf16 v[224:239], v[40:43], v[240:243], v[224:239]
    v_mfma_f32_32x32x16_bf16 v[224:239], v[44:47], v[244:247], v[224:239]
    ds_read_b128 v[40:43], v53 offset:32768
    ds_read_b128 v[44:47], v53 offset:33792
aex_b3:
    v_pk_add_f32 v[112:113], v[112:113], v[60:61] op_sel_hi:[1,0] neg_lo:[0,1] neg_hi:[0,1]
    v_pk_add_f32 v[114:115], v[114:115], v[60:61] op_sel_hi:[1,0] neg_lo:[0,1] neg_hi:[0,1]
    v_pk_add_f32 v[116:117], v[116:117], v[60:61] op_sel_hi:[1,0] neg_lo:[0,1] neg_hi:[0,1]
    v_pk_add_f32 v[118:119], v[118:119], v[60:61] op_sel_hi:[1,0] neg_lo:[0,1] neg_hi:[0,1]
    v_pk_add_f32 v[120:121], v[120:121], v[60:61] op_sel_hi:[1,0] neg_lo:[0,1] neg_hi:[0,1]
    v_pk_add_f32 v[122:123], v[122:123], v[60:61] op_sel_hi:[1,0] neg_lo:[0,1] neg_hi:[0,1]
    v_pk_add_f32 v[124:125], v[124:125], v[60:61] op_sel_hi:[1,0] neg_lo:[0,1] neg_hi:[0,1]
    v_pk_add_f32 v[126:127], v[126:127], v[60:61] op_sel_hi:[1,0] neg_lo:[0,1] neg_hi:[0,1]
    v_exp_f32 v112, v112
    v_exp_f32 v113, v113
    v_exp_f32 v114, v114
    v_exp_f32 v115, v115
    v_exp_f32 v116, v116
    v_exp_f32 v117, v117
    v_exp_f32 v118, v118
    v_exp_f32 v119, v119
    v_exp_f32 v120, v120
    v_exp_f32 v121, v121
    v_exp_f32 v122, v122
    v_exp_f32 v123, v123
    v_exp_f32 v124, v124
    v_exp_f32 v125, v125
    v_exp_f32 v126, v126
    v_exp_f32 v127, v127
    v_cvt_pk_bf16_f32 v248, v112, v113
    v_cvt_pk_bf16_f32 v249, v114, v115
    v_cvt_pk_bf16_f32 v250, v116, v117
    v_cvt_pk_bf16_f32 v251, v118, v119
    v_cvt_pk_bf16_f32 v252, v120, v121
    v_cvt_pk_bf16_f32 v253, v122, v123
    v_cvt_pk_bf16_f32 v254, v124, v125
    v_cvt_pk_bf16_f32 v255, v126, v127
    v_pk_add_f32 v[6:7], v[6:7], v[112:113]
    v_pk_add_f32 v[6:7], v[6:7], v[114:115]
    v_pk_add_f32 v[6:7], v[6:7], v[116:117]
    v_pk_add_f32 v[6:7], v[6:7], v[118:119]
    v_pk_add_f32 v[6:7], v[6:7], v[120:121]
    v_pk_add_f32 v[6:7], v[6:7], v[122:123]
    v_pk_add_f32 v[6:7], v[6:7], v[124:125]
    v_pk_add_f32 v[6:7], v[6:7], v[126:127]
    s_waitcnt lgkmcnt(4)
    v_mfma_f32_32x32x16_bf16 v[224:239], v[24:27], v[248:251], v[224:239]
    v_mfma_f32_32x32x16_bf16 v[224:239], v[28:31], v[252:255], v[224:239]
    ds_read_b128 v[24:27], v54 offset:32768
    ds_read_b128 v[28:31], v54 offset:33792
aex_b4:
    v_pk_add_f32 v[128:129], v[128:129], v[60:61] op_sel_hi:[1,0] neg_lo:[0,1] neg_hi:[0,1]
    v_pk_add_f32 v[130:131], v[130:131], v[60:61] op_sel_hi:[1,0] neg_lo:[0,1] neg_hi:[0,1]
    v_pk_add_f32 v[132:133], v[132:133], v[60:61] op_sel_hi:[1,0] neg_lo:[0,1] neg_hi:[0,1]
    v_pk_add_f32 v[134:135], v[134:135], v[60:61] op_sel_hi:[1,0] neg_lo:[0,1] neg_hi:[0,1]
    v_pk_add_f32 v[136:137], v[136:137], v[60:61] op_sel_hi:[1,0] neg_lo:[0,1] neg_hi:[0,1]
    v_pk_add_f32 v[138:139], v[138:139], v[60:61] op_sel_hi:[1,0] neg_lo:[0,1] neg_hi:[0,1]
    v_pk_add_f32 v[140:141], v[140:141], v[60:61] op_sel_hi:[1,0] neg_lo:[0,1] neg_hi:[0,1]
    v_pk_add_f32 v[142:143], v[142:143], v[60:61] op_sel_hi:[1,0] neg_lo:[0,1] neg_hi:[0,1]
    v_exp_f32 v128, v128
    v_exp_f32 v129, v129
    v_exp_f32 v130, v130
    v_exp_f32 v131, v131
    v_exp_f32 v132, v132
    v_exp_f32 v133, v133
    v_exp_f32 v134, v134
    v_exp_f32 v135, v135
    v_exp_f32 v136, v136
    v_exp_f32 v137, v137
    v_exp_f32 v138, v138
    v_exp_f32 v139, v139
    v_exp_f32 v140, v140
    v_exp_f32 v141, v141
    v_exp_f32 v142, v142
    v_exp_f32 v143, v143
    v_cvt_pk_bf16_f32 v240, v128, v129
    v_cvt_pk_bf16_f32 v241, v130, v131
    v_cvt_pk_bf16_f32 v242, v132, v133
    v_cvt_pk_bf16_f32 v243, v134, v135
    v_cvt_pk_bf16_f32 v244, v136, v137
    v_cvt_pk_bf16_f32 v245, v138, v139
    v_cvt_pk_bf16_f32 v246, v140, v141
    v_cvt_pk_bf16_f32 v247, v142, v143
    v_pk_add_f32 v[6:7], v[6:7], v[128:129]
    v_pk_add_f32 v[6:7], v[6:7], v[130:131]
    v_pk_add_f32 v[6:7], v[6:7], v[132:133]
    v_pk_add_f32 v[6:7], v[6:7], v[134:135]
    v_pk_add_f32 v[6:7], v[6:7], v[136:137]
    v_pk_add_f32 v[6:7], v[6:7], v[138:139]
    v_pk_add_f32 v[6:7], v[6:7], v[140:141]
    v_pk_add_f32 v[6:7], v[6:7], v[142:143]
    s_waitcnt lgkmcnt(4)
    v_mfma_f32_32x32x16_bf16 v[224:239], v[32:35], v[240:243], v[224:239]
    v_mfma_f32_32x32x16_bf16 v[224:239], v[36:39], v[244:247], v[224:239]
    ds_read_b128 v[32:35], v55 offset:32768
    ds_read_b128 v[36:39], v55 offset:33792
aex_b5:
    s_or_b32 s49, s38, 0
    s_cbranch_scc1 att_sp2xb
    s_cmp_eq_u32 s33, 0
    s_cbranch_scc1 att_sp2tb
    s_mov_b32 s49, 0
att_pollb:
    buffer_load_dword v57, v1, s[16:19], s40 offen sc1
    s_waitcnt vmcnt(0)
    v_cmp_ne_u32 vcc, 0, v57
    s_cbranch_vccnz att_gotb
    s_sleep 1
    s_add_u32 s49, s49, 1
    s_cmp_lt_u32 s49, 200000
    s_cbranch_scc1 att_pollb
att_gotb:
    s_add_u32 m0, s41, 0
    s_sub_u32 s49, s42, 65536
    buffer_load_dwordx4 v3, s[12:15], s49 offen offset:0 sc1 lds
    buffer_load_dwordx4 v3, s[12:15], s49 offen offset:1024 sc1 lds
    buffer_load_dwordx4 v3, s[12:15], s49 offen offset:2048 sc1 lds
    buffer_load_dwordx4 v3, s[12:15], s49 offen offset:3072 sc1 lds
    s_add_u32 m0, s41, 4096
    s_sub_u32 s49, s42, 61440
    buffer_load_dwordx4 v3, s[12:15], s49 offen offset:0 sc1 lds
    buffer_load_dwordx4 v3, s[12:15], s49 offen offset:1024 sc1 lds
    buffer_load_dwordx4 v3, s[12:15], s49 offen offset:2048 sc1 lds
    buffer_load_dwordx4 v3, s[12:15], s49 offen offset:3072 sc1 lds
att_sp2tb:
att_sp2xb:
    v_pk_add_f32 v[144:145], v[144:145], v[60:61] op_sel_hi:[1,0] neg_lo:[0,1] neg_hi:[0,1]
    v_pk_add_f32 v[146:147], v[146:147], v[60:61] op_sel_hi:[1,0] neg_lo:[0,1] neg_hi:[0,1]
    v_pk_add_f32 v[148:149], v[148:149], v[60:61] op_sel_hi:[1,0] neg_lo:[0,1] neg_hi:[0,1]
    v_pk_add_f32 v[150:151], v[150:151], v[60:61] op_sel_hi:[1,0] neg_lo:[0,1] neg_hi:[0,1]
    v_pk_add_f32 v[152:153], v[152:153], v[60:61] op_sel_hi:[1,0] neg_lo:[0,1] neg_hi:[0,1]
    v_pk_add_f32 v[154:155], v[154:155], v[60:61] op_sel_hi:[1,0] neg_lo:[0,1] neg_hi:[0,1]
    v_pk_add_f32 v[156:157], v[156:157], v[60:61] op_sel_hi:[1,0] neg_lo:[0,1] neg_hi:[0,1]
    v_pk_add_f32 v[158:159], v[158:159], v[60:61] op_sel_hi:[1,0] neg_lo:[0,1] neg_hi:[0,1]
    v_exp_f32 v144, v144
    v_exp_f32 v145, v145
    v_exp_f32 v146, v146
    v_exp_f32 v147, v147
    v_exp_f32 v148, v148
    v_exp_f32 v149, v149
    v_exp_f32 v150, v150
    v_exp_f32 v151, v151
    v_exp_f32 v152, v152
    v_exp_f32 v153, v153
    v_exp_f32 v154, v154
    v_exp_f32 v155, v155
    v_exp_f32 v156, v156
    v_exp_f32 v157, v157
    v_exp_f32 v158, v158
    v_exp_f32 v159, v159
    v_cvt_pk_bf16_f32 v248, v144, v145
    v_cvt_pk_bf16_f32 v249, v146, v147
    v_cvt_pk_bf16_f32 v250, v148, v149
    v_cvt_pk_bf16_f32 v251, v150, v151
    v_cvt_pk_bf16_f32 v252, v152, v153
    v_cvt_pk_bf16_f32 v253, v154, v155
    v_cvt_pk_bf16_f32 v254, v156, v157
    v_cvt_pk_bf16_f32 v255, v158, v159
    v_pk_add_f32 v[6:7], v[6:7], v[144:145]
    v_pk_add_f32 v[6:7], v[6:7], v[146:147]
    v_pk_add_f32 v[6:7], v[6:7], v[148:149]
    v_pk_add_f32 v[6:7], v[6:7], v[150:151]
    v_pk_add_f32 v[6:7], v[6:7], v[152:153]
    v_pk_add_f32 v[6:7], v[6:7], v[154:155]
    v_pk_add_f32 v[6:7], v[6:7], v[156:157]
    v_pk_add_f32 v[6:7], v[6:7], v[158:159]
    s_waitcnt lgkmcnt(4)
    v_mfma_f32_32x32x16_bf16 v[224:239], v[40:43], v[248:251], v[224:239]
    v_mfma_f32_32x32x16_bf16 v[224:239], v[44:47], v[252:255], v[224:239]
    ds_read_b128 v[40:43], v56 offset:32768
    ds_read_b128 v[44:47], v56 offset:33792
aex_b6:
    v_pk_add_f32 v[160:161], v[160:161], v[60:61] op_sel_hi:[1,0] neg_lo:[0,1] neg_hi:[0,1]
    v_pk_add_f32 v[162:163], v[162:163], v[60:61] op_sel_hi:[1,0] neg_lo:[0,1] neg_hi:[0,1]
    v_pk_add_f32 v[164:165], v[164:165], v[60:61] op_sel_hi:[1,0] neg_lo:[0,1] neg_hi:[0,1]
    v_pk_add_f32 v[166:167], v[166:167], v[60:61] op_sel_hi:[1,0] neg_lo:[0,1] neg_hi:[0,1]
    v_pk_add_f32 v[168:169], v[168:169], v[60:61] op_sel_hi:[1,0] neg_lo:[0,1] neg_hi:[0,1]
    v_pk_add_f32 v[170:171], v[170:171], v[60:61] op_sel_hi:[1,0] neg_lo:[0,1] neg_hi:[0,1]
    v_pk_add_f32 v[172:173], v[172:173], v[60:61] op_sel_hi:[1,0] neg_lo:[0,1] neg_hi:[0,1]
    v_pk_add_f32 v[174:175], v[174:175], v[60:61] op_sel_hi:[1,0] neg_lo:[0,1] neg_hi:[0,1]
    v_exp_f32 v160, v160
    v_exp_f32 v161, v161
    v_exp_f32 v162, v162
    v_exp_f32 v163, v163
    v_exp_f32 v164, v164
    v_exp_f32 v165, v165
    v_exp_f32 v166, v166
    v_exp_f32 v167, v167
    v_exp_f32 v168, v168
    v_exp_f32 v169, v169
    v_exp_f32 v170, v170
    v_exp_f32 v171, v171
    v_exp_f32 v172, v172
    v_exp_f32 v173, v173
    v_exp_f32 v174, v174
    v_exp_f32 v175, v175
    v_cvt_pk_bf16_f32 v240, v160, v161
    v_cvt_pk_bf16_f32 v241, v162, v163
    v_cvt_pk_bf16_f32 v242, v164, v165
    v_cvt_pk_bf16_f32 v243, v166, v167
    v_cvt_pk_bf16_f32 v244, v168, v169
    v_cvt_pk_bf16_f32 v245, v170, v171
    v_cvt_pk_bf16_f32 v246, v172, v173
    v_cvt_pk_bf16_f32 v247, v174, v175
    v_pk_add_f32 v[6:7], v[6:7], v[160:161]
    v_pk_add_f32 v[6:7], v[6:7], v[162:163]
    v_pk_add_f32 v[6:7], v[6:7], v[164:165]
    v_pk_add_f32 v[6:7], v[6:7], v[166:167]
    v_pk_add_f32 v[6:7], v[6:7], v[168:169]
    v_pk_add_f32 v[6:7], v[6:7], v[170:171]
    v_pk_add_f32 v[6:7], v[6:7], v[172:173]
    v_pk_add_f32 v[6:7], v[6:7], v[174:175]
    s_waitcnt lgkmcnt(4)
    v_mfma_f32_32x32x16_bf16 v[224:239], v[24:27], v[240:243], v[224:239]
    v_mfma_f32_32x32x16_bf16 v[224:239], v[28:31], v[244:247], v[224:239]
aex_b7:
    v_pk_add_f32 v[176:177], v[176:177], v[60:61] op_sel_hi:[1,0] neg_lo:[0,1] neg_hi:[0,1]
    v_pk_add_f32 v[178:179], v[178:179], v[60:61] op_sel_hi:[1,0] neg_lo:[0,1] neg_hi:[0,1]
    v_pk_add_f32 v[180:181], v[180:181], v[60:61] op_sel_hi:[1,0] neg_lo:[0,1] neg_hi:[0,1]
    v_pk_add_f32 v[182:183], v[182:183], v[60:61] op_sel_hi:[1,0] neg_lo:[0,1] neg_hi:[0,1]
    v_pk_add_f32 v[184:185], v[184:185], v[60:61] op_sel_hi:[1,0] neg_lo:[0,1] neg_hi:[0,1]
    v_pk_add_f32 v[186:187], v[186:187], v[60:61] op_sel_hi:[1,0] neg_lo:[0,1] neg_hi:[0,1]
    v_pk_add_f32 v[188:189], v[188:189], v[60:61] op_sel_hi:[1,0] neg_lo:[0,1] neg_hi:[0,1]
    v_pk_add_f32 v[190:191], v[190:191], v[60:61] op_sel_hi:[1,0] neg_lo:[0,1] neg_hi:[0,1]
    v_exp_f32 v176, v176
    v_exp_f32 v177, v177
    v_exp_f32 v178, v178
    v_exp_f32 v179, v179
    v_exp_f32 v180, v180
    v_exp_f32 v181, v181
    v_exp_f32 v182, v182
    v_exp_f32 v183, v183
    v_exp_f32 v184, v184
    v_exp_f32 v185, v185
    v_exp_f32 v186, v186
    v_exp_f32 v187, v187
    v_exp_f32 v188, v188
    v_exp_f32 v189, v189
    v_exp_f32 v190, v190
    v_exp_f32 v191, v191
    v_cvt_pk_bf16_f32 v248, v176, v177
    v_cvt_pk_bf16_f32 v249, v178, v179
    v_cvt_pk_bf16_f32 v250, v180, v181
    v_cvt_pk_bf16_f32 v251, v182, v183
    v_cvt_pk_bf16_f32 v252, v184, v185
    v_cvt_pk_bf16_f32 v253, v186, v187
    v_cvt_pk_bf16_f32 v254, v188, v189
    v_cvt_pk_bf16_f32 v255, v190, v191
    v_pk_add_f32 v[6:7], v[6:7], v[176:177]
    v_pk_add_f32 v[6:7], v[6:7], v[178:179]
    v_pk_add_f32 v[6:7], v[6:7], v[180:181]
    v_pk_add_f32 v[6:7], v[6:7], v[182:183]
    v_pk_add_f32 v[6:7], v[6:7], v[184:185]
    v_pk_add_f32 v[6:7], v[6:7], v[186:187]
    v_pk_add_f32 v[6:7], v[6:7], v[188:189]
    v_pk_add_f32 v[6:7], v[6:7], v[190:191]
    s_waitcnt lgkmcnt(2)
    v_mfma_f32_32x32x16_bf16 v[224:239], v[32:35], v[248:251], v[224:239]
    v_mfma_f32_32x32x16_bf16 v[224:239], v[36:39], v[252:255], v[224:239]
aex_b8:
    v_pk_add_f32 v[192:193], v[192:193], v[60:61] op_sel_hi:[1,0] neg_lo:[0,1] neg_hi:[0,1]
    v_pk_add_f32 v[194:195], v[194:195], v[60:61] op_sel_hi:[1,0] neg_lo:[0,1] neg_hi:[0,1]
    v_pk_add_f32 v[196:197], v[196:197], v[60:61] op_sel_hi:[1,0] neg_lo:[0,1] neg_hi:[0,1]
    v_pk_add_f32 v[198:199], v[198:199], v[60:61] op_sel_hi:[1,0] neg_lo:[0,1] neg_hi:[0,1]
    v_pk_add_f32 v[200:201], v[200:201], v[60:61] op_sel_hi:[1,0] neg_lo:[0,1] neg_hi:[0,1]
    v_pk_add_f32 v[202:203], v[202:203], v[60:61] op_sel_hi:[1,0] neg_lo:[0,1] neg_hi:[0,1]
    v_pk_add_f32 v[204:205], v[204:205], v[60:61] op_sel_hi:[1,0] neg_lo:[0,1] neg_hi:[0,1]
    v_pk_add_f32 v[206:207], v[206:207], v[60:61] op_sel_hi:[1,0] neg_lo:[0,1] neg_hi:[0,1]
    v_exp_f32 v192, v192
    v_exp_f32 v193, v193
    v_exp_f32 v194, v194
    v_exp_f32 v195, v195
    v_exp_f32 v196, v196
    v_exp_f32 v197, v197
    v_exp_f32 v198, v198
    v_exp_f32 v199, v199
    v_exp_f32 v200, v200
    v_exp_f32 v201, v201
    v_exp_f32 v202, v202
    v_exp_f32 v203, v203
    v_exp_f32 v204, v204
    v_exp_f32 v205, v205
    v_exp_f32 v206, v206
    v_exp_f32 v207, v207
    v_cvt_pk_bf16_f32 v240, v192, v193
    v_cvt_pk_bf16_f32 v241, v194, v195
    v_cvt_pk_bf16_f32 v242, v196, v197
    v_cvt_pk_bf16_f32 v243, v198, v199
    v_cvt_pk_bf16_f32 v244, v200, v201
    v_cvt_pk_bf16_f32 v245, v202, v203
    v_cvt_pk_bf16_f32 v246, v204, v205
    v_cvt_pk_bf16_f32 v247, v206, v207
    v_pk_add_f32 v[6:7], v[6:7], v[192:193]
    v_pk_add_f32 v[6:7], v[6:7], v[194:195]
    v_pk_add_f32 v[6:7], v[6:7], v[196:197]
    v_pk_add_f32 v[6:7], v[6:7], v[198:199]
    v_pk_add_f32 v[6:7], v[6:7], v[200:201]
    v_pk_add_f32 v[6:7], v[6:7], v[202:203]
    v_pk_add_f32 v[6:7], v[6:7], v[204:205]
    v_pk_add_f32 v[6:7], v[6:7], v[206:207]
    s_waitcnt lgkmcnt(0)
    v_mfma_f32_32x32x16_bf16 v[224:239], v[40:43], v[240:243], v[224:239]
    v_mfma_f32_32x32x16_bf16 v[224:239], v[44:47], v[244:247], v[224:239]
    s_cmp_lg_u32 s38, 0
    s_cbranch_scc1 att_fin
    s_waitcnt vmcnt(0)
    s_barrier
    s_mov_b32 s38, 1
    s_mov_b32 s26, 0
    s_cmp_lg_u32 s33, 0
    s_cbranch_scc1 att_part
att_fin:
    v_lshrrev_b32 v56, 7, v3
    v_mul_u32_u24 v56, 4352, v56
    v_bfe_u32 v53, v3, 4, 3
    v_lshl_add_u32 v56, v53, 3, v56
    v_mov_b32 v54, 0
    v_mov_b32 v55, 0
    s_cmp_lg_u32 s3, 0
    s_cbranch_scc1 att_nou
    buffer_load_dwordx2 v[54:55], v56, s[16:19], s60 offen sc1
att_nou:
    v_add_f32 v62, v62, v63
    v_mov_b32 v63, v62
    s_nop 1
    v_permlane32_swap_b32 v62, v63
    s_nop 1
    v_add_f32 v62, v62, v63
    v_rcp_f32 v62, v62
    s_lshl_b32 s44, s33, 5
    s_lshl_b32 s45, s32, 1
    s_add_u32 s44, s44, s45
    s_add_u32 s44, s44, s34
    s_lshl_b32 s44, s44, 14
    s_lshl_b32 s43, s35, 11
    s_add_u32 s44, s44, s43
    s_nop 2
    v_pk_mul_f32 v[208:209], v[208:209], v[62:63] op_sel_hi:[1,0]
    v_pk_mul_f32 v[210:211], v[210:211], v[62:63] op_sel_hi:[1,0]
    v_pk_mul_f32 v[212:213], v[212:213], v[62:63] op_sel_hi:[1,0]
    v_pk_mul_f32 v[214:215], v[214:215], v[62:63] op_sel_hi:[1,0]
    v_pk_mul_f32 v[216:217], v[216:217], v[62:63] op_sel_hi:[1,0]
    v_pk_mul_f32 v[218:219], v[218:219], v[62:63] op_sel_hi:[1,0]
    v_pk_mul_f32 v[220:221], v[220:221], v[62:63] op_sel_hi:[1,0]
    v_pk_mul_f32 v[222:223], v[222:223], v[62:63] op_sel_hi:[1,0]
    v_cvt_pk_bf16_f32 v24, v208, v209
    v_cvt_pk_bf16_f32 v25, v210, v211
    v_cvt_pk_bf16_f32 v26, v212, v213
    v_cvt_pk_bf16_f32 v27, v214, v215
    v_cvt_pk_bf16_f32 v28, v216, v217
    v_cvt_pk_bf16_f32 v29, v218, v219
    v_cvt_pk_bf16_f32 v30, v220, v221
    v_cvt_pk_bf16_f32 v31, v222, v223
    buffer_store_dwordx4 v[24:27], v2, s[20:23], s44 offen sc1
    buffer_store_dwordx4 v[28:31], v2, s[20:23], s44 offen offset:512 sc1
    v_add_f32 v6, v6, v7
    v_mov_b32 v7, v6
    s_nop 1
    v_permlane32_swap_b32 v6, v7
    s_nop 1
    v_add_f32 v6, v6, v7
    v_rcp_f32 v6, v6
    s_lshl_b32 s44, s33, 5
    s_lshl_b32 s45, s32, 1
    s_add_u32 s44, s44, s45
    s_add_u32 s44, s44, s34
    s_lshl_b32 s44, s44, 14
    s_lshl_b32 s43, s36, 11
    s_add_u32 s44, s44, s43
    s_nop 2
    v_pk_mul_f32 v[224:225], v[224:225], v[6:7] op_sel_hi:[1,0]
    v_pk_mul_f32 v[226:227], v[226:227], v[6:7] op_sel_hi:[1,0]
    v_pk_mul_f32 v[228:229], v[228:229], v[6:7] op_sel_hi:[1,0]
    v_pk_mul_f32 v[230:231], v[230:231], v[6:7] op_sel_hi:[1,0]
    v_pk_mul_f32 v[232:233], v[232:233], v[6:7] op_sel_hi:[1,0]
    v_pk_mul_f32 v[234:235], v[234:235], v[6:7] op_sel_hi:[1,0]
    v_pk_mul_f32 v[236:237], v[236:237], v[6:7] op_sel_hi:[1,0]
    v_pk_mul_f32 v[238:239], v[238:239], v[6:7] op_sel_hi:[1,0]
    v_cvt_pk_bf16_f32 v32, v224, v225
    v_cvt_pk_bf16_f32 v33, v226, v227
    v_cvt_pk_bf16_f32 v34, v228, v229
    v_cvt_pk_bf16_f32 v35, v230, v231
    v_cvt_pk_bf16_f32 v36, v232, v233
    v_cvt_pk_bf16_f32 v37, v234, v235
    v_cvt_pk_bf16_f32 v38, v236, v237
    v_cvt_pk_bf16_f32 v39, v238, v239
    buffer_store_dwordx4 v[32:35], v2, s[20:23], s44 offen sc1
    buffer_store_dwordx4 v[36:39], v2, s[20:23], s44 offen offset:512 sc1
    s_mul_i32 s34, s33, 4352
    s_lshl_b32 s35, s32, 2
    s_add_u32 s34, s34, s35
    s_add_u32 s34, s34, 592000
    s_mov_b32 s29, 1
    s_waitcnt vmcnt(0)
    v_and_b32 v54, v54, v55
    v_cmp_eq_u32 vcc, 7, v53
    s_nop 1
    v_cndmask_b32 v54, v54, 1, vcc
    v_cmp_eq_u32 vcc, 0, v54
    s_nop 1
    s_cmp_eq_u64 vcc, 0
    s_cselect_b32 s100, 1, 0
    s_branch k23_flag
k2_pf:
    s_load_dwordx2 s[20:21], s[0:1], 16
    s_load_dwordx2 s[22:23], s[0:1], 48
    s_sub_u32 s32, s31, 28
    s_lshl_b32 s32, s32, 2
    s_add_u32 s32, s32, s30
    s_sub_u32 s32, s32, 4
    s_lshl_b32 s32, s32, 3
    s_add_u32 s32, s32, s3
    s_lshl_b32 s32, s32, 13
    v_lshlrev_b32 v2, 7, v1
    s_waitcnt lgkmcnt(0)
    s_mov_b32 s12, s4
    s_mov_b32 s13, s5
    s_mov_b32 s14, 0x600000
    s_mov_b32 s15, 0x00020000
    s_mov_b32 s16, s8
    s_mov_b32 s17, s9
    s_mov_b32 s18, 0xe00000
    s_mov_b32 s19, 0x00020000
    s_add_u32 s33, s32, 3145728
    s_add_u32 s34, s32, 6291456
    buffer_load_dword v3, v2, s[12:15], s33 offen
    s_barrier
    s_add_u32 s33, s33, 1048576
    buffer_load_dword v3, v2, s[16:19], s34 offen
    s_barrier
    s_add_u32 s34, s34, 1048576
    buffer_load_dword v3, v2, s[16:19], s34 offen
    s_barrier
    s_add_u32 s34, s34, 1048576
    buffer_load_dword v3, v2, s[12:15], s33 offen
    s_barrier
    s_add_u32 s33, s33, 1048576
    buffer_load_dword v3, v2, s[16:19], s34 offen
    s_barrier
    s_add_u32 s34, s34, 1048576
    buffer_load_dword v3, v2, s[16:19], s34 offen
    s_barrier
    s_add_u32 s34, s34, 1048576
    buffer_load_dword v3, v2, s[12:15], s33 offen
    s_barrier
    s_add_u32 s33, s33, 1048576
    buffer_load_dword v3, v2, s[16:19], s34 offen
    s_barrier
    s_add_u32 s34, s34, 1048576
    buffer_load_dword v3, v2, s[16:19], s34 offen
    s_barrier
    s_add_u32 s34, s34, 1048576
    buffer_load_dword v3, v2, s[16:19], s34 offen
    s_barrier
    s_add_u32 s34, s34, 1048576
    buffer_load_dword v3, v2, s[16:19], s34 offen
    s_barrier
    s_add_u32 s34, s34, 1048576
    s_waitcnt lgkmcnt(0)
    s_mov_b32 s12, s22
    s_mov_b32 s13, s23
    s_mov_b32 s14, 0xa00000
    s_mov_b32 s15, 0x00020000
    s_add_u32 s33, s32, 6291456
    buffer_load_dword v3, v2, s[12:15], s33 offen
    s_barrier
    s_add_u32 s33, s33, 1048576
    buffer_load_dword v3, v2, s[12:15], s33 offen
    s_barrier
    s_add_u32 s33, s33, 1048576
    buffer_load_dword v3, v2, s[12:15], s33 offen
    s_barrier
    s_add_u32 s33, s33, 1048576
    buffer_load_dword v3, v2, s[12:15], s33 offen
    s_barrier
    s_add_u32 s33, s33, 1048576
    s_mov_b32 s16, s20
    s_mov_b32 s17, s21
    s_mov_b32 s18, 0x200000
    s_mov_b32 s19, 0x00020000
    buffer_load_dword v3, v2, s[16:19], s32 offen
    s_add_u32 s32, s32, 1048576
    buffer_load_dword v3, v2, s[16:19], s32 offen
    s_waitcnt vmcnt(0)
    s_mov_b32 s29, 0
    s_mov_b32 s63, 0
    s_cmp_ge_u32 s101, 4
    s_cbranch_scc1 k3_entry
    s_barrier
    s_branch k3_entry
k23_flag:
    s_barrier
    s_cmp_lg_u32 s101, 1
    s_cbranch_scc1 k3_entry
    s_add_u32 s16, s6, 0x2c00000
    s_addc_u32 s17, s7, 0
    s_mov_b32 s18, 0x200000
    s_mov_b32 s19, 0x00020000
    v_mov_b32 v2, 1
    v_mov_b32 v3, 0
    buffer_store_dword v2, v3, s[16:19], s34 offen sc1
k3_entry:
    s_mov_b32 s28, 0
k3_entry2:
    s_load_dwordx2 s[4:5], s[0:1], 0
    s_load_dwordx2 s[6:7], s[0:1], 16
    s_load_dwordx4 s[8:11], s[0:1], 48
    s_load_dwordx2 s[24:25], s[0:1], 64
    s_load_dwordx2 s[26:27], s[0:1], 80
    v_mbcnt_lo_u32_b32 v1, -1, 0
    v_mbcnt_hi_u32_b32 v1, -1, v1
    s_mov_b32 s3, s101
    s_and_b32 s30, s2, 7
    s_lshr_b32 s31, s2, 3
    s_and_b32 s32, s31, 7
    s_bfe_u32 s33, s30, 0x10001
    s_lshl_b32 s33, s33, 2
    s_lshr_b32 s34, s31, 3
    s_add_u32 s33, s33, s34
    s_and_b32 s30, s30, 1
    s_lshl_b32 s31, s29, 1
    s_add_u32 s31, s31, s30
    s_waitcnt lgkmcnt(0)
    s_add_u32 s52, s26, 0x2c00000
    s_addc_u32 s53, s27, 0
    s_mov_b32 s54, 0x200000
    s_mov_b32 s55, 0x00020000
    s_cmp_lg_u32 s3, 0
    s_cbranch_scc1 k3_uok
    s_cmp_lg_u32 s100, 0
    s_cbranch_scc1 k3_uok
    s_cmp_eq_u32 s29, 0
    s_cbranch_scc1 k3_uok
    v_min_u32 v2, 13, v1
    v_lshlrev_b32 v2, 2, v2
    s_mul_i32 s34, s32, 4352
    s_add_u32 s34, s34, 557184
    s_mov_b32 s35, 0
k3_upoll:
    buffer_load_dword v120, v2, s[52:55], s34 offen sc1
    s_waitcnt vmcnt(0)
    v_cmp_eq_u32 vcc, 0, v120
    s_cbranch_vccz k3_uok
    s_sleep 4
    s_add_u32 s35, s35, 1
    s_cmp_lt_u32 s35, 200000
    s_cbranch_scc1 k3_upoll
k3_uok:
    s_cmp_ge_u32 s3, 4
    s_cbranch_scc1 k3_prod
    s_mov_b32 s12, s4
    s_mov_b32 s13, s5
    s_mov_b32 s14, 0x400000
    s_mov_b32 s15, 0x00020000
    s_mov_b32 s16, s10
    s_mov_b32 s17, s11
    s_mov_b32 s18, 0x1000
    s_mov_b32 s19, 0x00020000
    s_mov_b32 s20, s24
    s_mov_b32 s21, s25
    s_mov_b32 s22, 0x400000
    s_mov_b32 s23, 0x00020000
    s_and_b32 s36, s3, 1
    s_lshr_b32 s35, s3, 1
    v_and_b32 v2, 15, v1
    v_lshrrev_b32 v64, 4, v1
    v_lshlrev_b32 v14, 11, v2
    v_lshl_add_u32 v15, v64, 3, v14
    v_and_b32 v3, 1, v64
    v_lshl_add_u32 v14, v3, 5, v14
    v_lshrrev_b32 v3, 1, v64
    v_lshl_add_u32 v14, v3, 4, v14
    v_lshlrev_b32 v64, 2, v2
    v_lshlrev_b32 v2, 1, v2
    s_lshl_b32 s37, s33, 8
    s_lshl_b32 s38, s36, 7
    s_add_u32 s37, s37, s38
    s_lshl_b32 s38, s31, 5
    s_add_u32 s37, s37, s38
    s_lshl_b32 s39, s37, 1
    s_lshl_b32 s37, s37, 11
    s_lshl_b32 s38, s32, 8
    s_add_u32 s37, s37, s38
    s_lshl_b32 s38, s35, 7
    s_add_u32 s37, s37, s38
    s_add_u32 s38, s37, 0x8000
    v_bfe_u32 v8, v1, 2, 2
    v_lshrrev_b32 v9, 4, v1
    v_lshl_add_u32 v8, v9, 2, v8
    v_lshlrev_b32 v4, 7, v8
    v_bfe_u32 v8, v1, 3, 2
    v_lshl_add_u32 v4, v8, 5, v4
    v_and_b32 v8, 3, v1
    v_lshl_add_u32 v4, v8, 3, v4
    s_lshl_b32 s46, s36, 13
    s_lshl_b32 s47, s35, 12
    s_add_u32 s47, s47, 16384
    v_add_u32 v4, s46, v4
    v_xor_b32 v5, 32, v4
    v_xor_b32 v6, 64, v4
    v_xor_b32 v7, 96, v4
    v_lshlrev_b32 v8, 4, v1
    v_add_u32 v8, s47, v8
    s_sub_u32 s48, s47, s46
    s_sub_u32 s49, s46, s47
    v_lshlrev_b32 v3, 10, v3
    v_add_u32 v3, s48, v3
    v_add_u32 v10, 73728, v4
    v_add_u32 v11, 73728, v5
    v_add_u32 v12, 73728, v6
    v_add_u32 v13, 73728, v7
    v_add_u32 v9, 73728, v8
    s_mul_i32 s51, s33, 4352
    s_add_u32 s51, s51, 592000
    v_min_u32 v120, 13, v1
    v_lshlrev_b32 v120, 2, v120
    s_mul_i32 s45, s32, 4352
    s_add_u32 s45, s45, 557184
    s_cmp_eq_u32 s29, 1
    s_cbranch_scc1 k3_cb
    s_barrier
    ds_read_b64_tr_b16 v[16:17], v4 offset:0
    ds_read_b64_tr_b16 v[18:19], v4 offset:2048
    ds_read_b128 v[48:51], v8 offset:0
    ds_read_b64_tr_b16 v[20:21], v5 offset:0
    ds_read_b64_tr_b16 v[22:23], v5 offset:2048
    ds_read_b64_tr_b16 v[24:25], v6 offset:0
    ds_read_b64_tr_b16 v[26:27], v6 offset:2048
    ds_read_b64_tr_b16 v[28:29], v7 offset:0
    ds_read_b64_tr_b16 v[30:31], v7 offset:2048
    ds_read_b128 v[52:55], v8 offset:1024
    ds_read_b128 v[56:59], v8 offset:2048
    ds_read_b128 v[60:63], v8 offset:3072
    ds_read_b64_tr_b16 v[32:33], v4 offset:4096
    ds_read_b64_tr_b16 v[34:35], v4 offset:6144
    ds_read_b64_tr_b16 v[36:37], v5 offset:4096
    ds_read_b64_tr_b16 v[38:39], v5 offset:6144
    ds_read_b64_tr_b16 v[40:41], v6 offset:4096
    ds_read_b64_tr_b16 v[42:43], v6 offset:6144
    ds_read_b64_tr_b16 v[44:45], v7 offset:4096
    ds_read_b64_tr_b16 v[46:47], v7 offset:6144
    s_waitcnt lgkmcnt(15)
    v_mfma_f32_16x16x32_bf16 v[128:131], v[48:51], v[16:19], 0
    v_mfma_f32_16x16x32_bf16 v[144:147], v[48:51], v[20:23], 0
    s_waitcnt lgkmcnt(13)
    v_mfma_f32_16x16x32_bf16 v[160:163], v[48:51], v[24:27], 0
    s_waitcnt lgkmcnt(11)
    v_mfma_f32_16x16x32_bf16 v[176:179], v[48:51], v[28:31], 0
    s_waitcnt lgkmcnt(10)
    v_mfma_f32_16x16x32_bf16 v[132:135], v[52:55], v[16:19], 0
    v_mfma_f32_16x16x32_bf16 v[148:151], v[52:55], v[20:23], 0
    v_mfma_f32_16x16x32_bf16 v[164:167], v[52:55], v[24:27], 0
    v_mfma_f32_16x16x32_bf16 v[180:183], v[52:55], v[28:31], 0
    s_waitcnt lgkmcnt(9)
    v_mfma_f32_16x16x32_bf16 v[136:139], v[56:59], v[16:19], 0
    v_mfma_f32_16x16x32_bf16 v[152:155], v[56:59], v[20:23], 0
    v_mfma_f32_16x16x32_bf16 v[168:171], v[56:59], v[24:27], 0
    v_mfma_f32_16x16x32_bf16 v[184:187], v[56:59], v[28:31], 0
    s_waitcnt lgkmcnt(8)
    v_mfma_f32_16x16x32_bf16 v[140:143], v[60:63], v[16:19], 0
    v_mfma_f32_16x16x32_bf16 v[156:159], v[60:63], v[20:23], 0
    v_mfma_f32_16x16x32_bf16 v[172:175], v[60:63], v[24:27], 0
    v_mfma_f32_16x16x32_bf16 v[188:191], v[60:63], v[28:31], 0
    s_waitcnt lgkmcnt(6)
    v_mfma_f32_16x16x32_bf16 v[192:195], v[48:51], v[32:35], 0
    s_barrier
    s_waitcnt lgkmcnt(4)
    v_mfma_f32_16x16x32_bf16 v[208:211], v[48:51], v[36:39], 0
    ds_read_b64_tr_b16 v[16:17], v4 offset:24576
    s_waitcnt lgkmcnt(3)
    v_mfma_f32_16x16x32_bf16 v[224:227], v[48:51], v[40:43], 0
    ds_read_b64_tr_b16 v[18:19], v4 offset:26624
    s_waitcnt lgkmcnt(2)
    v_mfma_f32_16x16x32_bf16 v[240:243], v[48:51], v[44:47], 0
    ds_read_b128 v[48:51], v8 offset:24576
    v_mfma_f32_16x16x32_bf16 v[196:199], v[52:55], v[32:35], 0
    ds_read_b64_tr_b16 v[20:21], v5 offset:24576
    v_mfma_f32_16x16x32_bf16 v[212:215], v[52:55], v[36:39], 0
    v_mfma_f32_16x16x32_bf16 v[228:231], v[52:55], v[40:43], 0
    ds_read_b64_tr_b16 v[22:23], v5 offset:26624
    v_mfma_f32_16x16x32_bf16 v[244:247], v[52:55], v[44:47], 0
    ds_read_b64_tr_b16 v[24:25], v6 offset:24576
    v_mfma_f32_16x16x32_bf16 v[200:203], v[56:59], v[32:35], 0
    ds_read_b64_tr_b16 v[26:27], v6 offset:26624
    v_mfma_f32_16x16x32_bf16 v[216:219], v[56:59], v[36:39], 0
    ds_read_b64_tr_b16 v[28:29], v7 offset:24576
    v_mfma_f32_16x16x32_bf16 v[232:235], v[56:59], v[40:43], 0
    ds_read_b64_tr_b16 v[30:31], v7 offset:26624
    v_mfma_f32_16x16x32_bf16 v[248:251], v[56:59], v[44:47], 0
    ds_read_b128 v[52:55], v8 offset:25600
    v_mfma_f32_16x16x32_bf16 v[204:207], v[60:63], v[32:35], 0
    ds_read_b128 v[56:59], v8 offset:26624
    v_mfma_f32_16x16x32_bf16 v[220:223], v[60:63], v[36:39], 0
    ds_read_b64_tr_b16 v[32:33], v4 offset:28672
    v_mfma_f32_16x16x32_bf16 v[236:239], v[60:63], v[40:43], 0
    ds_read_b64_tr_b16 v[34:35], v4 offset:30720
    v_mfma_f32_16x16x32_bf16 v[252:255], v[60:63], v[44:47], 0
    ds_read_b128 v[60:63], v8 offset:27648
    s_waitcnt lgkmcnt(11)
    v_mfma_f32_16x16x32_bf16 v[128:131], v[48:51], v[16:19], v[128:131]
    ds_read_b64_tr_b16 v[36:37], v5 offset:28672
    s_waitcnt lgkmcnt(10)
    v_mfma_f32_16x16x32_bf16 v[144:147], v[48:51], v[20:23], v[144:147]
    ds_read_b64_tr_b16 v[38:39], v5 offset:30720
    s_waitcnt lgkmcnt(9)
    v_mfma_f32_16x16x32_bf16 v[160:163], v[48:51], v[24:27], v[160:163]
    ds_read_b64_tr_b16 v[40:41], v6 offset:28672
    s_waitcnt lgkmcnt(8)
    v_mfma_f32_16x16x32_bf16 v[176:179], v[48:51], v[28:31], v[176:179]
    ds_read_b64_tr_b16 v[42:43], v6 offset:30720
    s_waitcnt lgkmcnt(8)
    v_mfma_f32_16x16x32_bf16 v[132:135], v[52:55], v[16:19], v[132:135]
    ds_read_b64_tr_b16 v[44:45], v7 offset:28672
    v_mfma_f32_16x16x32_bf16 v[148:151], v[52:55], v[20:23], v[148:151]
    ds_read_b64_tr_b16 v[46:47], v7 offset:30720
    v_mfma_f32_16x16x32_bf16 v[164:167], v[52:55], v[24:27], v[164:167]
    v_mfma_f32_16x16x32_bf16 v[180:183], v[52:55], v[28:31], v[180:183]
    s_waitcnt lgkmcnt(9)
    v_mfma_f32_16x16x32_bf16 v[136:139], v[56:59], v[16:19], v[136:139]
    v_mfma_f32_16x16x32_bf16 v[152:155], v[56:59], v[20:23], v[152:155]
    v_mfma_f32_16x16x32_bf16 v[168:171], v[56:59], v[24:27], v[168:171]
    v_mfma_f32_16x16x32_bf16 v[184:187], v[56:59], v[28:31], v[184:187]
    s_waitcnt lgkmcnt(6)
    v_mfma_f32_16x16x32_bf16 v[140:143], v[60:63], v[16:19], v[140:143]
    v_mfma_f32_16x16x32_bf16 v[156:159], v[60:63], v[20:23], v[156:159]
    v_mfma_f32_16x16x32_bf16 v[172:175], v[60:63], v[24:27], v[172:175]
    v_mfma_f32_16x16x32_bf16 v[188:191], v[60:63], v[28:31], v[188:191]
    v_mfma_f32_16x16x32_bf16 v[192:195], v[48:51], v[32:35], v[192:195]
    s_barrier
    s_waitcnt lgkmcnt(4)
    v_mfma_f32_16x16x32_bf16 v[208:211], v[48:51], v[36:39], v[208:211]
    ds_read_b64_tr_b16 v[16:17], v4 offset:49152
    s_waitcnt lgkmcnt(3)
    v_mfma_f32_16x16x32_bf16 v[224:227], v[48:51], v[40:43], v[224:227]
    ds_read_b64_tr_b16 v[18:19], v4 offset:51200
    s_waitcnt lgkmcnt(2)
    v_mfma_f32_16x16x32_bf16 v[240:243], v[48:51], v[44:47], v[240:243]
    ds_read_b128 v[48:51], v8 offset:49152
    v_mfma_f32_16x16x32_bf16 v[196:199], v[52:55], v[32:35], v[196:199]
    ds_read_b64_tr_b16 v[20:21], v5 offset:49152
    v_mfma_f32_16x16x32_bf16 v[212:215], v[52:55], v[36:39], v[212:215]
    v_mfma_f32_16x16x32_bf16 v[228:231], v[52:55], v[40:43], v[228:231]
    ds_read_b64_tr_b16 v[22:23], v5 offset:51200
    v_mfma_f32_16x16x32_bf16 v[244:247], v[52:55], v[44:47], v[244:247]
    ds_read_b64_tr_b16 v[24:25], v6 offset:49152
    v_mfma_f32_16x16x32_bf16 v[200:203], v[56:59], v[32:35], v[200:203]
    ds_read_b64_tr_b16 v[26:27], v6 offset:51200
    v_mfma_f32_16x16x32_bf16 v[216:219], v[56:59], v[36:39], v[216:219]
    ds_read_b64_tr_b16 v[28:29], v7 offset:49152
    v_mfma_f32_16x16x32_bf16 v[232:235], v[56:59], v[40:43], v[232:235]
    ds_read_b64_tr_b16 v[30:31], v7 offset:51200
    v_mfma_f32_16x16x32_bf16 v[248:251], v[56:59], v[44:47], v[248:251]
    ds_read_b128 v[52:55], v8 offset:50176
    v_mfma_f32_16x16x32_bf16 v[204:207], v[60:63], v[32:35], v[204:207]
    ds_read_b128 v[56:59], v8 offset:51200
    v_mfma_f32_16x16x32_bf16 v[220:223], v[60:63], v[36:39], v[220:223]
    ds_read_b64_tr_b16 v[32:33], v4 offset:53248
    v_mfma_f32_16x16x32_bf16 v[236:239], v[60:63], v[40:43], v[236:239]
    ds_read_b64_tr_b16 v[34:35], v4 offset:55296
    v_mfma_f32_16x16x32_bf16 v[252:255], v[60:63], v[44:47], v[252:255]
    ds_read_b128 v[60:63], v8 offset:52224
    s_waitcnt lgkmcnt(11)
    v_mfma_f32_16x16x32_bf16 v[128:131], v[48:51], v[16:19], v[128:131]
    ds_read_b64_tr_b16 v[36:37], v5 offset:53248
    s_waitcnt lgkmcnt(10)
    v_mfma_f32_16x16x32_bf16 v[144:147], v[48:51], v[20:23], v[144:147]
    ds_read_b64_tr_b16 v[38:39], v5 offset:55296
    s_waitcnt lgkmcnt(9)
    v_mfma_f32_16x16x32_bf16 v[160:163], v[48:51], v[24:27], v[160:163]
    ds_read_b64_tr_b16 v[40:41], v6 offset:53248
    s_waitcnt lgkmcnt(8)
    v_mfma_f32_16x16x32_bf16 v[176:179], v[48:51], v[28:31], v[176:179]
    ds_read_b64_tr_b16 v[42:43], v6 offset:55296
    s_waitcnt lgkmcnt(8)
    v_mfma_f32_16x16x32_bf16 v[132:135], v[52:55], v[16:19], v[132:135]
    ds_read_b64_tr_b16 v[44:45], v7 offset:53248
    v_mfma_f32_16x16x32_bf16 v[148:151], v[52:55], v[20:23], v[148:151]
    ds_read_b64_tr_b16 v[46:47], v7 offset:55296
    v_mfma_f32_16x16x32_bf16 v[164:167], v[52:55], v[24:27], v[164:167]
    v_mfma_f32_16x16x32_bf16 v[180:183], v[52:55], v[28:31], v[180:183]
    s_waitcnt lgkmcnt(9)
    v_mfma_f32_16x16x32_bf16 v[136:139], v[56:59], v[16:19], v[136:139]
    v_mfma_f32_16x16x32_bf16 v[152:155], v[56:59], v[20:23], v[152:155]
    v_mfma_f32_16x16x32_bf16 v[168:171], v[56:59], v[24:27], v[168:171]
    v_mfma_f32_16x16x32_bf16 v[184:187], v[56:59], v[28:31], v[184:187]
    s_waitcnt lgkmcnt(6)
    v_mfma_f32_16x16x32_bf16 v[140:143], v[60:63], v[16:19], v[140:143]
    v_mfma_f32_16x16x32_bf16 v[156:159], v[60:63], v[20:23], v[156:159]
    v_mfma_f32_16x16x32_bf16 v[172:175], v[60:63], v[24:27], v[172:175]
    v_mfma_f32_16x16x32_bf16 v[188:191], v[60:63], v[28:31], v[188:191]
    v_mfma_f32_16x16x32_bf16 v[192:195], v[48:51], v[32:35], v[192:195]
    s_barrier
    s_waitcnt lgkmcnt(4)
    v_mfma_f32_16x16x32_bf16 v[208:211], v[48:51], v[36:39], v[208:211]
    ds_read_b64_tr_b16 v[16:17], v10 offset:0
    s_waitcnt lgkmcnt(3)
    v_mfma_f32_16x16x32_bf16 v[224:227], v[48:51], v[40:43], v[224:227]
    ds_read_b64_tr_b16 v[18:19], v10 offset:2048
    s_waitcnt lgkmcnt(2)
    v_mfma_f32_16x16x32_bf16 v[240:243], v[48:51], v[44:47], v[240:243]
    ds_read_b128 v[48:51], v9 offset:0
    v_mfma_f32_16x16x32_bf16 v[196:199], v[52:55], v[32:35], v[196:199]
    ds_read_b64_tr_b16 v[20:21], v11 offset:0
    v_mfma_f32_16x16x32_bf16 v[212:215], v[52:55], v[36:39], v[212:215]
    v_mfma_f32_16x16x32_bf16 v[228:231], v[52:55], v[40:43], v[228:231]
    ds_read_b64_tr_b16 v[22:23], v11 offset:2048
    v_mfma_f32_16x16x32_bf16 v[244:247], v[52:55], v[44:47], v[244:247]
    ds_read_b64_tr_b16 v[24:25], v12 offset:0
    v_mfma_f32_16x16x32_bf16 v[200:203], v[56:59], v[32:35], v[200:203]
    ds_read_b64_tr_b16 v[26:27], v12 offset:2048
    v_mfma_f32_16x16x32_bf16 v[216:219], v[56:59], v[36:39], v[216:219]
    ds_read_b64_tr_b16 v[28:29], v13 offset:0
    v_mfma_f32_16x16x32_bf16 v[232:235], v[56:59], v[40:43], v[232:235]
    ds_read_b64_tr_b16 v[30:31], v13 offset:2048
    v_mfma_f32_16x16x32_bf16 v[248:251], v[56:59], v[44:47], v[248:251]
    ds_read_b128 v[52:55], v9 offset:1024
    v_mfma_f32_16x16x32_bf16 v[204:207], v[60:63], v[32:35], v[204:207]
    ds_read_b128 v[56:59], v9 offset:2048
    v_mfma_f32_16x16x32_bf16 v[220:223], v[60:63], v[36:39], v[220:223]
    ds_read_b64_tr_b16 v[32:33], v10 offset:4096
    v_mfma_f32_16x16x32_bf16 v[236:239], v[60:63], v[40:43], v[236:239]
    ds_read_b64_tr_b16 v[34:35], v10 offset:6144
    v_mfma_f32_16x16x32_bf16 v[252:255], v[60:63], v[44:47], v[252:255]
    ds_read_b128 v[60:63], v9 offset:3072
    s_waitcnt lgkmcnt(11)
    v_mfma_f32_16x16x32_bf16 v[128:131], v[48:51], v[16:19], v[128:131]
    ds_read_b64_tr_b16 v[36:37], v11 offset:4096
    s_waitcnt lgkmcnt(10)
    v_mfma_f32_16x16x32_bf16 v[144:147], v[48:51], v[20:23], v[144:147]
    ds_read_b64_tr_b16 v[38:39], v11 offset:6144
    s_waitcnt lgkmcnt(9)
    v_mfma_f32_16x16x32_bf16 v[160:163], v[48:51], v[24:27], v[160:163]
    ds_read_b64_tr_b16 v[40:41], v12 offset:4096
    s_waitcnt lgkmcnt(8)
    v_mfma_f32_16x16x32_bf16 v[176:179], v[48:51], v[28:31], v[176:179]
    ds_read_b64_tr_b16 v[42:43], v12 offset:6144
    s_waitcnt lgkmcnt(8)
    v_mfma_f32_16x16x32_bf16 v[132:135], v[52:55], v[16:19], v[132:135]
    ds_read_b64_tr_b16 v[44:45], v13 offset:4096
    v_mfma_f32_16x16x32_bf16 v[148:151], v[52:55], v[20:23], v[148:151]
    ds_read_b64_tr_b16 v[46:47], v13 offset:6144
    v_mfma_f32_16x16x32_bf16 v[164:167], v[52:55], v[24:27], v[164:167]
    v_mfma_f32_16x16x32_bf16 v[180:183], v[52:55], v[28:31], v[180:183]
    s_waitcnt lgkmcnt(9)
    v_mfma_f32_16x16x32_bf16 v[136:139], v[56:59], v[16:19], v[136:139]
    v_mfma_f32_16x16x32_bf16 v[152:155], v[56:59], v[20:23], v[152:155]
    v_mfma_f32_16x16x32_bf16 v[168:171], v[56:59], v[24:27], v[168:171]
    v_mfma_f32_16x16x32_bf16 v[184:187], v[56:59], v[28:31], v[184:187]
    s_waitcnt lgkmcnt(6)
    v_mfma_f32_16x16x32_bf16 v[140:143], v[60:63], v[16:19], v[140:143]
    v_mfma_f32_16x16x32_bf16 v[156:159], v[60:63], v[20:23], v[156:159]
    v_mfma_f32_16x16x32_bf16 v[172:175], v[60:63], v[24:27], v[172:175]
    v_mfma_f32_16x16x32_bf16 v[188:191], v[60:63], v[28:31], v[188:191]
    v_mfma_f32_16x16x32_bf16 v[192:195], v[48:51], v[32:35], v[192:195]
    s_barrier
    s_waitcnt lgkmcnt(4)
    v_mfma_f32_16x16x32_bf16 v[208:211], v[48:51], v[36:39], v[208:211]
    ds_read_b64_tr_b16 v[16:17], v10 offset:24576
    s_waitcnt lgkmcnt(3)
    v_mfma_f32_16x16x32_bf16 v[224:227], v[48:51], v[40:43], v[224:227]
    ds_read_b64_tr_b16 v[18:19], v10 offset:26624
    s_waitcnt lgkmcnt(2)
    v_mfma_f32_16x16x32_bf16 v[240:243], v[48:51], v[44:47], v[240:243]
    ds_read_b128 v[48:51], v9 offset:24576
    v_mfma_f32_16x16x32_bf16 v[196:199], v[52:55], v[32:35], v[196:199]
    ds_read_b64_tr_b16 v[20:21], v11 offset:24576
    v_mfma_f32_16x16x32_bf16 v[212:215], v[52:55], v[36:39], v[212:215]
    v_mfma_f32_16x16x32_bf16 v[228:231], v[52:55], v[40:43], v[228:231]
    ds_read_b64_tr_b16 v[22:23], v11 offset:26624
    v_mfma_f32_16x16x32_bf16 v[244:247], v[52:55], v[44:47], v[244:247]
    ds_read_b64_tr_b16 v[24:25], v12 offset:24576
    v_mfma_f32_16x16x32_bf16 v[200:203], v[56:59], v[32:35], v[200:203]
    ds_read_b64_tr_b16 v[26:27], v12 offset:26624
    v_mfma_f32_16x16x32_bf16 v[216:219], v[56:59], v[36:39], v[216:219]
    ds_read_b64_tr_b16 v[28:29], v13 offset:24576
    v_mfma_f32_16x16x32_bf16 v[232:235], v[56:59], v[40:43], v[232:235]
    ds_read_b64_tr_b16 v[30:31], v13 offset:26624
    v_mfma_f32_16x16x32_bf16 v[248:251], v[56:59], v[44:47], v[248:251]
    ds_read_b128 v[52:55], v9 offset:25600
    v_mfma_f32_16x16x32_bf16 v[204:207], v[60:63], v[32:35], v[204:207]
    ds_read_b128 v[56:59], v9 offset:26624
    v_mfma_f32_16x16x32_bf16 v[220:223], v[60:63], v[36:39], v[220:223]
    ds_read_b64_tr_b16 v[32:33], v10 offset:28672
    v_mfma_f32_16x16x32_bf16 v[236:239], v[60:63], v[40:43], v[236:239]
    ds_read_b64_tr_b16 v[34:35], v10 offset:30720
    v_mfma_f32_16x16x32_bf16 v[252:255], v[60:63], v[44:47], v[252:255]
    ds_read_b128 v[60:63], v9 offset:27648
    s_waitcnt lgkmcnt(11)
    v_mfma_f32_16x16x32_bf16 v[128:131], v[48:51], v[16:19], v[128:131]
    ds_read_b64_tr_b16 v[36:37], v11 offset:28672
    s_waitcnt lgkmcnt(10)
    v_mfma_f32_16x16x32_bf16 v[144:147], v[48:51], v[20:23], v[144:147]
    ds_read_b64_tr_b16 v[38:39], v11 offset:30720
    s_waitcnt lgkmcnt(9)
    v_mfma_f32_16x16x32_bf16 v[160:163], v[48:51], v[24:27], v[160:163]
    ds_read_b64_tr_b16 v[40:41], v12 offset:28672
    s_waitcnt lgkmcnt(8)
    v_mfma_f32_16x16x32_bf16 v[176:179], v[48:51], v[28:31], v[176:179]
    ds_read_b64_tr_b16 v[42:43], v12 offset:30720
    s_waitcnt lgkmcnt(8)
    v_mfma_f32_16x16x32_bf16 v[132:135], v[52:55], v[16:19], v[132:135]
    ds_read_b64_tr_b16 v[44:45], v13 offset:28672
    v_mfma_f32_16x16x32_bf16 v[148:151], v[52:55], v[20:23], v[148:151]
    ds_read_b64_tr_b16 v[46:47], v13 offset:30720
    v_mfma_f32_16x16x32_bf16 v[164:167], v[52:55], v[24:27], v[164:167]
    v_mfma_f32_16x16x32_bf16 v[180:183], v[52:55], v[28:31], v[180:183]
    s_waitcnt lgkmcnt(9)
    v_mfma_f32_16x16x32_bf16 v[136:139], v[56:59], v[16:19], v[136:139]
    v_mfma_f32_16x16x32_bf16 v[152:155], v[56:59], v[20:23], v[152:155]
    v_mfma_f32_16x16x32_bf16 v[168:171], v[56:59], v[24:27], v[168:171]
    v_mfma_f32_16x16x32_bf16 v[184:187], v[56:59], v[28:31], v[184:187]
    s_waitcnt lgkmcnt(6)
    v_mfma_f32_16x16x32_bf16 v[140:143], v[60:63], v[16:19], v[140:143]
    v_mfma_f32_16x16x32_bf16 v[156:159], v[60:63], v[20:23], v[156:159]
    v_mfma_f32_16x16x32_bf16 v[172:175], v[60:63], v[24:27], v[172:175]
    v_mfma_f32_16x16x32_bf16 v[188:191], v[60:63], v[28:31], v[188:191]
    v_mfma_f32_16x16x32_bf16 v[192:195], v[48:51], v[32:35], v[192:195]
    s_barrier
    s_waitcnt lgkmcnt(4)
    v_mfma_f32_16x16x32_bf16 v[208:211], v[48:51], v[36:39], v[208:211]
    ds_read_b64_tr_b16 v[16:17], v10 offset:49152
    s_waitcnt lgkmcnt(3)
    v_mfma_f32_16x16x32_bf16 v[224:227], v[48:51], v[40:43], v[224:227]
    ds_read_b64_tr_b16 v[18:19], v10 offset:51200
    s_waitcnt lgkmcnt(2)
    v_mfma_f32_16x16x32_bf16 v[240:243], v[48:51], v[44:47], v[240:243]
    ds_read_b128 v[48:51], v9 offset:49152
    v_mfma_f32_16x16x32_bf16 v[196:199], v[52:55], v[32:35], v[196:199]
    ds_read_b64_tr_b16 v[20:21], v11 offset:49152
    v_mfma_f32_16x16x32_bf16 v[212:215], v[52:55], v[36:39], v[212:215]
    v_mfma_f32_16x16x32_bf16 v[228:231], v[52:55], v[40:43], v[228:231]
    ds_read_b64_tr_b16 v[22:23], v11 offset:51200
    v_mfma_f32_16x16x32_bf16 v[244:247], v[52:55], v[44:47], v[244:247]
    ds_read_b64_tr_b16 v[24:25], v12 offset:49152
    v_mfma_f32_16x16x32_bf16 v[200:203], v[56:59], v[32:35], v[200:203]
    ds_read_b64_tr_b16 v[26:27], v12 offset:51200
    v_mfma_f32_16x16x32_bf16 v[216:219], v[56:59], v[36:39], v[216:219]
    ds_read_b64_tr_b16 v[28:29], v13 offset:49152
    v_mfma_f32_16x16x32_bf16 v[232:235], v[56:59], v[40:43], v[232:235]
    ds_read_b64_tr_b16 v[30:31], v13 offset:51200
    v_mfma_f32_16x16x32_bf16 v[248:251], v[56:59], v[44:47], v[248:251]
    ds_read_b128 v[52:55], v9 offset:50176
    v_mfma_f32_16x16x32_bf16 v[204:207], v[60:63], v[32:35], v[204:207]
    ds_read_b128 v[56:59], v9 offset:51200
    v_mfma_f32_16x16x32_bf16 v[220:223], v[60:63], v[36:39], v[220:223]
    ds_read_b64_tr_b16 v[32:33], v10 offset:53248
    v_mfma_f32_16x16x32_bf16 v[236:239], v[60:63], v[40:43], v[236:239]
    ds_read_b64_tr_b16 v[34:35], v10 offset:55296
    v_mfma_f32_16x16x32_bf16 v[252:255], v[60:63], v[44:47], v[252:255]
    ds_read_b128 v[60:63], v9 offset:52224
    s_waitcnt lgkmcnt(11)
    v_mfma_f32_16x16x32_bf16 v[128:131], v[48:51], v[16:19], v[128:131]
    ds_read_b64_tr_b16 v[36:37], v11 offset:53248
    s_waitcnt lgkmcnt(10)
    v_mfma_f32_16x16x32_bf16 v[144:147], v[48:51], v[20:23], v[144:147]
    ds_read_b64_tr_b16 v[38:39], v11 offset:55296
    s_waitcnt lgkmcnt(9)
    v_mfma_f32_16x16x32_bf16 v[160:163], v[48:51], v[24:27], v[160:163]
    ds_read_b64_tr_b16 v[40:41], v12 offset:53248
    s_waitcnt lgkmcnt(8)
    v_mfma_f32_16x16x32_bf16 v[176:179], v[48:51], v[28:31], v[176:179]
    ds_read_b64_tr_b16 v[42:43], v12 offset:55296
    s_waitcnt lgkmcnt(8)
    v_mfma_f32_16x16x32_bf16 v[132:135], v[52:55], v[16:19], v[132:135]
    ds_read_b64_tr_b16 v[44:45], v13 offset:53248
    v_mfma_f32_16x16x32_bf16 v[148:151], v[52:55], v[20:23], v[148:151]
    ds_read_b64_tr_b16 v[46:47], v13 offset:55296
    v_mfma_f32_16x16x32_bf16 v[164:167], v[52:55], v[24:27], v[164:167]
    v_mfma_f32_16x16x32_bf16 v[180:183], v[52:55], v[28:31], v[180:183]
    s_waitcnt lgkmcnt(9)
    v_mfma_f32_16x16x32_bf16 v[136:139], v[56:59], v[16:19], v[136:139]
    v_mfma_f32_16x16x32_bf16 v[152:155], v[56:59], v[20:23], v[152:155]
    v_mfma_f32_16x16x32_bf16 v[168:171], v[56:59], v[24:27], v[168:171]
    v_mfma_f32_16x16x32_bf16 v[184:187], v[56:59], v[28:31], v[184:187]
    s_waitcnt lgkmcnt(6)
    v_mfma_f32_16x16x32_bf16 v[140:143], v[60:63], v[16:19], v[140:143]
    v_mfma_f32_16x16x32_bf16 v[156:159], v[60:63], v[20:23], v[156:159]
    v_mfma_f32_16x16x32_bf16 v[172:175], v[60:63], v[24:27], v[172:175]
    v_mfma_f32_16x16x32_bf16 v[188:191], v[60:63], v[28:31], v[188:191]
    v_mfma_f32_16x16x32_bf16 v[192:195], v[48:51], v[32:35], v[192:195]
    s_barrier
    s_waitcnt lgkmcnt(4)
    v_mfma_f32_16x16x32_bf16 v[208:211], v[48:51], v[36:39], v[208:211]
    ds_read_b64_tr_b16 v[16:17], v4 offset:0
    s_waitcnt lgkmcnt(3)
    v_mfma_f32_16x16x32_bf16 v[224:227], v[48:51], v[40:43], v[224:227]
    ds_read_b64_tr_b16 v[18:19], v4 offset:2048
    s_waitcnt lgkmcnt(2)
    v_mfma_f32_16x16x32_bf16 v[240:243], v[48:51], v[44:47], v[240:243]
    ds_read_b128 v[48:51], v8 offset:0
    v_mfma_f32_16x16x32_bf16 v[196:199], v[52:55], v[32:35], v[196:199]
    ds_read_b64_tr_b16 v[20:21], v5 offset:0
    v_mfma_f32_16x16x32_bf16 v[212:215], v[52:55], v[36:39], v[212:215]
    v_mfma_f32_16x16x32_bf16 v[228:231], v[52:55], v[40:43], v[228:231]
    ds_read_b64_tr_b16 v[22:23], v5 offset:2048
    v_mfma_f32_16x16x32_bf16 v[244:247], v[52:55], v[44:47], v[244:247]
    ds_read_b64_tr_b16 v[24:25], v6 offset:0
    v_mfma_f32_16x16x32_bf16 v[200:203], v[56:59], v[32:35], v[200:203]
    ds_read_b64_tr_b16 v[26:27], v6 offset:2048
    v_mfma_f32_16x16x32_bf16 v[216:219], v[56:59], v[36:39], v[216:219]
    ds_read_b64_tr_b16 v[28:29], v7 offset:0
    v_mfma_f32_16x16x32_bf16 v[232:235], v[56:59], v[40:43], v[232:235]
    ds_read_b64_tr_b16 v[30:31], v7 offset:2048
    v_mfma_f32_16x16x32_bf16 v[248:251], v[56:59], v[44:47], v[248:251]
    ds_read_b128 v[52:55], v8 offset:1024
    v_mfma_f32_16x16x32_bf16 v[204:207], v[60:63], v[32:35], v[204:207]
    ds_read_b128 v[56:59], v8 offset:2048
    v_mfma_f32_16x16x32_bf16 v[220:223], v[60:63], v[36:39], v[220:223]
    ds_read_b64_tr_b16 v[32:33], v4 offset:4096
    v_mfma_f32_16x16x32_bf16 v[236:239], v[60:63], v[40:43], v[236:239]
    ds_read_b64_tr_b16 v[34:35], v4 offset:6144
    v_mfma_f32_16x16x32_bf16 v[252:255], v[60:63], v[44:47], v[252:255]
    ds_read_b128 v[60:63], v8 offset:3072
    s_waitcnt lgkmcnt(11)
    v_mfma_f32_16x16x32_bf16 v[128:131], v[48:51], v[16:19], v[128:131]
    ds_read_b64_tr_b16 v[36:37], v5 offset:4096
    s_waitcnt lgkmcnt(10)
    v_mfma_f32_16x16x32_bf16 v[144:147], v[48:51], v[20:23], v[144:147]
    ds_read_b64_tr_b16 v[38:39], v5 offset:6144
    s_waitcnt lgkmcnt(9)
    v_mfma_f32_16x16x32_bf16 v[160:163], v[48:51], v[24:27], v[160:163]
    ds_read_b64_tr_b16 v[40:41], v6 offset:4096
    s_waitcnt lgkmcnt(8)
    v_mfma_f32_16x16x32_bf16 v[176:179], v[48:51], v[28:31], v[176:179]
    ds_read_b64_tr_b16 v[42:43], v6 offset:6144
    s_waitcnt lgkmcnt(8)
    v_mfma_f32_16x16x32_bf16 v[132:135], v[52:55], v[16:19], v[132:135]
    ds_read_b64_tr_b16 v[44:45], v7 offset:4096
    v_mfma_f32_16x16x32_bf16 v[148:151], v[52:55], v[20:23], v[148:151]
    ds_read_b64_tr_b16 v[46:47], v7 offset:6144
    v_mfma_f32_16x16x32_bf16 v[164:167], v[52:55], v[24:27], v[164:167]
    v_mfma_f32_16x16x32_bf16 v[180:183], v[52:55], v[28:31], v[180:183]
    s_waitcnt lgkmcnt(9)
    v_mfma_f32_16x16x32_bf16 v[136:139], v[56:59], v[16:19], v[136:139]
    v_mfma_f32_16x16x32_bf16 v[152:155], v[56:59], v[20:23], v[152:155]
    v_mfma_f32_16x16x32_bf16 v[168:171], v[56:59], v[24:27], v[168:171]
    v_mfma_f32_16x16x32_bf16 v[184:187], v[56:59], v[28:31], v[184:187]
    s_waitcnt lgkmcnt(6)
    v_mfma_f32_16x16x32_bf16 v[140:143], v[60:63], v[16:19], v[140:143]
    v_mfma_f32_16x16x32_bf16 v[156:159], v[60:63], v[20:23], v[156:159]
    v_mfma_f32_16x16x32_bf16 v[172:175], v[60:63], v[24:27], v[172:175]
    v_mfma_f32_16x16x32_bf16 v[188:191], v[60:63], v[28:31], v[188:191]
    v_mfma_f32_16x16x32_bf16 v[192:195], v[48:51], v[32:35], v[192:195]
    s_barrier
    s_waitcnt lgkmcnt(4)
    v_mfma_f32_16x16x32_bf16 v[208:211], v[48:51], v[36:39], v[208:211]
    ds_read_b64_tr_b16 v[16:17], v4 offset:24576
    s_waitcnt lgkmcnt(3)
    v_mfma_f32_16x16x32_bf16 v[224:227], v[48:51], v[40:43], v[224:227]
    ds_read_b64_tr_b16 v[18:19], v4 offset:26624
    s_waitcnt lgkmcnt(2)
    v_mfma_f32_16x16x32_bf16 v[240:243], v[48:51], v[44:47], v[240:243]
    ds_read_b128 v[48:51], v8 offset:24576
    v_mfma_f32_16x16x32_bf16 v[196:199], v[52:55], v[32:35], v[196:199]
    ds_read_b64_tr_b16 v[20:21], v5 offset:24576
    v_mfma_f32_16x16x32_bf16 v[212:215], v[52:55], v[36:39], v[212:215]
    v_mfma_f32_16x16x32_bf16 v[228:231], v[52:55], v[40:43], v[228:231]
    ds_read_b64_tr_b16 v[22:23], v5 offset:26624
    v_mfma_f32_16x16x32_bf16 v[244:247], v[52:55], v[44:47], v[244:247]
    ds_read_b64_tr_b16 v[24:25], v6 offset:24576
    v_mfma_f32_16x16x32_bf16 v[200:203], v[56:59], v[32:35], v[200:203]
    ds_read_b64_tr_b16 v[26:27], v6 offset:26624
    v_mfma_f32_16x16x32_bf16 v[216:219], v[56:59], v[36:39], v[216:219]
    ds_read_b64_tr_b16 v[28:29], v7 offset:24576
    v_mfma_f32_16x16x32_bf16 v[232:235], v[56:59], v[40:43], v[232:235]
    ds_read_b64_tr_b16 v[30:31], v7 offset:26624
    v_mfma_f32_16x16x32_bf16 v[248:251], v[56:59], v[44:47], v[248:251]
    ds_read_b128 v[52:55], v8 offset:25600
    v_mfma_f32_16x16x32_bf16 v[204:207], v[60:63], v[32:35], v[204:207]
    ds_read_b128 v[56:59], v8 offset:26624
    v_mfma_f32_16x16x32_bf16 v[220:223], v[60:63], v[36:39], v[220:223]
    ds_read_b64_tr_b16 v[32:33], v4 offset:28672
    v_mfma_f32_16x16x32_bf16 v[236:239], v[60:63], v[40:43], v[236:239]
    ds_read_b64_tr_b16 v[34:35], v4 offset:30720
    v_mfma_f32_16x16x32_bf16 v[252:255], v[60:63], v[44:47], v[252:255]
    ds_read_b128 v[60:63], v8 offset:27648
    s_waitcnt lgkmcnt(11)
    v_mfma_f32_16x16x32_bf16 v[128:131], v[48:51], v[16:19], v[128:131]
    ds_read_b64_tr_b16 v[36:37], v5 offset:28672
    s_waitcnt lgkmcnt(10)
    v_mfma_f32_16x16x32_bf16 v[144:147], v[48:51], v[20:23], v[144:147]
    ds_read_b64_tr_b16 v[38:39], v5 offset:30720
    s_waitcnt lgkmcnt(9)
    v_mfma_f32_16x16x32_bf16 v[160:163], v[48:51], v[24:27], v[160:163]
    ds_read_b64_tr_b16 v[40:41], v6 offset:28672
    s_waitcnt lgkmcnt(8)
    v_mfma_f32_16x16x32_bf16 v[176:179], v[48:51], v[28:31], v[176:179]
    ds_read_b64_tr_b16 v[42:43], v6 offset:30720
    s_waitcnt lgkmcnt(8)
    v_mfma_f32_16x16x32_bf16 v[132:135], v[52:55], v[16:19], v[132:135]
    ds_read_b64_tr_b16 v[44:45], v7 offset:28672
    v_mfma_f32_16x16x32_bf16 v[148:151], v[52:55], v[20:23], v[148:151]
    ds_read_b64_tr_b16 v[46:47], v7 offset:30720
    v_mfma_f32_16x16x32_bf16 v[164:167], v[52:55], v[24:27], v[164:167]
    v_mfma_f32_16x16x32_bf16 v[180:183], v[52:55], v[28:31], v[180:183]
    s_waitcnt lgkmcnt(9)
    v_mfma_f32_16x16x32_bf16 v[136:139], v[56:59], v[16:19], v[136:139]
    v_mfma_f32_16x16x32_bf16 v[152:155], v[56:59], v[20:23], v[152:155]
    v_mfma_f32_16x16x32_bf16 v[168:171], v[56:59], v[24:27], v[168:171]
    v_mfma_f32_16x16x32_bf16 v[184:187], v[56:59], v[28:31], v[184:187]
    s_waitcnt lgkmcnt(6)
    v_mfma_f32_16x16x32_bf16 v[140:143], v[60:63], v[16:19], v[140:143]
    v_mfma_f32_16x16x32_bf16 v[156:159], v[60:63], v[20:23], v[156:159]
    v_mfma_f32_16x16x32_bf16 v[172:175], v[60:63], v[24:27], v[172:175]
    v_mfma_f32_16x16x32_bf16 v[188:191], v[60:63], v[28:31], v[188:191]
    v_mfma_f32_16x16x32_bf16 v[192:195], v[48:51], v[32:35], v[192:195]
    s_barrier
    s_waitcnt lgkmcnt(4)
    v_mfma_f32_16x16x32_bf16 v[208:211], v[48:51], v[36:39], v[208:211]
    ds_read_b64_tr_b16 v[16:17], v4 offset:49152
    s_waitcnt lgkmcnt(3)
    v_mfma_f32_16x16x32_bf16 v[224:227], v[48:51], v[40:43], v[224:227]
    ds_read_b64_tr_b16 v[18:19], v4 offset:51200
    s_waitcnt lgkmcnt(2)
    v_mfma_f32_16x16x32_bf16 v[240:243], v[48:51], v[44:47], v[240:243]
    ds_read_b128 v[48:51], v8 offset:49152
    v_mfma_f32_16x16x32_bf16 v[196:199], v[52:55], v[32:35], v[196:199]
    ds_read_b64_tr_b16 v[20:21], v5 offset:49152
    v_mfma_f32_16x16x32_bf16 v[212:215], v[52:55], v[36:39], v[212:215]
    v_mfma_f32_16x16x32_bf16 v[228:231], v[52:55], v[40:43], v[228:231]
    ds_read_b64_tr_b16 v[22:23], v5 offset:51200
    v_mfma_f32_16x16x32_bf16 v[244:247], v[52:55], v[44:47], v[244:247]
    ds_read_b64_tr_b16 v[24:25], v6 offset:49152
    v_mfma_f32_16x16x32_bf16 v[200:203], v[56:59], v[32:35], v[200:203]
    ds_read_b64_tr_b16 v[26:27], v6 offset:51200
    v_mfma_f32_16x16x32_bf16 v[216:219], v[56:59], v[36:39], v[216:219]
    ds_read_b64_tr_b16 v[28:29], v7 offset:49152
    v_mfma_f32_16x16x32_bf16 v[232:235], v[56:59], v[40:43], v[232:235]
    ds_read_b64_tr_b16 v[30:31], v7 offset:51200
    v_mfma_f32_16x16x32_bf16 v[248:251], v[56:59], v[44:47], v[248:251]
    ds_read_b128 v[52:55], v8 offset:50176
    v_mfma_f32_16x16x32_bf16 v[204:207], v[60:63], v[32:35], v[204:207]
    ds_read_b128 v[56:59], v8 offset:51200
    v_mfma_f32_16x16x32_bf16 v[220:223], v[60:63], v[36:39], v[220:223]
    ds_read_b64_tr_b16 v[32:33], v4 offset:53248
    v_mfma_f32_16x16x32_bf16 v[236:239], v[60:63], v[40:43], v[236:239]
    ds_read_b64_tr_b16 v[34:35], v4 offset:55296
    v_mfma_f32_16x16x32_bf16 v[252:255], v[60:63], v[44:47], v[252:255]
    ds_read_b128 v[60:63], v8 offset:52224
    s_waitcnt lgkmcnt(11)
    v_mfma_f32_16x16x32_bf16 v[128:131], v[48:51], v[16:19], v[128:131]
    ds_read_b64_tr_b16 v[36:37], v5 offset:53248
    s_waitcnt lgkmcnt(10)
    v_mfma_f32_16x16x32_bf16 v[144:147], v[48:51], v[20:23], v[144:147]
    ds_read_b64_tr_b16 v[38:39], v5 offset:55296
    s_waitcnt lgkmcnt(9)
    v_mfma_f32_16x16x32_bf16 v[160:163], v[48:51], v[24:27], v[160:163]
    ds_read_b64_tr_b16 v[40:41], v6 offset:53248
    s_waitcnt lgkmcnt(8)
    v_mfma_f32_16x16x32_bf16 v[176:179], v[48:51], v[28:31], v[176:179]
    ds_read_b64_tr_b16 v[42:43], v6 offset:55296
    s_waitcnt lgkmcnt(8)
    v_mfma_f32_16x16x32_bf16 v[132:135], v[52:55], v[16:19], v[132:135]
    ds_read_b64_tr_b16 v[44:45], v7 offset:53248
    v_mfma_f32_16x16x32_bf16 v[148:151], v[52:55], v[20:23], v[148:151]
    ds_read_b64_tr_b16 v[46:47], v7 offset:55296
    v_mfma_f32_16x16x32_bf16 v[164:167], v[52:55], v[24:27], v[164:167]
    v_mfma_f32_16x16x32_bf16 v[180:183], v[52:55], v[28:31], v[180:183]
    s_waitcnt lgkmcnt(9)
    v_mfma_f32_16x16x32_bf16 v[136:139], v[56:59], v[16:19], v[136:139]
    v_mfma_f32_16x16x32_bf16 v[152:155], v[56:59], v[20:23], v[152:155]
    v_mfma_f32_16x16x32_bf16 v[168:171], v[56:59], v[24:27], v[168:171]
    v_mfma_f32_16x16x32_bf16 v[184:187], v[56:59], v[28:31], v[184:187]
    s_waitcnt lgkmcnt(6)
    v_mfma_f32_16x16x32_bf16 v[140:143], v[60:63], v[16:19], v[140:143]
    v_mfma_f32_16x16x32_bf16 v[156:159], v[60:63], v[20:23], v[156:159]
    v_mfma_f32_16x16x32_bf16 v[172:175], v[60:63], v[24:27], v[172:175]
    v_mfma_f32_16x16x32_bf16 v[188:191], v[60:63], v[28:31], v[188:191]
    v_mfma_f32_16x16x32_bf16 v[192:195], v[48:51], v[32:35], v[192:195]
    s_barrier
    s_waitcnt lgkmcnt(4)
    v_mfma_f32_16x16x32_bf16 v[208:211], v[48:51], v[36:39], v[208:211]
    ds_read_b64_tr_b16 v[16:17], v10 offset:0
    s_waitcnt lgkmcnt(3)
    v_mfma_f32_16x16x32_bf16 v[224:227], v[48:51], v[40:43], v[224:227]
    ds_read_b64_tr_b16 v[18:19], v10 offset:2048
    s_waitcnt lgkmcnt(2)
    v_mfma_f32_16x16x32_bf16 v[240:243], v[48:51], v[44:47], v[240:243]
    ds_read_b128 v[48:51], v9 offset:0
    v_mfma_f32_16x16x32_bf16 v[196:199], v[52:55], v[32:35], v[196:199]
    ds_read_b64_tr_b16 v[20:21], v11 offset:0
    v_mfma_f32_16x16x32_bf16 v[212:215], v[52:55], v[36:39], v[212:215]
    v_mfma_f32_16x16x32_bf16 v[228:231], v[52:55], v[40:43], v[228:231]
    ds_read_b64_tr_b16 v[22:23], v11 offset:2048
    v_mfma_f32_16x16x32_bf16 v[244:247], v[52:55], v[44:47], v[244:247]
    ds_read_b64_tr_b16 v[24:25], v12 offset:0
    v_mfma_f32_16x16x32_bf16 v[200:203], v[56:59], v[32:35], v[200:203]
    ds_read_b64_tr_b16 v[26:27], v12 offset:2048
    v_mfma_f32_16x16x32_bf16 v[216:219], v[56:59], v[36:39], v[216:219]
    ds_read_b64_tr_b16 v[28:29], v13 offset:0
    v_mfma_f32_16x16x32_bf16 v[232:235], v[56:59], v[40:43], v[232:235]
    ds_read_b64_tr_b16 v[30:31], v13 offset:2048
    v_mfma_f32_16x16x32_bf16 v[248:251], v[56:59], v[44:47], v[248:251]
    ds_read_b128 v[52:55], v9 offset:1024
    v_mfma_f32_16x16x32_bf16 v[204:207], v[60:63], v[32:35], v[204:207]
    ds_read_b128 v[56:59], v9 offset:2048
    v_mfma_f32_16x16x32_bf16 v[220:223], v[60:63], v[36:39], v[220:223]
    ds_read_b64_tr_b16 v[32:33], v10 offset:4096
    v_mfma_f32_16x16x32_bf16 v[236:239], v[60:63], v[40:43], v[236:239]
    ds_read_b64_tr_b16 v[34:35], v10 offset:6144
    v_mfma_f32_16x16x32_bf16 v[252:255], v[60:63], v[44:47], v[252:255]
    ds_read_b128 v[60:63], v9 offset:3072
    s_waitcnt lgkmcnt(11)
    v_mfma_f32_16x16x32_bf16 v[128:131], v[48:51], v[16:19], v[128:131]
    ds_read_b64_tr_b16 v[36:37], v11 offset:4096
    s_waitcnt lgkmcnt(10)
    v_mfma_f32_16x16x32_bf16 v[144:147], v[48:51], v[20:23], v[144:147]
    ds_read_b64_tr_b16 v[38:39], v11 offset:6144
    s_waitcnt lgkmcnt(9)
    v_mfma_f32_16x16x32_bf16 v[160:163], v[48:51], v[24:27], v[160:163]
    ds_read_b64_tr_b16 v[40:41], v12 offset:4096
    s_waitcnt lgkmcnt(8)
    v_mfma_f32_16x16x32_bf16 v[176:179], v[48:51], v[28:31], v[176:179]
    ds_read_b64_tr_b16 v[42:43], v12 offset:6144
    s_waitcnt lgkmcnt(8)
    v_mfma_f32_16x16x32_bf16 v[132:135], v[52:55], v[16:19], v[132:135]
    ds_read_b64_tr_b16 v[44:45], v13 offset:4096
    v_mfma_f32_16x16x32_bf16 v[148:151], v[52:55], v[20:23], v[148:151]
    ds_read_b64_tr_b16 v[46:47], v13 offset:6144
    v_mfma_f32_16x16x32_bf16 v[164:167], v[52:55], v[24:27], v[164:167]
    v_mfma_f32_16x16x32_bf16 v[180:183], v[52:55], v[28:31], v[180:183]
    s_waitcnt lgkmcnt(9)
    v_mfma_f32_16x16x32_bf16 v[136:139], v[56:59], v[16:19], v[136:139]
    v_mfma_f32_16x16x32_bf16 v[152:155], v[56:59], v[20:23], v[152:155]
    v_mfma_f32_16x16x32_bf16 v[168:171], v[56:59], v[24:27], v[168:171]
    v_mfma_f32_16x16x32_bf16 v[184:187], v[56:59], v[28:31], v[184:187]
    s_waitcnt lgkmcnt(6)
    v_mfma_f32_16x16x32_bf16 v[140:143], v[60:63], v[16:19], v[140:143]
    v_mfma_f32_16x16x32_bf16 v[156:159], v[60:63], v[20:23], v[156:159]
    v_mfma_f32_16x16x32_bf16 v[172:175], v[60:63], v[24:27], v[172:175]
    v_mfma_f32_16x16x32_bf16 v[188:191], v[60:63], v[28:31], v[188:191]
    v_mfma_f32_16x16x32_bf16 v[192:195], v[48:51], v[32:35], v[192:195]
    buffer_load_dword v65, v120, s[52:55], s45 offen sc1
    s_barrier
    s_waitcnt lgkmcnt(4)
    v_mfma_f32_16x16x32_bf16 v[208:211], v[48:51], v[36:39], v[208:211]
    ds_read_b64_tr_b16 v[16:17], v10 offset:24576
    s_waitcnt lgkmcnt(3)
    v_mfma_f32_16x16x32_bf16 v[224:227], v[48:51], v[40:43], v[224:227]
    ds_read_b64_tr_b16 v[18:19], v10 offset:26624
    s_waitcnt lgkmcnt(2)
    v_mfma_f32_16x16x32_bf16 v[240:243], v[48:51], v[44:47], v[240:243]
    ds_read_b128 v[48:51], v9 offset:24576
    v_mfma_f32_16x16x32_bf16 v[196:199], v[52:55], v[32:35], v[196:199]
    ds_read_b64_tr_b16 v[20:21], v11 offset:24576
    v_mfma_f32_16x16x32_bf16 v[212:215], v[52:55], v[36:39], v[212:215]
    v_mfma_f32_16x16x32_bf16 v[228:231], v[52:55], v[40:43], v[228:231]
    ds_read_b64_tr_b16 v[22:23], v11 offset:26624
    v_mfma_f32_16x16x32_bf16 v[244:247], v[52:55], v[44:47], v[244:247]
    ds_read_b64_tr_b16 v[24:25], v12 offset:24576
    v_mfma_f32_16x16x32_bf16 v[200:203], v[56:59], v[32:35], v[200:203]
    ds_read_b64_tr_b16 v[26:27], v12 offset:26624
    v_mfma_f32_16x16x32_bf16 v[216:219], v[56:59], v[36:39], v[216:219]
    ds_read_b64_tr_b16 v[28:29], v13 offset:24576
    v_mfma_f32_16x16x32_bf16 v[232:235], v[56:59], v[40:43], v[232:235]
    ds_read_b64_tr_b16 v[30:31], v13 offset:26624
    v_mfma_f32_16x16x32_bf16 v[248:251], v[56:59], v[44:47], v[248:251]
    ds_read_b128 v[52:55], v9 offset:25600
    v_mfma_f32_16x16x32_bf16 v[204:207], v[60:63], v[32:35], v[204:207]
    ds_read_b128 v[56:59], v9 offset:26624
    v_mfma_f32_16x16x32_bf16 v[220:223], v[60:63], v[36:39], v[220:223]
    ds_read_b64_tr_b16 v[32:33], v10 offset:28672
    v_mfma_f32_16x16x32_bf16 v[236:239], v[60:63], v[40:43], v[236:239]
    ds_read_b64_tr_b16 v[34:35], v10 offset:30720
    v_mfma_f32_16x16x32_bf16 v[252:255], v[60:63], v[44:47], v[252:255]
    ds_read_b128 v[60:63], v9 offset:27648
    s_waitcnt lgkmcnt(11)
    v_mfma_f32_16x16x32_bf16 v[128:131], v[48:51], v[16:19], v[128:131]
    ds_read_b64_tr_b16 v[36:37], v11 offset:28672
    s_waitcnt lgkmcnt(10)
    v_mfma_f32_16x16x32_bf16 v[144:147], v[48:51], v[20:23], v[144:147]
    ds_read_b64_tr_b16 v[38:39], v11 offset:30720
    s_waitcnt lgkmcnt(9)
    v_mfma_f32_16x16x32_bf16 v[160:163], v[48:51], v[24:27], v[160:163]
    ds_read_b64_tr_b16 v[40:41], v12 offset:28672
    s_waitcnt lgkmcnt(8)
    v_mfma_f32_16x16x32_bf16 v[176:179], v[48:51], v[28:31], v[176:179]
    ds_read_b64_tr_b16 v[42:43], v12 offset:30720
    s_waitcnt lgkmcnt(8)
    v_mfma_f32_16x16x32_bf16 v[132:135], v[52:55], v[16:19], v[132:135]
    ds_read_b64_tr_b16 v[44:45], v13 offset:28672
    v_mfma_f32_16x16x32_bf16 v[148:151], v[52:55], v[20:23], v[148:151]
    ds_read_b64_tr_b16 v[46:47], v13 offset:30720
    v_mfma_f32_16x16x32_bf16 v[164:167], v[52:55], v[24:27], v[164:167]
    v_mfma_f32_16x16x32_bf16 v[180:183], v[52:55], v[28:31], v[180:183]
    s_waitcnt lgkmcnt(9)
    v_mfma_f32_16x16x32_bf16 v[136:139], v[56:59], v[16:19], v[136:139]
    v_mfma_f32_16x16x32_bf16 v[152:155], v[56:59], v[20:23], v[152:155]
    v_mfma_f32_16x16x32_bf16 v[168:171], v[56:59], v[24:27], v[168:171]
    v_mfma_f32_16x16x32_bf16 v[184:187], v[56:59], v[28:31], v[184:187]
    s_waitcnt lgkmcnt(6)
    v_mfma_f32_16x16x32_bf16 v[140:143], v[60:63], v[16:19], v[140:143]
    v_mfma_f32_16x16x32_bf16 v[156:159], v[60:63], v[20:23], v[156:159]
    v_mfma_f32_16x16x32_bf16 v[172:175], v[60:63], v[24:27], v[172:175]
    v_mfma_f32_16x16x32_bf16 v[188:191], v[60:63], v[28:31], v[188:191]
    v_mfma_f32_16x16x32_bf16 v[192:195], v[48:51], v[32:35], v[192:195]
    s_barrier
    s_waitcnt lgkmcnt(4)
    v_mfma_f32_16x16x32_bf16 v[208:211], v[48:51], v[36:39], v[208:211]
    ds_read_b64_tr_b16 v[16:17], v10 offset:49152
    s_waitcnt lgkmcnt(3)
    v_mfma_f32_16x16x32_bf16 v[224:227], v[48:51], v[40:43], v[224:227]
    ds_read_b64_tr_b16 v[18:19], v10 offset:51200
    s_waitcnt lgkmcnt(2)
    v_mfma_f32_16x16x32_bf16 v[240:243], v[48:51], v[44:47], v[240:243]
    ds_read_b128 v[48:51], v9 offset:49152
    v_mfma_f32_16x16x32_bf16 v[196:199], v[52:55], v[32:35], v[196:199]
    ds_read_b64_tr_b16 v[20:21], v11 offset:49152
    v_mfma_f32_16x16x32_bf16 v[212:215], v[52:55], v[36:39], v[212:215]
    v_mfma_f32_16x16x32_bf16 v[228:231], v[52:55], v[40:43], v[228:231]
    ds_read_b64_tr_b16 v[22:23], v11 offset:51200
    v_mfma_f32_16x16x32_bf16 v[244:247], v[52:55], v[44:47], v[244:247]
    ds_read_b64_tr_b16 v[24:25], v12 offset:49152
    v_mfma_f32_16x16x32_bf16 v[200:203], v[56:59], v[32:35], v[200:203]
    ds_read_b64_tr_b16 v[26:27], v12 offset:51200
    v_mfma_f32_16x16x32_bf16 v[216:219], v[56:59], v[36:39], v[216:219]
    ds_read_b64_tr_b16 v[28:29], v13 offset:49152
    v_mfma_f32_16x16x32_bf16 v[232:235], v[56:59], v[40:43], v[232:235]
    ds_read_b64_tr_b16 v[30:31], v13 offset:51200
    v_mfma_f32_16x16x32_bf16 v[248:251], v[56:59], v[44:47], v[248:251]
    ds_read_b128 v[52:55], v9 offset:50176
    v_mfma_f32_16x16x32_bf16 v[204:207], v[60:63], v[32:35], v[204:207]
    ds_read_b128 v[56:59], v9 offset:51200
    v_mfma_f32_16x16x32_bf16 v[220:223], v[60:63], v[36:39], v[220:223]
    ds_read_b64_tr_b16 v[32:33], v10 offset:53248
    v_mfma_f32_16x16x32_bf16 v[236:239], v[60:63], v[40:43], v[236:239]
    ds_read_b64_tr_b16 v[34:35], v10 offset:55296
    v_mfma_f32_16x16x32_bf16 v[252:255], v[60:63], v[44:47], v[252:255]
    ds_read_b128 v[60:63], v9 offset:52224
    s_waitcnt lgkmcnt(11)
    v_mfma_f32_16x16x32_bf16 v[128:131], v[48:51], v[16:19], v[128:131]
    ds_read_b64_tr_b16 v[36:37], v11 offset:53248
    s_waitcnt lgkmcnt(10)
    v_mfma_f32_16x16x32_bf16 v[144:147], v[48:51], v[20:23], v[144:147]
    ds_read_b64_tr_b16 v[38:39], v11 offset:55296
    s_waitcnt lgkmcnt(9)
    v_mfma_f32_16x16x32_bf16 v[160:163], v[48:51], v[24:27], v[160:163]
    ds_read_b64_tr_b16 v[40:41], v12 offset:53248
    s_waitcnt lgkmcnt(8)
    v_mfma_f32_16x16x32_bf16 v[176:179], v[48:51], v[28:31], v[176:179]
    ds_read_b64_tr_b16 v[42:43], v12 offset:55296
    s_waitcnt lgkmcnt(8)
    v_mfma_f32_16x16x32_bf16 v[132:135], v[52:55], v[16:19], v[132:135]
    ds_read_b64_tr_b16 v[44:45], v13 offset:53248
    v_mfma_f32_16x16x32_bf16 v[148:151], v[52:55], v[20:23], v[148:151]
    ds_read_b64_tr_b16 v[46:47], v13 offset:55296
    v_mfma_f32_16x16x32_bf16 v[164:167], v[52:55], v[24:27], v[164:167]
    v_mfma_f32_16x16x32_bf16 v[180:183], v[52:55], v[28:31], v[180:183]
    s_waitcnt lgkmcnt(9)
    v_mfma_f32_16x16x32_bf16 v[136:139], v[56:59], v[16:19], v[136:139]
    v_mfma_f32_16x16x32_bf16 v[152:155], v[56:59], v[20:23], v[152:155]
    v_mfma_f32_16x16x32_bf16 v[168:171], v[56:59], v[24:27], v[168:171]
    v_mfma_f32_16x16x32_bf16 v[184:187], v[56:59], v[28:31], v[184:187]
    s_waitcnt lgkmcnt(6)
    v_mfma_f32_16x16x32_bf16 v[140:143], v[60:63], v[16:19], v[140:143]
    v_mfma_f32_16x16x32_bf16 v[156:159], v[60:63], v[20:23], v[156:159]
    v_mfma_f32_16x16x32_bf16 v[172:175], v[60:63], v[24:27], v[172:175]
    v_mfma_f32_16x16x32_bf16 v[188:191], v[60:63], v[28:31], v[188:191]
    v_mfma_f32_16x16x32_bf16 v[192:195], v[48:51], v[32:35], v[192:195]
    s_barrier
    s_waitcnt lgkmcnt(4)
    v_mfma_f32_16x16x32_bf16 v[208:211], v[48:51], v[36:39], v[208:211]
    ds_read_b64_tr_b16 v[16:17], v4 offset:0
    s_waitcnt lgkmcnt(3)
    v_mfma_f32_16x16x32_bf16 v[224:227], v[48:51], v[40:43], v[224:227]
    ds_read_b64_tr_b16 v[18:19], v4 offset:2048
    s_waitcnt lgkmcnt(2)
    v_mfma_f32_16x16x32_bf16 v[240:243], v[48:51], v[44:47], v[240:243]
    ds_read_b128 v[48:51], v8 offset:0
    v_mfma_f32_16x16x32_bf16 v[196:199], v[52:55], v[32:35], v[196:199]
    ds_read_b64_tr_b16 v[20:21], v5 offset:0
    v_mfma_f32_16x16x32_bf16 v[212:215], v[52:55], v[36:39], v[212:215]
    v_mfma_f32_16x16x32_bf16 v[228:231], v[52:55], v[40:43], v[228:231]
    ds_read_b64_tr_b16 v[22:23], v5 offset:2048
    v_mfma_f32_16x16x32_bf16 v[244:247], v[52:55], v[44:47], v[244:247]
    ds_read_b64_tr_b16 v[24:25], v6 offset:0
    v_mfma_f32_16x16x32_bf16 v[200:203], v[56:59], v[32:35], v[200:203]
    ds_read_b64_tr_b16 v[26:27], v6 offset:2048
    v_mfma_f32_16x16x32_bf16 v[216:219], v[56:59], v[36:39], v[216:219]
    ds_read_b64_tr_b16 v[28:29], v7 offset:0
    v_mfma_f32_16x16x32_bf16 v[232:235], v[56:59], v[40:43], v[232:235]
    ds_read_b64_tr_b16 v[30:31], v7 offset:2048
    v_mfma_f32_16x16x32_bf16 v[248:251], v[56:59], v[44:47], v[248:251]
    ds_read_b128 v[52:55], v8 offset:1024
    v_mfma_f32_16x16x32_bf16 v[204:207], v[60:63], v[32:35], v[204:207]
    ds_read_b128 v[56:59], v8 offset:2048
    v_mfma_f32_16x16x32_bf16 v[220:223], v[60:63], v[36:39], v[220:223]
    ds_read_b64_tr_b16 v[32:33], v4 offset:4096
    v_mfma_f32_16x16x32_bf16 v[236:239], v[60:63], v[40:43], v[236:239]
    ds_read_b64_tr_b16 v[34:35], v4 offset:6144
    v_mfma_f32_16x16x32_bf16 v[252:255], v[60:63], v[44:47], v[252:255]
    ds_read_b128 v[60:63], v8 offset:3072
    s_waitcnt lgkmcnt(11)
    v_mfma_f32_16x16x32_bf16 v[128:131], v[48:51], v[16:19], v[128:131]
    ds_read_b64_tr_b16 v[36:37], v5 offset:4096
    s_waitcnt lgkmcnt(10)
    v_mfma_f32_16x16x32_bf16 v[144:147], v[48:51], v[20:23], v[144:147]
    ds_read_b64_tr_b16 v[38:39], v5 offset:6144
    s_waitcnt lgkmcnt(9)
    v_mfma_f32_16x16x32_bf16 v[160:163], v[48:51], v[24:27], v[160:163]
    ds_read_b64_tr_b16 v[40:41], v6 offset:4096
    s_waitcnt lgkmcnt(8)
    v_mfma_f32_16x16x32_bf16 v[176:179], v[48:51], v[28:31], v[176:179]
    ds_read_b64_tr_b16 v[42:43], v6 offset:6144
    s_waitcnt lgkmcnt(8)
    v_mfma_f32_16x16x32_bf16 v[132:135], v[52:55], v[16:19], v[132:135]
    ds_read_b64_tr_b16 v[44:45], v7 offset:4096
    v_mfma_f32_16x16x32_bf16 v[148:151], v[52:55], v[20:23], v[148:151]
    ds_read_b64_tr_b16 v[46:47], v7 offset:6144
    v_mfma_f32_16x16x32_bf16 v[164:167], v[52:55], v[24:27], v[164:167]
    v_mfma_f32_16x16x32_bf16 v[180:183], v[52:55], v[28:31], v[180:183]
    s_waitcnt lgkmcnt(9)
    v_mfma_f32_16x16x32_bf16 v[136:139], v[56:59], v[16:19], v[136:139]
    v_mfma_f32_16x16x32_bf16 v[152:155], v[56:59], v[20:23], v[152:155]
    v_mfma_f32_16x16x32_bf16 v[168:171], v[56:59], v[24:27], v[168:171]
    v_mfma_f32_16x16x32_bf16 v[184:187], v[56:59], v[28:31], v[184:187]
    s_waitcnt lgkmcnt(6)
    v_mfma_f32_16x16x32_bf16 v[140:143], v[60:63], v[16:19], v[140:143]
    v_mfma_f32_16x16x32_bf16 v[156:159], v[60:63], v[20:23], v[156:159]
    v_mfma_f32_16x16x32_bf16 v[172:175], v[60:63], v[24:27], v[172:175]
    v_mfma_f32_16x16x32_bf16 v[188:191], v[60:63], v[28:31], v[188:191]
    v_mfma_f32_16x16x32_bf16 v[192:195], v[48:51], v[32:35], v[192:195]
    s_barrier
    s_waitcnt lgkmcnt(4)
    v_mfma_f32_16x16x32_bf16 v[208:211], v[48:51], v[36:39], v[208:211]
    ds_read_b64_tr_b16 v[16:17], v4 offset:24576
    s_waitcnt lgkmcnt(3)
    v_mfma_f32_16x16x32_bf16 v[224:227], v[48:51], v[40:43], v[224:227]
    ds_read_b64_tr_b16 v[18:19], v4 offset:26624
    s_waitcnt lgkmcnt(2)
    v_mfma_f32_16x16x32_bf16 v[240:243], v[48:51], v[44:47], v[240:243]
    ds_read_b128 v[48:51], v8 offset:24576
    v_mfma_f32_16x16x32_bf16 v[196:199], v[52:55], v[32:35], v[196:199]
    ds_read_b64_tr_b16 v[20:21], v5 offset:24576
    v_mfma_f32_16x16x32_bf16 v[212:215], v[52:55], v[36:39], v[212:215]
    v_mfma_f32_16x16x32_bf16 v[228:231], v[52:55], v[40:43], v[228:231]
    ds_read_b64_tr_b16 v[22:23], v5 offset:26624
    v_mfma_f32_16x16x32_bf16 v[244:247], v[52:55], v[44:47], v[244:247]
    ds_read_b64_tr_b16 v[24:25], v6 offset:24576
    v_mfma_f32_16x16x32_bf16 v[200:203], v[56:59], v[32:35], v[200:203]
    ds_read_b64_tr_b16 v[26:27], v6 offset:26624
    v_mfma_f32_16x16x32_bf16 v[216:219], v[56:59], v[36:39], v[216:219]
    ds_read_b64_tr_b16 v[28:29], v7 offset:24576
    v_mfma_f32_16x16x32_bf16 v[232:235], v[56:59], v[40:43], v[232:235]
    ds_read_b64_tr_b16 v[30:31], v7 offset:26624
    v_mfma_f32_16x16x32_bf16 v[248:251], v[56:59], v[44:47], v[248:251]
    ds_read_b128 v[52:55], v8 offset:25600
    v_mfma_f32_16x16x32_bf16 v[204:207], v[60:63], v[32:35], v[204:207]
    ds_read_b128 v[56:59], v8 offset:26624
    v_mfma_f32_16x16x32_bf16 v[220:223], v[60:63], v[36:39], v[220:223]
    ds_read_b64_tr_b16 v[32:33], v4 offset:28672
    v_mfma_f32_16x16x32_bf16 v[236:239], v[60:63], v[40:43], v[236:239]
    ds_read_b64_tr_b16 v[34:35], v4 offset:30720
    v_mfma_f32_16x16x32_bf16 v[252:255], v[60:63], v[44:47], v[252:255]
    ds_read_b128 v[60:63], v8 offset:27648
    s_waitcnt lgkmcnt(11)
    v_mfma_f32_16x16x32_bf16 v[128:131], v[48:51], v[16:19], v[128:131]
    ds_read_b64_tr_b16 v[36:37], v5 offset:28672
    s_waitcnt lgkmcnt(10)
    v_mfma_f32_16x16x32_bf16 v[144:147], v[48:51], v[20:23], v[144:147]
    ds_read_b64_tr_b16 v[38:39], v5 offset:30720
    s_waitcnt lgkmcnt(9)
    v_mfma_f32_16x16x32_bf16 v[160:163], v[48:51], v[24:27], v[160:163]
    ds_read_b64_tr_b16 v[40:41], v6 offset:28672
    s_waitcnt lgkmcnt(8)
    v_mfma_f32_16x16x32_bf16 v[176:179], v[48:51], v[28:31], v[176:179]
    ds_read_b64_tr_b16 v[42:43], v6 offset:30720
    s_waitcnt lgkmcnt(8)
    v_mfma_f32_16x16x32_bf16 v[132:135], v[52:55], v[16:19], v[132:135]
    ds_read_b64_tr_b16 v[44:45], v7 offset:28672
    v_mfma_f32_16x16x32_bf16 v[148:151], v[52:55], v[20:23], v[148:151]
    ds_read_b64_tr_b16 v[46:47], v7 offset:30720
    v_mfma_f32_16x16x32_bf16 v[164:167], v[52:55], v[24:27], v[164:167]
    v_mfma_f32_16x16x32_bf16 v[180:183], v[52:55], v[28:31], v[180:183]
    s_waitcnt lgkmcnt(9)
    v_mfma_f32_16x16x32_bf16 v[136:139], v[56:59], v[16:19], v[136:139]
    v_mfma_f32_16x16x32_bf16 v[152:155], v[56:59], v[20:23], v[152:155]
    v_mfma_f32_16x16x32_bf16 v[168:171], v[56:59], v[24:27], v[168:171]
    v_mfma_f32_16x16x32_bf16 v[184:187], v[56:59], v[28:31], v[184:187]
    s_waitcnt lgkmcnt(6)
    v_mfma_f32_16x16x32_bf16 v[140:143], v[60:63], v[16:19], v[140:143]
    v_mfma_f32_16x16x32_bf16 v[156:159], v[60:63], v[20:23], v[156:159]
    v_mfma_f32_16x16x32_bf16 v[172:175], v[60:63], v[24:27], v[172:175]
    v_mfma_f32_16x16x32_bf16 v[188:191], v[60:63], v[28:31], v[188:191]
    v_mfma_f32_16x16x32_bf16 v[192:195], v[48:51], v[32:35], v[192:195]
    s_mov_b32 s50, 0
    k3_fpoll:
    s_waitcnt vmcnt(0)
    v_cmp_eq_u32 vcc, 0, v65
    s_cbranch_vccz k3_fok
    s_sleep 4
    buffer_load_dword v65, v120, s[52:55], s45 offen sc1
    s_add_u32 s50, s50, 1
    s_cmp_lt_u32 s50, 200000
    s_cbranch_scc1 k3_fpoll
    k3_fok:
    s_barrier
    s_waitcnt lgkmcnt(4)
    v_mfma_f32_16x16x32_bf16 v[208:211], v[48:51], v[36:39], v[208:211]
    ds_read_b64_tr_b16 v[16:17], v4 offset:49152
    s_waitcnt lgkmcnt(3)
    v_mfma_f32_16x16x32_bf16 v[224:227], v[48:51], v[40:43], v[224:227]
    ds_read_b64_tr_b16 v[18:19], v4 offset:51200
    s_waitcnt lgkmcnt(2)
    v_mfma_f32_16x16x32_bf16 v[240:243], v[48:51], v[44:47], v[240:243]
    ds_read_b128 v[48:51], v8 offset:49152
    v_mfma_f32_16x16x32_bf16 v[196:199], v[52:55], v[32:35], v[196:199]
    ds_read_b64_tr_b16 v[20:21], v5 offset:49152
    v_mfma_f32_16x16x32_bf16 v[212:215], v[52:55], v[36:39], v[212:215]
    s_mov_b32 s44, 3
k3a_l0:
    v_mfma_f32_16x16x32_bf16 v[228:231], v[52:55], v[40:43], v[228:231]
    ds_read_b64_tr_b16 v[22:23], v5 offset:51200
    v_mfma_f32_16x16x32_bf16 v[244:247], v[52:55], v[44:47], v[244:247]
    ds_read_b64_tr_b16 v[24:25], v6 offset:49152
    v_mfma_f32_16x16x32_bf16 v[200:203], v[56:59], v[32:35], v[200:203]
    ds_read_b64_tr_b16 v[26:27], v6 offset:51200
    v_mfma_f32_16x16x32_bf16 v[216:219], v[56:59], v[36:39], v[216:219]
    ds_read_b64_tr_b16 v[28:29], v7 offset:49152
    v_mfma_f32_16x16x32_bf16 v[232:235], v[56:59], v[40:43], v[232:235]
    ds_read_b64_tr_b16 v[30:31], v7 offset:51200
    v_mfma_f32_16x16x32_bf16 v[248:251], v[56:59], v[44:47], v[248:251]
    ds_read_b128 v[52:55], v8 offset:50176
    v_mfma_f32_16x16x32_bf16 v[204:207], v[60:63], v[32:35], v[204:207]
    ds_read_b128 v[56:59], v8 offset:51200
    v_mfma_f32_16x16x32_bf16 v[220:223], v[60:63], v[36:39], v[220:223]
    ds_read_b64_tr_b16 v[32:33], v4 offset:53248
    v_mfma_f32_16x16x32_bf16 v[236:239], v[60:63], v[40:43], v[236:239]
    ds_read_b64_tr_b16 v[34:35], v4 offset:55296
    v_mfma_f32_16x16x32_bf16 v[252:255], v[60:63], v[44:47], v[252:255]
    ds_read_b128 v[60:63], v8 offset:52224
    s_waitcnt lgkmcnt(11)
    v_mfma_f32_16x16x32_bf16 v[128:131], v[48:51], v[16:19], v[128:131]
    ds_read_b64_tr_b16 v[36:37], v5 offset:53248
    s_waitcnt lgkmcnt(10)
    v_mfma_f32_16x16x32_bf16 v[144:147], v[48:51], v[20:23], v[144:147]
    ds_read_b64_tr_b16 v[38:39], v5 offset:55296
    s_waitcnt lgkmcnt(9)
    v_mfma_f32_16x16x32_bf16 v[160:163], v[48:51], v[24:27], v[160:163]
    ds_read_b64_tr_b16 v[40:41], v6 offset:53248
    s_waitcnt lgkmcnt(8)
    v_mfma_f32_16x16x32_bf16 v[176:179], v[48:51], v[28:31], v[176:179]
    ds_read_b64_tr_b16 v[42:43], v6 offset:55296
    s_waitcnt lgkmcnt(8)
    v_mfma_f32_16x16x32_bf16 v[132:135], v[52:55], v[16:19], v[132:135]
    ds_read_b64_tr_b16 v[44:45], v7 offset:53248
    v_mfma_f32_16x16x32_bf16 v[148:151], v[52:55], v[20:23], v[148:151]
    ds_read_b64_tr_b16 v[46:47], v7 offset:55296
    v_mfma_f32_16x16x32_bf16 v[164:167], v[52:55], v[24:27], v[164:167]
    v_mfma_f32_16x16x32_bf16 v[180:183], v[52:55], v[28:31], v[180:183]
    s_waitcnt lgkmcnt(9)
    v_mfma_f32_16x16x32_bf16 v[136:139], v[56:59], v[16:19], v[136:139]
    v_mfma_f32_16x16x32_bf16 v[152:155], v[56:59], v[20:23], v[152:155]
    v_mfma_f32_16x16x32_bf16 v[168:171], v[56:59], v[24:27], v[168:171]
    v_mfma_f32_16x16x32_bf16 v[184:187], v[56:59], v[28:31], v[184:187]
    s_waitcnt lgkmcnt(6)
    v_mfma_f32_16x16x32_bf16 v[140:143], v[60:63], v[16:19], v[140:143]
    v_mfma_f32_16x16x32_bf16 v[156:159], v[60:63], v[20:23], v[156:159]
    v_mfma_f32_16x16x32_bf16 v[172:175], v[60:63], v[24:27], v[172:175]
    v_mfma_f32_16x16x32_bf16 v[188:191], v[60:63], v[28:31], v[188:191]
    v_mfma_f32_16x16x32_bf16 v[192:195], v[48:51], v[32:35], v[192:195]
    s_barrier
    s_waitcnt lgkmcnt(4)
    v_mfma_f32_16x16x32_bf16 v[208:211], v[48:51], v[36:39], v[208:211]
    ds_read_b64_tr_b16 v[16:17], v10 offset:0
    s_waitcnt lgkmcnt(3)
    v_mfma_f32_16x16x32_bf16 v[224:227], v[48:51], v[40:43], v[224:227]
    ds_read_b64_tr_b16 v[18:19], v10 offset:2048
    s_waitcnt lgkmcnt(2)
    v_mfma_f32_16x16x32_bf16 v[240:243], v[48:51], v[44:47], v[240:243]
    ds_read_b128 v[48:51], v9 offset:0
    v_mfma_f32_16x16x32_bf16 v[196:199], v[52:55], v[32:35], v[196:199]
    ds_read_b64_tr_b16 v[20:21], v11 offset:0
    v_mfma_f32_16x16x32_bf16 v[212:215], v[52:55], v[36:39], v[212:215]
    v_mfma_f32_16x16x32_bf16 v[228:231], v[52:55], v[40:43], v[228:231]
    ds_read_b64_tr_b16 v[22:23], v11 offset:2048
    v_mfma_f32_16x16x32_bf16 v[244:247], v[52:55], v[44:47], v[244:247]
    ds_read_b64_tr_b16 v[24:25], v12 offset:0
    v_mfma_f32_16x16x32_bf16 v[200:203], v[56:59], v[32:35], v[200:203]
    ds_read_b64_tr_b16 v[26:27], v12 offset:2048
    v_mfma_f32_16x16x32_bf16 v[216:219], v[56:59], v[36:39], v[216:219]
    ds_read_b64_tr_b16 v[28:29], v13 offset:0
    v_mfma_f32_16x16x32_bf16 v[232:235], v[56:59], v[40:43], v[232:235]
    ds_read_b64_tr_b16 v[30:31], v13 offset:2048
    v_mfma_f32_16x16x32_bf16 v[248:251], v[56:59], v[44:47], v[248:251]
    ds_read_b128 v[52:55], v9 offset:1024
    v_mfma_f32_16x16x32_bf16 v[204:207], v[60:63], v[32:35], v[204:207]
    ds_read_b128 v[56:59], v9 offset:2048
    v_mfma_f32_16x16x32_bf16 v[220:223], v[60:63], v[36:39], v[220:223]
    ds_read_b64_tr_b16 v[32:33], v10 offset:4096
    v_mfma_f32_16x16x32_bf16 v[236:239], v[60:63], v[40:43], v[236:239]
    ds_read_b64_tr_b16 v[34:35], v10 offset:6144
    v_mfma_f32_16x16x32_bf16 v[252:255], v[60:63], v[44:47], v[252:255]
    ds_read_b128 v[60:63], v9 offset:3072
    s_waitcnt lgkmcnt(11)
    v_mfma_f32_16x16x32_bf16 v[128:131], v[48:51], v[16:19], v[128:131]
    ds_read_b64_tr_b16 v[36:37], v11 offset:4096
    s_waitcnt lgkmcnt(10)
    v_mfma_f32_16x16x32_bf16 v[144:147], v[48:51], v[20:23], v[144:147]
    ds_read_b64_tr_b16 v[38:39], v11 offset:6144
    s_waitcnt lgkmcnt(9)
    v_mfma_f32_16x16x32_bf16 v[160:163], v[48:51], v[24:27], v[160:163]
    ds_read_b64_tr_b16 v[40:41], v12 offset:4096
    s_waitcnt lgkmcnt(8)
    v_mfma_f32_16x16x32_bf16 v[176:179], v[48:51], v[28:31], v[176:179]
    ds_read_b64_tr_b16 v[42:43], v12 offset:6144
    s_waitcnt lgkmcnt(8)
    v_mfma_f32_16x16x32_bf16 v[132:135], v[52:55], v[16:19], v[132:135]
    ds_read_b64_tr_b16 v[44:45], v13 offset:4096
    v_mfma_f32_16x16x32_bf16 v[148:151], v[52:55], v[20:23], v[148:151]
    ds_read_b64_tr_b16 v[46:47], v13 offset:6144
    v_mfma_f32_16x16x32_bf16 v[164:167], v[52:55], v[24:27], v[164:167]
    v_mfma_f32_16x16x32_bf16 v[180:183], v[52:55], v[28:31], v[180:183]
    s_waitcnt lgkmcnt(9)
    v_mfma_f32_16x16x32_bf16 v[136:139], v[56:59], v[16:19], v[136:139]
    v_mfma_f32_16x16x32_bf16 v[152:155], v[56:59], v[20:23], v[152:155]
    v_mfma_f32_16x16x32_bf16 v[168:171], v[56:59], v[24:27], v[168:171]
    v_mfma_f32_16x16x32_bf16 v[184:187], v[56:59], v[28:31], v[184:187]
    s_waitcnt lgkmcnt(6)
    v_mfma_f32_16x16x32_bf16 v[140:143], v[60:63], v[16:19], v[140:143]
    v_mfma_f32_16x16x32_bf16 v[156:159], v[60:63], v[20:23], v[156:159]
    v_mfma_f32_16x16x32_bf16 v[172:175], v[60:63], v[24:27], v[172:175]
    v_mfma_f32_16x16x32_bf16 v[188:191], v[60:63], v[28:31], v[188:191]
    v_mfma_f32_16x16x32_bf16 v[192:195], v[48:51], v[32:35], v[192:195]
    s_barrier
    s_waitcnt lgkmcnt(4)
    v_mfma_f32_16x16x32_bf16 v[208:211], v[48:51], v[36:39], v[208:211]
    ds_read_b64_tr_b16 v[16:17], v10 offset:24576
    s_waitcnt lgkmcnt(3)
    v_mfma_f32_16x16x32_bf16 v[224:227], v[48:51], v[40:43], v[224:227]
    ds_read_b64_tr_b16 v[18:19], v10 offset:26624
    s_waitcnt lgkmcnt(2)
    v_mfma_f32_16x16x32_bf16 v[240:243], v[48:51], v[44:47], v[240:243]
    ds_read_b128 v[48:51], v9 offset:24576
    v_mfma_f32_16x16x32_bf16 v[196:199], v[52:55], v[32:35], v[196:199]
    ds_read_b64_tr_b16 v[20:21], v11 offset:24576
    v_mfma_f32_16x16x32_bf16 v[212:215], v[52:55], v[36:39], v[212:215]
    v_mfma_f32_16x16x32_bf16 v[228:231], v[52:55], v[40:43], v[228:231]
    ds_read_b64_tr_b16 v[22:23], v11 offset:26624
    v_mfma_f32_16x16x32_bf16 v[244:247], v[52:55], v[44:47], v[244:247]
    ds_read_b64_tr_b16 v[24:25], v12 offset:24576
    v_mfma_f32_16x16x32_bf16 v[200:203], v[56:59], v[32:35], v[200:203]
    ds_read_b64_tr_b16 v[26:27], v12 offset:26624
    v_mfma_f32_16x16x32_bf16 v[216:219], v[56:59], v[36:39], v[216:219]
    ds_read_b64_tr_b16 v[28:29], v13 offset:24576
    v_mfma_f32_16x16x32_bf16 v[232:235], v[56:59], v[40:43], v[232:235]
    ds_read_b64_tr_b16 v[30:31], v13 offset:26624
    v_mfma_f32_16x16x32_bf16 v[248:251], v[56:59], v[44:47], v[248:251]
    ds_read_b128 v[52:55], v9 offset:25600
    v_mfma_f32_16x16x32_bf16 v[204:207], v[60:63], v[32:35], v[204:207]
    ds_read_b128 v[56:59], v9 offset:26624
    v_mfma_f32_16x16x32_bf16 v[220:223], v[60:63], v[36:39], v[220:223]
    ds_read_b64_tr_b16 v[32:33], v10 offset:28672
    v_mfma_f32_16x16x32_bf16 v[236:239], v[60:63], v[40:43], v[236:239]
    ds_read_b64_tr_b16 v[34:35], v10 offset:30720
    v_mfma_f32_16x16x32_bf16 v[252:255], v[60:63], v[44:47], v[252:255]
    ds_read_b128 v[60:63], v9 offset:27648
    s_waitcnt lgkmcnt(11)
    v_mfma_f32_16x16x32_bf16 v[128:131], v[48:51], v[16:19], v[128:131]
    ds_read_b64_tr_b16 v[36:37], v11 offset:28672
    s_waitcnt lgkmcnt(10)
    v_mfma_f32_16x16x32_bf16 v[144:147], v[48:51], v[20:23], v[144:147]
    ds_read_b64_tr_b16 v[38:39], v11 offset:30720
    s_waitcnt lgkmcnt(9)
    v_mfma_f32_16x16x32_bf16 v[160:163], v[48:51], v[24:27], v[160:163]
    ds_read_b64_tr_b16 v[40:41], v12 offset:28672
    s_waitcnt lgkmcnt(8)
    v_mfma_f32_16x16x32_bf16 v[176:179], v[48:51], v[28:31], v[176:179]
    ds_read_b64_tr_b16 v[42:43], v12 offset:30720
    s_waitcnt lgkmcnt(8)
    v_mfma_f32_16x16x32_bf16 v[132:135], v[52:55], v[16:19], v[132:135]
    ds_read_b64_tr_b16 v[44:45], v13 offset:28672
    v_mfma_f32_16x16x32_bf16 v[148:151], v[52:55], v[20:23], v[148:151]
    ds_read_b64_tr_b16 v[46:47], v13 offset:30720
    v_mfma_f32_16x16x32_bf16 v[164:167], v[52:55], v[24:27], v[164:167]
    v_mfma_f32_16x16x32_bf16 v[180:183], v[52:55], v[28:31], v[180:183]
    s_waitcnt lgkmcnt(9)
    v_mfma_f32_16x16x32_bf16 v[136:139], v[56:59], v[16:19], v[136:139]
    v_mfma_f32_16x16x32_bf16 v[152:155], v[56:59], v[20:23], v[152:155]
    v_mfma_f32_16x16x32_bf16 v[168:171], v[56:59], v[24:27], v[168:171]
    v_mfma_f32_16x16x32_bf16 v[184:187], v[56:59], v[28:31], v[184:187]
    s_waitcnt lgkmcnt(6)
    v_mfma_f32_16x16x32_bf16 v[140:143], v[60:63], v[16:19], v[140:143]
    v_mfma_f32_16x16x32_bf16 v[156:159], v[60:63], v[20:23], v[156:159]
    v_mfma_f32_16x16x32_bf16 v[172:175], v[60:63], v[24:27], v[172:175]
    v_mfma_f32_16x16x32_bf16 v[188:191], v[60:63], v[28:31], v[188:191]
    v_mfma_f32_16x16x32_bf16 v[192:195], v[48:51], v[32:35], v[192:195]
    s_barrier
    s_waitcnt lgkmcnt(4)
    v_mfma_f32_16x16x32_bf16 v[208:211], v[48:51], v[36:39], v[208:211]
    ds_read_b64_tr_b16 v[16:17], v10 offset:49152
    s_waitcnt lgkmcnt(3)
    v_mfma_f32_16x16x32_bf16 v[224:227], v[48:51], v[40:43], v[224:227]
    ds_read_b64_tr_b16 v[18:19], v10 offset:51200
    s_waitcnt lgkmcnt(2)
    v_mfma_f32_16x16x32_bf16 v[240:243], v[48:51], v[44:47], v[240:243]
    ds_read_b128 v[48:51], v9 offset:49152
    v_mfma_f32_16x16x32_bf16 v[196:199], v[52:55], v[32:35], v[196:199]
    ds_read_b64_tr_b16 v[20:21], v11 offset:49152
    v_mfma_f32_16x16x32_bf16 v[212:215], v[52:55], v[36:39], v[212:215]
    v_mfma_f32_16x16x32_bf16 v[228:231], v[52:55], v[40:43], v[228:231]
    ds_read_b64_tr_b16 v[22:23], v11 offset:51200
    v_mfma_f32_16x16x32_bf16 v[244:247], v[52:55], v[44:47], v[244:247]
    ds_read_b64_tr_b16 v[24:25], v12 offset:49152
    v_mfma_f32_16x16x32_bf16 v[200:203], v[56:59], v[32:35], v[200:203]
    ds_read_b64_tr_b16 v[26:27], v12 offset:51200
    v_mfma_f32_16x16x32_bf16 v[216:219], v[56:59], v[36:39], v[216:219]
    ds_read_b64_tr_b16 v[28:29], v13 offset:49152
    v_mfma_f32_16x16x32_bf16 v[232:235], v[56:59], v[40:43], v[232:235]
    ds_read_b64_tr_b16 v[30:31], v13 offset:51200
    v_mfma_f32_16x16x32_bf16 v[248:251], v[56:59], v[44:47], v[248:251]
    ds_read_b128 v[52:55], v9 offset:50176
    v_mfma_f32_16x16x32_bf16 v[204:207], v[60:63], v[32:35], v[204:207]
    ds_read_b128 v[56:59], v9 offset:51200
    v_mfma_f32_16x16x32_bf16 v[220:223], v[60:63], v[36:39], v[220:223]
    ds_read_b64_tr_b16 v[32:33], v10 offset:53248
    v_mfma_f32_16x16x32_bf16 v[236:239], v[60:63], v[40:43], v[236:239]
    ds_read_b64_tr_b16 v[34:35], v10 offset:55296
    v_mfma_f32_16x16x32_bf16 v[252:255], v[60:63], v[44:47], v[252:255]
    ds_read_b128 v[60:63], v9 offset:52224
    s_waitcnt lgkmcnt(11)
    v_mfma_f32_16x16x32_bf16 v[128:131], v[48:51], v[16:19], v[128:131]
    ds_read_b64_tr_b16 v[36:37], v11 offset:53248
    s_waitcnt lgkmcnt(10)
    v_mfma_f32_16x16x32_bf16 v[144:147], v[48:51], v[20:23], v[144:147]
    ds_read_b64_tr_b16 v[38:39], v11 offset:55296
    s_waitcnt lgkmcnt(9)
    v_mfma_f32_16x16x32_bf16 v[160:163], v[48:51], v[24:27], v[160:163]
    ds_read_b64_tr_b16 v[40:41], v12 offset:53248
    s_waitcnt lgkmcnt(8)
    v_mfma_f32_16x16x32_bf16 v[176:179], v[48:51], v[28:31], v[176:179]
    ds_read_b64_tr_b16 v[42:43], v12 offset:55296
    s_waitcnt lgkmcnt(8)
    v_mfma_f32_16x16x32_bf16 v[132:135], v[52:55], v[16:19], v[132:135]
    ds_read_b64_tr_b16 v[44:45], v13 offset:53248
    v_mfma_f32_16x16x32_bf16 v[148:151], v[52:55], v[20:23], v[148:151]
    ds_read_b64_tr_b16 v[46:47], v13 offset:55296
    v_mfma_f32_16x16x32_bf16 v[164:167], v[52:55], v[24:27], v[164:167]
    v_mfma_f32_16x16x32_bf16 v[180:183], v[52:55], v[28:31], v[180:183]
    s_waitcnt lgkmcnt(9)
    v_mfma_f32_16x16x32_bf16 v[136:139], v[56:59], v[16:19], v[136:139]
    v_mfma_f32_16x16x32_bf16 v[152:155], v[56:59], v[20:23], v[152:155]
    v_mfma_f32_16x16x32_bf16 v[168:171], v[56:59], v[24:27], v[168:171]
    v_mfma_f32_16x16x32_bf16 v[184:187], v[56:59], v[28:31], v[184:187]
    s_waitcnt lgkmcnt(6)
    v_mfma_f32_16x16x32_bf16 v[140:143], v[60:63], v[16:19], v[140:143]
    v_mfma_f32_16x16x32_bf16 v[156:159], v[60:63], v[20:23], v[156:159]
    v_mfma_f32_16x16x32_bf16 v[172:175], v[60:63], v[24:27], v[172:175]
    v_mfma_f32_16x16x32_bf16 v[188:191], v[60:63], v[28:31], v[188:191]
    v_mfma_f32_16x16x32_bf16 v[192:195], v[48:51], v[32:35], v[192:195]
    s_barrier
    s_waitcnt lgkmcnt(4)
    v_mfma_f32_16x16x32_bf16 v[208:211], v[48:51], v[36:39], v[208:211]
    ds_read_b64_tr_b16 v[16:17], v4 offset:0
    s_waitcnt lgkmcnt(3)
    v_mfma_f32_16x16x32_bf16 v[224:227], v[48:51], v[40:43], v[224:227]
    ds_read_b64_tr_b16 v[18:19], v4 offset:2048
    s_waitcnt lgkmcnt(2)
    v_mfma_f32_16x16x32_bf16 v[240:243], v[48:51], v[44:47], v[240:243]
    ds_read_b128 v[48:51], v8 offset:0
    v_mfma_f32_16x16x32_bf16 v[196:199], v[52:55], v[32:35], v[196:199]
    ds_read_b64_tr_b16 v[20:21], v5 offset:0
    v_mfma_f32_16x16x32_bf16 v[212:215], v[52:55], v[36:39], v[212:215]
    v_mfma_f32_16x16x32_bf16 v[228:231], v[52:55], v[40:43], v[228:231]
    ds_read_b64_tr_b16 v[22:23], v5 offset:2048
    v_mfma_f32_16x16x32_bf16 v[244:247], v[52:55], v[44:47], v[244:247]
    ds_read_b64_tr_b16 v[24:25], v6 offset:0
    v_mfma_f32_16x16x32_bf16 v[200:203], v[56:59], v[32:35], v[200:203]
    ds_read_b64_tr_b16 v[26:27], v6 offset:2048
    v_mfma_f32_16x16x32_bf16 v[216:219], v[56:59], v[36:39], v[216:219]
    ds_read_b64_tr_b16 v[28:29], v7 offset:0
    v_mfma_f32_16x16x32_bf16 v[232:235], v[56:59], v[40:43], v[232:235]
    ds_read_b64_tr_b16 v[30:31], v7 offset:2048
    v_mfma_f32_16x16x32_bf16 v[248:251], v[56:59], v[44:47], v[248:251]
    ds_read_b128 v[52:55], v8 offset:1024
    v_mfma_f32_16x16x32_bf16 v[204:207], v[60:63], v[32:35], v[204:207]
    ds_read_b128 v[56:59], v8 offset:2048
    v_mfma_f32_16x16x32_bf16 v[220:223], v[60:63], v[36:39], v[220:223]
    ds_read_b64_tr_b16 v[32:33], v4 offset:4096
    v_mfma_f32_16x16x32_bf16 v[236:239], v[60:63], v[40:43], v[236:239]
    ds_read_b64_tr_b16 v[34:35], v4 offset:6144
    v_mfma_f32_16x16x32_bf16 v[252:255], v[60:63], v[44:47], v[252:255]
    ds_read_b128 v[60:63], v8 offset:3072
    s_waitcnt lgkmcnt(11)
    v_mfma_f32_16x16x32_bf16 v[128:131], v[48:51], v[16:19], v[128:131]
    ds_read_b64_tr_b16 v[36:37], v5 offset:4096
    s_waitcnt lgkmcnt(10)
    v_mfma_f32_16x16x32_bf16 v[144:147], v[48:51], v[20:23], v[144:147]
    ds_read_b64_tr_b16 v[38:39], v5 offset:6144
    s_waitcnt lgkmcnt(9)
    v_mfma_f32_16x16x32_bf16 v[160:163], v[48:51], v[24:27], v[160:163]
    ds_read_b64_tr_b16 v[40:41], v6 offset:4096
    s_waitcnt lgkmcnt(8)
    v_mfma_f32_16x16x32_bf16 v[176:179], v[48:51], v[28:31], v[176:179]
    ds_read_b64_tr_b16 v[42:43], v6 offset:6144
    s_waitcnt lgkmcnt(8)
    v_mfma_f32_16x16x32_bf16 v[132:135], v[52:55], v[16:19], v[132:135]
    ds_read_b64_tr_b16 v[44:45], v7 offset:4096
    v_mfma_f32_16x16x32_bf16 v[148:151], v[52:55], v[20:23], v[148:151]
    ds_read_b64_tr_b16 v[46:47], v7 offset:6144
    v_mfma_f32_16x16x32_bf16 v[164:167], v[52:55], v[24:27], v[164:167]
    v_mfma_f32_16x16x32_bf16 v[180:183], v[52:55], v[28:31], v[180:183]
    s_waitcnt lgkmcnt(9)
    v_mfma_f32_16x16x32_bf16 v[136:139], v[56:59], v[16:19], v[136:139]
    v_mfma_f32_16x16x32_bf16 v[152:155], v[56:59], v[20:23], v[152:155]
    v_mfma_f32_16x16x32_bf16 v[168:171], v[56:59], v[24:27], v[168:171]
    v_mfma_f32_16x16x32_bf16 v[184:187], v[56:59], v[28:31], v[184:187]
    s_waitcnt lgkmcnt(6)
    v_mfma_f32_16x16x32_bf16 v[140:143], v[60:63], v[16:19], v[140:143]
    v_mfma_f32_16x16x32_bf16 v[156:159], v[60:63], v[20:23], v[156:159]
    v_mfma_f32_16x16x32_bf16 v[172:175], v[60:63], v[24:27], v[172:175]
    v_mfma_f32_16x16x32_bf16 v[188:191], v[60:63], v[28:31], v[188:191]
    v_mfma_f32_16x16x32_bf16 v[192:195], v[48:51], v[32:35], v[192:195]
    s_barrier
    s_waitcnt lgkmcnt(4)
    v_mfma_f32_16x16x32_bf16 v[208:211], v[48:51], v[36:39], v[208:211]
    ds_read_b64_tr_b16 v[16:17], v4 offset:24576
    s_waitcnt lgkmcnt(3)
    v_mfma_f32_16x16x32_bf16 v[224:227], v[48:51], v[40:43], v[224:227]
    ds_read_b64_tr_b16 v[18:19], v4 offset:26624
    s_waitcnt lgkmcnt(2)
    v_mfma_f32_16x16x32_bf16 v[240:243], v[48:51], v[44:47], v[240:243]
    ds_read_b128 v[48:51], v8 offset:24576
    v_mfma_f32_16x16x32_bf16 v[196:199], v[52:55], v[32:35], v[196:199]
    ds_read_b64_tr_b16 v[20:21], v5 offset:24576
    v_mfma_f32_16x16x32_bf16 v[212:215], v[52:55], v[36:39], v[212:215]
    v_mfma_f32_16x16x32_bf16 v[228:231], v[52:55], v[40:43], v[228:231]
    ds_read_b64_tr_b16 v[22:23], v5 offset:26624
    v_mfma_f32_16x16x32_bf16 v[244:247], v[52:55], v[44:47], v[244:247]
    ds_read_b64_tr_b16 v[24:25], v6 offset:24576
    v_mfma_f32_16x16x32_bf16 v[200:203], v[56:59], v[32:35], v[200:203]
    ds_read_b64_tr_b16 v[26:27], v6 offset:26624
    v_mfma_f32_16x16x32_bf16 v[216:219], v[56:59], v[36:39], v[216:219]
    ds_read_b64_tr_b16 v[28:29], v7 offset:24576
    v_mfma_f32_16x16x32_bf16 v[232:235], v[56:59], v[40:43], v[232:235]
    ds_read_b64_tr_b16 v[30:31], v7 offset:26624
    v_mfma_f32_16x16x32_bf16 v[248:251], v[56:59], v[44:47], v[248:251]
    ds_read_b128 v[52:55], v8 offset:25600
    v_mfma_f32_16x16x32_bf16 v[204:207], v[60:63], v[32:35], v[204:207]
    ds_read_b128 v[56:59], v8 offset:26624
    v_mfma_f32_16x16x32_bf16 v[220:223], v[60:63], v[36:39], v[220:223]
    ds_read_b64_tr_b16 v[32:33], v4 offset:28672
    v_mfma_f32_16x16x32_bf16 v[236:239], v[60:63], v[40:43], v[236:239]
    ds_read_b64_tr_b16 v[34:35], v4 offset:30720
    v_mfma_f32_16x16x32_bf16 v[252:255], v[60:63], v[44:47], v[252:255]
    ds_read_b128 v[60:63], v8 offset:27648
    s_waitcnt lgkmcnt(11)
    v_mfma_f32_16x16x32_bf16 v[128:131], v[48:51], v[16:19], v[128:131]
    ds_read_b64_tr_b16 v[36:37], v5 offset:28672
    s_waitcnt lgkmcnt(10)
    v_mfma_f32_16x16x32_bf16 v[144:147], v[48:51], v[20:23], v[144:147]
    ds_read_b64_tr_b16 v[38:39], v5 offset:30720
    s_waitcnt lgkmcnt(9)
    v_mfma_f32_16x16x32_bf16 v[160:163], v[48:51], v[24:27], v[160:163]
    ds_read_b64_tr_b16 v[40:41], v6 offset:28672
    s_waitcnt lgkmcnt(8)
    v_mfma_f32_16x16x32_bf16 v[176:179], v[48:51], v[28:31], v[176:179]
    ds_read_b64_tr_b16 v[42:43], v6 offset:30720
    s_waitcnt lgkmcnt(8)
    v_mfma_f32_16x16x32_bf16 v[132:135], v[52:55], v[16:19], v[132:135]
    ds_read_b64_tr_b16 v[44:45], v7 offset:28672
    v_mfma_f32_16x16x32_bf16 v[148:151], v[52:55], v[20:23], v[148:151]
    ds_read_b64_tr_b16 v[46:47], v7 offset:30720
    v_mfma_f32_16x16x32_bf16 v[164:167], v[52:55], v[24:27], v[164:167]
    v_mfma_f32_16x16x32_bf16 v[180:183], v[52:55], v[28:31], v[180:183]
    s_waitcnt lgkmcnt(9)
    v_mfma_f32_16x16x32_bf16 v[136:139], v[56:59], v[16:19], v[136:139]
    v_mfma_f32_16x16x32_bf16 v[152:155], v[56:59], v[20:23], v[152:155]
    v_mfma_f32_16x16x32_bf16 v[168:171], v[56:59], v[24:27], v[168:171]
    v_mfma_f32_16x16x32_bf16 v[184:187], v[56:59], v[28:31], v[184:187]
    s_waitcnt lgkmcnt(6)
    v_mfma_f32_16x16x32_bf16 v[140:143], v[60:63], v[16:19], v[140:143]
    v_mfma_f32_16x16x32_bf16 v[156:159], v[60:63], v[20:23], v[156:159]
    v_mfma_f32_16x16x32_bf16 v[172:175], v[60:63], v[24:27], v[172:175]
    v_mfma_f32_16x16x32_bf16 v[188:191], v[60:63], v[28:31], v[188:191]
    v_mfma_f32_16x16x32_bf16 v[192:195], v[48:51], v[32:35], v[192:195]
    s_barrier
    s_waitcnt lgkmcnt(4)
    v_mfma_f32_16x16x32_bf16 v[208:211], v[48:51], v[36:39], v[208:211]
    ds_read_b64_tr_b16 v[16:17], v4 offset:49152
    s_waitcnt lgkmcnt(3)
    v_mfma_f32_16x16x32_bf16 v[224:227], v[48:51], v[40:43], v[224:227]
    ds_read_b64_tr_b16 v[18:19], v4 offset:51200
    s_waitcnt lgkmcnt(2)
    v_mfma_f32_16x16x32_bf16 v[240:243], v[48:51], v[44:47], v[240:243]
    ds_read_b128 v[48:51], v8 offset:49152
    s_sub_u32 s44, s44, 1
    v_mfma_f32_16x16x32_bf16 v[196:199], v[52:55], v[32:35], v[196:199]
    ds_read_b64_tr_b16 v[20:21], v5 offset:49152
    s_cmp_lg_u32 s44, 0
    v_mfma_f32_16x16x32_bf16 v[212:215], v[52:55], v[36:39], v[212:215]
    s_cbranch_scc1 k3a_l0
    v_mfma_f32_16x16x32_bf16 v[228:231], v[52:55], v[40:43], v[228:231]
    ds_read_b64_tr_b16 v[22:23], v5 offset:51200
    v_mfma_f32_16x16x32_bf16 v[244:247], v[52:55], v[44:47], v[244:247]
    ds_read_b64_tr_b16 v[24:25], v6 offset:49152
    v_mfma_f32_16x16x32_bf16 v[200:203], v[56:59], v[32:35], v[200:203]
    ds_read_b64_tr_b16 v[26:27], v6 offset:51200
    v_mfma_f32_16x16x32_bf16 v[216:219], v[56:59], v[36:39], v[216:219]
    ds_read_b64_tr_b16 v[28:29], v7 offset:49152
    v_mfma_f32_16x16x32_bf16 v[232:235], v[56:59], v[40:43], v[232:235]
    ds_read_b64_tr_b16 v[30:31], v7 offset:51200
    v_mfma_f32_16x16x32_bf16 v[248:251], v[56:59], v[44:47], v[248:251]
    ds_read_b128 v[52:55], v8 offset:50176
    v_mfma_f32_16x16x32_bf16 v[204:207], v[60:63], v[32:35], v[204:207]
    ds_read_b128 v[56:59], v8 offset:51200
    v_mfma_f32_16x16x32_bf16 v[220:223], v[60:63], v[36:39], v[220:223]
    ds_read_b64_tr_b16 v[32:33], v4 offset:53248
    v_mfma_f32_16x16x32_bf16 v[236:239], v[60:63], v[40:43], v[236:239]
    ds_read_b64_tr_b16 v[34:35], v4 offset:55296
    v_mfma_f32_16x16x32_bf16 v[252:255], v[60:63], v[44:47], v[252:255]
    ds_read_b128 v[60:63], v8 offset:52224
    s_waitcnt lgkmcnt(11)
    v_mfma_f32_16x16x32_bf16 v[128:131], v[48:51], v[16:19], v[128:131]
    ds_read_b64_tr_b16 v[36:37], v5 offset:53248
    s_waitcnt lgkmcnt(10)
    v_mfma_f32_16x16x32_bf16 v[144:147], v[48:51], v[20:23], v[144:147]
    ds_read_b64_tr_b16 v[38:39], v5 offset:55296
    s_waitcnt lgkmcnt(9)
    v_mfma_f32_16x16x32_bf16 v[160:163], v[48:51], v[24:27], v[160:163]
    ds_read_b64_tr_b16 v[40:41], v6 offset:53248
    s_waitcnt lgkmcnt(8)
    v_mfma_f32_16x16x32_bf16 v[176:179], v[48:51], v[28:31], v[176:179]
    ds_read_b64_tr_b16 v[42:43], v6 offset:55296
    s_waitcnt lgkmcnt(8)
    v_mfma_f32_16x16x32_bf16 v[132:135], v[52:55], v[16:19], v[132:135]
    ds_read_b64_tr_b16 v[44:45], v7 offset:53248
    v_mfma_f32_16x16x32_bf16 v[148:151], v[52:55], v[20:23], v[148:151]
    ds_read_b64_tr_b16 v[46:47], v7 offset:55296
    v_mfma_f32_16x16x32_bf16 v[164:167], v[52:55], v[24:27], v[164:167]
    v_mfma_f32_16x16x32_bf16 v[180:183], v[52:55], v[28:31], v[180:183]
    s_waitcnt lgkmcnt(9)
    v_mfma_f32_16x16x32_bf16 v[136:139], v[56:59], v[16:19], v[136:139]
    v_mfma_f32_16x16x32_bf16 v[152:155], v[56:59], v[20:23], v[152:155]
    v_mfma_f32_16x16x32_bf16 v[168:171], v[56:59], v[24:27], v[168:171]
    v_mfma_f32_16x16x32_bf16 v[184:187], v[56:59], v[28:31], v[184:187]
    s_waitcnt lgkmcnt(6)
    v_mfma_f32_16x16x32_bf16 v[140:143], v[60:63], v[16:19], v[140:143]
    v_mfma_f32_16x16x32_bf16 v[156:159], v[60:63], v[20:23], v[156:159]
    v_mfma_f32_16x16x32_bf16 v[172:175], v[60:63], v[24:27], v[172:175]
    v_mfma_f32_16x16x32_bf16 v[188:191], v[60:63], v[28:31], v[188:191]
    v_mfma_f32_16x16x32_bf16 v[192:195], v[48:51], v[32:35], v[192:195]
    s_barrier
    s_waitcnt lgkmcnt(4)
    v_mfma_f32_16x16x32_bf16 v[208:211], v[48:51], v[36:39], v[208:211]
    ds_read_b64_tr_b16 v[16:17], v10 offset:0
    s_waitcnt lgkmcnt(3)
    v_mfma_f32_16x16x32_bf16 v[224:227], v[48:51], v[40:43], v[224:227]
    ds_read_b64_tr_b16 v[18:19], v10 offset:2048
    s_waitcnt lgkmcnt(2)
    v_mfma_f32_16x16x32_bf16 v[240:243], v[48:51], v[44:47], v[240:243]
    ds_read_b128 v[48:51], v9 offset:0
    v_mfma_f32_16x16x32_bf16 v[196:199], v[52:55], v[32:35], v[196:199]
    ds_read_b64_tr_b16 v[20:21], v11 offset:0
    v_mfma_f32_16x16x32_bf16 v[212:215], v[52:55], v[36:39], v[212:215]
    v_mfma_f32_16x16x32_bf16 v[228:231], v[52:55], v[40:43], v[228:231]
    ds_read_b64_tr_b16 v[22:23], v11 offset:2048
    v_mfma_f32_16x16x32_bf16 v[244:247], v[52:55], v[44:47], v[244:247]
    ds_read_b64_tr_b16 v[24:25], v12 offset:0
    v_mfma_f32_16x16x32_bf16 v[200:203], v[56:59], v[32:35], v[200:203]
    ds_read_b64_tr_b16 v[26:27], v12 offset:2048
    v_mfma_f32_16x16x32_bf16 v[216:219], v[56:59], v[36:39], v[216:219]
    ds_read_b64_tr_b16 v[28:29], v13 offset:0
    v_mfma_f32_16x16x32_bf16 v[232:235], v[56:59], v[40:43], v[232:235]
    ds_read_b64_tr_b16 v[30:31], v13 offset:2048
    v_mfma_f32_16x16x32_bf16 v[248:251], v[56:59], v[44:47], v[248:251]
    ds_read_b128 v[52:55], v9 offset:1024
    v_mfma_f32_16x16x32_bf16 v[204:207], v[60:63], v[32:35], v[204:207]
    ds_read_b128 v[56:59], v9 offset:2048
    v_mfma_f32_16x16x32_bf16 v[220:223], v[60:63], v[36:39], v[220:223]
    ds_read_b64_tr_b16 v[32:33], v10 offset:4096
    v_mfma_f32_16x16x32_bf16 v[236:239], v[60:63], v[40:43], v[236:239]
    ds_read_b64_tr_b16 v[34:35], v10 offset:6144
    v_mfma_f32_16x16x32_bf16 v[252:255], v[60:63], v[44:47], v[252:255]
    ds_read_b128 v[60:63], v9 offset:3072
    s_waitcnt lgkmcnt(11)
    v_mfma_f32_16x16x32_bf16 v[128:131], v[48:51], v[16:19], v[128:131]
    ds_read_b64_tr_b16 v[36:37], v11 offset:4096
    s_waitcnt lgkmcnt(10)
    v_mfma_f32_16x16x32_bf16 v[144:147], v[48:51], v[20:23], v[144:147]
    ds_read_b64_tr_b16 v[38:39], v11 offset:6144
    s_waitcnt lgkmcnt(9)
    v_mfma_f32_16x16x32_bf16 v[160:163], v[48:51], v[24:27], v[160:163]
    ds_read_b64_tr_b16 v[40:41], v12 offset:4096
    s_waitcnt lgkmcnt(8)
    v_mfma_f32_16x16x32_bf16 v[176:179], v[48:51], v[28:31], v[176:179]
    ds_read_b64_tr_b16 v[42:43], v12 offset:6144
    s_waitcnt lgkmcnt(8)
    v_mfma_f32_16x16x32_bf16 v[132:135], v[52:55], v[16:19], v[132:135]
    ds_read_b64_tr_b16 v[44:45], v13 offset:4096
    v_mfma_f32_16x16x32_bf16 v[148:151], v[52:55], v[20:23], v[148:151]
    ds_read_b64_tr_b16 v[46:47], v13 offset:6144
    v_mfma_f32_16x16x32_bf16 v[164:167], v[52:55], v[24:27], v[164:167]
    v_mfma_f32_16x16x32_bf16 v[180:183], v[52:55], v[28:31], v[180:183]
    s_waitcnt lgkmcnt(9)
    v_mfma_f32_16x16x32_bf16 v[136:139], v[56:59], v[16:19], v[136:139]
    v_mfma_f32_16x16x32_bf16 v[152:155], v[56:59], v[20:23], v[152:155]
    v_mfma_f32_16x16x32_bf16 v[168:171], v[56:59], v[24:27], v[168:171]
    v_mfma_f32_16x16x32_bf16 v[184:187], v[56:59], v[28:31], v[184:187]
    s_waitcnt lgkmcnt(6)
    v_mfma_f32_16x16x32_bf16 v[140:143], v[60:63], v[16:19], v[140:143]
    v_mfma_f32_16x16x32_bf16 v[156:159], v[60:63], v[20:23], v[156:159]
    v_mfma_f32_16x16x32_bf16 v[172:175], v[60:63], v[24:27], v[172:175]
    v_mfma_f32_16x16x32_bf16 v[188:191], v[60:63], v[28:31], v[188:191]
    v_mfma_f32_16x16x32_bf16 v[192:195], v[48:51], v[32:35], v[192:195]
    s_barrier
    s_waitcnt lgkmcnt(4)
    v_mfma_f32_16x16x32_bf16 v[208:211], v[48:51], v[36:39], v[208:211]
    ds_read_b64_tr_b16 v[16:17], v10 offset:24576
    s_waitcnt lgkmcnt(3)
    v_mfma_f32_16x16x32_bf16 v[224:227], v[48:51], v[40:43], v[224:227]
    ds_read_b64_tr_b16 v[18:19], v10 offset:26624
    s_waitcnt lgkmcnt(2)
    v_mfma_f32_16x16x32_bf16 v[240:243], v[48:51], v[44:47], v[240:243]
    ds_read_b128 v[48:51], v9 offset:24576
    v_mfma_f32_16x16x32_bf16 v[196:199], v[52:55], v[32:35], v[196:199]
    ds_read_b64_tr_b16 v[20:21], v11 offset:24576
    v_mfma_f32_16x16x32_bf16 v[212:215], v[52:55], v[36:39], v[212:215]
    v_mfma_f32_16x16x32_bf16 v[228:231], v[52:55], v[40:43], v[228:231]
    ds_read_b64_tr_b16 v[22:23], v11 offset:26624
    v_mfma_f32_16x16x32_bf16 v[244:247], v[52:55], v[44:47], v[244:247]
    ds_read_b64_tr_b16 v[24:25], v12 offset:24576
    v_mfma_f32_16x16x32_bf16 v[200:203], v[56:59], v[32:35], v[200:203]
    ds_read_b64_tr_b16 v[26:27], v12 offset:26624
    v_mfma_f32_16x16x32_bf16 v[216:219], v[56:59], v[36:39], v[216:219]
    ds_read_b64_tr_b16 v[28:29], v13 offset:24576
    v_mfma_f32_16x16x32_bf16 v[232:235], v[56:59], v[40:43], v[232:235]
    ds_read_b64_tr_b16 v[30:31], v13 offset:26624
    v_mfma_f32_16x16x32_bf16 v[248:251], v[56:59], v[44:47], v[248:251]
    ds_read_b128 v[52:55], v9 offset:25600
    v_mfma_f32_16x16x32_bf16 v[204:207], v[60:63], v[32:35], v[204:207]
    ds_read_b128 v[56:59], v9 offset:26624
    v_mfma_f32_16x16x32_bf16 v[220:223], v[60:63], v[36:39], v[220:223]
    ds_read_b64_tr_b16 v[32:33], v10 offset:28672
    v_mfma_f32_16x16x32_bf16 v[236:239], v[60:63], v[40:43], v[236:239]
    ds_read_b64_tr_b16 v[34:35], v10 offset:30720
    v_mfma_f32_16x16x32_bf16 v[252:255], v[60:63], v[44:47], v[252:255]
    ds_read_b128 v[60:63], v9 offset:27648
    s_waitcnt lgkmcnt(11)
    v_mfma_f32_16x16x32_bf16 v[128:131], v[48:51], v[16:19], v[128:131]
    ds_read_b64_tr_b16 v[36:37], v11 offset:28672
    s_waitcnt lgkmcnt(10)
    v_mfma_f32_16x16x32_bf16 v[144:147], v[48:51], v[20:23], v[144:147]
    ds_read_b64_tr_b16 v[38:39], v11 offset:30720
    s_waitcnt lgkmcnt(9)
    v_mfma_f32_16x16x32_bf16 v[160:163], v[48:51], v[24:27], v[160:163]
    ds_read_b64_tr_b16 v[40:41], v12 offset:28672
    s_waitcnt lgkmcnt(8)
    v_mfma_f32_16x16x32_bf16 v[176:179], v[48:51], v[28:31], v[176:179]
    ds_read_b64_tr_b16 v[42:43], v12 offset:30720
    s_waitcnt lgkmcnt(8)
    v_mfma_f32_16x16x32_bf16 v[132:135], v[52:55], v[16:19], v[132:135]
    ds_read_b64_tr_b16 v[44:45], v13 offset:28672
    v_mfma_f32_16x16x32_bf16 v[148:151], v[52:55], v[20:23], v[148:151]
    ds_read_b64_tr_b16 v[46:47], v13 offset:30720
    v_mfma_f32_16x16x32_bf16 v[164:167], v[52:55], v[24:27], v[164:167]
    v_mfma_f32_16x16x32_bf16 v[180:183], v[52:55], v[28:31], v[180:183]
    s_waitcnt lgkmcnt(9)
    v_mfma_f32_16x16x32_bf16 v[136:139], v[56:59], v[16:19], v[136:139]
    v_mfma_f32_16x16x32_bf16 v[152:155], v[56:59], v[20:23], v[152:155]
    v_mfma_f32_16x16x32_bf16 v[168:171], v[56:59], v[24:27], v[168:171]
    v_mfma_f32_16x16x32_bf16 v[184:187], v[56:59], v[28:31], v[184:187]
    s_waitcnt lgkmcnt(6)
    v_mfma_f32_16x16x32_bf16 v[140:143], v[60:63], v[16:19], v[140:143]
    v_mfma_f32_16x16x32_bf16 v[156:159], v[60:63], v[20:23], v[156:159]
    v_mfma_f32_16x16x32_bf16 v[172:175], v[60:63], v[24:27], v[172:175]
    v_mfma_f32_16x16x32_bf16 v[188:191], v[60:63], v[28:31], v[188:191]
    v_mfma_f32_16x16x32_bf16 v[192:195], v[48:51], v[32:35], v[192:195]
    s_barrier
    s_waitcnt lgkmcnt(4)
    v_mfma_f32_16x16x32_bf16 v[208:211], v[48:51], v[36:39], v[208:211]
    ds_read_b64_tr_b16 v[16:17], v10 offset:49152
    s_waitcnt lgkmcnt(3)
    v_mfma_f32_16x16x32_bf16 v[224:227], v[48:51], v[40:43], v[224:227]
    ds_read_b64_tr_b16 v[18:19], v10 offset:51200
    s_waitcnt lgkmcnt(2)
    v_mfma_f32_16x16x32_bf16 v[240:243], v[48:51], v[44:47], v[240:243]
    ds_read_b128 v[48:51], v9 offset:49152
    v_mfma_f32_16x16x32_bf16 v[196:199], v[52:55], v[32:35], v[196:199]
    ds_read_b64_tr_b16 v[20:21], v11 offset:49152
    v_mfma_f32_16x16x32_bf16 v[212:215], v[52:55], v[36:39], v[212:215]
    v_mfma_f32_16x16x32_bf16 v[228:231], v[52:55], v[40:43], v[228:231]
    ds_read_b64_tr_b16 v[22:23], v11 offset:51200
    v_mfma_f32_16x16x32_bf16 v[244:247], v[52:55], v[44:47], v[244:247]
    ds_read_b64_tr_b16 v[24:25], v12 offset:49152
    v_mfma_f32_16x16x32_bf16 v[200:203], v[56:59], v[32:35], v[200:203]
    ds_read_b64_tr_b16 v[26:27], v12 offset:51200
    v_mfma_f32_16x16x32_bf16 v[216:219], v[56:59], v[36:39], v[216:219]
    ds_read_b64_tr_b16 v[28:29], v13 offset:49152
    v_mfma_f32_16x16x32_bf16 v[232:235], v[56:59], v[40:43], v[232:235]
    ds_read_b64_tr_b16 v[30:31], v13 offset:51200
    v_mfma_f32_16x16x32_bf16 v[248:251], v[56:59], v[44:47], v[248:251]
    ds_read_b128 v[52:55], v9 offset:50176
    v_mfma_f32_16x16x32_bf16 v[204:207], v[60:63], v[32:35], v[204:207]
    ds_read_b128 v[56:59], v9 offset:51200
    v_mfma_f32_16x16x32_bf16 v[220:223], v[60:63], v[36:39], v[220:223]
    ds_read_b64_tr_b16 v[32:33], v10 offset:53248
    v_mfma_f32_16x16x32_bf16 v[236:239], v[60:63], v[40:43], v[236:239]
    ds_read_b64_tr_b16 v[34:35], v10 offset:55296
    v_mfma_f32_16x16x32_bf16 v[252:255], v[60:63], v[44:47], v[252:255]
    ds_read_b128 v[60:63], v9 offset:52224
    s_waitcnt lgkmcnt(11)
    v_mfma_f32_16x16x32_bf16 v[128:131], v[48:51], v[16:19], v[128:131]
    ds_read_b64_tr_b16 v[36:37], v11 offset:53248
    s_waitcnt lgkmcnt(10)
    v_mfma_f32_16x16x32_bf16 v[144:147], v[48:51], v[20:23], v[144:147]
    ds_read_b64_tr_b16 v[38:39], v11 offset:55296
    s_waitcnt lgkmcnt(9)
    v_mfma_f32_16x16x32_bf16 v[160:163], v[48:51], v[24:27], v[160:163]
    ds_read_b64_tr_b16 v[40:41], v12 offset:53248
    s_waitcnt lgkmcnt(8)
    v_mfma_f32_16x16x32_bf16 v[176:179], v[48:51], v[28:31], v[176:179]
    ds_read_b64_tr_b16 v[42:43], v12 offset:55296
    s_waitcnt lgkmcnt(8)
    v_mfma_f32_16x16x32_bf16 v[132:135], v[52:55], v[16:19], v[132:135]
    ds_read_b64_tr_b16 v[44:45], v13 offset:53248
    v_mfma_f32_16x16x32_bf16 v[148:151], v[52:55], v[20:23], v[148:151]
    ds_read_b64_tr_b16 v[46:47], v13 offset:55296
    v_mfma_f32_16x16x32_bf16 v[164:167], v[52:55], v[24:27], v[164:167]
    v_mfma_f32_16x16x32_bf16 v[180:183], v[52:55], v[28:31], v[180:183]
    s_waitcnt lgkmcnt(9)
    v_mfma_f32_16x16x32_bf16 v[136:139], v[56:59], v[16:19], v[136:139]
    v_mfma_f32_16x16x32_bf16 v[152:155], v[56:59], v[20:23], v[152:155]
    v_mfma_f32_16x16x32_bf16 v[168:171], v[56:59], v[24:27], v[168:171]
    v_mfma_f32_16x16x32_bf16 v[184:187], v[56:59], v[28:31], v[184:187]
    s_waitcnt lgkmcnt(6)
    v_mfma_f32_16x16x32_bf16 v[140:143], v[60:63], v[16:19], v[140:143]
    v_mfma_f32_16x16x32_bf16 v[156:159], v[60:63], v[20:23], v[156:159]
    v_mfma_f32_16x16x32_bf16 v[172:175], v[60:63], v[24:27], v[172:175]
    v_mfma_f32_16x16x32_bf16 v[188:191], v[60:63], v[28:31], v[188:191]
    v_mfma_f32_16x16x32_bf16 v[192:195], v[48:51], v[32:35], v[192:195]
    buffer_load_dwordx2 v[66:67], v15, s[12:15], s37 offen offset:0
    buffer_load_dwordx2 v[68:69], v15, s[12:15], s37 offen offset:32
    buffer_load_dwordx2 v[70:71], v15, s[12:15], s37 offen offset:64
    buffer_load_dwordx2 v[72:73], v15, s[12:15], s37 offen offset:96
    buffer_load_dwordx2 v[74:75], v15, s[12:15], s38 offen offset:0
    s_barrier
    s_waitcnt lgkmcnt(4)
    v_mfma_f32_16x16x32_bf16 v[208:211], v[48:51], v[36:39], v[208:211]
    ds_read_b64_tr_b16 v[16:17], v4 offset:0
    s_waitcnt lgkmcnt(3)
    v_mfma_f32_16x16x32_bf16 v[224:227], v[48:51], v[40:43], v[224:227]
    ds_read_b64_tr_b16 v[18:19], v4 offset:2048
    s_waitcnt lgkmcnt(2)
    v_mfma_f32_16x16x32_bf16 v[240:243], v[48:51], v[44:47], v[240:243]
    ds_read_b128 v[48:51], v8 offset:0
    v_mfma_f32_16x16x32_bf16 v[196:199], v[52:55], v[32:35], v[196:199]
    ds_read_b64_tr_b16 v[20:21], v5 offset:0
    v_mfma_f32_16x16x32_bf16 v[212:215], v[52:55], v[36:39], v[212:215]
    v_mfma_f32_16x16x32_bf16 v[228:231], v[52:55], v[40:43], v[228:231]
    ds_read_b64_tr_b16 v[22:23], v5 offset:2048
    v_mfma_f32_16x16x32_bf16 v[244:247], v[52:55], v[44:47], v[244:247]
    ds_read_b64_tr_b16 v[24:25], v6 offset:0
    v_mfma_f32_16x16x32_bf16 v[200:203], v[56:59], v[32:35], v[200:203]
    ds_read_b64_tr_b16 v[26:27], v6 offset:2048
    v_mfma_f32_16x16x32_bf16 v[216:219], v[56:59], v[36:39], v[216:219]
    ds_read_b64_tr_b16 v[28:29], v7 offset:0
    v_mfma_f32_16x16x32_bf16 v[232:235], v[56:59], v[40:43], v[232:235]
    ds_read_b64_tr_b16 v[30:31], v7 offset:2048
    v_mfma_f32_16x16x32_bf16 v[248:251], v[56:59], v[44:47], v[248:251]
    ds_read_b128 v[52:55], v8 offset:1024
    v_mfma_f32_16x16x32_bf16 v[204:207], v[60:63], v[32:35], v[204:207]
    ds_read_b128 v[56:59], v8 offset:2048
    v_mfma_f32_16x16x32_bf16 v[220:223], v[60:63], v[36:39], v[220:223]
    ds_read_b64_tr_b16 v[32:33], v4 offset:4096
    v_mfma_f32_16x16x32_bf16 v[236:239], v[60:63], v[40:43], v[236:239]
    ds_read_b64_tr_b16 v[34:35], v4 offset:6144
    v_mfma_f32_16x16x32_bf16 v[252:255], v[60:63], v[44:47], v[252:255]
    ds_read_b128 v[60:63], v8 offset:3072
    s_waitcnt lgkmcnt(11)
    v_mfma_f32_16x16x32_bf16 v[128:131], v[48:51], v[16:19], v[128:131]
    ds_read_b64_tr_b16 v[36:37], v5 offset:4096
    s_waitcnt lgkmcnt(10)
    v_mfma_f32_16x16x32_bf16 v[144:147], v[48:51], v[20:23], v[144:147]
    ds_read_b64_tr_b16 v[38:39], v5 offset:6144
    s_waitcnt lgkmcnt(9)
    v_mfma_f32_16x16x32_bf16 v[160:163], v[48:51], v[24:27], v[160:163]
    ds_read_b64_tr_b16 v[40:41], v6 offset:4096
    s_waitcnt lgkmcnt(8)
    v_mfma_f32_16x16x32_bf16 v[176:179], v[48:51], v[28:31], v[176:179]
    ds_read_b64_tr_b16 v[42:43], v6 offset:6144
    s_waitcnt lgkmcnt(8)
    v_mfma_f32_16x16x32_bf16 v[132:135], v[52:55], v[16:19], v[132:135]
    ds_read_b64_tr_b16 v[44:45], v7 offset:4096
    v_mfma_f32_16x16x32_bf16 v[148:151], v[52:55], v[20:23], v[148:151]
    ds_read_b64_tr_b16 v[46:47], v7 offset:6144
    v_mfma_f32_16x16x32_bf16 v[164:167], v[52:55], v[24:27], v[164:167]
    v_mfma_f32_16x16x32_bf16 v[180:183], v[52:55], v[28:31], v[180:183]
    s_waitcnt lgkmcnt(9)
    v_mfma_f32_16x16x32_bf16 v[136:139], v[56:59], v[16:19], v[136:139]
    v_mfma_f32_16x16x32_bf16 v[152:155], v[56:59], v[20:23], v[152:155]
    v_mfma_f32_16x16x32_bf16 v[168:171], v[56:59], v[24:27], v[168:171]
    v_mfma_f32_16x16x32_bf16 v[184:187], v[56:59], v[28:31], v[184:187]
    s_waitcnt lgkmcnt(6)
    v_mfma_f32_16x16x32_bf16 v[140:143], v[60:63], v[16:19], v[140:143]
    v_mfma_f32_16x16x32_bf16 v[156:159], v[60:63], v[20:23], v[156:159]
    v_mfma_f32_16x16x32_bf16 v[172:175], v[60:63], v[24:27], v[172:175]
    v_mfma_f32_16x16x32_bf16 v[188:191], v[60:63], v[28:31], v[188:191]
    v_mfma_f32_16x16x32_bf16 v[192:195], v[48:51], v[32:35], v[192:195]
    buffer_load_dwordx2 v[76:77], v15, s[12:15], s38 offen offset:32
    buffer_load_dwordx2 v[78:79], v15, s[12:15], s38 offen offset:64
    buffer_load_dwordx2 v[80:81], v15, s[12:15], s38 offen offset:96
    buffer_load_ushort v82, v2, s[16:19], s39 offen
    buffer_load_ushort v83, v2, s[16:19], s39 offen offset:32
    s_barrier
    s_waitcnt lgkmcnt(4)
    v_mfma_f32_16x16x32_bf16 v[208:211], v[48:51], v[36:39], v[208:211]
    ds_read_b64_tr_b16 v[16:17], v4 offset:24576
    s_waitcnt lgkmcnt(3)
    v_mfma_f32_16x16x32_bf16 v[224:227], v[48:51], v[40:43], v[224:227]
    ds_read_b64_tr_b16 v[18:19], v4 offset:26624
    s_waitcnt lgkmcnt(2)
    v_mfma_f32_16x16x32_bf16 v[240:243], v[48:51], v[44:47], v[240:243]
    ds_read_b128 v[48:51], v8 offset:24576
    v_mfma_f32_16x16x32_bf16 v[196:199], v[52:55], v[32:35], v[196:199]
    ds_read_b64_tr_b16 v[20:21], v5 offset:24576
    v_mfma_f32_16x16x32_bf16 v[212:215], v[52:55], v[36:39], v[212:215]
    v_mfma_f32_16x16x32_bf16 v[228:231], v[52:55], v[40:43], v[228:231]
    ds_read_b64_tr_b16 v[22:23], v5 offset:26624
    v_mfma_f32_16x16x32_bf16 v[244:247], v[52:55], v[44:47], v[244:247]
    ds_read_b64_tr_b16 v[24:25], v6 offset:24576
    v_mfma_f32_16x16x32_bf16 v[200:203], v[56:59], v[32:35], v[200:203]
    ds_read_b64_tr_b16 v[26:27], v6 offset:26624
    v_mfma_f32_16x16x32_bf16 v[216:219], v[56:59], v[36:39], v[216:219]
    ds_read_b64_tr_b16 v[28:29], v7 offset:24576
    v_mfma_f32_16x16x32_bf16 v[232:235], v[56:59], v[40:43], v[232:235]
    ds_read_b64_tr_b16 v[30:31], v7 offset:26624
    v_mfma_f32_16x16x32_bf16 v[248:251], v[56:59], v[44:47], v[248:251]
    ds_read_b128 v[52:55], v8 offset:25600
    v_mfma_f32_16x16x32_bf16 v[204:207], v[60:63], v[32:35], v[204:207]
    ds_read_b128 v[56:59], v8 offset:26624
    v_mfma_f32_16x16x32_bf16 v[220:223], v[60:63], v[36:39], v[220:223]
    ds_read_b64_tr_b16 v[32:33], v4 offset:28672
    v_mfma_f32_16x16x32_bf16 v[236:239], v[60:63], v[40:43], v[236:239]
    ds_read_b64_tr_b16 v[34:35], v4 offset:30720
    v_mfma_f32_16x16x32_bf16 v[252:255], v[60:63], v[44:47], v[252:255]
    ds_read_b128 v[60:63], v8 offset:27648
    s_waitcnt lgkmcnt(11)
    v_mfma_f32_16x16x32_bf16 v[128:131], v[48:51], v[16:19], v[128:131]
    ds_read_b64_tr_b16 v[36:37], v5 offset:28672
    s_waitcnt lgkmcnt(10)
    v_mfma_f32_16x16x32_bf16 v[144:147], v[48:51], v[20:23], v[144:147]
    ds_read_b64_tr_b16 v[38:39], v5 offset:30720
    s_waitcnt lgkmcnt(9)
    v_mfma_f32_16x16x32_bf16 v[160:163], v[48:51], v[24:27], v[160:163]
    ds_read_b64_tr_b16 v[40:41], v6 offset:28672
    s_waitcnt lgkmcnt(8)
    v_mfma_f32_16x16x32_bf16 v[176:179], v[48:51], v[28:31], v[176:179]
    ds_read_b64_tr_b16 v[42:43], v6 offset:30720
    s_waitcnt lgkmcnt(8)
    v_mfma_f32_16x16x32_bf16 v[132:135], v[52:55], v[16:19], v[132:135]
    ds_read_b64_tr_b16 v[44:45], v7 offset:28672
    v_mfma_f32_16x16x32_bf16 v[148:151], v[52:55], v[20:23], v[148:151]
    ds_read_b64_tr_b16 v[46:47], v7 offset:30720
    v_mfma_f32_16x16x32_bf16 v[164:167], v[52:55], v[24:27], v[164:167]
    v_mfma_f32_16x16x32_bf16 v[180:183], v[52:55], v[28:31], v[180:183]
    s_waitcnt lgkmcnt(9)
    v_mfma_f32_16x16x32_bf16 v[136:139], v[56:59], v[16:19], v[136:139]
    v_mfma_f32_16x16x32_bf16 v[152:155], v[56:59], v[20:23], v[152:155]
    v_mfma_f32_16x16x32_bf16 v[168:171], v[56:59], v[24:27], v[168:171]
    v_mfma_f32_16x16x32_bf16 v[184:187], v[56:59], v[28:31], v[184:187]
    s_waitcnt lgkmcnt(6)
    v_mfma_f32_16x16x32_bf16 v[140:143], v[60:63], v[16:19], v[140:143]
    v_mfma_f32_16x16x32_bf16 v[156:159], v[60:63], v[20:23], v[156:159]
    v_mfma_f32_16x16x32_bf16 v[172:175], v[60:63], v[24:27], v[172:175]
    v_mfma_f32_16x16x32_bf16 v[188:191], v[60:63], v[28:31], v[188:191]
    v_mfma_f32_16x16x32_bf16 v[192:195], v[48:51], v[32:35], v[192:195]
    s_barrier
    s_waitcnt lgkmcnt(4)
    v_mfma_f32_16x16x32_bf16 v[208:211], v[48:51], v[36:39], v[208:211]
    ds_read_b64_tr_b16 v[16:17], v4 offset:49152
    s_waitcnt lgkmcnt(3)
    v_mfma_f32_16x16x32_bf16 v[224:227], v[48:51], v[40:43], v[224:227]
    ds_read_b64_tr_b16 v[18:19], v4 offset:51200
    s_waitcnt lgkmcnt(2)
    v_mfma_f32_16x16x32_bf16 v[240:243], v[48:51], v[44:47], v[240:243]
    ds_read_b128 v[48:51], v8 offset:49152
    v_mfma_f32_16x16x32_bf16 v[196:199], v[52:55], v[32:35], v[196:199]
    ds_read_b64_tr_b16 v[20:21], v5 offset:49152
    v_mfma_f32_16x16x32_bf16 v[212:215], v[52:55], v[36:39], v[212:215]
    v_mfma_f32_16x16x32_bf16 v[228:231], v[52:55], v[40:43], v[228:231]
    ds_read_b64_tr_b16 v[22:23], v5 offset:51200
    v_mfma_f32_16x16x32_bf16 v[244:247], v[52:55], v[44:47], v[244:247]
    ds_read_b64_tr_b16 v[24:25], v6 offset:49152
    v_mfma_f32_16x16x32_bf16 v[200:203], v[56:59], v[32:35], v[200:203]
    ds_read_b64_tr_b16 v[26:27], v6 offset:51200
    v_mfma_f32_16x16x32_bf16 v[216:219], v[56:59], v[36:39], v[216:219]
    ds_read_b64_tr_b16 v[28:29], v7 offset:49152
    v_mfma_f32_16x16x32_bf16 v[232:235], v[56:59], v[40:43], v[232:235]
    ds_read_b64_tr_b16 v[30:31], v7 offset:51200
    v_mfma_f32_16x16x32_bf16 v[248:251], v[56:59], v[44:47], v[248:251]
    ds_read_b128 v[52:55], v8 offset:50176
    v_mfma_f32_16x16x32_bf16 v[204:207], v[60:63], v[32:35], v[204:207]
    ds_read_b128 v[56:59], v8 offset:51200
    v_mfma_f32_16x16x32_bf16 v[220:223], v[60:63], v[36:39], v[220:223]
    ds_read_b64_tr_b16 v[32:33], v4 offset:53248
    v_mfma_f32_16x16x32_bf16 v[236:239], v[60:63], v[40:43], v[236:239]
    ds_read_b64_tr_b16 v[34:35], v4 offset:55296
    v_mfma_f32_16x16x32_bf16 v[252:255], v[60:63], v[44:47], v[252:255]
    ds_read_b128 v[60:63], v8 offset:52224
    s_waitcnt lgkmcnt(11)
    v_mfma_f32_16x16x32_bf16 v[128:131], v[48:51], v[16:19], v[128:131]
    ds_read_b64_tr_b16 v[36:37], v5 offset:53248
    s_waitcnt lgkmcnt(10)
    v_mfma_f32_16x16x32_bf16 v[144:147], v[48:51], v[20:23], v[144:147]
    ds_read_b64_tr_b16 v[38:39], v5 offset:55296
    s_waitcnt lgkmcnt(9)
    v_mfma_f32_16x16x32_bf16 v[160:163], v[48:51], v[24:27], v[160:163]
    ds_read_b64_tr_b16 v[40:41], v6 offset:53248
    s_waitcnt lgkmcnt(8)
    v_mfma_f32_16x16x32_bf16 v[176:179], v[48:51], v[28:31], v[176:179]
    ds_read_b64_tr_b16 v[42:43], v6 offset:55296
    s_waitcnt lgkmcnt(8)
    v_mfma_f32_16x16x32_bf16 v[132:135], v[52:55], v[16:19], v[132:135]
    ds_read_b64_tr_b16 v[44:45], v7 offset:53248
    v_mfma_f32_16x16x32_bf16 v[148:151], v[52:55], v[20:23], v[148:151]
    ds_read_b64_tr_b16 v[46:47], v7 offset:55296
    v_mfma_f32_16x16x32_bf16 v[164:167], v[52:55], v[24:27], v[164:167]
    v_mfma_f32_16x16x32_bf16 v[180:183], v[52:55], v[28:31], v[180:183]
    s_waitcnt lgkmcnt(9)
    v_mfma_f32_16x16x32_bf16 v[136:139], v[56:59], v[16:19], v[136:139]
    v_mfma_f32_16x16x32_bf16 v[152:155], v[56:59], v[20:23], v[152:155]
    v_mfma_f32_16x16x32_bf16 v[168:171], v[56:59], v[24:27], v[168:171]
    v_mfma_f32_16x16x32_bf16 v[184:187], v[56:59], v[28:31], v[184:187]
    s_waitcnt lgkmcnt(6)
    v_mfma_f32_16x16x32_bf16 v[140:143], v[60:63], v[16:19], v[140:143]
    v_mfma_f32_16x16x32_bf16 v[156:159], v[60:63], v[20:23], v[156:159]
    v_mfma_f32_16x16x32_bf16 v[172:175], v[60:63], v[24:27], v[172:175]
    v_mfma_f32_16x16x32_bf16 v[188:191], v[60:63], v[28:31], v[188:191]
    v_mfma_f32_16x16x32_bf16 v[192:195], v[48:51], v[32:35], v[192:195]
    s_barrier
    s_waitcnt lgkmcnt(4)
    v_mfma_f32_16x16x32_bf16 v[208:211], v[48:51], v[36:39], v[208:211]
    ds_read_b64_tr_b16 v[16:17], v10 offset:0
    s_waitcnt lgkmcnt(3)
    v_mfma_f32_16x16x32_bf16 v[224:227], v[48:51], v[40:43], v[224:227]
    ds_read_b64_tr_b16 v[18:19], v10 offset:2048
    s_waitcnt lgkmcnt(2)
    v_mfma_f32_16x16x32_bf16 v[240:243], v[48:51], v[44:47], v[240:243]
    ds_read_b128 v[48:51], v9 offset:0
    v_mfma_f32_16x16x32_bf16 v[196:199], v[52:55], v[32:35], v[196:199]
    ds_read_b64_tr_b16 v[20:21], v11 offset:0
    v_mfma_f32_16x16x32_bf16 v[212:215], v[52:55], v[36:39], v[212:215]
    v_mfma_f32_16x16x32_bf16 v[228:231], v[52:55], v[40:43], v[228:231]
    ds_read_b64_tr_b16 v[22:23], v11 offset:2048
    v_mfma_f32_16x16x32_bf16 v[244:247], v[52:55], v[44:47], v[244:247]
    ds_read_b64_tr_b16 v[24:25], v12 offset:0
    v_mfma_f32_16x16x32_bf16 v[200:203], v[56:59], v[32:35], v[200:203]
    ds_read_b64_tr_b16 v[26:27], v12 offset:2048
    v_mfma_f32_16x16x32_bf16 v[216:219], v[56:59], v[36:39], v[216:219]
    ds_read_b64_tr_b16 v[28:29], v13 offset:0
    v_mfma_f32_16x16x32_bf16 v[232:235], v[56:59], v[40:43], v[232:235]
    ds_read_b64_tr_b16 v[30:31], v13 offset:2048
    v_mfma_f32_16x16x32_bf16 v[248:251], v[56:59], v[44:47], v[248:251]
    ds_read_b128 v[52:55], v9 offset:1024
    v_mfma_f32_16x16x32_bf16 v[204:207], v[60:63], v[32:35], v[204:207]
    ds_read_b128 v[56:59], v9 offset:2048
    v_mfma_f32_16x16x32_bf16 v[220:223], v[60:63], v[36:39], v[220:223]
    ds_read_b64_tr_b16 v[32:33], v10 offset:4096
    v_mfma_f32_16x16x32_bf16 v[236:239], v[60:63], v[40:43], v[236:239]
    ds_read_b64_tr_b16 v[34:35], v10 offset:6144
    v_mfma_f32_16x16x32_bf16 v[252:255], v[60:63], v[44:47], v[252:255]
    ds_read_b128 v[60:63], v9 offset:3072
    s_waitcnt lgkmcnt(11)
    v_mfma_f32_16x16x32_bf16 v[128:131], v[48:51], v[16:19], v[128:131]
    ds_read_b64_tr_b16 v[36:37], v11 offset:4096
    s_waitcnt lgkmcnt(10)
    v_mfma_f32_16x16x32_bf16 v[144:147], v[48:51], v[20:23], v[144:147]
    ds_read_b64_tr_b16 v[38:39], v11 offset:6144
    s_waitcnt lgkmcnt(9)
    v_mfma_f32_16x16x32_bf16 v[160:163], v[48:51], v[24:27], v[160:163]
    ds_read_b64_tr_b16 v[40:41], v12 offset:4096
    s_waitcnt lgkmcnt(8)
    v_mfma_f32_16x16x32_bf16 v[176:179], v[48:51], v[28:31], v[176:179]
    ds_read_b64_tr_b16 v[42:43], v12 offset:6144
    s_waitcnt lgkmcnt(8)
    v_mfma_f32_16x16x32_bf16 v[132:135], v[52:55], v[16:19], v[132:135]
    ds_read_b64_tr_b16 v[44:45], v13 offset:4096
    v_mfma_f32_16x16x32_bf16 v[148:151], v[52:55], v[20:23], v[148:151]
    ds_read_b64_tr_b16 v[46:47], v13 offset:6144
    v_mfma_f32_16x16x32_bf16 v[164:167], v[52:55], v[24:27], v[164:167]
    v_mfma_f32_16x16x32_bf16 v[180:183], v[52:55], v[28:31], v[180:183]
    s_waitcnt lgkmcnt(9)
    v_mfma_f32_16x16x32_bf16 v[136:139], v[56:59], v[16:19], v[136:139]
    v_mfma_f32_16x16x32_bf16 v[152:155], v[56:59], v[20:23], v[152:155]
    v_mfma_f32_16x16x32_bf16 v[168:171], v[56:59], v[24:27], v[168:171]
    v_mfma_f32_16x16x32_bf16 v[184:187], v[56:59], v[28:31], v[184:187]
    s_waitcnt lgkmcnt(6)
    v_mfma_f32_16x16x32_bf16 v[140:143], v[60:63], v[16:19], v[140:143]
    v_mfma_f32_16x16x32_bf16 v[156:159], v[60:63], v[20:23], v[156:159]
    v_mfma_f32_16x16x32_bf16 v[172:175], v[60:63], v[24:27], v[172:175]
    v_mfma_f32_16x16x32_bf16 v[188:191], v[60:63], v[28:31], v[188:191]
    v_mfma_f32_16x16x32_bf16 v[192:195], v[48:51], v[32:35], v[192:195]
    s_waitcnt lgkmcnt(4)
    v_mfma_f32_16x16x32_bf16 v[208:211], v[48:51], v[36:39], v[208:211]
    s_waitcnt lgkmcnt(2)
    v_mfma_f32_16x16x32_bf16 v[224:227], v[48:51], v[40:43], v[224:227]
    s_waitcnt lgkmcnt(0)
    v_mfma_f32_16x16x32_bf16 v[240:243], v[48:51], v[44:47], v[240:243]
    v_mfma_f32_16x16x32_bf16 v[196:199], v[52:55], v[32:35], v[196:199]
    v_mfma_f32_16x16x32_bf16 v[212:215], v[52:55], v[36:39], v[212:215]
    v_mfma_f32_16x16x32_bf16 v[228:231], v[52:55], v[40:43], v[228:231]
    v_mfma_f32_16x16x32_bf16 v[244:247], v[52:55], v[44:47], v[244:247]
    v_mfma_f32_16x16x32_bf16 v[200:203], v[56:59], v[32:35], v[200:203]
    v_mfma_f32_16x16x32_bf16 v[216:219], v[56:59], v[36:39], v[216:219]
    v_mfma_f32_16x16x32_bf16 v[232:235], v[56:59], v[40:43], v[232:235]
    v_mfma_f32_16x16x32_bf16 v[248:251], v[56:59], v[44:47], v[248:251]
    v_mfma_f32_16x16x32_bf16 v[204:207], v[60:63], v[32:35], v[204:207]
    v_mfma_f32_16x16x32_bf16 v[220:223], v[60:63], v[36:39], v[220:223]
    v_mfma_f32_16x16x32_bf16 v[236:239], v[60:63], v[40:43], v[236:239]
    v_mfma_f32_16x16x32_bf16 v[252:255], v[60:63], v[44:47], v[252:255]
    s_branch k3_cend
k3_cb:
    s_barrier
    s_barrier
    ds_read_b64_tr_b16 v[16:17], v4 offset:0
    ds_read_b64_tr_b16 v[18:19], v4 offset:2048
    ds_read_b128 v[48:51], v8 offset:0
    ds_read_b64_tr_b16 v[20:21], v5 offset:0
    ds_read_b64_tr_b16 v[22:23], v5 offset:2048
    ds_read_b64_tr_b16 v[24:25], v6 offset:0
    ds_read_b64_tr_b16 v[26:27], v6 offset:2048
    ds_read_b64_tr_b16 v[28:29], v7 offset:0
    ds_read_b64_tr_b16 v[30:31], v7 offset:2048
    ds_read_b128 v[52:55], v8 offset:1024
    ds_read_b128 v[56:59], v8 offset:2048
    ds_read_b128 v[60:63], v8 offset:3072
    ds_read_b64_tr_b16 v[32:33], v4 offset:4096
    ds_read_b64_tr_b16 v[34:35], v4 offset:6144
    ds_read_b64_tr_b16 v[36:37], v5 offset:4096
    ds_read_b64_tr_b16 v[38:39], v5 offset:6144
    ds_read_b64_tr_b16 v[40:41], v6 offset:4096
    ds_read_b64_tr_b16 v[42:43], v6 offset:6144
    ds_read_b64_tr_b16 v[44:45], v7 offset:4096
    ds_read_b64_tr_b16 v[46:47], v7 offset:6144
    s_waitcnt lgkmcnt(15)
    v_mfma_f32_16x16x32_bf16 v[128:131], v[48:51], v[16:19], 0
    v_mfma_f32_16x16x32_bf16 v[144:147], v[48:51], v[20:23], 0
    s_waitcnt lgkmcnt(13)
    v_mfma_f32_16x16x32_bf16 v[160:163], v[48:51], v[24:27], 0
    s_waitcnt lgkmcnt(11)
    v_mfma_f32_16x16x32_bf16 v[176:179], v[48:51], v[28:31], 0
    s_waitcnt lgkmcnt(10)
    v_mfma_f32_16x16x32_bf16 v[132:135], v[52:55], v[16:19], 0
    v_mfma_f32_16x16x32_bf16 v[148:151], v[52:55], v[20:23], 0
    v_mfma_f32_16x16x32_bf16 v[164:167], v[52:55], v[24:27], 0
    v_mfma_f32_16x16x32_bf16 v[180:183], v[52:55], v[28:31], 0
    s_waitcnt lgkmcnt(9)
    v_mfma_f32_16x16x32_bf16 v[136:139], v[56:59], v[16:19], 0
    v_mfma_f32_16x16x32_bf16 v[152:155], v[56:59], v[20:23], 0
    v_mfma_f32_16x16x32_bf16 v[168:171], v[56:59], v[24:27], 0
    v_mfma_f32_16x16x32_bf16 v[184:187], v[56:59], v[28:31], 0
    s_waitcnt lgkmcnt(8)
    v_mfma_f32_16x16x32_bf16 v[140:143], v[60:63], v[16:19], 0
    v_mfma_f32_16x16x32_bf16 v[156:159], v[60:63], v[20:23], 0
    v_mfma_f32_16x16x32_bf16 v[172:175], v[60:63], v[24:27], 0
    v_mfma_f32_16x16x32_bf16 v[188:191], v[60:63], v[28:31], 0
    s_waitcnt lgkmcnt(6)
    v_mfma_f32_16x16x32_bf16 v[192:195], v[48:51], v[32:35], 0
    s_barrier
    s_waitcnt lgkmcnt(4)
    v_mfma_f32_16x16x32_bf16 v[208:211], v[48:51], v[36:39], 0
    ds_read_b64_tr_b16 v[16:17], v4 offset:24576
    s_waitcnt lgkmcnt(3)
    v_mfma_f32_16x16x32_bf16 v[224:227], v[48:51], v[40:43], 0
    ds_read_b64_tr_b16 v[18:19], v4 offset:26624
    s_waitcnt lgkmcnt(2)
    v_mfma_f32_16x16x32_bf16 v[240:243], v[48:51], v[44:47], 0
    ds_read_b128 v[48:51], v8 offset:24576
    v_mfma_f32_16x16x32_bf16 v[196:199], v[52:55], v[32:35], 0
    ds_read_b64_tr_b16 v[20:21], v5 offset:24576
    v_mfma_f32_16x16x32_bf16 v[212:215], v[52:55], v[36:39], 0
    v_mfma_f32_16x16x32_bf16 v[228:231], v[52:55], v[40:43], 0
    ds_read_b64_tr_b16 v[22:23], v5 offset:26624
    v_mfma_f32_16x16x32_bf16 v[244:247], v[52:55], v[44:47], 0
    ds_read_b64_tr_b16 v[24:25], v6 offset:24576
    v_mfma_f32_16x16x32_bf16 v[200:203], v[56:59], v[32:35], 0
    ds_read_b64_tr_b16 v[26:27], v6 offset:26624
    v_mfma_f32_16x16x32_bf16 v[216:219], v[56:59], v[36:39], 0
    ds_read_b64_tr_b16 v[28:29], v7 offset:24576
    v_mfma_f32_16x16x32_bf16 v[232:235], v[56:59], v[40:43], 0
    ds_read_b64_tr_b16 v[30:31], v7 offset:26624
    v_mfma_f32_16x16x32_bf16 v[248:251], v[56:59], v[44:47], 0
    ds_read_b128 v[52:55], v8 offset:25600
    v_mfma_f32_16x16x32_bf16 v[204:207], v[60:63], v[32:35], 0
    ds_read_b128 v[56:59], v8 offset:26624
    v_mfma_f32_16x16x32_bf16 v[220:223], v[60:63], v[36:39], 0
    ds_read_b64_tr_b16 v[32:33], v4 offset:28672
    v_mfma_f32_16x16x32_bf16 v[236:239], v[60:63], v[40:43], 0
    ds_read_b64_tr_b16 v[34:35], v4 offset:30720
    v_mfma_f32_16x16x32_bf16 v[252:255], v[60:63], v[44:47], 0
    ds_read_b128 v[60:63], v8 offset:27648
    s_waitcnt lgkmcnt(11)
    v_mfma_f32_16x16x32_bf16 v[128:131], v[48:51], v[16:19], v[128:131]
    ds_read_b64_tr_b16 v[36:37], v5 offset:28672
    s_waitcnt lgkmcnt(10)
    v_mfma_f32_16x16x32_bf16 v[144:147], v[48:51], v[20:23], v[144:147]
    ds_read_b64_tr_b16 v[38:39], v5 offset:30720
    s_waitcnt lgkmcnt(9)
    v_mfma_f32_16x16x32_bf16 v[160:163], v[48:51], v[24:27], v[160:163]
    ds_read_b64_tr_b16 v[40:41], v6 offset:28672
    s_waitcnt lgkmcnt(8)
    v_mfma_f32_16x16x32_bf16 v[176:179], v[48:51], v[28:31], v[176:179]
    ds_read_b64_tr_b16 v[42:43], v6 offset:30720
    s_waitcnt lgkmcnt(8)
    v_mfma_f32_16x16x32_bf16 v[132:135], v[52:55], v[16:19], v[132:135]
    ds_read_b64_tr_b16 v[44:45], v7 offset:28672
    v_mfma_f32_16x16x32_bf16 v[148:151], v[52:55], v[20:23], v[148:151]
    ds_read_b64_tr_b16 v[46:47], v7 offset:30720
    v_mfma_f32_16x16x32_bf16 v[164:167], v[52:55], v[24:27], v[164:167]
    v_mfma_f32_16x16x32_bf16 v[180:183], v[52:55], v[28:31], v[180:183]
    s_waitcnt lgkmcnt(9)
    v_mfma_f32_16x16x32_bf16 v[136:139], v[56:59], v[16:19], v[136:139]
    v_mfma_f32_16x16x32_bf16 v[152:155], v[56:59], v[20:23], v[152:155]
    v_mfma_f32_16x16x32_bf16 v[168:171], v[56:59], v[24:27], v[168:171]
    v_mfma_f32_16x16x32_bf16 v[184:187], v[56:59], v[28:31], v[184:187]
    s_waitcnt lgkmcnt(6)
    v_mfma_f32_16x16x32_bf16 v[140:143], v[60:63], v[16:19], v[140:143]
    v_mfma_f32_16x16x32_bf16 v[156:159], v[60:63], v[20:23], v[156:159]
    v_mfma_f32_16x16x32_bf16 v[172:175], v[60:63], v[24:27], v[172:175]
    v_mfma_f32_16x16x32_bf16 v[188:191], v[60:63], v[28:31], v[188:191]
    v_mfma_f32_16x16x32_bf16 v[192:195], v[48:51], v[32:35], v[192:195]
    s_barrier
    s_waitcnt lgkmcnt(4)
    v_mfma_f32_16x16x32_bf16 v[208:211], v[48:51], v[36:39], v[208:211]
    ds_read_b64_tr_b16 v[16:17], v4 offset:49152
    s_waitcnt lgkmcnt(3)
    v_mfma_f32_16x16x32_bf16 v[224:227], v[48:51], v[40:43], v[224:227]
    ds_read_b64_tr_b16 v[18:19], v4 offset:51200
    s_waitcnt lgkmcnt(2)
    v_mfma_f32_16x16x32_bf16 v[240:243], v[48:51], v[44:47], v[240:243]
    ds_read_b128 v[48:51], v8 offset:49152
    v_mfma_f32_16x16x32_bf16 v[196:199], v[52:55], v[32:35], v[196:199]
    ds_read_b64_tr_b16 v[20:21], v5 offset:49152
    v_mfma_f32_16x16x32_bf16 v[212:215], v[52:55], v[36:39], v[212:215]
    v_mfma_f32_16x16x32_bf16 v[228:231], v[52:55], v[40:43], v[228:231]
    ds_read_b64_tr_b16 v[22:23], v5 offset:51200
    v_mfma_f32_16x16x32_bf16 v[244:247], v[52:55], v[44:47], v[244:247]
    ds_read_b64_tr_b16 v[24:25], v6 offset:49152
    v_mfma_f32_16x16x32_bf16 v[200:203], v[56:59], v[32:35], v[200:203]
    ds_read_b64_tr_b16 v[26:27], v6 offset:51200
    v_mfma_f32_16x16x32_bf16 v[216:219], v[56:59], v[36:39], v[216:219]
    ds_read_b64_tr_b16 v[28:29], v7 offset:49152
    v_mfma_f32_16x16x32_bf16 v[232:235], v[56:59], v[40:43], v[232:235]
    ds_read_b64_tr_b16 v[30:31], v7 offset:51200
    v_mfma_f32_16x16x32_bf16 v[248:251], v[56:59], v[44:47], v[248:251]
    ds_read_b128 v[52:55], v8 offset:50176
    v_mfma_f32_16x16x32_bf16 v[204:207], v[60:63], v[32:35], v[204:207]
    ds_read_b128 v[56:59], v8 offset:51200
    v_mfma_f32_16x16x32_bf16 v[220:223], v[60:63], v[36:39], v[220:223]
    ds_read_b64_tr_b16 v[32:33], v4 offset:53248
    v_mfma_f32_16x16x32_bf16 v[236:239], v[60:63], v[40:43], v[236:239]
    ds_read_b64_tr_b16 v[34:35], v4 offset:55296
    v_mfma_f32_16x16x32_bf16 v[252:255], v[60:63], v[44:47], v[252:255]
    ds_read_b128 v[60:63], v8 offset:52224
    s_waitcnt lgkmcnt(11)
    v_mfma_f32_16x16x32_bf16 v[128:131], v[48:51], v[16:19], v[128:131]
    ds_read_b64_tr_b16 v[36:37], v5 offset:53248
    s_waitcnt lgkmcnt(10)
    v_mfma_f32_16x16x32_bf16 v[144:147], v[48:51], v[20:23], v[144:147]
    ds_read_b64_tr_b16 v[38:39], v5 offset:55296
    s_waitcnt lgkmcnt(9)
    v_mfma_f32_16x16x32_bf16 v[160:163], v[48:51], v[24:27], v[160:163]
    ds_read_b64_tr_b16 v[40:41], v6 offset:53248
    s_waitcnt lgkmcnt(8)
    v_mfma_f32_16x16x32_bf16 v[176:179], v[48:51], v[28:31], v[176:179]
    ds_read_b64_tr_b16 v[42:43], v6 offset:55296
    s_waitcnt lgkmcnt(8)
    v_mfma_f32_16x16x32_bf16 v[132:135], v[52:55], v[16:19], v[132:135]
    ds_read_b64_tr_b16 v[44:45], v7 offset:53248
    v_mfma_f32_16x16x32_bf16 v[148:151], v[52:55], v[20:23], v[148:151]
    ds_read_b64_tr_b16 v[46:47], v7 offset:55296
    v_mfma_f32_16x16x32_bf16 v[164:167], v[52:55], v[24:27], v[164:167]
    v_mfma_f32_16x16x32_bf16 v[180:183], v[52:55], v[28:31], v[180:183]
    s_waitcnt lgkmcnt(9)
    v_mfma_f32_16x16x32_bf16 v[136:139], v[56:59], v[16:19], v[136:139]
    v_mfma_f32_16x16x32_bf16 v[152:155], v[56:59], v[20:23], v[152:155]
    v_mfma_f32_16x16x32_bf16 v[168:171], v[56:59], v[24:27], v[168:171]
    v_mfma_f32_16x16x32_bf16 v[184:187], v[56:59], v[28:31], v[184:187]
    s_waitcnt lgkmcnt(6)
    v_mfma_f32_16x16x32_bf16 v[140:143], v[60:63], v[16:19], v[140:143]
    v_mfma_f32_16x16x32_bf16 v[156:159], v[60:63], v[20:23], v[156:159]
    v_mfma_f32_16x16x32_bf16 v[172:175], v[60:63], v[24:27], v[172:175]
    v_mfma_f32_16x16x32_bf16 v[188:191], v[60:63], v[28:31], v[188:191]
    v_mfma_f32_16x16x32_bf16 v[192:195], v[48:51], v[32:35], v[192:195]
    s_barrier
    s_waitcnt lgkmcnt(4)
    v_mfma_f32_16x16x32_bf16 v[208:211], v[48:51], v[36:39], v[208:211]
    ds_read_b64_tr_b16 v[16:17], v10 offset:0
    s_waitcnt lgkmcnt(3)
    v_mfma_f32_16x16x32_bf16 v[224:227], v[48:51], v[40:43], v[224:227]
    ds_read_b64_tr_b16 v[18:19], v10 offset:2048
    s_waitcnt lgkmcnt(2)
    v_mfma_f32_16x16x32_bf16 v[240:243], v[48:51], v[44:47], v[240:243]
    ds_read_b128 v[48:51], v9 offset:0
    v_mfma_f32_16x16x32_bf16 v[196:199], v[52:55], v[32:35], v[196:199]
    ds_read_b64_tr_b16 v[20:21], v11 offset:0
    v_mfma_f32_16x16x32_bf16 v[212:215], v[52:55], v[36:39], v[212:215]
    v_mfma_f32_16x16x32_bf16 v[228:231], v[52:55], v[40:43], v[228:231]
    ds_read_b64_tr_b16 v[22:23], v11 offset:2048
    v_mfma_f32_16x16x32_bf16 v[244:247], v[52:55], v[44:47], v[244:247]
    ds_read_b64_tr_b16 v[24:25], v12 offset:0
    v_mfma_f32_16x16x32_bf16 v[200:203], v[56:59], v[32:35], v[200:203]
    ds_read_b64_tr_b16 v[26:27], v12 offset:2048
    v_mfma_f32_16x16x32_bf16 v[216:219], v[56:59], v[36:39], v[216:219]
    ds_read_b64_tr_b16 v[28:29], v13 offset:0
    v_mfma_f32_16x16x32_bf16 v[232:235], v[56:59], v[40:43], v[232:235]
    ds_read_b64_tr_b16 v[30:31], v13 offset:2048
    v_mfma_f32_16x16x32_bf16 v[248:251], v[56:59], v[44:47], v[248:251]
    ds_read_b128 v[52:55], v9 offset:1024
    v_mfma_f32_16x16x32_bf16 v[204:207], v[60:63], v[32:35], v[204:207]
    ds_read_b128 v[56:59], v9 offset:2048
    v_mfma_f32_16x16x32_bf16 v[220:223], v[60:63], v[36:39], v[220:223]
    ds_read_b64_tr_b16 v[32:33], v10 offset:4096
    v_mfma_f32_16x16x32_bf16 v[236:239], v[60:63], v[40:43], v[236:239]
    ds_read_b64_tr_b16 v[34:35], v10 offset:6144
    v_mfma_f32_16x16x32_bf16 v[252:255], v[60:63], v[44:47], v[252:255]
    ds_read_b128 v[60:63], v9 offset:3072
    s_waitcnt lgkmcnt(11)
    v_mfma_f32_16x16x32_bf16 v[128:131], v[48:51], v[16:19], v[128:131]
    ds_read_b64_tr_b16 v[36:37], v11 offset:4096
    s_waitcnt lgkmcnt(10)
    v_mfma_f32_16x16x32_bf16 v[144:147], v[48:51], v[20:23], v[144:147]
    ds_read_b64_tr_b16 v[38:39], v11 offset:6144
    s_waitcnt lgkmcnt(9)
    v_mfma_f32_16x16x32_bf16 v[160:163], v[48:51], v[24:27], v[160:163]
    ds_read_b64_tr_b16 v[40:41], v12 offset:4096
    s_waitcnt lgkmcnt(8)
    v_mfma_f32_16x16x32_bf16 v[176:179], v[48:51], v[28:31], v[176:179]
    ds_read_b64_tr_b16 v[42:43], v12 offset:6144
    s_waitcnt lgkmcnt(8)
    v_mfma_f32_16x16x32_bf16 v[132:135], v[52:55], v[16:19], v[132:135]
    ds_read_b64_tr_b16 v[44:45], v13 offset:4096
    v_mfma_f32_16x16x32_bf16 v[148:151], v[52:55], v[20:23], v[148:151]
    ds_read_b64_tr_b16 v[46:47], v13 offset:6144
    v_mfma_f32_16x16x32_bf16 v[164:167], v[52:55], v[24:27], v[164:167]
    v_mfma_f32_16x16x32_bf16 v[180:183], v[52:55], v[28:31], v[180:183]
    s_waitcnt lgkmcnt(9)
    v_mfma_f32_16x16x32_bf16 v[136:139], v[56:59], v[16:19], v[136:139]
    v_mfma_f32_16x16x32_bf16 v[152:155], v[56:59], v[20:23], v[152:155]
    v_mfma_f32_16x16x32_bf16 v[168:171], v[56:59], v[24:27], v[168:171]
    v_mfma_f32_16x16x32_bf16 v[184:187], v[56:59], v[28:31], v[184:187]
    s_waitcnt lgkmcnt(6)
    v_mfma_f32_16x16x32_bf16 v[140:143], v[60:63], v[16:19], v[140:143]
    v_mfma_f32_16x16x32_bf16 v[156:159], v[60:63], v[20:23], v[156:159]
    v_mfma_f32_16x16x32_bf16 v[172:175], v[60:63], v[24:27], v[172:175]
    v_mfma_f32_16x16x32_bf16 v[188:191], v[60:63], v[28:31], v[188:191]
    v_mfma_f32_16x16x32_bf16 v[192:195], v[48:51], v[32:35], v[192:195]
    s_barrier
    s_waitcnt lgkmcnt(4)
    v_mfma_f32_16x16x32_bf16 v[208:211], v[48:51], v[36:39], v[208:211]
    ds_read_b64_tr_b16 v[16:17], v10 offset:24576
    s_waitcnt lgkmcnt(3)
    v_mfma_f32_16x16x32_bf16 v[224:227], v[48:51], v[40:43], v[224:227]
    ds_read_b64_tr_b16 v[18:19], v10 offset:26624
    s_waitcnt lgkmcnt(2)
    v_mfma_f32_16x16x32_bf16 v[240:243], v[48:51], v[44:47], v[240:243]
    ds_read_b128 v[48:51], v9 offset:24576
    v_mfma_f32_16x16x32_bf16 v[196:199], v[52:55], v[32:35], v[196:199]
    ds_read_b64_tr_b16 v[20:21], v11 offset:24576
    v_mfma_f32_16x16x32_bf16 v[212:215], v[52:55], v[36:39], v[212:215]
    v_mfma_f32_16x16x32_bf16 v[228:231], v[52:55], v[40:43], v[228:231]
    ds_read_b64_tr_b16 v[22:23], v11 offset:26624
    v_mfma_f32_16x16x32_bf16 v[244:247], v[52:55], v[44:47], v[244:247]
    ds_read_b64_tr_b16 v[24:25], v12 offset:24576
    v_mfma_f32_16x16x32_bf16 v[200:203], v[56:59], v[32:35], v[200:203]
    ds_read_b64_tr_b16 v[26:27], v12 offset:26624
    v_mfma_f32_16x16x32_bf16 v[216:219], v[56:59], v[36:39], v[216:219]
    ds_read_b64_tr_b16 v[28:29], v13 offset:24576
    v_mfma_f32_16x16x32_bf16 v[232:235], v[56:59], v[40:43], v[232:235]
    ds_read_b64_tr_b16 v[30:31], v13 offset:26624
    v_mfma_f32_16x16x32_bf16 v[248:251], v[56:59], v[44:47], v[248:251]
    ds_read_b128 v[52:55], v9 offset:25600
    v_mfma_f32_16x16x32_bf16 v[204:207], v[60:63], v[32:35], v[204:207]
    ds_read_b128 v[56:59], v9 offset:26624
    v_mfma_f32_16x16x32_bf16 v[220:223], v[60:63], v[36:39], v[220:223]
    ds_read_b64_tr_b16 v[32:33], v10 offset:28672
    v_mfma_f32_16x16x32_bf16 v[236:239], v[60:63], v[40:43], v[236:239]
    ds_read_b64_tr_b16 v[34:35], v10 offset:30720
    v_mfma_f32_16x16x32_bf16 v[252:255], v[60:63], v[44:47], v[252:255]
    ds_read_b128 v[60:63], v9 offset:27648
    s_waitcnt lgkmcnt(11)
    v_mfma_f32_16x16x32_bf16 v[128:131], v[48:51], v[16:19], v[128:131]
    ds_read_b64_tr_b16 v[36:37], v11 offset:28672
    s_waitcnt lgkmcnt(10)
    v_mfma_f32_16x16x32_bf16 v[144:147], v[48:51], v[20:23], v[144:147]
    ds_read_b64_tr_b16 v[38:39], v11 offset:30720
    s_waitcnt lgkmcnt(9)
    v_mfma_f32_16x16x32_bf16 v[160:163], v[48:51], v[24:27], v[160:163]
    ds_read_b64_tr_b16 v[40:41], v12 offset:28672
    s_waitcnt lgkmcnt(8)
    v_mfma_f32_16x16x32_bf16 v[176:179], v[48:51], v[28:31], v[176:179]
    ds_read_b64_tr_b16 v[42:43], v12 offset:30720
    s_waitcnt lgkmcnt(8)
    v_mfma_f32_16x16x32_bf16 v[132:135], v[52:55], v[16:19], v[132:135]
    ds_read_b64_tr_b16 v[44:45], v13 offset:28672
    v_mfma_f32_16x16x32_bf16 v[148:151], v[52:55], v[20:23], v[148:151]
    ds_read_b64_tr_b16 v[46:47], v13 offset:30720
    v_mfma_f32_16x16x32_bf16 v[164:167], v[52:55], v[24:27], v[164:167]
    v_mfma_f32_16x16x32_bf16 v[180:183], v[52:55], v[28:31], v[180:183]
    s_waitcnt lgkmcnt(9)
    v_mfma_f32_16x16x32_bf16 v[136:139], v[56:59], v[16:19], v[136:139]
    v_mfma_f32_16x16x32_bf16 v[152:155], v[56:59], v[20:23], v[152:155]
    v_mfma_f32_16x16x32_bf16 v[168:171], v[56:59], v[24:27], v[168:171]
    v_mfma_f32_16x16x32_bf16 v[184:187], v[56:59], v[28:31], v[184:187]
    s_waitcnt lgkmcnt(6)
    v_mfma_f32_16x16x32_bf16 v[140:143], v[60:63], v[16:19], v[140:143]
    v_mfma_f32_16x16x32_bf16 v[156:159], v[60:63], v[20:23], v[156:159]
    v_mfma_f32_16x16x32_bf16 v[172:175], v[60:63], v[24:27], v[172:175]
    v_mfma_f32_16x16x32_bf16 v[188:191], v[60:63], v[28:31], v[188:191]
    v_mfma_f32_16x16x32_bf16 v[192:195], v[48:51], v[32:35], v[192:195]
    s_barrier
    s_waitcnt lgkmcnt(4)
    v_mfma_f32_16x16x32_bf16 v[208:211], v[48:51], v[36:39], v[208:211]
    ds_read_b64_tr_b16 v[16:17], v10 offset:49152
    s_waitcnt lgkmcnt(3)
    v_mfma_f32_16x16x32_bf16 v[224:227], v[48:51], v[40:43], v[224:227]
    ds_read_b64_tr_b16 v[18:19], v10 offset:51200
    s_waitcnt lgkmcnt(2)
    v_mfma_f32_16x16x32_bf16 v[240:243], v[48:51], v[44:47], v[240:243]
    ds_read_b128 v[48:51], v9 offset:49152
    v_mfma_f32_16x16x32_bf16 v[196:199], v[52:55], v[32:35], v[196:199]
    ds_read_b64_tr_b16 v[20:21], v11 offset:49152
    v_mfma_f32_16x16x32_bf16 v[212:215], v[52:55], v[36:39], v[212:215]
    v_mfma_f32_16x16x32_bf16 v[228:231], v[52:55], v[40:43], v[228:231]
    ds_read_b64_tr_b16 v[22:23], v11 offset:51200
    v_mfma_f32_16x16x32_bf16 v[244:247], v[52:55], v[44:47], v[244:247]
    ds_read_b64_tr_b16 v[24:25], v12 offset:49152
    v_mfma_f32_16x16x32_bf16 v[200:203], v[56:59], v[32:35], v[200:203]
    ds_read_b64_tr_b16 v[26:27], v12 offset:51200
    v_mfma_f32_16x16x32_bf16 v[216:219], v[56:59], v[36:39], v[216:219]
    ds_read_b64_tr_b16 v[28:29], v13 offset:49152
    v_mfma_f32_16x16x32_bf16 v[232:235], v[56:59], v[40:43], v[232:235]
    ds_read_b64_tr_b16 v[30:31], v13 offset:51200
    v_mfma_f32_16x16x32_bf16 v[248:251], v[56:59], v[44:47], v[248:251]
    ds_read_b128 v[52:55], v9 offset:50176
    v_mfma_f32_16x16x32_bf16 v[204:207], v[60:63], v[32:35], v[204:207]
    ds_read_b128 v[56:59], v9 offset:51200
    v_mfma_f32_16x16x32_bf16 v[220:223], v[60:63], v[36:39], v[220:223]
    ds_read_b64_tr_b16 v[32:33], v10 offset:53248
    v_mfma_f32_16x16x32_bf16 v[236:239], v[60:63], v[40:43], v[236:239]
    ds_read_b64_tr_b16 v[34:35], v10 offset:55296
    v_mfma_f32_16x16x32_bf16 v[252:255], v[60:63], v[44:47], v[252:255]
    ds_read_b128 v[60:63], v9 offset:52224
    s_waitcnt lgkmcnt(11)
    v_mfma_f32_16x16x32_bf16 v[128:131], v[48:51], v[16:19], v[128:131]
    ds_read_b64_tr_b16 v[36:37], v11 offset:53248
    s_waitcnt lgkmcnt(10)
    v_mfma_f32_16x16x32_bf16 v[144:147], v[48:51], v[20:23], v[144:147]
    ds_read_b64_tr_b16 v[38:39], v11 offset:55296
    s_waitcnt lgkmcnt(9)
    v_mfma_f32_16x16x32_bf16 v[160:163], v[48:51], v[24:27], v[160:163]
    ds_read_b64_tr_b16 v[40:41], v12 offset:53248
    s_waitcnt lgkmcnt(8)
    v_mfma_f32_16x16x32_bf16 v[176:179], v[48:51], v[28:31], v[176:179]
    ds_read_b64_tr_b16 v[42:43], v12 offset:55296
    s_waitcnt lgkmcnt(8)
    v_mfma_f32_16x16x32_bf16 v[132:135], v[52:55], v[16:19], v[132:135]
    ds_read_b64_tr_b16 v[44:45], v13 offset:53248
    v_mfma_f32_16x16x32_bf16 v[148:151], v[52:55], v[20:23], v[148:151]
    ds_read_b64_tr_b16 v[46:47], v13 offset:55296
    v_mfma_f32_16x16x32_bf16 v[164:167], v[52:55], v[24:27], v[164:167]
    v_mfma_f32_16x16x32_bf16 v[180:183], v[52:55], v[28:31], v[180:183]
    s_waitcnt lgkmcnt(9)
    v_mfma_f32_16x16x32_bf16 v[136:139], v[56:59], v[16:19], v[136:139]
    v_mfma_f32_16x16x32_bf16 v[152:155], v[56:59], v[20:23], v[152:155]
    v_mfma_f32_16x16x32_bf16 v[168:171], v[56:59], v[24:27], v[168:171]
    v_mfma_f32_16x16x32_bf16 v[184:187], v[56:59], v[28:31], v[184:187]
    s_waitcnt lgkmcnt(6)
    v_mfma_f32_16x16x32_bf16 v[140:143], v[60:63], v[16:19], v[140:143]
    v_mfma_f32_16x16x32_bf16 v[156:159], v[60:63], v[20:23], v[156:159]
    v_mfma_f32_16x16x32_bf16 v[172:175], v[60:63], v[24:27], v[172:175]
    v_mfma_f32_16x16x32_bf16 v[188:191], v[60:63], v[28:31], v[188:191]
    v_mfma_f32_16x16x32_bf16 v[192:195], v[48:51], v[32:35], v[192:195]
    s_barrier
    s_waitcnt lgkmcnt(4)
    v_mfma_f32_16x16x32_bf16 v[208:211], v[48:51], v[36:39], v[208:211]
    ds_read_b64_tr_b16 v[16:17], v4 offset:0
    s_waitcnt lgkmcnt(3)
    v_mfma_f32_16x16x32_bf16 v[224:227], v[48:51], v[40:43], v[224:227]
    ds_read_b64_tr_b16 v[18:19], v4 offset:2048
    s_waitcnt lgkmcnt(2)
    v_mfma_f32_16x16x32_bf16 v[240:243], v[48:51], v[44:47], v[240:243]
    ds_read_b128 v[48:51], v8 offset:0
    v_mfma_f32_16x16x32_bf16 v[196:199], v[52:55], v[32:35], v[196:199]
    ds_read_b64_tr_b16 v[20:21], v5 offset:0
    v_mfma_f32_16x16x32_bf16 v[212:215], v[52:55], v[36:39], v[212:215]
    v_mfma_f32_16x16x32_bf16 v[228:231], v[52:55], v[40:43], v[228:231]
    ds_read_b64_tr_b16 v[22:23], v5 offset:2048
    v_mfma_f32_16x16x32_bf16 v[244:247], v[52:55], v[44:47], v[244:247]
    ds_read_b64_tr_b16 v[24:25], v6 offset:0
    v_mfma_f32_16x16x32_bf16 v[200:203], v[56:59], v[32:35], v[200:203]
    ds_read_b64_tr_b16 v[26:27], v6 offset:2048
    v_mfma_f32_16x16x32_bf16 v[216:219], v[56:59], v[36:39], v[216:219]
    ds_read_b64_tr_b16 v[28:29], v7 offset:0
    v_mfma_f32_16x16x32_bf16 v[232:235], v[56:59], v[40:43], v[232:235]
    ds_read_b64_tr_b16 v[30:31], v7 offset:2048
    v_mfma_f32_16x16x32_bf16 v[248:251], v[56:59], v[44:47], v[248:251]
    ds_read_b128 v[52:55], v8 offset:1024
    v_mfma_f32_16x16x32_bf16 v[204:207], v[60:63], v[32:35], v[204:207]
    ds_read_b128 v[56:59], v8 offset:2048
    v_mfma_f32_16x16x32_bf16 v[220:223], v[60:63], v[36:39], v[220:223]
    ds_read_b64_tr_b16 v[32:33], v4 offset:4096
    v_mfma_f32_16x16x32_bf16 v[236:239], v[60:63], v[40:43], v[236:239]
    ds_read_b64_tr_b16 v[34:35], v4 offset:6144
    v_mfma_f32_16x16x32_bf16 v[252:255], v[60:63], v[44:47], v[252:255]
    ds_read_b128 v[60:63], v8 offset:3072
    s_waitcnt lgkmcnt(11)
    v_mfma_f32_16x16x32_bf16 v[128:131], v[48:51], v[16:19], v[128:131]
    ds_read_b64_tr_b16 v[36:37], v5 offset:4096
    s_waitcnt lgkmcnt(10)
    v_mfma_f32_16x16x32_bf16 v[144:147], v[48:51], v[20:23], v[144:147]
    ds_read_b64_tr_b16 v[38:39], v5 offset:6144
    s_waitcnt lgkmcnt(9)
    v_mfma_f32_16x16x32_bf16 v[160:163], v[48:51], v[24:27], v[160:163]
    ds_read_b64_tr_b16 v[40:41], v6 offset:4096
    s_waitcnt lgkmcnt(8)
    v_mfma_f32_16x16x32_bf16 v[176:179], v[48:51], v[28:31], v[176:179]
    ds_read_b64_tr_b16 v[42:43], v6 offset:6144
    s_waitcnt lgkmcnt(8)
    v_mfma_f32_16x16x32_bf16 v[132:135], v[52:55], v[16:19], v[132:135]
    ds_read_b64_tr_b16 v[44:45], v7 offset:4096
    v_mfma_f32_16x16x32_bf16 v[148:151], v[52:55], v[20:23], v[148:151]
    ds_read_b64_tr_b16 v[46:47], v7 offset:6144
    v_mfma_f32_16x16x32_bf16 v[164:167], v[52:55], v[24:27], v[164:167]
    v_mfma_f32_16x16x32_bf16 v[180:183], v[52:55], v[28:31], v[180:183]
    s_waitcnt lgkmcnt(9)
    v_mfma_f32_16x16x32_bf16 v[136:139], v[56:59], v[16:19], v[136:139]
    v_mfma_f32_16x16x32_bf16 v[152:155], v[56:59], v[20:23], v[152:155]
    v_mfma_f32_16x16x32_bf16 v[168:171], v[56:59], v[24:27], v[168:171]
    v_mfma_f32_16x16x32_bf16 v[184:187], v[56:59], v[28:31], v[184:187]
    s_waitcnt lgkmcnt(6)
    v_mfma_f32_16x16x32_bf16 v[140:143], v[60:63], v[16:19], v[140:143]
    v_mfma_f32_16x16x32_bf16 v[156:159], v[60:63], v[20:23], v[156:159]
    v_mfma_f32_16x16x32_bf16 v[172:175], v[60:63], v[24:27], v[172:175]
    v_mfma_f32_16x16x32_bf16 v[188:191], v[60:63], v[28:31], v[188:191]
    v_mfma_f32_16x16x32_bf16 v[192:195], v[48:51], v[32:35], v[192:195]
    s_barrier
    s_waitcnt lgkmcnt(4)
    v_mfma_f32_16x16x32_bf16 v[208:211], v[48:51], v[36:39], v[208:211]
    ds_read_b64_tr_b16 v[16:17], v4 offset:24576
    s_waitcnt lgkmcnt(3)
    v_mfma_f32_16x16x32_bf16 v[224:227], v[48:51], v[40:43], v[224:227]
    ds_read_b64_tr_b16 v[18:19], v4 offset:26624
    s_waitcnt lgkmcnt(2)
    v_mfma_f32_16x16x32_bf16 v[240:243], v[48:51], v[44:47], v[240:243]
    ds_read_b128 v[48:51], v8 offset:24576
    v_mfma_f32_16x16x32_bf16 v[196:199], v[52:55], v[32:35], v[196:199]
    ds_read_b64_tr_b16 v[20:21], v5 offset:24576
    v_mfma_f32_16x16x32_bf16 v[212:215], v[52:55], v[36:39], v[212:215]
    v_mfma_f32_16x16x32_bf16 v[228:231], v[52:55], v[40:43], v[228:231]
    ds_read_b64_tr_b16 v[22:23], v5 offset:26624
    v_mfma_f32_16x16x32_bf16 v[244:247], v[52:55], v[44:47], v[244:247]
    ds_read_b64_tr_b16 v[24:25], v6 offset:24576
    v_mfma_f32_16x16x32_bf16 v[200:203], v[56:59], v[32:35], v[200:203]
    ds_read_b64_tr_b16 v[26:27], v6 offset:26624
    v_mfma_f32_16x16x32_bf16 v[216:219], v[56:59], v[36:39], v[216:219]
    ds_read_b64_tr_b16 v[28:29], v7 offset:24576
    v_mfma_f32_16x16x32_bf16 v[232:235], v[56:59], v[40:43], v[232:235]
    ds_read_b64_tr_b16 v[30:31], v7 offset:26624
    v_mfma_f32_16x16x32_bf16 v[248:251], v[56:59], v[44:47], v[248:251]
    ds_read_b128 v[52:55], v8 offset:25600
    v_mfma_f32_16x16x32_bf16 v[204:207], v[60:63], v[32:35], v[204:207]
    ds_read_b128 v[56:59], v8 offset:26624
    v_mfma_f32_16x16x32_bf16 v[220:223], v[60:63], v[36:39], v[220:223]
    ds_read_b64_tr_b16 v[32:33], v4 offset:28672
    v_mfma_f32_16x16x32_bf16 v[236:239], v[60:63], v[40:43], v[236:239]
    ds_read_b64_tr_b16 v[34:35], v4 offset:30720
    v_mfma_f32_16x16x32_bf16 v[252:255], v[60:63], v[44:47], v[252:255]
    ds_read_b128 v[60:63], v8 offset:27648
    s_waitcnt lgkmcnt(11)
    v_mfma_f32_16x16x32_bf16 v[128:131], v[48:51], v[16:19], v[128:131]
    ds_read_b64_tr_b16 v[36:37], v5 offset:28672
    s_waitcnt lgkmcnt(10)
    v_mfma_f32_16x16x32_bf16 v[144:147], v[48:51], v[20:23], v[144:147]
    ds_read_b64_tr_b16 v[38:39], v5 offset:30720
    s_waitcnt lgkmcnt(9)
    v_mfma_f32_16x16x32_bf16 v[160:163], v[48:51], v[24:27], v[160:163]
    ds_read_b64_tr_b16 v[40:41], v6 offset:28672
    s_waitcnt lgkmcnt(8)
    v_mfma_f32_16x16x32_bf16 v[176:179], v[48:51], v[28:31], v[176:179]
    ds_read_b64_tr_b16 v[42:43], v6 offset:30720
    s_waitcnt lgkmcnt(8)
    v_mfma_f32_16x16x32_bf16 v[132:135], v[52:55], v[16:19], v[132:135]
    ds_read_b64_tr_b16 v[44:45], v7 offset:28672
    v_mfma_f32_16x16x32_bf16 v[148:151], v[52:55], v[20:23], v[148:151]
    ds_read_b64_tr_b16 v[46:47], v7 offset:30720
    v_mfma_f32_16x16x32_bf16 v[164:167], v[52:55], v[24:27], v[164:167]
    v_mfma_f32_16x16x32_bf16 v[180:183], v[52:55], v[28:31], v[180:183]
    s_waitcnt lgkmcnt(9)
    v_mfma_f32_16x16x32_bf16 v[136:139], v[56:59], v[16:19], v[136:139]
    v_mfma_f32_16x16x32_bf16 v[152:155], v[56:59], v[20:23], v[152:155]
    v_mfma_f32_16x16x32_bf16 v[168:171], v[56:59], v[24:27], v[168:171]
    v_mfma_f32_16x16x32_bf16 v[184:187], v[56:59], v[28:31], v[184:187]
    s_waitcnt lgkmcnt(6)
    v_mfma_f32_16x16x32_bf16 v[140:143], v[60:63], v[16:19], v[140:143]
    v_mfma_f32_16x16x32_bf16 v[156:159], v[60:63], v[20:23], v[156:159]
    v_mfma_f32_16x16x32_bf16 v[172:175], v[60:63], v[24:27], v[172:175]
    v_mfma_f32_16x16x32_bf16 v[188:191], v[60:63], v[28:31], v[188:191]
    v_mfma_f32_16x16x32_bf16 v[192:195], v[48:51], v[32:35], v[192:195]
    s_barrier
    s_waitcnt lgkmcnt(4)
    v_mfma_f32_16x16x32_bf16 v[208:211], v[48:51], v[36:39], v[208:211]
    ds_read_b64_tr_b16 v[16:17], v4 offset:49152
    s_waitcnt lgkmcnt(3)
    v_mfma_f32_16x16x32_bf16 v[224:227], v[48:51], v[40:43], v[224:227]
    ds_read_b64_tr_b16 v[18:19], v4 offset:51200
    s_waitcnt lgkmcnt(2)
    v_mfma_f32_16x16x32_bf16 v[240:243], v[48:51], v[44:47], v[240:243]
    ds_read_b128 v[48:51], v8 offset:49152
    v_mfma_f32_16x16x32_bf16 v[196:199], v[52:55], v[32:35], v[196:199]
    ds_read_b64_tr_b16 v[20:21], v5 offset:49152
    v_mfma_f32_16x16x32_bf16 v[212:215], v[52:55], v[36:39], v[212:215]
    v_mfma_f32_16x16x32_bf16 v[228:231], v[52:55], v[40:43], v[228:231]
    ds_read_b64_tr_b16 v[22:23], v5 offset:51200
    v_mfma_f32_16x16x32_bf16 v[244:247], v[52:55], v[44:47], v[244:247]
    ds_read_b64_tr_b16 v[24:25], v6 offset:49152
    v_mfma_f32_16x16x32_bf16 v[200:203], v[56:59], v[32:35], v[200:203]
    ds_read_b64_tr_b16 v[26:27], v6 offset:51200
    v_mfma_f32_16x16x32_bf16 v[216:219], v[56:59], v[36:39], v[216:219]
    ds_read_b64_tr_b16 v[28:29], v7 offset:49152
    v_mfma_f32_16x16x32_bf16 v[232:235], v[56:59], v[40:43], v[232:235]
    ds_read_b64_tr_b16 v[30:31], v7 offset:51200
    v_mfma_f32_16x16x32_bf16 v[248:251], v[56:59], v[44:47], v[248:251]
    ds_read_b128 v[52:55], v8 offset:50176
    v_mfma_f32_16x16x32_bf16 v[204:207], v[60:63], v[32:35], v[204:207]
    ds_read_b128 v[56:59], v8 offset:51200
    v_mfma_f32_16x16x32_bf16 v[220:223], v[60:63], v[36:39], v[220:223]
    ds_read_b64_tr_b16 v[32:33], v4 offset:53248
    v_mfma_f32_16x16x32_bf16 v[236:239], v[60:63], v[40:43], v[236:239]
    ds_read_b64_tr_b16 v[34:35], v4 offset:55296
    v_mfma_f32_16x16x32_bf16 v[252:255], v[60:63], v[44:47], v[252:255]
    ds_read_b128 v[60:63], v8 offset:52224
    s_waitcnt lgkmcnt(11)
    v_mfma_f32_16x16x32_bf16 v[128:131], v[48:51], v[16:19], v[128:131]
    ds_read_b64_tr_b16 v[36:37], v5 offset:53248
    s_waitcnt lgkmcnt(10)
    v_mfma_f32_16x16x32_bf16 v[144:147], v[48:51], v[20:23], v[144:147]
    ds_read_b64_tr_b16 v[38:39], v5 offset:55296
    s_waitcnt lgkmcnt(9)
    v_mfma_f32_16x16x32_bf16 v[160:163], v[48:51], v[24:27], v[160:163]
    ds_read_b64_tr_b16 v[40:41], v6 offset:53248
    s_waitcnt lgkmcnt(8)
    v_mfma_f32_16x16x32_bf16 v[176:179], v[48:51], v[28:31], v[176:179]
    ds_read_b64_tr_b16 v[42:43], v6 offset:55296
    s_waitcnt lgkmcnt(8)
    v_mfma_f32_16x16x32_bf16 v[132:135], v[52:55], v[16:19], v[132:135]
    ds_read_b64_tr_b16 v[44:45], v7 offset:53248
    v_mfma_f32_16x16x32_bf16 v[148:151], v[52:55], v[20:23], v[148:151]
    ds_read_b64_tr_b16 v[46:47], v7 offset:55296
    v_mfma_f32_16x16x32_bf16 v[164:167], v[52:55], v[24:27], v[164:167]
    v_mfma_f32_16x16x32_bf16 v[180:183], v[52:55], v[28:31], v[180:183]
    s_waitcnt lgkmcnt(9)
    v_mfma_f32_16x16x32_bf16 v[136:139], v[56:59], v[16:19], v[136:139]
    v_mfma_f32_16x16x32_bf16 v[152:155], v[56:59], v[20:23], v[152:155]
    v_mfma_f32_16x16x32_bf16 v[168:171], v[56:59], v[24:27], v[168:171]
    v_mfma_f32_16x16x32_bf16 v[184:187], v[56:59], v[28:31], v[184:187]
    s_waitcnt lgkmcnt(6)
    v_mfma_f32_16x16x32_bf16 v[140:143], v[60:63], v[16:19], v[140:143]
    v_mfma_f32_16x16x32_bf16 v[156:159], v[60:63], v[20:23], v[156:159]
    v_mfma_f32_16x16x32_bf16 v[172:175], v[60:63], v[24:27], v[172:175]
    v_mfma_f32_16x16x32_bf16 v[188:191], v[60:63], v[28:31], v[188:191]
    v_mfma_f32_16x16x32_bf16 v[192:195], v[48:51], v[32:35], v[192:195]
    buffer_load_dword v65, v64, s[52:55], s51 offen sc1
    s_barrier
    s_waitcnt lgkmcnt(4)
    v_mfma_f32_16x16x32_bf16 v[208:211], v[48:51], v[36:39], v[208:211]
    ds_read_b64_tr_b16 v[16:17], v10 offset:0
    s_waitcnt lgkmcnt(3)
    v_mfma_f32_16x16x32_bf16 v[224:227], v[48:51], v[40:43], v[224:227]
    ds_read_b64_tr_b16 v[18:19], v10 offset:2048
    s_waitcnt lgkmcnt(2)
    v_mfma_f32_16x16x32_bf16 v[240:243], v[48:51], v[44:47], v[240:243]
    ds_read_b128 v[48:51], v9 offset:0
    v_mfma_f32_16x16x32_bf16 v[196:199], v[52:55], v[32:35], v[196:199]
    ds_read_b64_tr_b16 v[20:21], v11 offset:0
    v_mfma_f32_16x16x32_bf16 v[212:215], v[52:55], v[36:39], v[212:215]
    v_mfma_f32_16x16x32_bf16 v[228:231], v[52:55], v[40:43], v[228:231]
    ds_read_b64_tr_b16 v[22:23], v11 offset:2048
    v_mfma_f32_16x16x32_bf16 v[244:247], v[52:55], v[44:47], v[244:247]
    ds_read_b64_tr_b16 v[24:25], v12 offset:0
    v_mfma_f32_16x16x32_bf16 v[200:203], v[56:59], v[32:35], v[200:203]
    ds_read_b64_tr_b16 v[26:27], v12 offset:2048
    v_mfma_f32_16x16x32_bf16 v[216:219], v[56:59], v[36:39], v[216:219]
    ds_read_b64_tr_b16 v[28:29], v13 offset:0
    v_mfma_f32_16x16x32_bf16 v[232:235], v[56:59], v[40:43], v[232:235]
    ds_read_b64_tr_b16 v[30:31], v13 offset:2048
    v_mfma_f32_16x16x32_bf16 v[248:251], v[56:59], v[44:47], v[248:251]
    ds_read_b128 v[52:55], v9 offset:1024
    v_mfma_f32_16x16x32_bf16 v[204:207], v[60:63], v[32:35], v[204:207]
    ds_read_b128 v[56:59], v9 offset:2048
    v_mfma_f32_16x16x32_bf16 v[220:223], v[60:63], v[36:39], v[220:223]
    ds_read_b64_tr_b16 v[32:33], v10 offset:4096
    v_mfma_f32_16x16x32_bf16 v[236:239], v[60:63], v[40:43], v[236:239]
    ds_read_b64_tr_b16 v[34:35], v10 offset:6144
    v_mfma_f32_16x16x32_bf16 v[252:255], v[60:63], v[44:47], v[252:255]
    ds_read_b128 v[60:63], v9 offset:3072
    s_waitcnt lgkmcnt(11)
    v_mfma_f32_16x16x32_bf16 v[128:131], v[48:51], v[16:19], v[128:131]
    ds_read_b64_tr_b16 v[36:37], v11 offset:4096
    s_waitcnt lgkmcnt(10)
    v_mfma_f32_16x16x32_bf16 v[144:147], v[48:51], v[20:23], v[144:147]
    ds_read_b64_tr_b16 v[38:39], v11 offset:6144
    s_waitcnt lgkmcnt(9)
    v_mfma_f32_16x16x32_bf16 v[160:163], v[48:51], v[24:27], v[160:163]
    ds_read_b64_tr_b16 v[40:41], v12 offset:4096
    s_waitcnt lgkmcnt(8)
    v_mfma_f32_16x16x32_bf16 v[176:179], v[48:51], v[28:31], v[176:179]
    ds_read_b64_tr_b16 v[42:43], v12 offset:6144
    s_waitcnt lgkmcnt(8)
    v_mfma_f32_16x16x32_bf16 v[132:135], v[52:55], v[16:19], v[132:135]
    ds_read_b64_tr_b16 v[44:45], v13 offset:4096
    v_mfma_f32_16x16x32_bf16 v[148:151], v[52:55], v[20:23], v[148:151]
    ds_read_b64_tr_b16 v[46:47], v13 offset:6144
    v_mfma_f32_16x16x32_bf16 v[164:167], v[52:55], v[24:27], v[164:167]
    v_mfma_f32_16x16x32_bf16 v[180:183], v[52:55], v[28:31], v[180:183]
    s_waitcnt lgkmcnt(9)
    v_mfma_f32_16x16x32_bf16 v[136:139], v[56:59], v[16:19], v[136:139]
    v_mfma_f32_16x16x32_bf16 v[152:155], v[56:59], v[20:23], v[152:155]
    v_mfma_f32_16x16x32_bf16 v[168:171], v[56:59], v[24:27], v[168:171]
    v_mfma_f32_16x16x32_bf16 v[184:187], v[56:59], v[28:31], v[184:187]
    s_waitcnt lgkmcnt(6)
    v_mfma_f32_16x16x32_bf16 v[140:143], v[60:63], v[16:19], v[140:143]
    v_mfma_f32_16x16x32_bf16 v[156:159], v[60:63], v[20:23], v[156:159]
    v_mfma_f32_16x16x32_bf16 v[172:175], v[60:63], v[24:27], v[172:175]
    v_mfma_f32_16x16x32_bf16 v[188:191], v[60:63], v[28:31], v[188:191]
    v_mfma_f32_16x16x32_bf16 v[192:195], v[48:51], v[32:35], v[192:195]
    s_barrier
    s_waitcnt lgkmcnt(4)
    v_mfma_f32_16x16x32_bf16 v[208:211], v[48:51], v[36:39], v[208:211]
    ds_read_b64_tr_b16 v[16:17], v10 offset:24576
    s_waitcnt lgkmcnt(3)
    v_mfma_f32_16x16x32_bf16 v[224:227], v[48:51], v[40:43], v[224:227]
    ds_read_b64_tr_b16 v[18:19], v10 offset:26624
    s_waitcnt lgkmcnt(2)
    v_mfma_f32_16x16x32_bf16 v[240:243], v[48:51], v[44:47], v[240:243]
    ds_read_b128 v[48:51], v9 offset:24576
    v_mfma_f32_16x16x32_bf16 v[196:199], v[52:55], v[32:35], v[196:199]
    ds_read_b64_tr_b16 v[20:21], v11 offset:24576
    v_mfma_f32_16x16x32_bf16 v[212:215], v[52:55], v[36:39], v[212:215]
    v_mfma_f32_16x16x32_bf16 v[228:231], v[52:55], v[40:43], v[228:231]
    ds_read_b64_tr_b16 v[22:23], v11 offset:26624
    v_mfma_f32_16x16x32_bf16 v[244:247], v[52:55], v[44:47], v[244:247]
    ds_read_b64_tr_b16 v[24:25], v12 offset:24576
    v_mfma_f32_16x16x32_bf16 v[200:203], v[56:59], v[32:35], v[200:203]
    ds_read_b64_tr_b16 v[26:27], v12 offset:26624
    v_mfma_f32_16x16x32_bf16 v[216:219], v[56:59], v[36:39], v[216:219]
    ds_read_b64_tr_b16 v[28:29], v13 offset:24576
    v_mfma_f32_16x16x32_bf16 v[232:235], v[56:59], v[40:43], v[232:235]
    ds_read_b64_tr_b16 v[30:31], v13 offset:26624
    v_mfma_f32_16x16x32_bf16 v[248:251], v[56:59], v[44:47], v[248:251]
    ds_read_b128 v[52:55], v9 offset:25600
    v_mfma_f32_16x16x32_bf16 v[204:207], v[60:63], v[32:35], v[204:207]
    ds_read_b128 v[56:59], v9 offset:26624
    v_mfma_f32_16x16x32_bf16 v[220:223], v[60:63], v[36:39], v[220:223]
    ds_read_b64_tr_b16 v[32:33], v10 offset:28672
    v_mfma_f32_16x16x32_bf16 v[236:239], v[60:63], v[40:43], v[236:239]
    ds_read_b64_tr_b16 v[34:35], v10 offset:30720
    v_mfma_f32_16x16x32_bf16 v[252:255], v[60:63], v[44:47], v[252:255]
    ds_read_b128 v[60:63], v9 offset:27648
    s_waitcnt lgkmcnt(11)
    v_mfma_f32_16x16x32_bf16 v[128:131], v[48:51], v[16:19], v[128:131]
    ds_read_b64_tr_b16 v[36:37], v11 offset:28672
    s_waitcnt lgkmcnt(10)
    v_mfma_f32_16x16x32_bf16 v[144:147], v[48:51], v[20:23], v[144:147]
    ds_read_b64_tr_b16 v[38:39], v11 offset:30720
    s_waitcnt lgkmcnt(9)
    v_mfma_f32_16x16x32_bf16 v[160:163], v[48:51], v[24:27], v[160:163]
    ds_read_b64_tr_b16 v[40:41], v12 offset:28672
    s_waitcnt lgkmcnt(8)
    v_mfma_f32_16x16x32_bf16 v[176:179], v[48:51], v[28:31], v[176:179]
    ds_read_b64_tr_b16 v[42:43], v12 offset:30720
    s_waitcnt lgkmcnt(8)
    v_mfma_f32_16x16x32_bf16 v[132:135], v[52:55], v[16:19], v[132:135]
    ds_read_b64_tr_b16 v[44:45], v13 offset:28672
    v_mfma_f32_16x16x32_bf16 v[148:151], v[52:55], v[20:23], v[148:151]
    ds_read_b64_tr_b16 v[46:47], v13 offset:30720
    v_mfma_f32_16x16x32_bf16 v[164:167], v[52:55], v[24:27], v[164:167]
    v_mfma_f32_16x16x32_bf16 v[180:183], v[52:55], v[28:31], v[180:183]
    s_waitcnt lgkmcnt(9)
    v_mfma_f32_16x16x32_bf16 v[136:139], v[56:59], v[16:19], v[136:139]
    v_mfma_f32_16x16x32_bf16 v[152:155], v[56:59], v[20:23], v[152:155]
    v_mfma_f32_16x16x32_bf16 v[168:171], v[56:59], v[24:27], v[168:171]
    v_mfma_f32_16x16x32_bf16 v[184:187], v[56:59], v[28:31], v[184:187]
    s_waitcnt lgkmcnt(6)
    v_mfma_f32_16x16x32_bf16 v[140:143], v[60:63], v[16:19], v[140:143]
    v_mfma_f32_16x16x32_bf16 v[156:159], v[60:63], v[20:23], v[156:159]
    v_mfma_f32_16x16x32_bf16 v[172:175], v[60:63], v[24:27], v[172:175]
    v_mfma_f32_16x16x32_bf16 v[188:191], v[60:63], v[28:31], v[188:191]
    v_mfma_f32_16x16x32_bf16 v[192:195], v[48:51], v[32:35], v[192:195]
    s_barrier
    s_waitcnt lgkmcnt(4)
    v_mfma_f32_16x16x32_bf16 v[208:211], v[48:51], v[36:39], v[208:211]
    ds_read_b64_tr_b16 v[16:17], v10 offset:49152
    s_waitcnt lgkmcnt(3)
    v_mfma_f32_16x16x32_bf16 v[224:227], v[48:51], v[40:43], v[224:227]
    ds_read_b64_tr_b16 v[18:19], v10 offset:51200
    s_waitcnt lgkmcnt(2)
    v_mfma_f32_16x16x32_bf16 v[240:243], v[48:51], v[44:47], v[240:243]
    ds_read_b128 v[48:51], v9 offset:49152
    v_mfma_f32_16x16x32_bf16 v[196:199], v[52:55], v[32:35], v[196:199]
    ds_read_b64_tr_b16 v[20:21], v11 offset:49152
    v_mfma_f32_16x16x32_bf16 v[212:215], v[52:55], v[36:39], v[212:215]
    v_mfma_f32_16x16x32_bf16 v[228:231], v[52:55], v[40:43], v[228:231]
    ds_read_b64_tr_b16 v[22:23], v11 offset:51200
    v_mfma_f32_16x16x32_bf16 v[244:247], v[52:55], v[44:47], v[244:247]
    ds_read_b64_tr_b16 v[24:25], v12 offset:49152
    v_mfma_f32_16x16x32_bf16 v[200:203], v[56:59], v[32:35], v[200:203]
    ds_read_b64_tr_b16 v[26:27], v12 offset:51200
    v_mfma_f32_16x16x32_bf16 v[216:219], v[56:59], v[36:39], v[216:219]
    ds_read_b64_tr_b16 v[28:29], v13 offset:49152
    v_mfma_f32_16x16x32_bf16 v[232:235], v[56:59], v[40:43], v[232:235]
    ds_read_b64_tr_b16 v[30:31], v13 offset:51200
    v_mfma_f32_16x16x32_bf16 v[248:251], v[56:59], v[44:47], v[248:251]
    ds_read_b128 v[52:55], v9 offset:50176
    v_mfma_f32_16x16x32_bf16 v[204:207], v[60:63], v[32:35], v[204:207]
    ds_read_b128 v[56:59], v9 offset:51200
    v_mfma_f32_16x16x32_bf16 v[220:223], v[60:63], v[36:39], v[220:223]
    ds_read_b64_tr_b16 v[32:33], v10 offset:53248
    v_mfma_f32_16x16x32_bf16 v[236:239], v[60:63], v[40:43], v[236:239]
    ds_read_b64_tr_b16 v[34:35], v10 offset:55296
    v_mfma_f32_16x16x32_bf16 v[252:255], v[60:63], v[44:47], v[252:255]
    ds_read_b128 v[60:63], v9 offset:52224
    s_waitcnt lgkmcnt(11)
    v_mfma_f32_16x16x32_bf16 v[128:131], v[48:51], v[16:19], v[128:131]
    ds_read_b64_tr_b16 v[36:37], v11 offset:53248
    s_waitcnt lgkmcnt(10)
    v_mfma_f32_16x16x32_bf16 v[144:147], v[48:51], v[20:23], v[144:147]
    ds_read_b64_tr_b16 v[38:39], v11 offset:55296
    s_waitcnt lgkmcnt(9)
    v_mfma_f32_16x16x32_bf16 v[160:163], v[48:51], v[24:27], v[160:163]
    ds_read_b64_tr_b16 v[40:41], v12 offset:53248
    s_waitcnt lgkmcnt(8)
    v_mfma_f32_16x16x32_bf16 v[176:179], v[48:51], v[28:31], v[176:179]
    ds_read_b64_tr_b16 v[42:43], v12 offset:55296
    s_waitcnt lgkmcnt(8)
    v_mfma_f32_16x16x32_bf16 v[132:135], v[52:55], v[16:19], v[132:135]
    ds_read_b64_tr_b16 v[44:45], v13 offset:53248
    v_mfma_f32_16x16x32_bf16 v[148:151], v[52:55], v[20:23], v[148:151]
    ds_read_b64_tr_b16 v[46:47], v13 offset:55296
    v_mfma_f32_16x16x32_bf16 v[164:167], v[52:55], v[24:27], v[164:167]
    v_mfma_f32_16x16x32_bf16 v[180:183], v[52:55], v[28:31], v[180:183]
    s_waitcnt lgkmcnt(9)
    v_mfma_f32_16x16x32_bf16 v[136:139], v[56:59], v[16:19], v[136:139]
    v_mfma_f32_16x16x32_bf16 v[152:155], v[56:59], v[20:23], v[152:155]
    v_mfma_f32_16x16x32_bf16 v[168:171], v[56:59], v[24:27], v[168:171]
    v_mfma_f32_16x16x32_bf16 v[184:187], v[56:59], v[28:31], v[184:187]
    s_waitcnt lgkmcnt(6)
    v_mfma_f32_16x16x32_bf16 v[140:143], v[60:63], v[16:19], v[140:143]
    v_mfma_f32_16x16x32_bf16 v[156:159], v[60:63], v[20:23], v[156:159]
    v_mfma_f32_16x16x32_bf16 v[172:175], v[60:63], v[24:27], v[172:175]
    v_mfma_f32_16x16x32_bf16 v[188:191], v[60:63], v[28:31], v[188:191]
    v_mfma_f32_16x16x32_bf16 v[192:195], v[48:51], v[32:35], v[192:195]
    s_mov_b32 s50, 0
    k3_opoll:
    s_waitcnt vmcnt(0)
    v_cmp_eq_u32 vcc, 0, v65
    s_cbranch_vccz k3_ook
    s_sleep 1
    buffer_load_dword v65, v64, s[52:55], s51 offen sc1
    s_add_u32 s50, s50, 1
    s_cmp_lt_u32 s50, 200000
    s_cbranch_scc1 k3_opoll
    k3_ook:
    s_barrier
    s_waitcnt lgkmcnt(4)
    v_mfma_f32_16x16x32_bf16 v[208:211], v[48:51], v[36:39], v[208:211]
    ds_read_b64_tr_b16 v[16:17], v4 offset:0
    s_waitcnt lgkmcnt(3)
    v_mfma_f32_16x16x32_bf16 v[224:227], v[48:51], v[40:43], v[224:227]
    ds_read_b64_tr_b16 v[18:19], v4 offset:2048
    s_waitcnt lgkmcnt(2)
    v_mfma_f32_16x16x32_bf16 v[240:243], v[48:51], v[44:47], v[240:243]
    ds_read_b128 v[48:51], v8 offset:0
    v_mfma_f32_16x16x32_bf16 v[196:199], v[52:55], v[32:35], v[196:199]
    ds_read_b64_tr_b16 v[20:21], v5 offset:0
    v_mfma_f32_16x16x32_bf16 v[212:215], v[52:55], v[36:39], v[212:215]
    v_mfma_f32_16x16x32_bf16 v[228:231], v[52:55], v[40:43], v[228:231]
    ds_read_b64_tr_b16 v[22:23], v5 offset:2048
    v_mfma_f32_16x16x32_bf16 v[244:247], v[52:55], v[44:47], v[244:247]
    ds_read_b64_tr_b16 v[24:25], v6 offset:0
    v_mfma_f32_16x16x32_bf16 v[200:203], v[56:59], v[32:35], v[200:203]
    ds_read_b64_tr_b16 v[26:27], v6 offset:2048
    v_mfma_f32_16x16x32_bf16 v[216:219], v[56:59], v[36:39], v[216:219]
    ds_read_b64_tr_b16 v[28:29], v7 offset:0
    v_mfma_f32_16x16x32_bf16 v[232:235], v[56:59], v[40:43], v[232:235]
    ds_read_b64_tr_b16 v[30:31], v7 offset:2048
    v_mfma_f32_16x16x32_bf16 v[248:251], v[56:59], v[44:47], v[248:251]
    ds_read_b128 v[52:55], v8 offset:1024
    v_mfma_f32_16x16x32_bf16 v[204:207], v[60:63], v[32:35], v[204:207]
    ds_read_b128 v[56:59], v8 offset:2048
    v_mfma_f32_16x16x32_bf16 v[220:223], v[60:63], v[36:39], v[220:223]
    ds_read_b64_tr_b16 v[32:33], v4 offset:4096
    v_mfma_f32_16x16x32_bf16 v[236:239], v[60:63], v[40:43], v[236:239]
    ds_read_b64_tr_b16 v[34:35], v4 offset:6144
    v_mfma_f32_16x16x32_bf16 v[252:255], v[60:63], v[44:47], v[252:255]
    ds_read_b128 v[60:63], v8 offset:3072
    s_waitcnt lgkmcnt(11)
    v_mfma_f32_16x16x32_bf16 v[128:131], v[48:51], v[16:19], v[128:131]
    ds_read_b64_tr_b16 v[36:37], v5 offset:4096
    s_waitcnt lgkmcnt(10)
    v_mfma_f32_16x16x32_bf16 v[144:147], v[48:51], v[20:23], v[144:147]
    ds_read_b64_tr_b16 v[38:39], v5 offset:6144
    s_waitcnt lgkmcnt(9)
    v_mfma_f32_16x16x32_bf16 v[160:163], v[48:51], v[24:27], v[160:163]
    ds_read_b64_tr_b16 v[40:41], v6 offset:4096
    s_waitcnt lgkmcnt(8)
    v_mfma_f32_16x16x32_bf16 v[176:179], v[48:51], v[28:31], v[176:179]
    ds_read_b64_tr_b16 v[42:43], v6 offset:6144
    s_waitcnt lgkmcnt(8)
    v_mfma_f32_16x16x32_bf16 v[132:135], v[52:55], v[16:19], v[132:135]
    ds_read_b64_tr_b16 v[44:45], v7 offset:4096
    v_mfma_f32_16x16x32_bf16 v[148:151], v[52:55], v[20:23], v[148:151]
    ds_read_b64_tr_b16 v[46:47], v7 offset:6144
    v_mfma_f32_16x16x32_bf16 v[164:167], v[52:55], v[24:27], v[164:167]
    v_mfma_f32_16x16x32_bf16 v[180:183], v[52:55], v[28:31], v[180:183]
    s_waitcnt lgkmcnt(9)
    v_mfma_f32_16x16x32_bf16 v[136:139], v[56:59], v[16:19], v[136:139]
    v_mfma_f32_16x16x32_bf16 v[152:155], v[56:59], v[20:23], v[152:155]
    v_mfma_f32_16x16x32_bf16 v[168:171], v[56:59], v[24:27], v[168:171]
    v_mfma_f32_16x16x32_bf16 v[184:187], v[56:59], v[28:31], v[184:187]
    s_waitcnt lgkmcnt(6)
    v_mfma_f32_16x16x32_bf16 v[140:143], v[60:63], v[16:19], v[140:143]
    v_mfma_f32_16x16x32_bf16 v[156:159], v[60:63], v[20:23], v[156:159]
    v_mfma_f32_16x16x32_bf16 v[172:175], v[60:63], v[24:27], v[172:175]
    v_mfma_f32_16x16x32_bf16 v[188:191], v[60:63], v[28:31], v[188:191]
    v_mfma_f32_16x16x32_bf16 v[192:195], v[48:51], v[32:35], v[192:195]
    s_barrier
    s_waitcnt lgkmcnt(4)
    v_mfma_f32_16x16x32_bf16 v[208:211], v[48:51], v[36:39], v[208:211]
    ds_read_b64_tr_b16 v[16:17], v4 offset:24576
    s_waitcnt lgkmcnt(3)
    v_mfma_f32_16x16x32_bf16 v[224:227], v[48:51], v[40:43], v[224:227]
    ds_read_b64_tr_b16 v[18:19], v4 offset:26624
    s_waitcnt lgkmcnt(2)
    v_mfma_f32_16x16x32_bf16 v[240:243], v[48:51], v[44:47], v[240:243]
    ds_read_b128 v[48:51], v8 offset:24576
    v_mfma_f32_16x16x32_bf16 v[196:199], v[52:55], v[32:35], v[196:199]
    ds_read_b64_tr_b16 v[20:21], v5 offset:24576
    v_mfma_f32_16x16x32_bf16 v[212:215], v[52:55], v[36:39], v[212:215]
    v_mfma_f32_16x16x32_bf16 v[228:231], v[52:55], v[40:43], v[228:231]
    ds_read_b64_tr_b16 v[22:23], v5 offset:26624
    v_mfma_f32_16x16x32_bf16 v[244:247], v[52:55], v[44:47], v[244:247]
    ds_read_b64_tr_b16 v[24:25], v6 offset:24576
    v_mfma_f32_16x16x32_bf16 v[200:203], v[56:59], v[32:35], v[200:203]
    ds_read_b64_tr_b16 v[26:27], v6 offset:26624
    v_mfma_f32_16x16x32_bf16 v[216:219], v[56:59], v[36:39], v[216:219]
    ds_read_b64_tr_b16 v[28:29], v7 offset:24576
    v_mfma_f32_16x16x32_bf16 v[232:235], v[56:59], v[40:43], v[232:235]
    ds_read_b64_tr_b16 v[30:31], v7 offset:26624
    v_mfma_f32_16x16x32_bf16 v[248:251], v[56:59], v[44:47], v[248:251]
    ds_read_b128 v[52:55], v8 offset:25600
    v_mfma_f32_16x16x32_bf16 v[204:207], v[60:63], v[32:35], v[204:207]
    ds_read_b128 v[56:59], v8 offset:26624
    v_mfma_f32_16x16x32_bf16 v[220:223], v[60:63], v[36:39], v[220:223]
    ds_read_b64_tr_b16 v[32:33], v4 offset:28672
    v_mfma_f32_16x16x32_bf16 v[236:239], v[60:63], v[40:43], v[236:239]
    ds_read_b64_tr_b16 v[34:35], v4 offset:30720
    v_mfma_f32_16x16x32_bf16 v[252:255], v[60:63], v[44:47], v[252:255]
    ds_read_b128 v[60:63], v8 offset:27648
    s_waitcnt lgkmcnt(11)
    v_mfma_f32_16x16x32_bf16 v[128:131], v[48:51], v[16:19], v[128:131]
    ds_read_b64_tr_b16 v[36:37], v5 offset:28672
    s_waitcnt lgkmcnt(10)
    v_mfma_f32_16x16x32_bf16 v[144:147], v[48:51], v[20:23], v[144:147]
    ds_read_b64_tr_b16 v[38:39], v5 offset:30720
    s_waitcnt lgkmcnt(9)
    v_mfma_f32_16x16x32_bf16 v[160:163], v[48:51], v[24:27], v[160:163]
    ds_read_b64_tr_b16 v[40:41], v6 offset:28672
    s_waitcnt lgkmcnt(8)
    v_mfma_f32_16x16x32_bf16 v[176:179], v[48:51], v[28:31], v[176:179]
    ds_read_b64_tr_b16 v[42:43], v6 offset:30720
    s_waitcnt lgkmcnt(8)
    v_mfma_f32_16x16x32_bf16 v[132:135], v[52:55], v[16:19], v[132:135]
    ds_read_b64_tr_b16 v[44:45], v7 offset:28672
    v_mfma_f32_16x16x32_bf16 v[148:151], v[52:55], v[20:23], v[148:151]
    ds_read_b64_tr_b16 v[46:47], v7 offset:30720
    v_mfma_f32_16x16x32_bf16 v[164:167], v[52:55], v[24:27], v[164:167]
    v_mfma_f32_16x16x32_bf16 v[180:183], v[52:55], v[28:31], v[180:183]
    s_waitcnt lgkmcnt(9)
    v_mfma_f32_16x16x32_bf16 v[136:139], v[56:59], v[16:19], v[136:139]
    v_mfma_f32_16x16x32_bf16 v[152:155], v[56:59], v[20:23], v[152:155]
    v_mfma_f32_16x16x32_bf16 v[168:171], v[56:59], v[24:27], v[168:171]
    v_mfma_f32_16x16x32_bf16 v[184:187], v[56:59], v[28:31], v[184:187]
    s_waitcnt lgkmcnt(6)
    v_mfma_f32_16x16x32_bf16 v[140:143], v[60:63], v[16:19], v[140:143]
    v_mfma_f32_16x16x32_bf16 v[156:159], v[60:63], v[20:23], v[156:159]
    v_mfma_f32_16x16x32_bf16 v[172:175], v[60:63], v[24:27], v[172:175]
    v_mfma_f32_16x16x32_bf16 v[188:191], v[60:63], v[28:31], v[188:191]
    v_mfma_f32_16x16x32_bf16 v[192:195], v[48:51], v[32:35], v[192:195]
    s_barrier
    s_waitcnt lgkmcnt(4)
    v_mfma_f32_16x16x32_bf16 v[208:211], v[48:51], v[36:39], v[208:211]
    ds_read_b64_tr_b16 v[16:17], v4 offset:49152
    s_waitcnt lgkmcnt(3)
    v_mfma_f32_16x16x32_bf16 v[224:227], v[48:51], v[40:43], v[224:227]
    ds_read_b64_tr_b16 v[18:19], v4 offset:51200
    s_waitcnt lgkmcnt(2)
    v_mfma_f32_16x16x32_bf16 v[240:243], v[48:51], v[44:47], v[240:243]
    ds_read_b128 v[48:51], v8 offset:49152
    v_mfma_f32_16x16x32_bf16 v[196:199], v[52:55], v[32:35], v[196:199]
    ds_read_b64_tr_b16 v[20:21], v5 offset:49152
    v_mfma_f32_16x16x32_bf16 v[212:215], v[52:55], v[36:39], v[212:215]
    v_mfma_f32_16x16x32_bf16 v[228:231], v[52:55], v[40:43], v[228:231]
    ds_read_b64_tr_b16 v[22:23], v5 offset:51200
    v_mfma_f32_16x16x32_bf16 v[244:247], v[52:55], v[44:47], v[244:247]
    ds_read_b64_tr_b16 v[24:25], v6 offset:49152
    v_mfma_f32_16x16x32_bf16 v[200:203], v[56:59], v[32:35], v[200:203]
    ds_read_b64_tr_b16 v[26:27], v6 offset:51200
    v_mfma_f32_16x16x32_bf16 v[216:219], v[56:59], v[36:39], v[216:219]
    ds_read_b64_tr_b16 v[28:29], v7 offset:49152
    v_mfma_f32_16x16x32_bf16 v[232:235], v[56:59], v[40:43], v[232:235]
    ds_read_b64_tr_b16 v[30:31], v7 offset:51200
    v_mfma_f32_16x16x32_bf16 v[248:251], v[56:59], v[44:47], v[248:251]
    ds_read_b128 v[52:55], v8 offset:50176
    v_mfma_f32_16x16x32_bf16 v[204:207], v[60:63], v[32:35], v[204:207]
    ds_read_b128 v[56:59], v8 offset:51200
    v_mfma_f32_16x16x32_bf16 v[220:223], v[60:63], v[36:39], v[220:223]
    ds_read_b64_tr_b16 v[32:33], v4 offset:53248
    v_mfma_f32_16x16x32_bf16 v[236:239], v[60:63], v[40:43], v[236:239]
    ds_read_b64_tr_b16 v[34:35], v4 offset:55296
    v_mfma_f32_16x16x32_bf16 v[252:255], v[60:63], v[44:47], v[252:255]
    ds_read_b128 v[60:63], v8 offset:52224
    s_waitcnt lgkmcnt(11)
    v_mfma_f32_16x16x32_bf16 v[128:131], v[48:51], v[16:19], v[128:131]
    ds_read_b64_tr_b16 v[36:37], v5 offset:53248
    s_waitcnt lgkmcnt(10)
    v_mfma_f32_16x16x32_bf16 v[144:147], v[48:51], v[20:23], v[144:147]
    ds_read_b64_tr_b16 v[38:39], v5 offset:55296
    s_waitcnt lgkmcnt(9)
    v_mfma_f32_16x16x32_bf16 v[160:163], v[48:51], v[24:27], v[160:163]
    ds_read_b64_tr_b16 v[40:41], v6 offset:53248
    s_waitcnt lgkmcnt(8)
    v_mfma_f32_16x16x32_bf16 v[176:179], v[48:51], v[28:31], v[176:179]
    ds_read_b64_tr_b16 v[42:43], v6 offset:55296
    s_waitcnt lgkmcnt(8)
    v_mfma_f32_16x16x32_bf16 v[132:135], v[52:55], v[16:19], v[132:135]
    ds_read_b64_tr_b16 v[44:45], v7 offset:53248
    v_mfma_f32_16x16x32_bf16 v[148:151], v[52:55], v[20:23], v[148:151]
    ds_read_b64_tr_b16 v[46:47], v7 offset:55296
    v_mfma_f32_16x16x32_bf16 v[164:167], v[52:55], v[24:27], v[164:167]
    v_mfma_f32_16x16x32_bf16 v[180:183], v[52:55], v[28:31], v[180:183]
    s_waitcnt lgkmcnt(9)
    v_mfma_f32_16x16x32_bf16 v[136:139], v[56:59], v[16:19], v[136:139]
    v_mfma_f32_16x16x32_bf16 v[152:155], v[56:59], v[20:23], v[152:155]
    v_mfma_f32_16x16x32_bf16 v[168:171], v[56:59], v[24:27], v[168:171]
    v_mfma_f32_16x16x32_bf16 v[184:187], v[56:59], v[28:31], v[184:187]
    s_waitcnt lgkmcnt(6)
    v_mfma_f32_16x16x32_bf16 v[140:143], v[60:63], v[16:19], v[140:143]
    v_mfma_f32_16x16x32_bf16 v[156:159], v[60:63], v[20:23], v[156:159]
    v_mfma_f32_16x16x32_bf16 v[172:175], v[60:63], v[24:27], v[172:175]
    v_mfma_f32_16x16x32_bf16 v[188:191], v[60:63], v[28:31], v[188:191]
    v_mfma_f32_16x16x32_bf16 v[192:195], v[48:51], v[32:35], v[192:195]
    s_barrier
    s_waitcnt lgkmcnt(4)
    v_mfma_f32_16x16x32_bf16 v[208:211], v[48:51], v[36:39], v[208:211]
    ds_read_b64_tr_b16 v[16:17], v10 offset:0
    s_waitcnt lgkmcnt(3)
    v_mfma_f32_16x16x32_bf16 v[224:227], v[48:51], v[40:43], v[224:227]
    ds_read_b64_tr_b16 v[18:19], v10 offset:2048
    s_waitcnt lgkmcnt(2)
    v_mfma_f32_16x16x32_bf16 v[240:243], v[48:51], v[44:47], v[240:243]
    ds_read_b128 v[48:51], v9 offset:0
    v_mfma_f32_16x16x32_bf16 v[196:199], v[52:55], v[32:35], v[196:199]
    ds_read_b64_tr_b16 v[20:21], v11 offset:0
    v_mfma_f32_16x16x32_bf16 v[212:215], v[52:55], v[36:39], v[212:215]
    v_mfma_f32_16x16x32_bf16 v[228:231], v[52:55], v[40:43], v[228:231]
    ds_read_b64_tr_b16 v[22:23], v11 offset:2048
    v_mfma_f32_16x16x32_bf16 v[244:247], v[52:55], v[44:47], v[244:247]
    ds_read_b64_tr_b16 v[24:25], v12 offset:0
    v_mfma_f32_16x16x32_bf16 v[200:203], v[56:59], v[32:35], v[200:203]
    ds_read_b64_tr_b16 v[26:27], v12 offset:2048
    v_mfma_f32_16x16x32_bf16 v[216:219], v[56:59], v[36:39], v[216:219]
    ds_read_b64_tr_b16 v[28:29], v13 offset:0
    v_mfma_f32_16x16x32_bf16 v[232:235], v[56:59], v[40:43], v[232:235]
    ds_read_b64_tr_b16 v[30:31], v13 offset:2048
    v_mfma_f32_16x16x32_bf16 v[248:251], v[56:59], v[44:47], v[248:251]
    ds_read_b128 v[52:55], v9 offset:1024
    v_mfma_f32_16x16x32_bf16 v[204:207], v[60:63], v[32:35], v[204:207]
    ds_read_b128 v[56:59], v9 offset:2048
    v_mfma_f32_16x16x32_bf16 v[220:223], v[60:63], v[36:39], v[220:223]
    ds_read_b64_tr_b16 v[32:33], v10 offset:4096
    v_mfma_f32_16x16x32_bf16 v[236:239], v[60:63], v[40:43], v[236:239]
    ds_read_b64_tr_b16 v[34:35], v10 offset:6144
    v_mfma_f32_16x16x32_bf16 v[252:255], v[60:63], v[44:47], v[252:255]
    ds_read_b128 v[60:63], v9 offset:3072
    s_waitcnt lgkmcnt(11)
    v_mfma_f32_16x16x32_bf16 v[128:131], v[48:51], v[16:19], v[128:131]
    ds_read_b64_tr_b16 v[36:37], v11 offset:4096
    s_waitcnt lgkmcnt(10)
    v_mfma_f32_16x16x32_bf16 v[144:147], v[48:51], v[20:23], v[144:147]
    ds_read_b64_tr_b16 v[38:39], v11 offset:6144
    s_waitcnt lgkmcnt(9)
    v_mfma_f32_16x16x32_bf16 v[160:163], v[48:51], v[24:27], v[160:163]
    ds_read_b64_tr_b16 v[40:41], v12 offset:4096
    s_waitcnt lgkmcnt(8)
    v_mfma_f32_16x16x32_bf16 v[176:179], v[48:51], v[28:31], v[176:179]
    ds_read_b64_tr_b16 v[42:43], v12 offset:6144
    s_waitcnt lgkmcnt(8)
    v_mfma_f32_16x16x32_bf16 v[132:135], v[52:55], v[16:19], v[132:135]
    ds_read_b64_tr_b16 v[44:45], v13 offset:4096
    v_mfma_f32_16x16x32_bf16 v[148:151], v[52:55], v[20:23], v[148:151]
    ds_read_b64_tr_b16 v[46:47], v13 offset:6144
    v_mfma_f32_16x16x32_bf16 v[164:167], v[52:55], v[24:27], v[164:167]
    v_mfma_f32_16x16x32_bf16 v[180:183], v[52:55], v[28:31], v[180:183]
    s_waitcnt lgkmcnt(9)
    v_mfma_f32_16x16x32_bf16 v[136:139], v[56:59], v[16:19], v[136:139]
    v_mfma_f32_16x16x32_bf16 v[152:155], v[56:59], v[20:23], v[152:155]
    v_mfma_f32_16x16x32_bf16 v[168:171], v[56:59], v[24:27], v[168:171]
    v_mfma_f32_16x16x32_bf16 v[184:187], v[56:59], v[28:31], v[184:187]
    s_waitcnt lgkmcnt(6)
    v_mfma_f32_16x16x32_bf16 v[140:143], v[60:63], v[16:19], v[140:143]
    v_mfma_f32_16x16x32_bf16 v[156:159], v[60:63], v[20:23], v[156:159]
    v_mfma_f32_16x16x32_bf16 v[172:175], v[60:63], v[24:27], v[172:175]
    v_mfma_f32_16x16x32_bf16 v[188:191], v[60:63], v[28:31], v[188:191]
    v_mfma_f32_16x16x32_bf16 v[192:195], v[48:51], v[32:35], v[192:195]
    s_barrier
    s_waitcnt lgkmcnt(4)
    v_mfma_f32_16x16x32_bf16 v[208:211], v[48:51], v[36:39], v[208:211]
    v_add_u32 v8, s49, v8
    v_add_u32 v9, s49, v9
    ds_read_b128 v[16:19], v9 offset:24576
    s_waitcnt lgkmcnt(3)
    v_mfma_f32_16x16x32_bf16 v[224:227], v[48:51], v[40:43], v[224:227]
    ds_read_b128 v[20:23], v9 offset:25600
    s_waitcnt lgkmcnt(2)
    v_mfma_f32_16x16x32_bf16 v[240:243], v[48:51], v[44:47], v[240:243]
    v_add_u32 v4, v3, v4
    v_add_u32 v10, v3, v10
    v_add_u32 v5, v3, v5
    v_add_u32 v11, v3, v11
    v_add_u32 v6, v3, v6
    v_add_u32 v12, v3, v12
    v_add_u32 v7, v3, v7
    v_add_u32 v13, v3, v13
    ds_read_b64_tr_b16 v[48:49], v10 offset:24576
    v_mfma_f32_16x16x32_bf16 v[196:199], v[52:55], v[32:35], v[196:199]
    ds_read_b64_tr_b16 v[50:51], v10 offset:25600
    v_mfma_f32_16x16x32_bf16 v[212:215], v[52:55], v[36:39], v[212:215]
    v_mfma_f32_16x16x32_bf16 v[228:231], v[52:55], v[40:43], v[228:231]
    ds_read_b128 v[24:27], v9 offset:26624
    v_mfma_f32_16x16x32_bf16 v[244:247], v[52:55], v[44:47], v[244:247]
    ds_read_b128 v[28:31], v9 offset:27648
    v_mfma_f32_16x16x32_bf16 v[200:203], v[56:59], v[32:35], v[200:203]
    ds_read_b64_tr_b16 v[52:53], v11 offset:24576
    v_mfma_f32_16x16x32_bf16 v[216:219], v[56:59], v[36:39], v[216:219]
    ds_read_b64_tr_b16 v[54:55], v11 offset:25600
    v_mfma_f32_16x16x32_bf16 v[232:235], v[56:59], v[40:43], v[232:235]
    v_mfma_f32_16x16x32_bf16 v[248:251], v[56:59], v[44:47], v[248:251]
    ds_read_b64_tr_b16 v[56:57], v12 offset:24576
    v_mfma_f32_16x16x32_bf16 v[204:207], v[60:63], v[32:35], v[204:207]
    ds_read_b64_tr_b16 v[58:59], v12 offset:25600
    v_mfma_f32_16x16x32_bf16 v[220:223], v[60:63], v[36:39], v[220:223]
    ds_read_b128 v[32:35], v9 offset:28672
    v_mfma_f32_16x16x32_bf16 v[236:239], v[60:63], v[40:43], v[236:239]
    ds_read_b128 v[36:39], v9 offset:29696
    v_mfma_f32_16x16x32_bf16 v[252:255], v[60:63], v[44:47], v[252:255]
    ds_read_b64_tr_b16 v[60:61], v13 offset:24576
    s_waitcnt lgkmcnt(9)
    v_mfma_f32_16x16x32_bf16 v[128:131], v[48:51], v[16:19], v[128:131]
    ds_read_b64_tr_b16 v[62:63], v13 offset:25600
    v_mfma_f32_16x16x32_bf16 v[144:147], v[48:51], v[20:23], v[144:147]
    ds_read_b128 v[40:43], v9 offset:30720
    s_waitcnt lgkmcnt(10)
    v_mfma_f32_16x16x32_bf16 v[160:163], v[48:51], v[24:27], v[160:163]
    ds_read_b128 v[44:47], v9 offset:31744
    s_waitcnt lgkmcnt(10)
    v_mfma_f32_16x16x32_bf16 v[176:179], v[48:51], v[28:31], v[176:179]
    s_waitcnt lgkmcnt(8)
    v_mfma_f32_16x16x32_bf16 v[132:135], v[52:55], v[16:19], v[132:135]
    v_mfma_f32_16x16x32_bf16 v[148:151], v[52:55], v[20:23], v[148:151]
    v_mfma_f32_16x16x32_bf16 v[164:167], v[52:55], v[24:27], v[164:167]
    v_mfma_f32_16x16x32_bf16 v[180:183], v[52:55], v[28:31], v[180:183]
    s_waitcnt lgkmcnt(6)
    v_mfma_f32_16x16x32_bf16 v[136:139], v[56:59], v[16:19], v[136:139]
    v_mfma_f32_16x16x32_bf16 v[152:155], v[56:59], v[20:23], v[152:155]
    v_mfma_f32_16x16x32_bf16 v[168:171], v[56:59], v[24:27], v[168:171]
    v_mfma_f32_16x16x32_bf16 v[184:187], v[56:59], v[28:31], v[184:187]
    s_waitcnt lgkmcnt(2)
    v_mfma_f32_16x16x32_bf16 v[140:143], v[60:63], v[16:19], v[140:143]
    v_mfma_f32_16x16x32_bf16 v[156:159], v[60:63], v[20:23], v[156:159]
    v_mfma_f32_16x16x32_bf16 v[172:175], v[60:63], v[24:27], v[172:175]
    v_mfma_f32_16x16x32_bf16 v[188:191], v[60:63], v[28:31], v[188:191]
    v_mfma_f32_16x16x32_bf16 v[192:195], v[48:51], v[32:35], v[192:195]
    s_barrier
    v_mfma_f32_16x16x32_bf16 v[208:211], v[48:51], v[36:39], v[208:211]
    ds_read_b128 v[16:19], v9 offset:49152
    s_waitcnt lgkmcnt(2)
    v_mfma_f32_16x16x32_bf16 v[224:227], v[48:51], v[40:43], v[224:227]
    ds_read_b128 v[20:23], v9 offset:50176
    s_waitcnt lgkmcnt(2)
    v_mfma_f32_16x16x32_bf16 v[240:243], v[48:51], v[44:47], v[240:243]
    ds_read_b64_tr_b16 v[48:49], v10 offset:49152
    v_mfma_f32_16x16x32_bf16 v[196:199], v[52:55], v[32:35], v[196:199]
    ds_read_b64_tr_b16 v[50:51], v10 offset:50176
    v_mfma_f32_16x16x32_bf16 v[212:215], v[52:55], v[36:39], v[212:215]
    v_mfma_f32_16x16x32_bf16 v[228:231], v[52:55], v[40:43], v[228:231]
    ds_read_b128 v[24:27], v9 offset:51200
    v_mfma_f32_16x16x32_bf16 v[244:247], v[52:55], v[44:47], v[244:247]
    ds_read_b128 v[28:31], v9 offset:52224
    v_mfma_f32_16x16x32_bf16 v[200:203], v[56:59], v[32:35], v[200:203]
    ds_read_b64_tr_b16 v[52:53], v11 offset:49152
    v_mfma_f32_16x16x32_bf16 v[216:219], v[56:59], v[36:39], v[216:219]
    ds_read_b64_tr_b16 v[54:55], v11 offset:50176
    v_mfma_f32_16x16x32_bf16 v[232:235], v[56:59], v[40:43], v[232:235]
    v_mfma_f32_16x16x32_bf16 v[248:251], v[56:59], v[44:47], v[248:251]
    ds_read_b64_tr_b16 v[56:57], v12 offset:49152
    v_mfma_f32_16x16x32_bf16 v[204:207], v[60:63], v[32:35], v[204:207]
    ds_read_b64_tr_b16 v[58:59], v12 offset:50176
    v_mfma_f32_16x16x32_bf16 v[220:223], v[60:63], v[36:39], v[220:223]
    ds_read_b128 v[32:35], v9 offset:53248
    v_mfma_f32_16x16x32_bf16 v[236:239], v[60:63], v[40:43], v[236:239]
    ds_read_b128 v[36:39], v9 offset:54272
    v_mfma_f32_16x16x32_bf16 v[252:255], v[60:63], v[44:47], v[252:255]
    ds_read_b64_tr_b16 v[60:61], v13 offset:49152
    s_waitcnt lgkmcnt(9)
    v_mfma_f32_16x16x32_bf16 v[128:131], v[48:51], v[16:19], v[128:131]
    ds_read_b64_tr_b16 v[62:63], v13 offset:50176
    v_mfma_f32_16x16x32_bf16 v[144:147], v[48:51], v[20:23], v[144:147]
    ds_read_b128 v[40:43], v9 offset:55296
    s_waitcnt lgkmcnt(10)
    v_mfma_f32_16x16x32_bf16 v[160:163], v[48:51], v[24:27], v[160:163]
    ds_read_b128 v[44:47], v9 offset:56320
    s_waitcnt lgkmcnt(10)
    v_mfma_f32_16x16x32_bf16 v[176:179], v[48:51], v[28:31], v[176:179]
    s_waitcnt lgkmcnt(8)
    v_mfma_f32_16x16x32_bf16 v[132:135], v[52:55], v[16:19], v[132:135]
    v_mfma_f32_16x16x32_bf16 v[148:151], v[52:55], v[20:23], v[148:151]
    v_mfma_f32_16x16x32_bf16 v[164:167], v[52:55], v[24:27], v[164:167]
    v_mfma_f32_16x16x32_bf16 v[180:183], v[52:55], v[28:31], v[180:183]
    s_waitcnt lgkmcnt(6)
    v_mfma_f32_16x16x32_bf16 v[136:139], v[56:59], v[16:19], v[136:139]
    v_mfma_f32_16x16x32_bf16 v[152:155], v[56:59], v[20:23], v[152:155]
    v_mfma_f32_16x16x32_bf16 v[168:171], v[56:59], v[24:27], v[168:171]
    v_mfma_f32_16x16x32_bf16 v[184:187], v[56:59], v[28:31], v[184:187]
    s_waitcnt lgkmcnt(2)
    v_mfma_f32_16x16x32_bf16 v[140:143], v[60:63], v[16:19], v[140:143]
    v_mfma_f32_16x16x32_bf16 v[156:159], v[60:63], v[20:23], v[156:159]
    v_mfma_f32_16x16x32_bf16 v[172:175], v[60:63], v[24:27], v[172:175]
    v_mfma_f32_16x16x32_bf16 v[188:191], v[60:63], v[28:31], v[188:191]
    v_mfma_f32_16x16x32_bf16 v[192:195], v[48:51], v[32:35], v[192:195]
    s_barrier
    v_mfma_f32_16x16x32_bf16 v[208:211], v[48:51], v[36:39], v[208:211]
    ds_read_b128 v[16:19], v8 offset:0
    s_waitcnt lgkmcnt(2)
    v_mfma_f32_16x16x32_bf16 v[224:227], v[48:51], v[40:43], v[224:227]
    ds_read_b128 v[20:23], v8 offset:1024
    s_waitcnt lgkmcnt(2)
    v_mfma_f32_16x16x32_bf16 v[240:243], v[48:51], v[44:47], v[240:243]
    ds_read_b64_tr_b16 v[48:49], v4 offset:0
    v_mfma_f32_16x16x32_bf16 v[196:199], v[52:55], v[32:35], v[196:199]
    ds_read_b64_tr_b16 v[50:51], v4 offset:1024
    v_mfma_f32_16x16x32_bf16 v[212:215], v[52:55], v[36:39], v[212:215]
    v_mfma_f32_16x16x32_bf16 v[228:231], v[52:55], v[40:43], v[228:231]
    ds_read_b128 v[24:27], v8 offset:2048
    v_mfma_f32_16x16x32_bf16 v[244:247], v[52:55], v[44:47], v[244:247]
    ds_read_b128 v[28:31], v8 offset:3072
    v_mfma_f32_16x16x32_bf16 v[200:203], v[56:59], v[32:35], v[200:203]
    ds_read_b64_tr_b16 v[52:53], v5 offset:0
    v_mfma_f32_16x16x32_bf16 v[216:219], v[56:59], v[36:39], v[216:219]
    ds_read_b64_tr_b16 v[54:55], v5 offset:1024
    v_mfma_f32_16x16x32_bf16 v[232:235], v[56:59], v[40:43], v[232:235]
    v_mfma_f32_16x16x32_bf16 v[248:251], v[56:59], v[44:47], v[248:251]
    ds_read_b64_tr_b16 v[56:57], v6 offset:0
    v_mfma_f32_16x16x32_bf16 v[204:207], v[60:63], v[32:35], v[204:207]
    ds_read_b64_tr_b16 v[58:59], v6 offset:1024
    v_mfma_f32_16x16x32_bf16 v[220:223], v[60:63], v[36:39], v[220:223]
    ds_read_b128 v[32:35], v8 offset:4096
    v_mfma_f32_16x16x32_bf16 v[236:239], v[60:63], v[40:43], v[236:239]
    ds_read_b128 v[36:39], v8 offset:5120
    v_mfma_f32_16x16x32_bf16 v[252:255], v[60:63], v[44:47], v[252:255]
    ds_read_b64_tr_b16 v[60:61], v7 offset:0
    s_waitcnt lgkmcnt(9)
    v_mfma_f32_16x16x32_bf16 v[128:131], v[48:51], v[16:19], v[128:131]
    ds_read_b64_tr_b16 v[62:63], v7 offset:1024
    v_mfma_f32_16x16x32_bf16 v[144:147], v[48:51], v[20:23], v[144:147]
    ds_read_b128 v[40:43], v8 offset:6144
    s_waitcnt lgkmcnt(10)
    v_mfma_f32_16x16x32_bf16 v[160:163], v[48:51], v[24:27], v[160:163]
    ds_read_b128 v[44:47], v8 offset:7168
    s_waitcnt lgkmcnt(10)
    v_mfma_f32_16x16x32_bf16 v[176:179], v[48:51], v[28:31], v[176:179]
    s_waitcnt lgkmcnt(8)
    v_mfma_f32_16x16x32_bf16 v[132:135], v[52:55], v[16:19], v[132:135]
    v_mfma_f32_16x16x32_bf16 v[148:151], v[52:55], v[20:23], v[148:151]
    v_mfma_f32_16x16x32_bf16 v[164:167], v[52:55], v[24:27], v[164:167]
    v_mfma_f32_16x16x32_bf16 v[180:183], v[52:55], v[28:31], v[180:183]
    s_waitcnt lgkmcnt(6)
    v_mfma_f32_16x16x32_bf16 v[136:139], v[56:59], v[16:19], v[136:139]
    v_mfma_f32_16x16x32_bf16 v[152:155], v[56:59], v[20:23], v[152:155]
    v_mfma_f32_16x16x32_bf16 v[168:171], v[56:59], v[24:27], v[168:171]
    v_mfma_f32_16x16x32_bf16 v[184:187], v[56:59], v[28:31], v[184:187]
    s_waitcnt lgkmcnt(2)
    v_mfma_f32_16x16x32_bf16 v[140:143], v[60:63], v[16:19], v[140:143]
    v_mfma_f32_16x16x32_bf16 v[156:159], v[60:63], v[20:23], v[156:159]
    v_mfma_f32_16x16x32_bf16 v[172:175], v[60:63], v[24:27], v[172:175]
    v_mfma_f32_16x16x32_bf16 v[188:191], v[60:63], v[28:31], v[188:191]
    v_mfma_f32_16x16x32_bf16 v[192:195], v[48:51], v[32:35], v[192:195]
    s_barrier
    v_mfma_f32_16x16x32_bf16 v[208:211], v[48:51], v[36:39], v[208:211]
    ds_read_b128 v[16:19], v8 offset:24576
    s_waitcnt lgkmcnt(2)
    v_mfma_f32_16x16x32_bf16 v[224:227], v[48:51], v[40:43], v[224:227]
    ds_read_b128 v[20:23], v8 offset:25600
    s_waitcnt lgkmcnt(2)
    v_mfma_f32_16x16x32_bf16 v[240:243], v[48:51], v[44:47], v[240:243]
    ds_read_b64_tr_b16 v[48:49], v4 offset:24576
    v_mfma_f32_16x16x32_bf16 v[196:199], v[52:55], v[32:35], v[196:199]
    ds_read_b64_tr_b16 v[50:51], v4 offset:25600
    v_mfma_f32_16x16x32_bf16 v[212:215], v[52:55], v[36:39], v[212:215]
    v_mfma_f32_16x16x32_bf16 v[228:231], v[52:55], v[40:43], v[228:231]
    ds_read_b128 v[24:27], v8 offset:26624
    v_mfma_f32_16x16x32_bf16 v[244:247], v[52:55], v[44:47], v[244:247]
    ds_read_b128 v[28:31], v8 offset:27648
    v_mfma_f32_16x16x32_bf16 v[200:203], v[56:59], v[32:35], v[200:203]
    ds_read_b64_tr_b16 v[52:53], v5 offset:24576
    v_mfma_f32_16x16x32_bf16 v[216:219], v[56:59], v[36:39], v[216:219]
    ds_read_b64_tr_b16 v[54:55], v5 offset:25600
    v_mfma_f32_16x16x32_bf16 v[232:235], v[56:59], v[40:43], v[232:235]
    v_mfma_f32_16x16x32_bf16 v[248:251], v[56:59], v[44:47], v[248:251]
    ds_read_b64_tr_b16 v[56:57], v6 offset:24576
    v_mfma_f32_16x16x32_bf16 v[204:207], v[60:63], v[32:35], v[204:207]
    ds_read_b64_tr_b16 v[58:59], v6 offset:25600
    v_mfma_f32_16x16x32_bf16 v[220:223], v[60:63], v[36:39], v[220:223]
    ds_read_b128 v[32:35], v8 offset:28672
    v_mfma_f32_16x16x32_bf16 v[236:239], v[60:63], v[40:43], v[236:239]
    ds_read_b128 v[36:39], v8 offset:29696
    v_mfma_f32_16x16x32_bf16 v[252:255], v[60:63], v[44:47], v[252:255]
    ds_read_b64_tr_b16 v[60:61], v7 offset:24576
    s_waitcnt lgkmcnt(9)
    v_mfma_f32_16x16x32_bf16 v[128:131], v[48:51], v[16:19], v[128:131]
    ds_read_b64_tr_b16 v[62:63], v7 offset:25600
    v_mfma_f32_16x16x32_bf16 v[144:147], v[48:51], v[20:23], v[144:147]
    ds_read_b128 v[40:43], v8 offset:30720
    s_waitcnt lgkmcnt(10)
    v_mfma_f32_16x16x32_bf16 v[160:163], v[48:51], v[24:27], v[160:163]
    ds_read_b128 v[44:47], v8 offset:31744
    s_waitcnt lgkmcnt(10)
    v_mfma_f32_16x16x32_bf16 v[176:179], v[48:51], v[28:31], v[176:179]
    s_waitcnt lgkmcnt(8)
    v_mfma_f32_16x16x32_bf16 v[132:135], v[52:55], v[16:19], v[132:135]
    v_mfma_f32_16x16x32_bf16 v[148:151], v[52:55], v[20:23], v[148:151]
    v_mfma_f32_16x16x32_bf16 v[164:167], v[52:55], v[24:27], v[164:167]
    v_mfma_f32_16x16x32_bf16 v[180:183], v[52:55], v[28:31], v[180:183]
    s_waitcnt lgkmcnt(6)
    v_mfma_f32_16x16x32_bf16 v[136:139], v[56:59], v[16:19], v[136:139]
    v_mfma_f32_16x16x32_bf16 v[152:155], v[56:59], v[20:23], v[152:155]
    v_mfma_f32_16x16x32_bf16 v[168:171], v[56:59], v[24:27], v[168:171]
    v_mfma_f32_16x16x32_bf16 v[184:187], v[56:59], v[28:31], v[184:187]
    s_waitcnt lgkmcnt(2)
    v_mfma_f32_16x16x32_bf16 v[140:143], v[60:63], v[16:19], v[140:143]
    v_mfma_f32_16x16x32_bf16 v[156:159], v[60:63], v[20:23], v[156:159]
    v_mfma_f32_16x16x32_bf16 v[172:175], v[60:63], v[24:27], v[172:175]
    v_mfma_f32_16x16x32_bf16 v[188:191], v[60:63], v[28:31], v[188:191]
    v_mfma_f32_16x16x32_bf16 v[192:195], v[48:51], v[32:35], v[192:195]
    s_barrier
    v_mfma_f32_16x16x32_bf16 v[208:211], v[48:51], v[36:39], v[208:211]
    ds_read_b128 v[16:19], v8 offset:49152
    s_waitcnt lgkmcnt(2)
    v_mfma_f32_16x16x32_bf16 v[224:227], v[48:51], v[40:43], v[224:227]
    ds_read_b128 v[20:23], v8 offset:50176
    s_waitcnt lgkmcnt(2)
    v_mfma_f32_16x16x32_bf16 v[240:243], v[48:51], v[44:47], v[240:243]
    ds_read_b64_tr_b16 v[48:49], v4 offset:49152
    v_mfma_f32_16x16x32_bf16 v[196:199], v[52:55], v[32:35], v[196:199]
    ds_read_b64_tr_b16 v[50:51], v4 offset:50176
    v_mfma_f32_16x16x32_bf16 v[212:215], v[52:55], v[36:39], v[212:215]
    v_mfma_f32_16x16x32_bf16 v[228:231], v[52:55], v[40:43], v[228:231]
    ds_read_b128 v[24:27], v8 offset:51200
    v_mfma_f32_16x16x32_bf16 v[244:247], v[52:55], v[44:47], v[244:247]
    ds_read_b128 v[28:31], v8 offset:52224
    v_mfma_f32_16x16x32_bf16 v[200:203], v[56:59], v[32:35], v[200:203]
    ds_read_b64_tr_b16 v[52:53], v5 offset:49152
    v_mfma_f32_16x16x32_bf16 v[216:219], v[56:59], v[36:39], v[216:219]
    ds_read_b64_tr_b16 v[54:55], v5 offset:50176
    v_mfma_f32_16x16x32_bf16 v[232:235], v[56:59], v[40:43], v[232:235]
    v_mfma_f32_16x16x32_bf16 v[248:251], v[56:59], v[44:47], v[248:251]
    ds_read_b64_tr_b16 v[56:57], v6 offset:49152
    v_mfma_f32_16x16x32_bf16 v[204:207], v[60:63], v[32:35], v[204:207]
    ds_read_b64_tr_b16 v[58:59], v6 offset:50176
    v_mfma_f32_16x16x32_bf16 v[220:223], v[60:63], v[36:39], v[220:223]
    ds_read_b128 v[32:35], v8 offset:53248
    v_mfma_f32_16x16x32_bf16 v[236:239], v[60:63], v[40:43], v[236:239]
    ds_read_b128 v[36:39], v8 offset:54272
    v_mfma_f32_16x16x32_bf16 v[252:255], v[60:63], v[44:47], v[252:255]
    ds_read_b64_tr_b16 v[60:61], v7 offset:49152
    s_waitcnt lgkmcnt(9)
    v_mfma_f32_16x16x32_bf16 v[128:131], v[48:51], v[16:19], v[128:131]
    ds_read_b64_tr_b16 v[62:63], v7 offset:50176
    v_mfma_f32_16x16x32_bf16 v[144:147], v[48:51], v[20:23], v[144:147]
    ds_read_b128 v[40:43], v8 offset:55296
    s_waitcnt lgkmcnt(10)
    v_mfma_f32_16x16x32_bf16 v[160:163], v[48:51], v[24:27], v[160:163]
    ds_read_b128 v[44:47], v8 offset:56320
    s_waitcnt lgkmcnt(10)
    v_mfma_f32_16x16x32_bf16 v[176:179], v[48:51], v[28:31], v[176:179]
    s_waitcnt lgkmcnt(8)
    v_mfma_f32_16x16x32_bf16 v[132:135], v[52:55], v[16:19], v[132:135]
    v_mfma_f32_16x16x32_bf16 v[148:151], v[52:55], v[20:23], v[148:151]
    v_mfma_f32_16x16x32_bf16 v[164:167], v[52:55], v[24:27], v[164:167]
    v_mfma_f32_16x16x32_bf16 v[180:183], v[52:55], v[28:31], v[180:183]
    s_waitcnt lgkmcnt(6)
    v_mfma_f32_16x16x32_bf16 v[136:139], v[56:59], v[16:19], v[136:139]
    v_mfma_f32_16x16x32_bf16 v[152:155], v[56:59], v[20:23], v[152:155]
    v_mfma_f32_16x16x32_bf16 v[168:171], v[56:59], v[24:27], v[168:171]
    v_mfma_f32_16x16x32_bf16 v[184:187], v[56:59], v[28:31], v[184:187]
    s_waitcnt lgkmcnt(2)
    v_mfma_f32_16x16x32_bf16 v[140:143], v[60:63], v[16:19], v[140:143]
    v_mfma_f32_16x16x32_bf16 v[156:159], v[60:63], v[20:23], v[156:159]
    v_mfma_f32_16x16x32_bf16 v[172:175], v[60:63], v[24:27], v[172:175]
    v_mfma_f32_16x16x32_bf16 v[188:191], v[60:63], v[28:31], v[188:191]
    v_mfma_f32_16x16x32_bf16 v[192:195], v[48:51], v[32:35], v[192:195]
    s_barrier
    v_mfma_f32_16x16x32_bf16 v[208:211], v[48:51], v[36:39], v[208:211]
    ds_read_b128 v[16:19], v9 offset:0
    s_waitcnt lgkmcnt(2)
    v_mfma_f32_16x16x32_bf16 v[224:227], v[48:51], v[40:43], v[224:227]
    ds_read_b128 v[20:23], v9 offset:1024
    s_waitcnt lgkmcnt(2)
    v_mfma_f32_16x16x32_bf16 v[240:243], v[48:51], v[44:47], v[240:243]
    ds_read_b64_tr_b16 v[48:49], v10 offset:0
    v_mfma_f32_16x16x32_bf16 v[196:199], v[52:55], v[32:35], v[196:199]
    ds_read_b64_tr_b16 v[50:51], v10 offset:1024
    v_mfma_f32_16x16x32_bf16 v[212:215], v[52:55], v[36:39], v[212:215]
    v_mfma_f32_16x16x32_bf16 v[228:231], v[52:55], v[40:43], v[228:231]
    ds_read_b128 v[24:27], v9 offset:2048
    v_mfma_f32_16x16x32_bf16 v[244:247], v[52:55], v[44:47], v[244:247]
    ds_read_b128 v[28:31], v9 offset:3072
    v_mfma_f32_16x16x32_bf16 v[200:203], v[56:59], v[32:35], v[200:203]
    ds_read_b64_tr_b16 v[52:53], v11 offset:0
    v_mfma_f32_16x16x32_bf16 v[216:219], v[56:59], v[36:39], v[216:219]
    ds_read_b64_tr_b16 v[54:55], v11 offset:1024
    v_mfma_f32_16x16x32_bf16 v[232:235], v[56:59], v[40:43], v[232:235]
    v_mfma_f32_16x16x32_bf16 v[248:251], v[56:59], v[44:47], v[248:251]
    ds_read_b64_tr_b16 v[56:57], v12 offset:0
    v_mfma_f32_16x16x32_bf16 v[204:207], v[60:63], v[32:35], v[204:207]
    ds_read_b64_tr_b16 v[58:59], v12 offset:1024
    v_mfma_f32_16x16x32_bf16 v[220:223], v[60:63], v[36:39], v[220:223]
    ds_read_b128 v[32:35], v9 offset:4096
    v_mfma_f32_16x16x32_bf16 v[236:239], v[60:63], v[40:43], v[236:239]
    ds_read_b128 v[36:39], v9 offset:5120
    v_mfma_f32_16x16x32_bf16 v[252:255], v[60:63], v[44:47], v[252:255]
    ds_read_b64_tr_b16 v[60:61], v13 offset:0
    s_waitcnt lgkmcnt(9)
    v_mfma_f32_16x16x32_bf16 v[128:131], v[48:51], v[16:19], v[128:131]
    ds_read_b64_tr_b16 v[62:63], v13 offset:1024
    v_mfma_f32_16x16x32_bf16 v[144:147], v[48:51], v[20:23], v[144:147]
    ds_read_b128 v[40:43], v9 offset:6144
    s_waitcnt lgkmcnt(10)
    v_mfma_f32_16x16x32_bf16 v[160:163], v[48:51], v[24:27], v[160:163]
    ds_read_b128 v[44:47], v9 offset:7168
    s_waitcnt lgkmcnt(10)
    v_mfma_f32_16x16x32_bf16 v[176:179], v[48:51], v[28:31], v[176:179]
    s_waitcnt lgkmcnt(8)
    v_mfma_f32_16x16x32_bf16 v[132:135], v[52:55], v[16:19], v[132:135]
    v_mfma_f32_16x16x32_bf16 v[148:151], v[52:55], v[20:23], v[148:151]
    v_mfma_f32_16x16x32_bf16 v[164:167], v[52:55], v[24:27], v[164:167]
    v_mfma_f32_16x16x32_bf16 v[180:183], v[52:55], v[28:31], v[180:183]
    s_waitcnt lgkmcnt(6)
    v_mfma_f32_16x16x32_bf16 v[136:139], v[56:59], v[16:19], v[136:139]
    v_mfma_f32_16x16x32_bf16 v[152:155], v[56:59], v[20:23], v[152:155]
    v_mfma_f32_16x16x32_bf16 v[168:171], v[56:59], v[24:27], v[168:171]
    v_mfma_f32_16x16x32_bf16 v[184:187], v[56:59], v[28:31], v[184:187]
    s_waitcnt lgkmcnt(2)
    v_mfma_f32_16x16x32_bf16 v[140:143], v[60:63], v[16:19], v[140:143]
    v_mfma_f32_16x16x32_bf16 v[156:159], v[60:63], v[20:23], v[156:159]
    v_mfma_f32_16x16x32_bf16 v[172:175], v[60:63], v[24:27], v[172:175]
    v_mfma_f32_16x16x32_bf16 v[188:191], v[60:63], v[28:31], v[188:191]
    v_mfma_f32_16x16x32_bf16 v[192:195], v[48:51], v[32:35], v[192:195]
    s_barrier
    v_mfma_f32_16x16x32_bf16 v[208:211], v[48:51], v[36:39], v[208:211]
    ds_read_b128 v[16:19], v9 offset:24576
    s_waitcnt lgkmcnt(2)
    v_mfma_f32_16x16x32_bf16 v[224:227], v[48:51], v[40:43], v[224:227]
    ds_read_b128 v[20:23], v9 offset:25600
    s_waitcnt lgkmcnt(2)
    v_mfma_f32_16x16x32_bf16 v[240:243], v[48:51], v[44:47], v[240:243]
    ds_read_b64_tr_b16 v[48:49], v10 offset:24576
    v_mfma_f32_16x16x32_bf16 v[196:199], v[52:55], v[32:35], v[196:199]
    ds_read_b64_tr_b16 v[50:51], v10 offset:25600
    v_mfma_f32_16x16x32_bf16 v[212:215], v[52:55], v[36:39], v[212:215]
    v_mfma_f32_16x16x32_bf16 v[228:231], v[52:55], v[40:43], v[228:231]
    ds_read_b128 v[24:27], v9 offset:26624
    v_mfma_f32_16x16x32_bf16 v[244:247], v[52:55], v[44:47], v[244:247]
    ds_read_b128 v[28:31], v9 offset:27648
    v_mfma_f32_16x16x32_bf16 v[200:203], v[56:59], v[32:35], v[200:203]
    ds_read_b64_tr_b16 v[52:53], v11 offset:24576
    v_mfma_f32_16x16x32_bf16 v[216:219], v[56:59], v[36:39], v[216:219]
    ds_read_b64_tr_b16 v[54:55], v11 offset:25600
    v_mfma_f32_16x16x32_bf16 v[232:235], v[56:59], v[40:43], v[232:235]
    v_mfma_f32_16x16x32_bf16 v[248:251], v[56:59], v[44:47], v[248:251]
    ds_read_b64_tr_b16 v[56:57], v12 offset:24576
    v_mfma_f32_16x16x32_bf16 v[204:207], v[60:63], v[32:35], v[204:207]
    ds_read_b64_tr_b16 v[58:59], v12 offset:25600
    v_mfma_f32_16x16x32_bf16 v[220:223], v[60:63], v[36:39], v[220:223]
    ds_read_b128 v[32:35], v9 offset:28672
    v_mfma_f32_16x16x32_bf16 v[236:239], v[60:63], v[40:43], v[236:239]
    ds_read_b128 v[36:39], v9 offset:29696
    v_mfma_f32_16x16x32_bf16 v[252:255], v[60:63], v[44:47], v[252:255]
    ds_read_b64_tr_b16 v[60:61], v13 offset:24576
    s_waitcnt lgkmcnt(9)
    v_mfma_f32_16x16x32_bf16 v[128:131], v[48:51], v[16:19], v[128:131]
    ds_read_b64_tr_b16 v[62:63], v13 offset:25600
    v_mfma_f32_16x16x32_bf16 v[144:147], v[48:51], v[20:23], v[144:147]
    ds_read_b128 v[40:43], v9 offset:30720
    s_waitcnt lgkmcnt(10)
    v_mfma_f32_16x16x32_bf16 v[160:163], v[48:51], v[24:27], v[160:163]
    ds_read_b128 v[44:47], v9 offset:31744
    s_waitcnt lgkmcnt(10)
    v_mfma_f32_16x16x32_bf16 v[176:179], v[48:51], v[28:31], v[176:179]
    s_waitcnt lgkmcnt(8)
    v_mfma_f32_16x16x32_bf16 v[132:135], v[52:55], v[16:19], v[132:135]
    v_mfma_f32_16x16x32_bf16 v[148:151], v[52:55], v[20:23], v[148:151]
    v_mfma_f32_16x16x32_bf16 v[164:167], v[52:55], v[24:27], v[164:167]
    v_mfma_f32_16x16x32_bf16 v[180:183], v[52:55], v[28:31], v[180:183]
    s_waitcnt lgkmcnt(6)
    v_mfma_f32_16x16x32_bf16 v[136:139], v[56:59], v[16:19], v[136:139]
    v_mfma_f32_16x16x32_bf16 v[152:155], v[56:59], v[20:23], v[152:155]
    v_mfma_f32_16x16x32_bf16 v[168:171], v[56:59], v[24:27], v[168:171]
    v_mfma_f32_16x16x32_bf16 v[184:187], v[56:59], v[28:31], v[184:187]
    s_waitcnt lgkmcnt(2)
    v_mfma_f32_16x16x32_bf16 v[140:143], v[60:63], v[16:19], v[140:143]
    v_mfma_f32_16x16x32_bf16 v[156:159], v[60:63], v[20:23], v[156:159]
    v_mfma_f32_16x16x32_bf16 v[172:175], v[60:63], v[24:27], v[172:175]
    v_mfma_f32_16x16x32_bf16 v[188:191], v[60:63], v[28:31], v[188:191]
    v_mfma_f32_16x16x32_bf16 v[192:195], v[48:51], v[32:35], v[192:195]
    s_barrier
    v_mfma_f32_16x16x32_bf16 v[208:211], v[48:51], v[36:39], v[208:211]
    ds_read_b128 v[16:19], v9 offset:49152
    s_waitcnt lgkmcnt(2)
    v_mfma_f32_16x16x32_bf16 v[224:227], v[48:51], v[40:43], v[224:227]
    ds_read_b128 v[20:23], v9 offset:50176
    s_waitcnt lgkmcnt(2)
    v_mfma_f32_16x16x32_bf16 v[240:243], v[48:51], v[44:47], v[240:243]
    ds_read_b64_tr_b16 v[48:49], v10 offset:49152
    v_mfma_f32_16x16x32_bf16 v[196:199], v[52:55], v[32:35], v[196:199]
    ds_read_b64_tr_b16 v[50:51], v10 offset:50176
    v_mfma_f32_16x16x32_bf16 v[212:215], v[52:55], v[36:39], v[212:215]
    v_mfma_f32_16x16x32_bf16 v[228:231], v[52:55], v[40:43], v[228:231]
    ds_read_b128 v[24:27], v9 offset:51200
    v_mfma_f32_16x16x32_bf16 v[244:247], v[52:55], v[44:47], v[244:247]
    ds_read_b128 v[28:31], v9 offset:52224
    v_mfma_f32_16x16x32_bf16 v[200:203], v[56:59], v[32:35], v[200:203]
    ds_read_b64_tr_b16 v[52:53], v11 offset:49152
    v_mfma_f32_16x16x32_bf16 v[216:219], v[56:59], v[36:39], v[216:219]
    ds_read_b64_tr_b16 v[54:55], v11 offset:50176
    v_mfma_f32_16x16x32_bf16 v[232:235], v[56:59], v[40:43], v[232:235]
    v_mfma_f32_16x16x32_bf16 v[248:251], v[56:59], v[44:47], v[248:251]
    ds_read_b64_tr_b16 v[56:57], v12 offset:49152
    v_mfma_f32_16x16x32_bf16 v[204:207], v[60:63], v[32:35], v[204:207]
    ds_read_b64_tr_b16 v[58:59], v12 offset:50176
    v_mfma_f32_16x16x32_bf16 v[220:223], v[60:63], v[36:39], v[220:223]
    ds_read_b128 v[32:35], v9 offset:53248
    v_mfma_f32_16x16x32_bf16 v[236:239], v[60:63], v[40:43], v[236:239]
    ds_read_b128 v[36:39], v9 offset:54272
    v_mfma_f32_16x16x32_bf16 v[252:255], v[60:63], v[44:47], v[252:255]
    ds_read_b64_tr_b16 v[60:61], v13 offset:49152
    s_waitcnt lgkmcnt(9)
    v_mfma_f32_16x16x32_bf16 v[128:131], v[48:51], v[16:19], v[128:131]
    ds_read_b64_tr_b16 v[62:63], v13 offset:50176
    v_mfma_f32_16x16x32_bf16 v[144:147], v[48:51], v[20:23], v[144:147]
    ds_read_b128 v[40:43], v9 offset:55296
    s_waitcnt lgkmcnt(10)
    v_mfma_f32_16x16x32_bf16 v[160:163], v[48:51], v[24:27], v[160:163]
    ds_read_b128 v[44:47], v9 offset:56320
    s_waitcnt lgkmcnt(10)
    v_mfma_f32_16x16x32_bf16 v[176:179], v[48:51], v[28:31], v[176:179]
    s_waitcnt lgkmcnt(8)
    v_mfma_f32_16x16x32_bf16 v[132:135], v[52:55], v[16:19], v[132:135]
    v_mfma_f32_16x16x32_bf16 v[148:151], v[52:55], v[20:23], v[148:151]
    v_mfma_f32_16x16x32_bf16 v[164:167], v[52:55], v[24:27], v[164:167]
    v_mfma_f32_16x16x32_bf16 v[180:183], v[52:55], v[28:31], v[180:183]
    s_waitcnt lgkmcnt(6)
    v_mfma_f32_16x16x32_bf16 v[136:139], v[56:59], v[16:19], v[136:139]
    v_mfma_f32_16x16x32_bf16 v[152:155], v[56:59], v[20:23], v[152:155]
    v_mfma_f32_16x16x32_bf16 v[168:171], v[56:59], v[24:27], v[168:171]
    v_mfma_f32_16x16x32_bf16 v[184:187], v[56:59], v[28:31], v[184:187]
    s_waitcnt lgkmcnt(2)
    v_mfma_f32_16x16x32_bf16 v[140:143], v[60:63], v[16:19], v[140:143]
    v_mfma_f32_16x16x32_bf16 v[156:159], v[60:63], v[20:23], v[156:159]
    v_mfma_f32_16x16x32_bf16 v[172:175], v[60:63], v[24:27], v[172:175]
    v_mfma_f32_16x16x32_bf16 v[188:191], v[60:63], v[28:31], v[188:191]
    v_mfma_f32_16x16x32_bf16 v[192:195], v[48:51], v[32:35], v[192:195]
    s_barrier
    v_mfma_f32_16x16x32_bf16 v[208:211], v[48:51], v[36:39], v[208:211]
    ds_read_b128 v[16:19], v8 offset:0
    s_waitcnt lgkmcnt(2)
    v_mfma_f32_16x16x32_bf16 v[224:227], v[48:51], v[40:43], v[224:227]
    ds_read_b128 v[20:23], v8 offset:1024
    s_waitcnt lgkmcnt(2)
    v_mfma_f32_16x16x32_bf16 v[240:243], v[48:51], v[44:47], v[240:243]
    ds_read_b64_tr_b16 v[48:49], v4 offset:0
    v_mfma_f32_16x16x32_bf16 v[196:199], v[52:55], v[32:35], v[196:199]
    ds_read_b64_tr_b16 v[50:51], v4 offset:1024
    v_mfma_f32_16x16x32_bf16 v[212:215], v[52:55], v[36:39], v[212:215]
    v_mfma_f32_16x16x32_bf16 v[228:231], v[52:55], v[40:43], v[228:231]
    ds_read_b128 v[24:27], v8 offset:2048
    v_mfma_f32_16x16x32_bf16 v[244:247], v[52:55], v[44:47], v[244:247]
    ds_read_b128 v[28:31], v8 offset:3072
    v_mfma_f32_16x16x32_bf16 v[200:203], v[56:59], v[32:35], v[200:203]
    ds_read_b64_tr_b16 v[52:53], v5 offset:0
    v_mfma_f32_16x16x32_bf16 v[216:219], v[56:59], v[36:39], v[216:219]
    ds_read_b64_tr_b16 v[54:55], v5 offset:1024
    v_mfma_f32_16x16x32_bf16 v[232:235], v[56:59], v[40:43], v[232:235]
    v_mfma_f32_16x16x32_bf16 v[248:251], v[56:59], v[44:47], v[248:251]
    ds_read_b64_tr_b16 v[56:57], v6 offset:0
    v_mfma_f32_16x16x32_bf16 v[204:207], v[60:63], v[32:35], v[204:207]
    ds_read_b64_tr_b16 v[58:59], v6 offset:1024
    v_mfma_f32_16x16x32_bf16 v[220:223], v[60:63], v[36:39], v[220:223]
    ds_read_b128 v[32:35], v8 offset:4096
    v_mfma_f32_16x16x32_bf16 v[236:239], v[60:63], v[40:43], v[236:239]
    ds_read_b128 v[36:39], v8 offset:5120
    v_mfma_f32_16x16x32_bf16 v[252:255], v[60:63], v[44:47], v[252:255]
    ds_read_b64_tr_b16 v[60:61], v7 offset:0
    s_waitcnt lgkmcnt(9)
    v_mfma_f32_16x16x32_bf16 v[128:131], v[48:51], v[16:19], v[128:131]
    ds_read_b64_tr_b16 v[62:63], v7 offset:1024
    v_mfma_f32_16x16x32_bf16 v[144:147], v[48:51], v[20:23], v[144:147]
    ds_read_b128 v[40:43], v8 offset:6144
    s_waitcnt lgkmcnt(10)
    v_mfma_f32_16x16x32_bf16 v[160:163], v[48:51], v[24:27], v[160:163]
    ds_read_b128 v[44:47], v8 offset:7168
    s_waitcnt lgkmcnt(10)
    v_mfma_f32_16x16x32_bf16 v[176:179], v[48:51], v[28:31], v[176:179]
    s_waitcnt lgkmcnt(8)
    v_mfma_f32_16x16x32_bf16 v[132:135], v[52:55], v[16:19], v[132:135]
    v_mfma_f32_16x16x32_bf16 v[148:151], v[52:55], v[20:23], v[148:151]
    v_mfma_f32_16x16x32_bf16 v[164:167], v[52:55], v[24:27], v[164:167]
    v_mfma_f32_16x16x32_bf16 v[180:183], v[52:55], v[28:31], v[180:183]
    s_waitcnt lgkmcnt(6)
    v_mfma_f32_16x16x32_bf16 v[136:139], v[56:59], v[16:19], v[136:139]
    v_mfma_f32_16x16x32_bf16 v[152:155], v[56:59], v[20:23], v[152:155]
    v_mfma_f32_16x16x32_bf16 v[168:171], v[56:59], v[24:27], v[168:171]
    v_mfma_f32_16x16x32_bf16 v[184:187], v[56:59], v[28:31], v[184:187]
    s_waitcnt lgkmcnt(2)
    v_mfma_f32_16x16x32_bf16 v[140:143], v[60:63], v[16:19], v[140:143]
    v_mfma_f32_16x16x32_bf16 v[156:159], v[60:63], v[20:23], v[156:159]
    v_mfma_f32_16x16x32_bf16 v[172:175], v[60:63], v[24:27], v[172:175]
    v_mfma_f32_16x16x32_bf16 v[188:191], v[60:63], v[28:31], v[188:191]
    v_mfma_f32_16x16x32_bf16 v[192:195], v[48:51], v[32:35], v[192:195]
    s_barrier
    v_mfma_f32_16x16x32_bf16 v[208:211], v[48:51], v[36:39], v[208:211]
    ds_read_b128 v[16:19], v8 offset:24576
    s_waitcnt lgkmcnt(2)
    v_mfma_f32_16x16x32_bf16 v[224:227], v[48:51], v[40:43], v[224:227]
    ds_read_b128 v[20:23], v8 offset:25600
    s_waitcnt lgkmcnt(2)
    v_mfma_f32_16x16x32_bf16 v[240:243], v[48:51], v[44:47], v[240:243]
    ds_read_b64_tr_b16 v[48:49], v4 offset:24576
    v_mfma_f32_16x16x32_bf16 v[196:199], v[52:55], v[32:35], v[196:199]
    ds_read_b64_tr_b16 v[50:51], v4 offset:25600
    v_mfma_f32_16x16x32_bf16 v[212:215], v[52:55], v[36:39], v[212:215]
    v_mfma_f32_16x16x32_bf16 v[228:231], v[52:55], v[40:43], v[228:231]
    ds_read_b128 v[24:27], v8 offset:26624
    v_mfma_f32_16x16x32_bf16 v[244:247], v[52:55], v[44:47], v[244:247]
    ds_read_b128 v[28:31], v8 offset:27648
    v_mfma_f32_16x16x32_bf16 v[200:203], v[56:59], v[32:35], v[200:203]
    ds_read_b64_tr_b16 v[52:53], v5 offset:24576
    v_mfma_f32_16x16x32_bf16 v[216:219], v[56:59], v[36:39], v[216:219]
    ds_read_b64_tr_b16 v[54:55], v5 offset:25600
    v_mfma_f32_16x16x32_bf16 v[232:235], v[56:59], v[40:43], v[232:235]
    v_mfma_f32_16x16x32_bf16 v[248:251], v[56:59], v[44:47], v[248:251]
    ds_read_b64_tr_b16 v[56:57], v6 offset:24576
    v_mfma_f32_16x16x32_bf16 v[204:207], v[60:63], v[32:35], v[204:207]
    ds_read_b64_tr_b16 v[58:59], v6 offset:25600
    v_mfma_f32_16x16x32_bf16 v[220:223], v[60:63], v[36:39], v[220:223]
    ds_read_b128 v[32:35], v8 offset:28672
    v_mfma_f32_16x16x32_bf16 v[236:239], v[60:63], v[40:43], v[236:239]
    ds_read_b128 v[36:39], v8 offset:29696
    v_mfma_f32_16x16x32_bf16 v[252:255], v[60:63], v[44:47], v[252:255]
    ds_read_b64_tr_b16 v[60:61], v7 offset:24576
    s_waitcnt lgkmcnt(9)
    v_mfma_f32_16x16x32_bf16 v[128:131], v[48:51], v[16:19], v[128:131]
    ds_read_b64_tr_b16 v[62:63], v7 offset:25600
    v_mfma_f32_16x16x32_bf16 v[144:147], v[48:51], v[20:23], v[144:147]
    ds_read_b128 v[40:43], v8 offset:30720
    s_waitcnt lgkmcnt(10)
    v_mfma_f32_16x16x32_bf16 v[160:163], v[48:51], v[24:27], v[160:163]
    ds_read_b128 v[44:47], v8 offset:31744
    s_waitcnt lgkmcnt(10)
    v_mfma_f32_16x16x32_bf16 v[176:179], v[48:51], v[28:31], v[176:179]
    s_waitcnt lgkmcnt(8)
    v_mfma_f32_16x16x32_bf16 v[132:135], v[52:55], v[16:19], v[132:135]
    v_mfma_f32_16x16x32_bf16 v[148:151], v[52:55], v[20:23], v[148:151]
    v_mfma_f32_16x16x32_bf16 v[164:167], v[52:55], v[24:27], v[164:167]
    v_mfma_f32_16x16x32_bf16 v[180:183], v[52:55], v[28:31], v[180:183]
    s_waitcnt lgkmcnt(6)
    v_mfma_f32_16x16x32_bf16 v[136:139], v[56:59], v[16:19], v[136:139]
    v_mfma_f32_16x16x32_bf16 v[152:155], v[56:59], v[20:23], v[152:155]
    v_mfma_f32_16x16x32_bf16 v[168:171], v[56:59], v[24:27], v[168:171]
    v_mfma_f32_16x16x32_bf16 v[184:187], v[56:59], v[28:31], v[184:187]
    s_waitcnt lgkmcnt(2)
    v_mfma_f32_16x16x32_bf16 v[140:143], v[60:63], v[16:19], v[140:143]
    v_mfma_f32_16x16x32_bf16 v[156:159], v[60:63], v[20:23], v[156:159]
    v_mfma_f32_16x16x32_bf16 v[172:175], v[60:63], v[24:27], v[172:175]
    v_mfma_f32_16x16x32_bf16 v[188:191], v[60:63], v[28:31], v[188:191]
    v_mfma_f32_16x16x32_bf16 v[192:195], v[48:51], v[32:35], v[192:195]
    s_barrier
    v_mfma_f32_16x16x32_bf16 v[208:211], v[48:51], v[36:39], v[208:211]
    ds_read_b128 v[16:19], v8 offset:49152
    s_waitcnt lgkmcnt(2)
    v_mfma_f32_16x16x32_bf16 v[224:227], v[48:51], v[40:43], v[224:227]
    ds_read_b128 v[20:23], v8 offset:50176
    s_waitcnt lgkmcnt(2)
    v_mfma_f32_16x16x32_bf16 v[240:243], v[48:51], v[44:47], v[240:243]
    ds_read_b64_tr_b16 v[48:49], v4 offset:49152
    v_mfma_f32_16x16x32_bf16 v[196:199], v[52:55], v[32:35], v[196:199]
    ds_read_b64_tr_b16 v[50:51], v4 offset:50176
    v_mfma_f32_16x16x32_bf16 v[212:215], v[52:55], v[36:39], v[212:215]
    v_mfma_f32_16x16x32_bf16 v[228:231], v[52:55], v[40:43], v[228:231]
    ds_read_b128 v[24:27], v8 offset:51200
    v_mfma_f32_16x16x32_bf16 v[244:247], v[52:55], v[44:47], v[244:247]
    ds_read_b128 v[28:31], v8 offset:52224
    v_mfma_f32_16x16x32_bf16 v[200:203], v[56:59], v[32:35], v[200:203]
    ds_read_b64_tr_b16 v[52:53], v5 offset:49152
    v_mfma_f32_16x16x32_bf16 v[216:219], v[56:59], v[36:39], v[216:219]
    ds_read_b64_tr_b16 v[54:55], v5 offset:50176
    v_mfma_f32_16x16x32_bf16 v[232:235], v[56:59], v[40:43], v[232:235]
    v_mfma_f32_16x16x32_bf16 v[248:251], v[56:59], v[44:47], v[248:251]
    ds_read_b64_tr_b16 v[56:57], v6 offset:49152
    v_mfma_f32_16x16x32_bf16 v[204:207], v[60:63], v[32:35], v[204:207]
    ds_read_b64_tr_b16 v[58:59], v6 offset:50176
    v_mfma_f32_16x16x32_bf16 v[220:223], v[60:63], v[36:39], v[220:223]
    ds_read_b128 v[32:35], v8 offset:53248
    v_mfma_f32_16x16x32_bf16 v[236:239], v[60:63], v[40:43], v[236:239]
    ds_read_b128 v[36:39], v8 offset:54272
    v_mfma_f32_16x16x32_bf16 v[252:255], v[60:63], v[44:47], v[252:255]
    ds_read_b64_tr_b16 v[60:61], v7 offset:49152
    s_waitcnt lgkmcnt(9)
    v_mfma_f32_16x16x32_bf16 v[128:131], v[48:51], v[16:19], v[128:131]
    ds_read_b64_tr_b16 v[62:63], v7 offset:50176
    v_mfma_f32_16x16x32_bf16 v[144:147], v[48:51], v[20:23], v[144:147]
    ds_read_b128 v[40:43], v8 offset:55296
    s_waitcnt lgkmcnt(10)
    v_mfma_f32_16x16x32_bf16 v[160:163], v[48:51], v[24:27], v[160:163]
    ds_read_b128 v[44:47], v8 offset:56320
    s_waitcnt lgkmcnt(10)
    v_mfma_f32_16x16x32_bf16 v[176:179], v[48:51], v[28:31], v[176:179]
    s_waitcnt lgkmcnt(8)
    v_mfma_f32_16x16x32_bf16 v[132:135], v[52:55], v[16:19], v[132:135]
    v_mfma_f32_16x16x32_bf16 v[148:151], v[52:55], v[20:23], v[148:151]
    v_mfma_f32_16x16x32_bf16 v[164:167], v[52:55], v[24:27], v[164:167]
    v_mfma_f32_16x16x32_bf16 v[180:183], v[52:55], v[28:31], v[180:183]
    s_waitcnt lgkmcnt(6)
    v_mfma_f32_16x16x32_bf16 v[136:139], v[56:59], v[16:19], v[136:139]
    v_mfma_f32_16x16x32_bf16 v[152:155], v[56:59], v[20:23], v[152:155]
    v_mfma_f32_16x16x32_bf16 v[168:171], v[56:59], v[24:27], v[168:171]
    v_mfma_f32_16x16x32_bf16 v[184:187], v[56:59], v[28:31], v[184:187]
    s_waitcnt lgkmcnt(2)
    v_mfma_f32_16x16x32_bf16 v[140:143], v[60:63], v[16:19], v[140:143]
    v_mfma_f32_16x16x32_bf16 v[156:159], v[60:63], v[20:23], v[156:159]
    v_mfma_f32_16x16x32_bf16 v[172:175], v[60:63], v[24:27], v[172:175]
    v_mfma_f32_16x16x32_bf16 v[188:191], v[60:63], v[28:31], v[188:191]
    v_mfma_f32_16x16x32_bf16 v[192:195], v[48:51], v[32:35], v[192:195]
    s_barrier
    v_mfma_f32_16x16x32_bf16 v[208:211], v[48:51], v[36:39], v[208:211]
    ds_read_b128 v[16:19], v9 offset:0
    s_waitcnt lgkmcnt(2)
    v_mfma_f32_16x16x32_bf16 v[224:227], v[48:51], v[40:43], v[224:227]
    ds_read_b128 v[20:23], v9 offset:1024
    s_waitcnt lgkmcnt(2)
    v_mfma_f32_16x16x32_bf16 v[240:243], v[48:51], v[44:47], v[240:243]
    ds_read_b64_tr_b16 v[48:49], v10 offset:0
    v_mfma_f32_16x16x32_bf16 v[196:199], v[52:55], v[32:35], v[196:199]
    ds_read_b64_tr_b16 v[50:51], v10 offset:1024
    v_mfma_f32_16x16x32_bf16 v[212:215], v[52:55], v[36:39], v[212:215]
    v_mfma_f32_16x16x32_bf16 v[228:231], v[52:55], v[40:43], v[228:231]
    ds_read_b128 v[24:27], v9 offset:2048
    v_mfma_f32_16x16x32_bf16 v[244:247], v[52:55], v[44:47], v[244:247]
    ds_read_b128 v[28:31], v9 offset:3072
    v_mfma_f32_16x16x32_bf16 v[200:203], v[56:59], v[32:35], v[200:203]
    ds_read_b64_tr_b16 v[52:53], v11 offset:0
    v_mfma_f32_16x16x32_bf16 v[216:219], v[56:59], v[36:39], v[216:219]
    ds_read_b64_tr_b16 v[54:55], v11 offset:1024
    v_mfma_f32_16x16x32_bf16 v[232:235], v[56:59], v[40:43], v[232:235]
    v_mfma_f32_16x16x32_bf16 v[248:251], v[56:59], v[44:47], v[248:251]
    ds_read_b64_tr_b16 v[56:57], v12 offset:0
    v_mfma_f32_16x16x32_bf16 v[204:207], v[60:63], v[32:35], v[204:207]
    ds_read_b64_tr_b16 v[58:59], v12 offset:1024
    v_mfma_f32_16x16x32_bf16 v[220:223], v[60:63], v[36:39], v[220:223]
    ds_read_b128 v[32:35], v9 offset:4096
    v_mfma_f32_16x16x32_bf16 v[236:239], v[60:63], v[40:43], v[236:239]
    ds_read_b128 v[36:39], v9 offset:5120
    v_mfma_f32_16x16x32_bf16 v[252:255], v[60:63], v[44:47], v[252:255]
    ds_read_b64_tr_b16 v[60:61], v13 offset:0
    s_waitcnt lgkmcnt(9)
    v_mfma_f32_16x16x32_bf16 v[128:131], v[48:51], v[16:19], v[128:131]
    ds_read_b64_tr_b16 v[62:63], v13 offset:1024
    v_mfma_f32_16x16x32_bf16 v[144:147], v[48:51], v[20:23], v[144:147]
    ds_read_b128 v[40:43], v9 offset:6144
    s_waitcnt lgkmcnt(10)
    v_mfma_f32_16x16x32_bf16 v[160:163], v[48:51], v[24:27], v[160:163]
    ds_read_b128 v[44:47], v9 offset:7168
    s_waitcnt lgkmcnt(10)
    v_mfma_f32_16x16x32_bf16 v[176:179], v[48:51], v[28:31], v[176:179]
    s_waitcnt lgkmcnt(8)
    v_mfma_f32_16x16x32_bf16 v[132:135], v[52:55], v[16:19], v[132:135]
    v_mfma_f32_16x16x32_bf16 v[148:151], v[52:55], v[20:23], v[148:151]
    v_mfma_f32_16x16x32_bf16 v[164:167], v[52:55], v[24:27], v[164:167]
    v_mfma_f32_16x16x32_bf16 v[180:183], v[52:55], v[28:31], v[180:183]
    s_waitcnt lgkmcnt(6)
    v_mfma_f32_16x16x32_bf16 v[136:139], v[56:59], v[16:19], v[136:139]
    v_mfma_f32_16x16x32_bf16 v[152:155], v[56:59], v[20:23], v[152:155]
    v_mfma_f32_16x16x32_bf16 v[168:171], v[56:59], v[24:27], v[168:171]
    v_mfma_f32_16x16x32_bf16 v[184:187], v[56:59], v[28:31], v[184:187]
    s_waitcnt lgkmcnt(2)
    v_mfma_f32_16x16x32_bf16 v[140:143], v[60:63], v[16:19], v[140:143]
    v_mfma_f32_16x16x32_bf16 v[156:159], v[60:63], v[20:23], v[156:159]
    v_mfma_f32_16x16x32_bf16 v[172:175], v[60:63], v[24:27], v[172:175]
    v_mfma_f32_16x16x32_bf16 v[188:191], v[60:63], v[28:31], v[188:191]
    v_mfma_f32_16x16x32_bf16 v[192:195], v[48:51], v[32:35], v[192:195]
    buffer_load_dwordx2 v[66:67], v15, s[12:15], s37 offen offset:0
    buffer_load_dwordx2 v[68:69], v15, s[12:15], s37 offen offset:32
    buffer_load_dwordx2 v[70:71], v15, s[12:15], s37 offen offset:64
    buffer_load_dwordx2 v[72:73], v15, s[12:15], s37 offen offset:96
    buffer_load_dwordx2 v[74:75], v15, s[12:15], s38 offen offset:0
    s_barrier
    v_mfma_f32_16x16x32_bf16 v[208:211], v[48:51], v[36:39], v[208:211]
    ds_read_b128 v[16:19], v9 offset:24576
    s_waitcnt lgkmcnt(2)
    v_mfma_f32_16x16x32_bf16 v[224:227], v[48:51], v[40:43], v[224:227]
    ds_read_b128 v[20:23], v9 offset:25600
    s_waitcnt lgkmcnt(2)
    v_mfma_f32_16x16x32_bf16 v[240:243], v[48:51], v[44:47], v[240:243]
    ds_read_b64_tr_b16 v[48:49], v10 offset:24576
    v_mfma_f32_16x16x32_bf16 v[196:199], v[52:55], v[32:35], v[196:199]
    ds_read_b64_tr_b16 v[50:51], v10 offset:25600
    v_mfma_f32_16x16x32_bf16 v[212:215], v[52:55], v[36:39], v[212:215]
    v_mfma_f32_16x16x32_bf16 v[228:231], v[52:55], v[40:43], v[228:231]
    ds_read_b128 v[24:27], v9 offset:26624
    v_mfma_f32_16x16x32_bf16 v[244:247], v[52:55], v[44:47], v[244:247]
    ds_read_b128 v[28:31], v9 offset:27648
    v_mfma_f32_16x16x32_bf16 v[200:203], v[56:59], v[32:35], v[200:203]
    ds_read_b64_tr_b16 v[52:53], v11 offset:24576
    v_mfma_f32_16x16x32_bf16 v[216:219], v[56:59], v[36:39], v[216:219]
    ds_read_b64_tr_b16 v[54:55], v11 offset:25600
    v_mfma_f32_16x16x32_bf16 v[232:235], v[56:59], v[40:43], v[232:235]
    v_mfma_f32_16x16x32_bf16 v[248:251], v[56:59], v[44:47], v[248:251]
    ds_read_b64_tr_b16 v[56:57], v12 offset:24576
    v_mfma_f32_16x16x32_bf16 v[204:207], v[60:63], v[32:35], v[204:207]
    ds_read_b64_tr_b16 v[58:59], v12 offset:25600
    v_mfma_f32_16x16x32_bf16 v[220:223], v[60:63], v[36:39], v[220:223]
    ds_read_b128 v[32:35], v9 offset:28672
    v_mfma_f32_16x16x32_bf16 v[236:239], v[60:63], v[40:43], v[236:239]
    ds_read_b128 v[36:39], v9 offset:29696
    v_mfma_f32_16x16x32_bf16 v[252:255], v[60:63], v[44:47], v[252:255]
    ds_read_b64_tr_b16 v[60:61], v13 offset:24576
    s_waitcnt lgkmcnt(9)
    v_mfma_f32_16x16x32_bf16 v[128:131], v[48:51], v[16:19], v[128:131]
    ds_read_b64_tr_b16 v[62:63], v13 offset:25600
    v_mfma_f32_16x16x32_bf16 v[144:147], v[48:51], v[20:23], v[144:147]
    ds_read_b128 v[40:43], v9 offset:30720
    s_waitcnt lgkmcnt(10)
    v_mfma_f32_16x16x32_bf16 v[160:163], v[48:51], v[24:27], v[160:163]
    ds_read_b128 v[44:47], v9 offset:31744
    s_waitcnt lgkmcnt(10)
    v_mfma_f32_16x16x32_bf16 v[176:179], v[48:51], v[28:31], v[176:179]
    s_waitcnt lgkmcnt(8)
    v_mfma_f32_16x16x32_bf16 v[132:135], v[52:55], v[16:19], v[132:135]
    v_mfma_f32_16x16x32_bf16 v[148:151], v[52:55], v[20:23], v[148:151]
    v_mfma_f32_16x16x32_bf16 v[164:167], v[52:55], v[24:27], v[164:167]
    v_mfma_f32_16x16x32_bf16 v[180:183], v[52:55], v[28:31], v[180:183]
    s_waitcnt lgkmcnt(6)
    v_mfma_f32_16x16x32_bf16 v[136:139], v[56:59], v[16:19], v[136:139]
    v_mfma_f32_16x16x32_bf16 v[152:155], v[56:59], v[20:23], v[152:155]
    v_mfma_f32_16x16x32_bf16 v[168:171], v[56:59], v[24:27], v[168:171]
    v_mfma_f32_16x16x32_bf16 v[184:187], v[56:59], v[28:31], v[184:187]
    s_waitcnt lgkmcnt(2)
    v_mfma_f32_16x16x32_bf16 v[140:143], v[60:63], v[16:19], v[140:143]
    v_mfma_f32_16x16x32_bf16 v[156:159], v[60:63], v[20:23], v[156:159]
    v_mfma_f32_16x16x32_bf16 v[172:175], v[60:63], v[24:27], v[172:175]
    v_mfma_f32_16x16x32_bf16 v[188:191], v[60:63], v[28:31], v[188:191]
    v_mfma_f32_16x16x32_bf16 v[192:195], v[48:51], v[32:35], v[192:195]
    buffer_load_dwordx2 v[76:77], v15, s[12:15], s38 offen offset:32
    buffer_load_dwordx2 v[78:79], v15, s[12:15], s38 offen offset:64
    buffer_load_dwordx2 v[80:81], v15, s[12:15], s38 offen offset:96
    buffer_load_ushort v82, v2, s[16:19], s39 offen
    buffer_load_ushort v83, v2, s[16:19], s39 offen offset:32
    s_barrier
    v_mfma_f32_16x16x32_bf16 v[208:211], v[48:51], v[36:39], v[208:211]
    ds_read_b128 v[16:19], v9 offset:49152
    s_waitcnt lgkmcnt(2)
    v_mfma_f32_16x16x32_bf16 v[224:227], v[48:51], v[40:43], v[224:227]
    ds_read_b128 v[20:23], v9 offset:50176
    s_waitcnt lgkmcnt(2)
    v_mfma_f32_16x16x32_bf16 v[240:243], v[48:51], v[44:47], v[240:243]
    ds_read_b64_tr_b16 v[48:49], v10 offset:49152
    v_mfma_f32_16x16x32_bf16 v[196:199], v[52:55], v[32:35], v[196:199]
    ds_read_b64_tr_b16 v[50:51], v10 offset:50176
    v_mfma_f32_16x16x32_bf16 v[212:215], v[52:55], v[36:39], v[212:215]
    v_mfma_f32_16x16x32_bf16 v[228:231], v[52:55], v[40:43], v[228:231]
    ds_read_b128 v[24:27], v9 offset:51200
    v_mfma_f32_16x16x32_bf16 v[244:247], v[52:55], v[44:47], v[244:247]
    ds_read_b128 v[28:31], v9 offset:52224
    v_mfma_f32_16x16x32_bf16 v[200:203], v[56:59], v[32:35], v[200:203]
    ds_read_b64_tr_b16 v[52:53], v11 offset:49152
    v_mfma_f32_16x16x32_bf16 v[216:219], v[56:59], v[36:39], v[216:219]
    ds_read_b64_tr_b16 v[54:55], v11 offset:50176
    v_mfma_f32_16x16x32_bf16 v[232:235], v[56:59], v[40:43], v[232:235]
    v_mfma_f32_16x16x32_bf16 v[248:251], v[56:59], v[44:47], v[248:251]
    ds_read_b64_tr_b16 v[56:57], v12 offset:49152
    v_mfma_f32_16x16x32_bf16 v[204:207], v[60:63], v[32:35], v[204:207]
    ds_read_b64_tr_b16 v[58:59], v12 offset:50176
    v_mfma_f32_16x16x32_bf16 v[220:223], v[60:63], v[36:39], v[220:223]
    ds_read_b128 v[32:35], v9 offset:53248
    v_mfma_f32_16x16x32_bf16 v[236:239], v[60:63], v[40:43], v[236:239]
    ds_read_b128 v[36:39], v9 offset:54272
    v_mfma_f32_16x16x32_bf16 v[252:255], v[60:63], v[44:47], v[252:255]
    ds_read_b64_tr_b16 v[60:61], v13 offset:49152
    s_waitcnt lgkmcnt(9)
    v_mfma_f32_16x16x32_bf16 v[128:131], v[48:51], v[16:19], v[128:131]
    ds_read_b64_tr_b16 v[62:63], v13 offset:50176
    v_mfma_f32_16x16x32_bf16 v[144:147], v[48:51], v[20:23], v[144:147]
    ds_read_b128 v[40:43], v9 offset:55296
    s_waitcnt lgkmcnt(10)
    v_mfma_f32_16x16x32_bf16 v[160:163], v[48:51], v[24:27], v[160:163]
    ds_read_b128 v[44:47], v9 offset:56320
    s_waitcnt lgkmcnt(10)
    v_mfma_f32_16x16x32_bf16 v[176:179], v[48:51], v[28:31], v[176:179]
    s_waitcnt lgkmcnt(8)
    v_mfma_f32_16x16x32_bf16 v[132:135], v[52:55], v[16:19], v[132:135]
    v_mfma_f32_16x16x32_bf16 v[148:151], v[52:55], v[20:23], v[148:151]
    v_mfma_f32_16x16x32_bf16 v[164:167], v[52:55], v[24:27], v[164:167]
    v_mfma_f32_16x16x32_bf16 v[180:183], v[52:55], v[28:31], v[180:183]
    s_waitcnt lgkmcnt(6)
    v_mfma_f32_16x16x32_bf16 v[136:139], v[56:59], v[16:19], v[136:139]
    v_mfma_f32_16x16x32_bf16 v[152:155], v[56:59], v[20:23], v[152:155]
    v_mfma_f32_16x16x32_bf16 v[168:171], v[56:59], v[24:27], v[168:171]
    v_mfma_f32_16x16x32_bf16 v[184:187], v[56:59], v[28:31], v[184:187]
    s_waitcnt lgkmcnt(2)
    v_mfma_f32_16x16x32_bf16 v[140:143], v[60:63], v[16:19], v[140:143]
    v_mfma_f32_16x16x32_bf16 v[156:159], v[60:63], v[20:23], v[156:159]
    v_mfma_f32_16x16x32_bf16 v[172:175], v[60:63], v[24:27], v[172:175]
    v_mfma_f32_16x16x32_bf16 v[188:191], v[60:63], v[28:31], v[188:191]
    v_mfma_f32_16x16x32_bf16 v[192:195], v[48:51], v[32:35], v[192:195]
    s_barrier
    v_mfma_f32_16x16x32_bf16 v[208:211], v[48:51], v[36:39], v[208:211]
    ds_read_b128 v[16:19], v8 offset:0
    s_waitcnt lgkmcnt(2)
    v_mfma_f32_16x16x32_bf16 v[224:227], v[48:51], v[40:43], v[224:227]
    ds_read_b128 v[20:23], v8 offset:1024
    s_waitcnt lgkmcnt(2)
    v_mfma_f32_16x16x32_bf16 v[240:243], v[48:51], v[44:47], v[240:243]
    ds_read_b64_tr_b16 v[48:49], v4 offset:0
    v_mfma_f32_16x16x32_bf16 v[196:199], v[52:55], v[32:35], v[196:199]
    ds_read_b64_tr_b16 v[50:51], v4 offset:1024
    v_mfma_f32_16x16x32_bf16 v[212:215], v[52:55], v[36:39], v[212:215]
    v_mfma_f32_16x16x32_bf16 v[228:231], v[52:55], v[40:43], v[228:231]
    ds_read_b128 v[24:27], v8 offset:2048
    v_mfma_f32_16x16x32_bf16 v[244:247], v[52:55], v[44:47], v[244:247]
    ds_read_b128 v[28:31], v8 offset:3072
    v_mfma_f32_16x16x32_bf16 v[200:203], v[56:59], v[32:35], v[200:203]
    ds_read_b64_tr_b16 v[52:53], v5 offset:0
    v_mfma_f32_16x16x32_bf16 v[216:219], v[56:59], v[36:39], v[216:219]
    ds_read_b64_tr_b16 v[54:55], v5 offset:1024
    v_mfma_f32_16x16x32_bf16 v[232:235], v[56:59], v[40:43], v[232:235]
    v_mfma_f32_16x16x32_bf16 v[248:251], v[56:59], v[44:47], v[248:251]
    ds_read_b64_tr_b16 v[56:57], v6 offset:0
    v_mfma_f32_16x16x32_bf16 v[204:207], v[60:63], v[32:35], v[204:207]
    ds_read_b64_tr_b16 v[58:59], v6 offset:1024
    v_mfma_f32_16x16x32_bf16 v[220:223], v[60:63], v[36:39], v[220:223]
    ds_read_b128 v[32:35], v8 offset:4096
    v_mfma_f32_16x16x32_bf16 v[236:239], v[60:63], v[40:43], v[236:239]
    ds_read_b128 v[36:39], v8 offset:5120
    v_mfma_f32_16x16x32_bf16 v[252:255], v[60:63], v[44:47], v[252:255]
    ds_read_b64_tr_b16 v[60:61], v7 offset:0
    s_waitcnt lgkmcnt(9)
    v_mfma_f32_16x16x32_bf16 v[128:131], v[48:51], v[16:19], v[128:131]
    ds_read_b64_tr_b16 v[62:63], v7 offset:1024
    v_mfma_f32_16x16x32_bf16 v[144:147], v[48:51], v[20:23], v[144:147]
    ds_read_b128 v[40:43], v8 offset:6144
    s_waitcnt lgkmcnt(10)
    v_mfma_f32_16x16x32_bf16 v[160:163], v[48:51], v[24:27], v[160:163]
    ds_read_b128 v[44:47], v8 offset:7168
    s_waitcnt lgkmcnt(10)
    v_mfma_f32_16x16x32_bf16 v[176:179], v[48:51], v[28:31], v[176:179]
    s_waitcnt lgkmcnt(8)
    v_mfma_f32_16x16x32_bf16 v[132:135], v[52:55], v[16:19], v[132:135]
    v_mfma_f32_16x16x32_bf16 v[148:151], v[52:55], v[20:23], v[148:151]
    v_mfma_f32_16x16x32_bf16 v[164:167], v[52:55], v[24:27], v[164:167]
    v_mfma_f32_16x16x32_bf16 v[180:183], v[52:55], v[28:31], v[180:183]
    s_waitcnt lgkmcnt(6)
    v_mfma_f32_16x16x32_bf16 v[136:139], v[56:59], v[16:19], v[136:139]
    v_mfma_f32_16x16x32_bf16 v[152:155], v[56:59], v[20:23], v[152:155]
    v_mfma_f32_16x16x32_bf16 v[168:171], v[56:59], v[24:27], v[168:171]
    v_mfma_f32_16x16x32_bf16 v[184:187], v[56:59], v[28:31], v[184:187]
    s_waitcnt lgkmcnt(2)
    v_mfma_f32_16x16x32_bf16 v[140:143], v[60:63], v[16:19], v[140:143]
    v_mfma_f32_16x16x32_bf16 v[156:159], v[60:63], v[20:23], v[156:159]
    v_mfma_f32_16x16x32_bf16 v[172:175], v[60:63], v[24:27], v[172:175]
    v_mfma_f32_16x16x32_bf16 v[188:191], v[60:63], v[28:31], v[188:191]
    v_mfma_f32_16x16x32_bf16 v[192:195], v[48:51], v[32:35], v[192:195]
    s_barrier
    v_mfma_f32_16x16x32_bf16 v[208:211], v[48:51], v[36:39], v[208:211]
    ds_read_b128 v[16:19], v8 offset:24576
    s_waitcnt lgkmcnt(2)
    v_mfma_f32_16x16x32_bf16 v[224:227], v[48:51], v[40:43], v[224:227]
    ds_read_b128 v[20:23], v8 offset:25600
    s_waitcnt lgkmcnt(2)
    v_mfma_f32_16x16x32_bf16 v[240:243], v[48:51], v[44:47], v[240:243]
    ds_read_b64_tr_b16 v[48:49], v4 offset:24576
    v_mfma_f32_16x16x32_bf16 v[196:199], v[52:55], v[32:35], v[196:199]
    ds_read_b64_tr_b16 v[50:51], v4 offset:25600
    v_mfma_f32_16x16x32_bf16 v[212:215], v[52:55], v[36:39], v[212:215]
    v_mfma_f32_16x16x32_bf16 v[228:231], v[52:55], v[40:43], v[228:231]
    ds_read_b128 v[24:27], v8 offset:26624
    v_mfma_f32_16x16x32_bf16 v[244:247], v[52:55], v[44:47], v[244:247]
    ds_read_b128 v[28:31], v8 offset:27648
    v_mfma_f32_16x16x32_bf16 v[200:203], v[56:59], v[32:35], v[200:203]
    ds_read_b64_tr_b16 v[52:53], v5 offset:24576
    v_mfma_f32_16x16x32_bf16 v[216:219], v[56:59], v[36:39], v[216:219]
    ds_read_b64_tr_b16 v[54:55], v5 offset:25600
    v_mfma_f32_16x16x32_bf16 v[232:235], v[56:59], v[40:43], v[232:235]
    v_mfma_f32_16x16x32_bf16 v[248:251], v[56:59], v[44:47], v[248:251]
    ds_read_b64_tr_b16 v[56:57], v6 offset:24576
    v_mfma_f32_16x16x32_bf16 v[204:207], v[60:63], v[32:35], v[204:207]
    ds_read_b64_tr_b16 v[58:59], v6 offset:25600
    v_mfma_f32_16x16x32_bf16 v[220:223], v[60:63], v[36:39], v[220:223]
    ds_read_b128 v[32:35], v8 offset:28672
    v_mfma_f32_16x16x32_bf16 v[236:239], v[60:63], v[40:43], v[236:239]
    ds_read_b128 v[36:39], v8 offset:29696
    v_mfma_f32_16x16x32_bf16 v[252:255], v[60:63], v[44:47], v[252:255]
    ds_read_b64_tr_b16 v[60:61], v7 offset:24576
    s_waitcnt lgkmcnt(9)
    v_mfma_f32_16x16x32_bf16 v[128:131], v[48:51], v[16:19], v[128:131]
    ds_read_b64_tr_b16 v[62:63], v7 offset:25600
    v_mfma_f32_16x16x32_bf16 v[144:147], v[48:51], v[20:23], v[144:147]
    ds_read_b128 v[40:43], v8 offset:30720
    s_waitcnt lgkmcnt(10)
    v_mfma_f32_16x16x32_bf16 v[160:163], v[48:51], v[24:27], v[160:163]
    ds_read_b128 v[44:47], v8 offset:31744
    s_waitcnt lgkmcnt(10)
    v_mfma_f32_16x16x32_bf16 v[176:179], v[48:51], v[28:31], v[176:179]
    s_waitcnt lgkmcnt(8)
    v_mfma_f32_16x16x32_bf16 v[132:135], v[52:55], v[16:19], v[132:135]
    v_mfma_f32_16x16x32_bf16 v[148:151], v[52:55], v[20:23], v[148:151]
    v_mfma_f32_16x16x32_bf16 v[164:167], v[52:55], v[24:27], v[164:167]
    v_mfma_f32_16x16x32_bf16 v[180:183], v[52:55], v[28:31], v[180:183]
    s_waitcnt lgkmcnt(6)
    v_mfma_f32_16x16x32_bf16 v[136:139], v[56:59], v[16:19], v[136:139]
    v_mfma_f32_16x16x32_bf16 v[152:155], v[56:59], v[20:23], v[152:155]
    v_mfma_f32_16x16x32_bf16 v[168:171], v[56:59], v[24:27], v[168:171]
    v_mfma_f32_16x16x32_bf16 v[184:187], v[56:59], v[28:31], v[184:187]
    s_waitcnt lgkmcnt(2)
    v_mfma_f32_16x16x32_bf16 v[140:143], v[60:63], v[16:19], v[140:143]
    v_mfma_f32_16x16x32_bf16 v[156:159], v[60:63], v[20:23], v[156:159]
    v_mfma_f32_16x16x32_bf16 v[172:175], v[60:63], v[24:27], v[172:175]
    v_mfma_f32_16x16x32_bf16 v[188:191], v[60:63], v[28:31], v[188:191]
    v_mfma_f32_16x16x32_bf16 v[192:195], v[48:51], v[32:35], v[192:195]
    v_mfma_f32_16x16x32_bf16 v[208:211], v[48:51], v[36:39], v[208:211]
    s_waitcnt lgkmcnt(1)
    v_mfma_f32_16x16x32_bf16 v[224:227], v[48:51], v[40:43], v[224:227]
    s_waitcnt lgkmcnt(0)
    v_mfma_f32_16x16x32_bf16 v[240:243], v[48:51], v[44:47], v[240:243]
    v_mfma_f32_16x16x32_bf16 v[196:199], v[52:55], v[32:35], v[196:199]
    v_mfma_f32_16x16x32_bf16 v[212:215], v[52:55], v[36:39], v[212:215]
    v_mfma_f32_16x16x32_bf16 v[228:231], v[52:55], v[40:43], v[228:231]
    v_mfma_f32_16x16x32_bf16 v[244:247], v[52:55], v[44:47], v[244:247]
    v_mfma_f32_16x16x32_bf16 v[200:203], v[56:59], v[32:35], v[200:203]
    v_mfma_f32_16x16x32_bf16 v[216:219], v[56:59], v[36:39], v[216:219]
    v_mfma_f32_16x16x32_bf16 v[232:235], v[56:59], v[40:43], v[232:235]
    v_mfma_f32_16x16x32_bf16 v[248:251], v[56:59], v[44:47], v[248:251]
    v_mfma_f32_16x16x32_bf16 v[204:207], v[60:63], v[32:35], v[204:207]
    v_mfma_f32_16x16x32_bf16 v[220:223], v[60:63], v[36:39], v[220:223]
    v_mfma_f32_16x16x32_bf16 v[236:239], v[60:63], v[40:43], v[236:239]
    v_mfma_f32_16x16x32_bf16 v[252:255], v[60:63], v[44:47], v[252:255]
k3_cend:
    s_add_u32 s12, s26, 0x6000000
    s_addc_u32 s13, s27, 0
    s_mov_b32 s14, 0x2000000
    s_mov_b32 s15, 0x00020000
    s_lshl_b32 s40, s33, 3
    s_add_u32 s40, s40, s32
    s_lshl_b32 s40, s40, 2
    s_add_u32 s40, s40, s3
    s_mul_i32 s41, s40, 4352
    s_lshl_b32 s42, s31, 2
    s_add_u32 s42, s42, s41
    s_mul_i32 s40, s40, 65536
    s_mul_i32 s43, s31, 4096
    s_add_u32 s43, s43, s40
    v_lshlrev_b32 v8, 4, v1
    s_cmp_eq_u32 s31, 0
    s_cbranch_scc1 k3_keep0
    s_add_u32 s44, s43, 0
    v_cvt_pk_bf16_f32 v16, v128, v129
    v_cvt_pk_bf16_f32 v17, v130, v131
    v_cvt_pk_bf16_f32 v18, v132, v133
    v_cvt_pk_bf16_f32 v19, v134, v135
    v_cvt_pk_bf16_f32 v20, v136, v137
    v_cvt_pk_bf16_f32 v21, v138, v139
    v_cvt_pk_bf16_f32 v22, v140, v141
    v_cvt_pk_bf16_f32 v23, v142, v143
    v_cvt_pk_bf16_f32 v24, v144, v145
    v_cvt_pk_bf16_f32 v25, v146, v147
    v_cvt_pk_bf16_f32 v26, v148, v149
    v_cvt_pk_bf16_f32 v27, v150, v151
    v_cvt_pk_bf16_f32 v28, v152, v153
    v_cvt_pk_bf16_f32 v29, v154, v155
    v_cvt_pk_bf16_f32 v30, v156, v157
    v_cvt_pk_bf16_f32 v31, v158, v159
    buffer_store_dwordx4 v[16:19], v8, s[12:15], s44 offen offset:0 sc1
    buffer_store_dwordx4 v[20:23], v8, s[12:15], s44 offen offset:1024 sc1
    buffer_store_dwordx4 v[24:27], v8, s[12:15], s44 offen offset:2048 sc1
    buffer_store_dwordx4 v[28:31], v8, s[12:15], s44 offen offset:3072 sc1
    s_branch k3_sent0
k3_keep0:
    v_mov_b32 v84, v128
    v_mov_b32 v85, v129
    v_mov_b32 v86, v130
    v_mov_b32 v87, v131
    v_mov_b32 v88, v132
    v_mov_b32 v89, v133
    v_mov_b32 v90, v134
    v_mov_b32 v91, v135
    v_mov_b32 v92, v136
    v_mov_b32 v93, v137
    v_mov_b32 v94, v138
    v_mov_b32 v95, v139
    v_mov_b32 v96, v140
    v_mov_b32 v97, v141
    v_mov_b32 v98, v142
    v_mov_b32 v99, v143
    v_mov_b32 v100, v144
    v_mov_b32 v101, v145
    v_mov_b32 v102, v146
    v_mov_b32 v103, v147
    v_mov_b32 v104, v148
    v_mov_b32 v105, v149
    v_mov_b32 v106, v150
    v_mov_b32 v107, v151
    v_mov_b32 v108, v152
    v_mov_b32 v109, v153
    v_mov_b32 v110, v154
    v_mov_b32 v111, v155
    v_mov_b32 v112, v156
    v_mov_b32 v113, v157
    v_mov_b32 v114, v158
    v_mov_b32 v115, v159
k3_sent0:
    s_cmp_eq_u32 s31, 1
    s_cbranch_scc1 k3_keep1
    s_add_u32 s44, s43, 16384
    v_cvt_pk_bf16_f32 v32, v160, v161
    v_cvt_pk_bf16_f32 v33, v162, v163
    v_cvt_pk_bf16_f32 v34, v164, v165
    v_cvt_pk_bf16_f32 v35, v166, v167
    v_cvt_pk_bf16_f32 v36, v168, v169
    v_cvt_pk_bf16_f32 v37, v170, v171
    v_cvt_pk_bf16_f32 v38, v172, v173
    v_cvt_pk_bf16_f32 v39, v174, v175
    v_cvt_pk_bf16_f32 v40, v176, v177
    v_cvt_pk_bf16_f32 v41, v178, v179
    v_cvt_pk_bf16_f32 v42, v180, v181
    v_cvt_pk_bf16_f32 v43, v182, v183
    v_cvt_pk_bf16_f32 v44, v184, v185
    v_cvt_pk_bf16_f32 v45, v186, v187
    v_cvt_pk_bf16_f32 v46, v188, v189
    v_cvt_pk_bf16_f32 v47, v190, v191
    buffer_store_dwordx4 v[32:35], v8, s[12:15], s44 offen offset:0 sc1
    buffer_store_dwordx4 v[36:39], v8, s[12:15], s44 offen offset:1024 sc1
    buffer_store_dwordx4 v[40:43], v8, s[12:15], s44 offen offset:2048 sc1
    buffer_store_dwordx4 v[44:47], v8, s[12:15], s44 offen offset:3072 sc1
    s_branch k3_sent1
k3_keep1:
    v_mov_b32 v84, v160
    v_mov_b32 v85, v161
    v_mov_b32 v86, v162
    v_mov_b32 v87, v163
    v_mov_b32 v88, v164
    v_mov_b32 v89, v165
    v_mov_b32 v90, v166
    v_mov_b32 v91, v167
    v_mov_b32 v92, v168
    v_mov_b32 v93, v169
    v_mov_b32 v94, v170
    v_mov_b32 v95, v171
    v_mov_b32 v96, v172
    v_mov_b32 v97, v173
    v_mov_b32 v98, v174
    v_mov_b32 v99, v175
    v_mov_b32 v100, v176
    v_mov_b32 v101, v177
    v_mov_b32 v102, v178
    v_mov_b32 v103, v179
    v_mov_b32 v104, v180
    v_mov_b32 v105, v181
    v_mov_b32 v106, v182
    v_mov_b32 v107, v183
    v_mov_b32 v108, v184
    v_mov_b32 v109, v185
    v_mov_b32 v110, v186
    v_mov_b32 v111, v187
    v_mov_b32 v112, v188
    v_mov_b32 v113, v189
    v_mov_b32 v114, v190
    v_mov_b32 v115, v191
k3_sent1:
    s_cmp_eq_u32 s31, 2
    s_cbranch_scc1 k3_keep2
    s_add_u32 s44, s43, 32768
    v_cvt_pk_bf16_f32 v16, v192, v193
    v_cvt_pk_bf16_f32 v17, v194, v195
    v_cvt_pk_bf16_f32 v18, v196, v197
    v_cvt_pk_bf16_f32 v19, v198, v199
    v_cvt_pk_bf16_f32 v20, v200, v201
    v_cvt_pk_bf16_f32 v21, v202, v203
    v_cvt_pk_bf16_f32 v22, v204, v205
    v_cvt_pk_bf16_f32 v23, v206, v207
    v_cvt_pk_bf16_f32 v24, v208, v209
    v_cvt_pk_bf16_f32 v25, v210, v211
    v_cvt_pk_bf16_f32 v26, v212, v213
    v_cvt_pk_bf16_f32 v27, v214, v215
    v_cvt_pk_bf16_f32 v28, v216, v217
    v_cvt_pk_bf16_f32 v29, v218, v219
    v_cvt_pk_bf16_f32 v30, v220, v221
    v_cvt_pk_bf16_f32 v31, v222, v223
    buffer_store_dwordx4 v[16:19], v8, s[12:15], s44 offen offset:0 sc1
    buffer_store_dwordx4 v[20:23], v8, s[12:15], s44 offen offset:1024 sc1
    buffer_store_dwordx4 v[24:27], v8, s[12:15], s44 offen offset:2048 sc1
    buffer_store_dwordx4 v[28:31], v8, s[12:15], s44 offen offset:3072 sc1
    s_branch k3_sent2
k3_keep2:
    v_mov_b32 v84, v192
    v_mov_b32 v85, v193
    v_mov_b32 v86, v194
    v_mov_b32 v87, v195
    v_mov_b32 v88, v196
    v_mov_b32 v89, v197
    v_mov_b32 v90, v198
    v_mov_b32 v91, v199
    v_mov_b32 v92, v200
    v_mov_b32 v93, v201
    v_mov_b32 v94, v202
    v_mov_b32 v95, v203
    v_mov_b32 v96, v204
    v_mov_b32 v97, v205
    v_mov_b32 v98, v206
    v_mov_b32 v99, v207
    v_mov_b32 v100, v208
    v_mov_b32 v101, v209
    v_mov_b32 v102, v210
    v_mov_b32 v103, v211
    v_mov_b32 v104, v212
    v_mov_b32 v105, v213
    v_mov_b32 v106, v214
    v_mov_b32 v107, v215
    v_mov_b32 v108, v216
    v_mov_b32 v109, v217
    v_mov_b32 v110, v218
    v_mov_b32 v111, v219
    v_mov_b32 v112, v220
    v_mov_b32 v113, v221
    v_mov_b32 v114, v222
    v_mov_b32 v115, v223
k3_sent2:
    s_cmp_eq_u32 s31, 3
    s_cbranch_scc1 k3_keep3
    s_add_u32 s44, s43, 49152
    v_cvt_pk_bf16_f32 v32, v224, v225
    v_cvt_pk_bf16_f32 v33, v226, v227
    v_cvt_pk_bf16_f32 v34, v228, v229
    v_cvt_pk_bf16_f32 v35, v230, v231
    v_cvt_pk_bf16_f32 v36, v232, v233
    v_cvt_pk_bf16_f32 v37, v234, v235
    v_cvt_pk_bf16_f32 v38, v236, v237
    v_cvt_pk_bf16_f32 v39, v238, v239
    v_cvt_pk_bf16_f32 v40, v240, v241
    v_cvt_pk_bf16_f32 v41, v242, v243
    v_cvt_pk_bf16_f32 v42, v244, v245
    v_cvt_pk_bf16_f32 v43, v246, v247
    v_cvt_pk_bf16_f32 v44, v248, v249
    v_cvt_pk_bf16_f32 v45, v250, v251
    v_cvt_pk_bf16_f32 v46, v252, v253
    v_cvt_pk_bf16_f32 v47, v254, v255
    buffer_store_dwordx4 v[32:35], v8, s[12:15], s44 offen offset:0 sc1
    buffer_store_dwordx4 v[36:39], v8, s[12:15], s44 offen offset:1024 sc1
    buffer_store_dwordx4 v[40:43], v8, s[12:15], s44 offen offset:2048 sc1
    buffer_store_dwordx4 v[44:47], v8, s[12:15], s44 offen offset:3072 sc1
    s_branch k3_sent3
k3_keep3:
    v_mov_b32 v84, v224
    v_mov_b32 v85, v225
    v_mov_b32 v86, v226
    v_mov_b32 v87, v227
    v_mov_b32 v88, v228
    v_mov_b32 v89, v229
    v_mov_b32 v90, v230
    v_mov_b32 v91, v231
    v_mov_b32 v92, v232
    v_mov_b32 v93, v233
    v_mov_b32 v94, v234
    v_mov_b32 v95, v235
    v_mov_b32 v96, v236
    v_mov_b32 v97, v237
    v_mov_b32 v98, v238
    v_mov_b32 v99, v239
    v_mov_b32 v100, v240
    v_mov_b32 v101, v241
    v_mov_b32 v102, v242
    v_mov_b32 v103, v243
    v_mov_b32 v104, v244
    v_mov_b32 v105, v245
    v_mov_b32 v106, v246
    v_mov_b32 v107, v247
    v_mov_b32 v108, v248
    v_mov_b32 v109, v249
    v_mov_b32 v110, v250
    v_mov_b32 v111, v251
    v_mov_b32 v112, v252
    v_mov_b32 v113, v253
    v_mov_b32 v114, v254
    v_mov_b32 v115, v255
k3_sent3:
    s_mov_b32 s39, 0xffff0000
    s_waitcnt vmcnt(12)
    v_lshlrev_b32 v82, 16, v82
    v_lshlrev_b32 v83, 16, v83
    v_lshlrev_b32 v4, 16, v66
    v_and_b32 v5, s39, v66
    v_add_f32 v4, v4, v82
    v_add_f32 v5, v5, v82
    v_pk_add_f32 v[84:85], v[84:85], v[4:5]
    v_lshlrev_b32 v4, 16, v67
    v_and_b32 v5, s39, v67
    v_add_f32 v4, v4, v82
    v_add_f32 v5, v5, v82
    v_pk_add_f32 v[86:87], v[86:87], v[4:5]
    v_lshlrev_b32 v4, 16, v68
    v_and_b32 v5, s39, v68
    v_add_f32 v4, v4, v82
    v_add_f32 v5, v5, v82
    v_pk_add_f32 v[88:89], v[88:89], v[4:5]
    v_lshlrev_b32 v4, 16, v69
    v_and_b32 v5, s39, v69
    v_add_f32 v4, v4, v82
    v_add_f32 v5, v5, v82
    v_pk_add_f32 v[90:91], v[90:91], v[4:5]
    v_lshlrev_b32 v4, 16, v70
    v_and_b32 v5, s39, v70
    v_add_f32 v4, v4, v82
    v_add_f32 v5, v5, v82
    v_pk_add_f32 v[92:93], v[92:93], v[4:5]
    v_lshlrev_b32 v4, 16, v71
    v_and_b32 v5, s39, v71
    v_add_f32 v4, v4, v82
    v_add_f32 v5, v5, v82
    v_pk_add_f32 v[94:95], v[94:95], v[4:5]
    v_lshlrev_b32 v4, 16, v72
    v_and_b32 v5, s39, v72
    v_add_f32 v4, v4, v82
    v_add_f32 v5, v5, v82
    v_pk_add_f32 v[96:97], v[96:97], v[4:5]
    v_lshlrev_b32 v4, 16, v73
    v_and_b32 v5, s39, v73
    v_add_f32 v4, v4, v82
    v_add_f32 v5, v5, v82
    v_pk_add_f32 v[98:99], v[98:99], v[4:5]
    v_lshlrev_b32 v4, 16, v74
    v_and_b32 v5, s39, v74
    v_add_f32 v4, v4, v83
    v_add_f32 v5, v5, v83
    v_pk_add_f32 v[100:101], v[100:101], v[4:5]
    v_lshlrev_b32 v4, 16, v75
    v_and_b32 v5, s39, v75
    v_add_f32 v4, v4, v83
    v_add_f32 v5, v5, v83
    v_pk_add_f32 v[102:103], v[102:103], v[4:5]
    v_lshlrev_b32 v4, 16, v76
    v_and_b32 v5, s39, v76
    v_add_f32 v4, v4, v83
    v_add_f32 v5, v5, v83
    v_pk_add_f32 v[104:105], v[104:105], v[4:5]
    v_lshlrev_b32 v4, 16, v77
    v_and_b32 v5, s39, v77
    v_add_f32 v4, v4, v83
    v_add_f32 v5, v5, v83
    v_pk_add_f32 v[106:107], v[106:107], v[4:5]
    v_lshlrev_b32 v4, 16, v78
    v_and_b32 v5, s39, v78
    v_add_f32 v4, v4, v83
    v_add_f32 v5, v5, v83
    v_pk_add_f32 v[108:109], v[108:109], v[4:5]
    v_lshlrev_b32 v4, 16, v79
    v_and_b32 v5, s39, v79
    v_add_f32 v4, v4, v83
    v_add_f32 v5, v5, v83
    v_pk_add_f32 v[110:111], v[110:111], v[4:5]
    v_lshlrev_b32 v4, 16, v80
    v_and_b32 v5, s39, v80
    v_add_f32 v4, v4, v83
    v_add_f32 v5, v5, v83
    v_pk_add_f32 v[112:113], v[112:113], v[4:5]
    v_lshlrev_b32 v4, 16, v81
    v_and_b32 v5, s39, v81
    v_add_f32 v4, v4, v83
    v_add_f32 v5, v5, v83
    v_pk_add_f32 v[114:115], v[114:115], v[4:5]
    v_mov_b32 v10, 1
    v_mov_b32 v11, 0
    v_and_b32 v12, 3, v1
    v_lshlrev_b32 v12, 2, v12
    s_mul_i32 s43, s31, 16384
    s_add_u32 s43, s43, s40
    s_waitcnt vmcnt(0)
    buffer_store_dword v10, v11, s[52:55], s42 offen sc1
    s_mov_b32 s46, 0
k3_poll:
    buffer_load_dword v13, v12, s[52:55], s41 offen sc1
    s_waitcnt vmcnt(0)
    v_cmp_eq_u32 vcc, 0, v13
    s_cbranch_vccz k3_got
    s_sleep 4
    s_add_u32 s46, s46, 1
    s_cmp_lt_u32 s46, 200000
    s_cbranch_scc1 k3_poll
k3_got:
    s_xor_b32 s44, s31, 1
    s_mul_i32 s44, s44, 4096
    s_add_u32 s44, s44, s43
    s_add_u32 s45, s44, 4096
    buffer_load_dwordx4 v[128:131], v8, s[12:15], s44 offen offset:0 sc1
    buffer_load_dwordx4 v[132:135], v8, s[12:15], s44 offen offset:1024 sc1
    buffer_load_dwordx4 v[136:139], v8, s[12:15], s44 offen offset:2048 sc1
    buffer_load_dwordx4 v[140:143], v8, s[12:15], s44 offen offset:3072 sc1
    s_xor_b32 s44, s31, 2
    s_mul_i32 s44, s44, 4096
    s_add_u32 s44, s44, s43
    s_add_u32 s45, s44, 4096
    buffer_load_dwordx4 v[144:147], v8, s[12:15], s44 offen offset:0 sc1
    buffer_load_dwordx4 v[148:151], v8, s[12:15], s44 offen offset:1024 sc1
    buffer_load_dwordx4 v[152:155], v8, s[12:15], s44 offen offset:2048 sc1
    buffer_load_dwordx4 v[156:159], v8, s[12:15], s44 offen offset:3072 sc1
    s_xor_b32 s44, s31, 3
    s_mul_i32 s44, s44, 4096
    s_add_u32 s44, s44, s43
    s_add_u32 s45, s44, 4096
    buffer_load_dwordx4 v[160:163], v8, s[12:15], s44 offen offset:0 sc1
    buffer_load_dwordx4 v[164:167], v8, s[12:15], s44 offen offset:1024 sc1
    buffer_load_dwordx4 v[168:171], v8, s[12:15], s44 offen offset:2048 sc1
    buffer_load_dwordx4 v[172:175], v8, s[12:15], s44 offen offset:3072 sc1
    s_waitcnt vmcnt(11)
    v_lshlrev_b32 v4, 16, v128
    v_and_b32 v5, s39, v128
    v_pk_add_f32 v[84:85], v[84:85], v[4:5]
    v_lshlrev_b32 v6, 16, v129
    v_and_b32 v7, s39, v129
    v_pk_add_f32 v[86:87], v[86:87], v[6:7]
    v_lshlrev_b32 v4, 16, v130
    v_and_b32 v5, s39, v130
    v_pk_add_f32 v[88:89], v[88:89], v[4:5]
    v_lshlrev_b32 v6, 16, v131
    v_and_b32 v7, s39, v131
    v_pk_add_f32 v[90:91], v[90:91], v[6:7]
    s_waitcnt vmcnt(10)
    v_lshlrev_b32 v4, 16, v132
    v_and_b32 v5, s39, v132
    v_pk_add_f32 v[92:93], v[92:93], v[4:5]
    v_lshlrev_b32 v6, 16, v133
    v_and_b32 v7, s39, v133
    v_pk_add_f32 v[94:95], v[94:95], v[6:7]
    v_lshlrev_b32 v4, 16, v134
    v_and_b32 v5, s39, v134
    v_pk_add_f32 v[96:97], v[96:97], v[4:5]
    v_lshlrev_b32 v6, 16, v135
    v_and_b32 v7, s39, v135
    v_pk_add_f32 v[98:99], v[98:99], v[6:7]
    s_waitcnt vmcnt(9)
    v_lshlrev_b32 v4, 16, v136
    v_and_b32 v5, s39, v136
    v_pk_add_f32 v[100:101], v[100:101], v[4:5]
    v_lshlrev_b32 v6, 16, v137
    v_and_b32 v7, s39, v137
    v_pk_add_f32 v[102:103], v[102:103], v[6:7]
    v_lshlrev_b32 v4, 16, v138
    v_and_b32 v5, s39, v138
    v_pk_add_f32 v[104:105], v[104:105], v[4:5]
    v_lshlrev_b32 v6, 16, v139
    v_and_b32 v7, s39, v139
    v_pk_add_f32 v[106:107], v[106:107], v[6:7]
    s_waitcnt vmcnt(8)
    v_lshlrev_b32 v4, 16, v140
    v_and_b32 v5, s39, v140
    v_pk_add_f32 v[108:109], v[108:109], v[4:5]
    v_lshlrev_b32 v6, 16, v141
    v_and_b32 v7, s39, v141
    v_pk_add_f32 v[110:111], v[110:111], v[6:7]
    v_lshlrev_b32 v4, 16, v142
    v_and_b32 v5, s39, v142
    v_pk_add_f32 v[112:113], v[112:113], v[4:5]
    v_lshlrev_b32 v6, 16, v143
    v_and_b32 v7, s39, v143
    v_pk_add_f32 v[114:115], v[114:115], v[6:7]
    s_waitcnt vmcnt(7)
    v_lshlrev_b32 v4, 16, v144
    v_and_b32 v5, s39, v144
    v_pk_add_f32 v[84:85], v[84:85], v[4:5]
    v_lshlrev_b32 v6, 16, v145
    v_and_b32 v7, s39, v145
    v_pk_add_f32 v[86:87], v[86:87], v[6:7]
    v_lshlrev_b32 v4, 16, v146
    v_and_b32 v5, s39, v146
    v_pk_add_f32 v[88:89], v[88:89], v[4:5]
    v_lshlrev_b32 v6, 16, v147
    v_and_b32 v7, s39, v147
    v_pk_add_f32 v[90:91], v[90:91], v[6:7]
    s_waitcnt vmcnt(6)
    v_lshlrev_b32 v4, 16, v148
    v_and_b32 v5, s39, v148
    v_pk_add_f32 v[92:93], v[92:93], v[4:5]
    v_lshlrev_b32 v6, 16, v149
    v_and_b32 v7, s39, v149
    v_pk_add_f32 v[94:95], v[94:95], v[6:7]
    v_lshlrev_b32 v4, 16, v150
    v_and_b32 v5, s39, v150
    v_pk_add_f32 v[96:97], v[96:97], v[4:5]
    v_lshlrev_b32 v6, 16, v151
    v_and_b32 v7, s39, v151
    v_pk_add_f32 v[98:99], v[98:99], v[6:7]
    s_waitcnt vmcnt(5)
    v_lshlrev_b32 v4, 16, v152
    v_and_b32 v5, s39, v152
    v_pk_add_f32 v[100:101], v[100:101], v[4:5]
    v_lshlrev_b32 v6, 16, v153
    v_and_b32 v7, s39, v153
    v_pk_add_f32 v[102:103], v[102:103], v[6:7]
    v_lshlrev_b32 v4, 16, v154
    v_and_b32 v5, s39, v154
    v_pk_add_f32 v[104:105], v[104:105], v[4:5]
    v_lshlrev_b32 v6, 16, v155
    v_and_b32 v7, s39, v155
    v_pk_add_f32 v[106:107], v[106:107], v[6:7]
    s_waitcnt vmcnt(4)
    v_lshlrev_b32 v4, 16, v156
    v_and_b32 v5, s39, v156
    v_pk_add_f32 v[108:109], v[108:109], v[4:5]
    v_lshlrev_b32 v6, 16, v157
    v_and_b32 v7, s39, v157
    v_pk_add_f32 v[110:111], v[110:111], v[6:7]
    v_lshlrev_b32 v4, 16, v158
    v_and_b32 v5, s39, v158
    v_pk_add_f32 v[112:113], v[112:113], v[4:5]
    v_lshlrev_b32 v6, 16, v159
    v_and_b32 v7, s39, v159
    v_pk_add_f32 v[114:115], v[114:115], v[6:7]
    s_waitcnt vmcnt(3)
    v_lshlrev_b32 v4, 16, v160
    v_and_b32 v5, s39, v160
    v_pk_add_f32 v[84:85], v[84:85], v[4:5]
    v_lshlrev_b32 v6, 16, v161
    v_and_b32 v7, s39, v161
    v_pk_add_f32 v[86:87], v[86:87], v[6:7]
    v_lshlrev_b32 v4, 16, v162
    v_and_b32 v5, s39, v162
    v_pk_add_f32 v[88:89], v[88:89], v[4:5]
    v_lshlrev_b32 v6, 16, v163
    v_and_b32 v7, s39, v163
    v_pk_add_f32 v[90:91], v[90:91], v[6:7]
    s_waitcnt vmcnt(2)
    v_lshlrev_b32 v4, 16, v164
    v_and_b32 v5, s39, v164
    v_pk_add_f32 v[92:93], v[92:93], v[4:5]
    v_lshlrev_b32 v6, 16, v165
    v_and_b32 v7, s39, v165
    v_pk_add_f32 v[94:95], v[94:95], v[6:7]
    v_lshlrev_b32 v4, 16, v166
    v_and_b32 v5, s39, v166
    v_pk_add_f32 v[96:97], v[96:97], v[4:5]
    v_lshlrev_b32 v6, 16, v167
    v_and_b32 v7, s39, v167
    v_pk_add_f32 v[98:99], v[98:99], v[6:7]
    s_waitcnt vmcnt(1)
    v_lshlrev_b32 v4, 16, v168
    v_and_b32 v5, s39, v168
    v_pk_add_f32 v[100:101], v[100:101], v[4:5]
    v_lshlrev_b32 v6, 16, v169
    v_and_b32 v7, s39, v169
    v_pk_add_f32 v[102:103], v[102:103], v[6:7]
    v_lshlrev_b32 v4, 16, v170
    v_and_b32 v5, s39, v170
    v_pk_add_f32 v[104:105], v[104:105], v[4:5]
    v_lshlrev_b32 v6, 16, v171
    v_and_b32 v7, s39, v171
    v_pk_add_f32 v[106:107], v[106:107], v[6:7]
    s_waitcnt vmcnt(0)
    v_lshlrev_b32 v4, 16, v172
    v_and_b32 v5, s39, v172
    v_pk_add_f32 v[108:109], v[108:109], v[4:5]
    v_lshlrev_b32 v6, 16, v173
    v_and_b32 v7, s39, v173
    v_pk_add_f32 v[110:111], v[110:111], v[6:7]
    v_lshlrev_b32 v4, 16, v174
    v_and_b32 v5, s39, v174
    v_pk_add_f32 v[112:113], v[112:113], v[4:5]
    v_lshlrev_b32 v6, 16, v175
    v_and_b32 v7, s39, v175
    v_pk_add_f32 v[114:115], v[114:115], v[6:7]
    v_cvt_pk_bf16_f32 v16, v84, v85
    v_cvt_pk_bf16_f32 v17, v86, v87
    v_cvt_pk_bf16_f32 v18, v88, v89
    v_cvt_pk_bf16_f32 v19, v90, v91
    s_nop 1
    v_permlane16_swap_b32 v16, v18
    v_permlane16_swap_b32 v17, v19
    s_nop 1
    buffer_store_dwordx4 v[16:19], v14, s[20:23], s37 offen offset:0
    v_cvt_pk_bf16_f32 v20, v92, v93
    v_cvt_pk_bf16_f32 v21, v94, v95
    v_cvt_pk_bf16_f32 v22, v96, v97
    v_cvt_pk_bf16_f32 v23, v98, v99
    s_nop 1
    v_permlane16_swap_b32 v20, v22
    v_permlane16_swap_b32 v21, v23
    s_nop 1
    buffer_store_dwordx4 v[20:23], v14, s[20:23], s37 offen offset:64
    v_cvt_pk_bf16_f32 v24, v100, v101
    v_cvt_pk_bf16_f32 v25, v102, v103
    v_cvt_pk_bf16_f32 v26, v104, v105
    v_cvt_pk_bf16_f32 v27, v106, v107
    s_nop 1
    v_permlane16_swap_b32 v24, v26
    v_permlane16_swap_b32 v25, v27
    s_nop 1
    buffer_store_dwordx4 v[24:27], v14, s[20:23], s38 offen offset:0
    v_cvt_pk_bf16_f32 v28, v108, v109
    v_cvt_pk_bf16_f32 v29, v110, v111
    v_cvt_pk_bf16_f32 v30, v112, v113
    v_cvt_pk_bf16_f32 v31, v114, v115
    s_nop 1
    v_permlane16_swap_b32 v28, v30
    v_permlane16_swap_b32 v29, v31
    s_nop 1
    buffer_store_dwordx4 v[28:31], v14, s[20:23], s38 offen offset:64
    s_endpgm
k3_prod:
    s_sub_u32 s3, s3, 4
    s_mov_b32 s12, s8
    s_mov_b32 s13, s9
    s_mov_b32 s14, 0xe00000
    s_mov_b32 s15, 0x00020000
    s_add_u32 s16, s26, 0x1400000
    s_addc_u32 s17, s27, 0
    s_mov_b32 s18, 0x700000
    s_mov_b32 s19, 0x00020000
    v_lshrrev_b32 v2, 3, v1
    v_mul_u32_u24 v4, 4096, v2
    v_lshrrev_b32 v2, 4, v1
    v_lshlrev_b32 v2, 1, v2
    v_and_b32 v3, 7, v1
    v_xor_b32 v2, v2, v3
    v_lshl_add_u32 v4, v2, 4, v4
    v_add_u32 v5, 128, v4
    v_add_u32 v6, 256, v4
    v_add_u32 v7, 384, v4
    v_lshrrev_b32 v2, 3, v1
    v_mul_u32_u24 v9, 2048, v2
    v_lshrrev_b32 v2, 4, v1
    v_lshlrev_b32 v2, 1, v2
    v_and_b32 v3, 7, v1
    v_xor_b32 v2, v2, v3
    v_lshl_add_u32 v9, v2, 4, v9
    v_add_u32 v10, 128, v9
    v_lshlrev_b32 v8, 4, v1
    s_mul_i32 s34, s30, 40
    s_mul_i32 s35, s30, 16
    s_add_u32 s35, s35, 80
    s_cmp_eq_u32 s29, 0
    s_cselect_b32 s34, s34, s35
    s_mul_i32 s35, s3, 32768
    s_lshl_b32 s36, s33, 9
    s_add_u32 s35, s35, s36
    s_mul_i32 s36, s34, 131072
    s_add_u32 s35, s35, s36
    s_mul_i32 s36, s32, 917504
    s_lshl_b32 s37, s34, 13
    s_add_u32 s36, s36, s37
    s_lshl_b32 s37, s3, 11
    s_add_u32 s36, s36, s37
    s_lshl_b32 s38, s3, 10
    s_add_u32 s39, s37, 16384
    s_mov_b32 s40, 0
    s_cmp_eq_u32 s29, 1
    s_cbranch_scc1 k3_pb
    s_mov_b32 s46, 0
    s_mov_b32 s47, 0
    s_add_u32 m0, s40, s38
    s_nop 0
    buffer_load_dwordx4 v4, s[12:15], s35 offen lds
    s_add_u32 m0, m0, 4096
    s_nop 0
    buffer_load_dwordx4 v5, s[12:15], s35 offen lds
    s_add_u32 m0, m0, 4096
    s_nop 0
    buffer_load_dwordx4 v6, s[12:15], s35 offen lds
    s_add_u32 m0, m0, 4096
    s_nop 0
    buffer_load_dwordx4 v7, s[12:15], s35 offen lds
    s_add_u32 s35, s35, 131072
    s_add_u32 s40, s40, 24576
    s_cmp_eq_u32 s40, 147456
    s_cselect_b32 s40, 0, s40
    s_add_u32 s46, s46, 1
    s_and_b32 s48, s46, 3
    s_cselect_b32 s48, 0, 524288
    s_add_u32 s35, s35, s48
    s_cmp_eq_u32 s46, 20
    s_cselect_b32 s48, 4718592, 0
    s_sub_u32 s35, s35, s48
    s_add_u32 m0, s40, s38
    s_nop 0
    buffer_load_dwordx4 v4, s[12:15], s35 offen lds
    s_add_u32 m0, m0, 4096
    s_nop 0
    buffer_load_dwordx4 v5, s[12:15], s35 offen lds
    s_add_u32 m0, m0, 4096
    s_nop 0
    buffer_load_dwordx4 v6, s[12:15], s35 offen lds
    s_add_u32 m0, m0, 4096
    s_nop 0
    buffer_load_dwordx4 v7, s[12:15], s35 offen lds
    s_add_u32 s35, s35, 131072
    s_add_u32 s40, s40, 24576
    s_cmp_eq_u32 s40, 147456
    s_cselect_b32 s40, 0, s40
    s_add_u32 s46, s46, 1
    s_and_b32 s48, s46, 3
    s_cselect_b32 s48, 0, 524288
    s_add_u32 s35, s35, s48
    s_cmp_eq_u32 s46, 20
    s_cselect_b32 s48, 4718592, 0
    s_sub_u32 s35, s35, s48
    s_add_u32 m0, s40, s38
    s_nop 0
    buffer_load_dwordx4 v4, s[12:15], s35 offen lds
    s_add_u32 m0, m0, 4096
    s_nop 0
    buffer_load_dwordx4 v5, s[12:15], s35 offen lds
    s_add_u32 m0, m0, 4096
    s_nop 0
    buffer_load_dwordx4 v6, s[12:15], s35 offen lds
    s_add_u32 m0, m0, 4096
    s_nop 0
    buffer_load_dwordx4 v7, s[12:15], s35 offen lds
    s_add_u32 s35, s35, 131072
    s_add_u32 s40, s40, 24576
    s_cmp_eq_u32 s40, 147456
    s_cselect_b32 s40, 0, s40
    s_add_u32 s46, s46, 1
    s_and_b32 s48, s46, 3
    s_cselect_b32 s48, 0, 524288
    s_add_u32 s35, s35, s48
    s_cmp_eq_u32 s46, 20
    s_cselect_b32 s48, 4718592, 0
    s_sub_u32 s35, s35, s48
    s_add_u32 m0, s40, s38
    s_nop 0
    buffer_load_dwordx4 v4, s[12:15], s35 offen lds
    s_add_u32 m0, m0, 4096
    s_nop 0
    buffer_load_dwordx4 v5, s[12:15], s35 offen lds
    s_add_u32 m0, m0, 4096
    s_nop 0
    buffer_load_dwordx4 v6, s[12:15], s35 offen lds
    s_add_u32 m0, m0, 4096
    s_nop 0
    buffer_load_dwordx4 v7, s[12:15], s35 offen lds
    s_add_u32 s35, s35, 131072
    s_add_u32 s40, s40, 24576
    s_cmp_eq_u32 s40, 147456
    s_cselect_b32 s40, 0, s40
    s_add_u32 s46, s46, 1
    s_and_b32 s48, s46, 3
    s_cselect_b32 s48, 0, 524288
    s_add_u32 s35, s35, s48
    s_cmp_eq_u32 s46, 20
    s_cselect_b32 s48, 4718592, 0
    s_sub_u32 s35, s35, s48
    s_add_u32 m0, s40, s38
    s_nop 0
    buffer_load_dwordx4 v4, s[12:15], s35 offen lds
    s_add_u32 m0, m0, 4096
    s_nop 0
    buffer_load_dwordx4 v5, s[12:15], s35 offen lds
    s_add_u32 m0, m0, 4096
    s_nop 0
    buffer_load_dwordx4 v6, s[12:15], s35 offen lds
    s_add_u32 m0, m0, 4096
    s_nop 0
    buffer_load_dwordx4 v7, s[12:15], s35 offen lds
    s_add_u32 s35, s35, 131072
    s_add_u32 s40, s40, 24576
    s_cmp_eq_u32 s40, 147456
    s_cselect_b32 s40, 0, s40
    s_add_u32 s46, s46, 1
    s_and_b32 s48, s46, 3
    s_cselect_b32 s48, 0, 524288
    s_add_u32 s35, s35, s48
    s_cmp_eq_u32 s46, 20
    s_cselect_b32 s48, 4718592, 0
    s_sub_u32 s35, s35, s48
    s_add_u32 m0, s40, s38
    s_nop 0
    buffer_load_dwordx4 v4, s[12:15], s35 offen lds
    s_add_u32 m0, m0, 4096
    s_nop 0
    buffer_load_dwordx4 v5, s[12:15], s35 offen lds
    s_add_u32 m0, m0, 4096
    s_nop 0
    buffer_load_dwordx4 v6, s[12:15], s35 offen lds
    s_add_u32 m0, m0, 4096
    s_nop 0
    buffer_load_dwordx4 v7, s[12:15], s35 offen lds
    s_add_u32 s35, s35, 131072
    s_add_u32 s40, s40, 24576
    s_cmp_eq_u32 s40, 147456
    s_cselect_b32 s40, 0, s40
    s_add_u32 s46, s46, 1
    s_and_b32 s48, s46, 3
    s_cselect_b32 s48, 0, 524288
    s_add_u32 s35, s35, s48
    s_cmp_eq_u32 s46, 20
    s_cselect_b32 s48, 4718592, 0
    s_sub_u32 s35, s35, s48
    s_cmp_lg_u32 s3, 0
    s_cbranch_scc1 k3pa_w
    v_min_u32 v11, 19, v1
    s_mul_i32 s48, s30, 20
    v_add_u32 v11, s48, v11
    v_lshrrev_b32 v12, 5, v11
    v_mul_u32_u24 v12, 4352, v12
    v_and_b32 v11, 31, v11
    v_lshl_add_u32 v11, v11, 2, v12
    s_mul_i32 s49, s32, 8704
    s_add_u32 s49, s49, 626816
    s_mov_b32 s50, 0
k3_epoll:
    buffer_load_dword v13, v11, s[52:55], s49 offen sc1
    s_waitcnt vmcnt(0)
    v_cmp_eq_u32 vcc, 0, v13
    s_cbranch_vccz k3_eok
    s_sleep 4
    s_add_u32 s50, s50, 1
    s_cmp_lt_u32 s50, 200000
    s_cbranch_scc1 k3_epoll
k3_eok:
    s_mov_b32 m0, 16384
    s_add_u32 s48, s36, 0
    buffer_load_dwordx4 v8, s[16:19], s48 offen offset:0 sc1 lds
    buffer_load_dwordx4 v8, s[16:19], s48 offen offset:1024 sc1 lds
    buffer_load_dwordx4 v8, s[16:19], s48 offen offset:2048 sc1 lds
    buffer_load_dwordx4 v8, s[16:19], s48 offen offset:3072 sc1 lds
    s_mov_b32 m0, 20480
    s_add_u32 s48, s36, 4096
    buffer_load_dwordx4 v8, s[16:19], s48 offen offset:0 sc1 lds
    buffer_load_dwordx4 v8, s[16:19], s48 offen offset:1024 sc1 lds
    buffer_load_dwordx4 v8, s[16:19], s48 offen offset:2048 sc1 lds
    buffer_load_dwordx4 v8, s[16:19], s48 offen offset:3072 sc1 lds
    s_mov_b32 m0, 40960
    s_add_u32 s48, s36, 8192
    buffer_load_dwordx4 v8, s[16:19], s48 offen offset:0 sc1 lds
    buffer_load_dwordx4 v8, s[16:19], s48 offen offset:1024 sc1 lds
    buffer_load_dwordx4 v8, s[16:19], s48 offen offset:2048 sc1 lds
    buffer_load_dwordx4 v8, s[16:19], s48 offen offset:3072 sc1 lds
    s_mov_b32 m0, 45056
    s_add_u32 s48, s36, 12288
    buffer_load_dwordx4 v8, s[16:19], s48 offen offset:0 sc1 lds
    buffer_load_dwordx4 v8, s[16:19], s48 offen offset:1024 sc1 lds
    buffer_load_dwordx4 v8, s[16:19], s48 offen offset:2048 sc1 lds
    buffer_load_dwordx4 v8, s[16:19], s48 offen offset:3072 sc1 lds
k3pa_w:
    s_add_u32 s36, s36, 16384
    s_mov_b32 s47, 2
    s_mov_b32 s40, 49152
    s_barrier
    s_add_u32 m0, s40, s39
    s_nop 0
    buffer_load_dwordx4 v8, s[16:19], s36 offen sc1 lds
    buffer_load_dwordx4 v8, s[16:19], s36 offen offset:1024 sc1 lds
    s_add_u32 s36, s36, 8192
    s_add_u32 s40, s40, 24576
    s_cmp_eq_u32 s40, 147456
    s_cselect_b32 s40, 0, s40
    s_add_u32 s47, s47, 1
    s_and_b32 s48, s47, 3
    s_cselect_b32 s48, 0, 32768
    s_add_u32 s36, s36, s48
    s_cmp_eq_u32 s47, 20
    s_cselect_b32 s48, 294912, 0
    s_sub_u32 s36, s36, s48
    s_add_u32 m0, s40, s39
    s_nop 0
    buffer_load_dwordx4 v8, s[16:19], s36 offen sc1 lds
    buffer_load_dwordx4 v8, s[16:19], s36 offen offset:1024 sc1 lds
    s_add_u32 s36, s36, 8192
    s_add_u32 s40, s40, 24576
    s_cmp_eq_u32 s40, 147456
    s_cselect_b32 s40, 0, s40
    s_add_u32 s47, s47, 1
    s_and_b32 s48, s47, 3
    s_cselect_b32 s48, 0, 32768
    s_add_u32 s36, s36, s48
    s_cmp_eq_u32 s47, 20
    s_cselect_b32 s48, 294912, 0
    s_sub_u32 s36, s36, s48
    s_add_u32 m0, s40, s39
    s_nop 0
    buffer_load_dwordx4 v8, s[16:19], s36 offen sc1 lds
    buffer_load_dwordx4 v8, s[16:19], s36 offen offset:1024 sc1 lds
    s_add_u32 s36, s36, 8192
    s_add_u32 s40, s40, 24576
    s_cmp_eq_u32 s40, 147456
    s_cselect_b32 s40, 0, s40
    s_add_u32 s47, s47, 1
    s_and_b32 s48, s47, 3
    s_cselect_b32 s48, 0, 32768
    s_add_u32 s36, s36, s48
    s_cmp_eq_u32 s47, 20
    s_cselect_b32 s48, 294912, 0
    s_sub_u32 s36, s36, s48
    s_add_u32 m0, s40, s39
    s_nop 0
    buffer_load_dwordx4 v8, s[16:19], s36 offen sc1 lds
    buffer_load_dwordx4 v8, s[16:19], s36 offen offset:1024 sc1 lds
    s_add_u32 s36, s36, 8192
    s_add_u32 s40, s40, 24576
    s_cmp_eq_u32 s40, 147456
    s_cselect_b32 s40, 0, s40
    s_add_u32 s47, s47, 1
    s_and_b32 s48, s47, 3
    s_cselect_b32 s48, 0, 32768
    s_add_u32 s36, s36, s48
    s_cmp_eq_u32 s47, 20
    s_cselect_b32 s48, 294912, 0
    s_sub_u32 s36, s36, s48
    s_waitcnt vmcnt(8)
    s_barrier
    s_barrier
    s_waitcnt vmcnt(6)
    s_barrier
    s_add_u32 m0, s40, s38
    s_nop 0
    buffer_load_dwordx4 v4, s[12:15], s35 offen lds
    s_add_u32 m0, m0, 4096
    s_nop 0
    buffer_load_dwordx4 v5, s[12:15], s35 offen lds
    s_add_u32 m0, m0, 4096
    s_nop 0
    buffer_load_dwordx4 v6, s[12:15], s35 offen lds
    s_add_u32 m0, m0, 4096
    s_nop 0
    buffer_load_dwordx4 v7, s[12:15], s35 offen lds
    s_add_u32 s35, s35, 131072
    s_add_u32 m0, s40, s39
    s_nop 0
    buffer_load_dwordx4 v8, s[16:19], s36 offen sc1 lds
    buffer_load_dwordx4 v8, s[16:19], s36 offen offset:1024 sc1 lds
    s_add_u32 s36, s36, 8192
    s_add_u32 s40, s40, 24576
    s_cmp_eq_u32 s40, 147456
    s_cselect_b32 s40, 0, s40
    s_add_u32 s46, s46, 1
    s_and_b32 s48, s46, 3
    s_cselect_b32 s48, 0, 524288
    s_add_u32 s35, s35, s48
    s_cmp_eq_u32 s46, 20
    s_cselect_b32 s48, 4718592, 0
    s_sub_u32 s35, s35, s48
    s_add_u32 s47, s47, 1
    s_and_b32 s48, s47, 3
    s_cselect_b32 s48, 0, 32768
    s_add_u32 s36, s36, s48
    s_cmp_eq_u32 s47, 20
    s_cselect_b32 s48, 294912, 0
    s_sub_u32 s36, s36, s48
    s_waitcnt vmcnt(10)
    s_barrier
    s_add_u32 m0, s40, s38
    s_nop 0
    buffer_load_dwordx4 v4, s[12:15], s35 offen lds
    s_add_u32 m0, m0, 4096
    s_nop 0
    buffer_load_dwordx4 v5, s[12:15], s35 offen lds
    s_add_u32 m0, m0, 4096
    s_nop 0
    buffer_load_dwordx4 v6, s[12:15], s35 offen lds
    s_add_u32 m0, m0, 4096
    s_nop 0
    buffer_load_dwordx4 v7, s[12:15], s35 offen lds
    s_add_u32 s35, s35, 131072
    s_add_u32 m0, s40, s39
    s_nop 0
    buffer_load_dwordx4 v8, s[16:19], s36 offen sc1 lds
    buffer_load_dwordx4 v8, s[16:19], s36 offen offset:1024 sc1 lds
    s_add_u32 s36, s36, 8192
    s_add_u32 s40, s40, 24576
    s_cmp_eq_u32 s40, 147456
    s_cselect_b32 s40, 0, s40
    s_add_u32 s46, s46, 1
    s_and_b32 s48, s46, 3
    s_cselect_b32 s48, 0, 524288
    s_add_u32 s35, s35, s48
    s_cmp_eq_u32 s46, 20
    s_cselect_b32 s48, 4718592, 0
    s_sub_u32 s35, s35, s48
    s_add_u32 s47, s47, 1
    s_and_b32 s48, s47, 3
    s_cselect_b32 s48, 0, 32768
    s_add_u32 s36, s36, s48
    s_cmp_eq_u32 s47, 20
    s_cselect_b32 s48, 294912, 0
    s_sub_u32 s36, s36, s48
    s_waitcnt vmcnt(14)
    s_barrier
    s_add_u32 m0, s40, s38
    s_nop 0
    buffer_load_dwordx4 v4, s[12:15], s35 offen lds
    s_add_u32 m0, m0, 4096
    s_nop 0
    buffer_load_dwordx4 v5, s[12:15], s35 offen lds
    s_add_u32 m0, m0, 4096
    s_nop 0
    buffer_load_dwordx4 v6, s[12:15], s35 offen lds
    s_add_u32 m0, m0, 4096
    s_nop 0
    buffer_load_dwordx4 v7, s[12:15], s35 offen lds
    s_add_u32 s35, s35, 131072
    s_add_u32 m0, s40, s39
    s_nop 0
    buffer_load_dwordx4 v8, s[16:19], s36 offen sc1 lds
    buffer_load_dwordx4 v8, s[16:19], s36 offen offset:1024 sc1 lds
    s_add_u32 s36, s36, 8192
    s_add_u32 s40, s40, 24576
    s_cmp_eq_u32 s40, 147456
    s_cselect_b32 s40, 0, s40
    s_add_u32 s46, s46, 1
    s_and_b32 s48, s46, 3
    s_cselect_b32 s48, 0, 524288
    s_add_u32 s35, s35, s48
    s_cmp_eq_u32 s46, 20
    s_cselect_b32 s48, 4718592, 0
    s_sub_u32 s35, s35, s48
    s_add_u32 s47, s47, 1
    s_and_b32 s48, s47, 3
    s_cselect_b32 s48, 0, 32768
    s_add_u32 s36, s36, s48
    s_cmp_eq_u32 s47, 20
    s_cselect_b32 s48, 294912, 0
    s_sub_u32 s36, s36, s48
    s_mov_b32 s44, 31
k3pa_loop:
    s_waitcnt vmcnt(18)
    s_barrier
    s_add_u32 m0, s40, s38
    s_nop 0
    buffer_load_dwordx4 v4, s[12:15], s35 offen lds
    s_add_u32 m0, m0, 4096
    s_nop 0
    buffer_load_dwordx4 v5, s[12:15], s35 offen lds
    s_add_u32 m0, m0, 4096
    s_nop 0
    buffer_load_dwordx4 v6, s[12:15], s35 offen lds
    s_add_u32 m0, m0, 4096
    s_nop 0
    buffer_load_dwordx4 v7, s[12:15], s35 offen lds
    s_add_u32 s35, s35, 131072
    s_add_u32 m0, s40, s39
    s_nop 0
    buffer_load_dwordx4 v8, s[16:19], s36 offen sc1 lds
    buffer_load_dwordx4 v8, s[16:19], s36 offen offset:1024 sc1 lds
    s_add_u32 s36, s36, 8192
    s_add_u32 s40, s40, 24576
    s_cmp_eq_u32 s40, 147456
    s_cselect_b32 s40, 0, s40
    s_add_u32 s46, s46, 1
    s_and_b32 s48, s46, 3
    s_cselect_b32 s48, 0, 524288
    s_add_u32 s35, s35, s48
    s_cmp_eq_u32 s46, 20
    s_cselect_b32 s48, 4718592, 0
    s_sub_u32 s35, s35, s48
    s_add_u32 s47, s47, 1
    s_and_b32 s48, s47, 3
    s_cselect_b32 s48, 0, 32768
    s_add_u32 s36, s36, s48
    s_cmp_eq_u32 s47, 20
    s_cselect_b32 s48, 294912, 0
    s_sub_u32 s36, s36, s48
    s_sub_u32 s44, s44, 1
    s_cmp_lg_u32 s44, 0
    s_cbranch_scc1 k3pa_loop
    s_waitcnt vmcnt(18)
    s_barrier
    s_waitcnt vmcnt(12)
    s_barrier
    s_waitcnt vmcnt(6)
    s_barrier
    s_waitcnt vmcnt(0)
    s_barrier
    s_endpgm
k3_pb:
    s_barrier
    s_add_u32 m0, s40, s38
    s_nop 0
    buffer_load_dwordx4 v4, s[12:15], s35 offen lds
    s_add_u32 m0, m0, 4096
    s_nop 0
    buffer_load_dwordx4 v5, s[12:15], s35 offen lds
    s_add_u32 m0, m0, 4096
    s_nop 0
    buffer_load_dwordx4 v6, s[12:15], s35 offen lds
    s_add_u32 m0, m0, 4096
    s_nop 0
    buffer_load_dwordx4 v7, s[12:15], s35 offen lds
    s_add_u32 s35, s35, 131072
    s_add_u32 m0, s40, s39
    s_nop 0
    buffer_load_dwordx4 v8, s[16:19], s36 offen sc1 lds
    buffer_load_dwordx4 v8, s[16:19], s36 offen offset:1024 sc1 lds
    s_add_u32 s36, s36, 8192
    s_add_u32 s40, s40, 24576
    s_cmp_eq_u32 s40, 147456
    s_cselect_b32 s40, 0, s40
    s_add_u32 m0, s40, s38
    s_nop 0
    buffer_load_dwordx4 v4, s[12:15], s35 offen lds
    s_add_u32 m0, m0, 4096
    s_nop 0
    buffer_load_dwordx4 v5, s[12:15], s35 offen lds
    s_add_u32 m0, m0, 4096
    s_nop 0
    buffer_load_dwordx4 v6, s[12:15], s35 offen lds
    s_add_u32 m0, m0, 4096
    s_nop 0
    buffer_load_dwordx4 v7, s[12:15], s35 offen lds
    s_add_u32 s35, s35, 131072
    s_add_u32 m0, s40, s39
    s_nop 0
    buffer_load_dwordx4 v8, s[16:19], s36 offen sc1 lds
    buffer_load_dwordx4 v8, s[16:19], s36 offen offset:1024 sc1 lds
    s_add_u32 s36, s36, 8192
    s_add_u32 s40, s40, 24576
    s_cmp_eq_u32 s40, 147456
    s_cselect_b32 s40, 0, s40
    s_waitcnt vmcnt(6)
    s_barrier
    s_add_u32 m0, s40, s38
    s_nop 0
    buffer_load_dwordx4 v4, s[12:15], s35 offen lds
    s_add_u32 m0, m0, 4096
    s_nop 0
    buffer_load_dwordx4 v5, s[12:15], s35 offen lds
    s_add_u32 m0, m0, 4096
    s_nop 0
    buffer_load_dwordx4 v6, s[12:15], s35 offen lds
    s_add_u32 m0, m0, 4096
    s_nop 0
    buffer_load_dwordx4 v7, s[12:15], s35 offen lds
    s_add_u32 s35, s35, 131072
    s_add_u32 m0, s40, s39
    s_nop 0
    buffer_load_dwordx4 v8, s[16:19], s36 offen sc1 lds
    buffer_load_dwordx4 v8, s[16:19], s36 offen offset:1024 sc1 lds
    s_add_u32 s36, s36, 8192
    s_add_u32 s40, s40, 24576
    s_cmp_eq_u32 s40, 147456
    s_cselect_b32 s40, 0, s40
    s_add_u32 m0, s40, s38
    s_nop 0
    buffer_load_dwordx4 v4, s[12:15], s35 offen lds
    s_add_u32 m0, m0, 4096
    s_nop 0
    buffer_load_dwordx4 v5, s[12:15], s35 offen lds
    s_add_u32 m0, m0, 4096
    s_nop 0
    buffer_load_dwordx4 v6, s[12:15], s35 offen lds
    s_add_u32 m0, m0, 4096
    s_nop 0
    buffer_load_dwordx4 v7, s[12:15], s35 offen lds
    s_add_u32 s35, s35, 131072
    s_add_u32 m0, s40, s39
    s_nop 0
    buffer_load_dwordx4 v8, s[16:19], s36 offen sc1 lds
    buffer_load_dwordx4 v8, s[16:19], s36 offen offset:1024 sc1 lds
    s_add_u32 s36, s36, 8192
    s_add_u32 s40, s40, 24576
    s_cmp_eq_u32 s40, 147456
    s_cselect_b32 s40, 0, s40
    s_waitcnt vmcnt(12)
    s_barrier
    s_add_u32 m0, s40, s38
    s_nop 0
    buffer_load_dwordx4 v4, s[12:15], s35 offen lds
    s_add_u32 m0, m0, 4096
    s_nop 0
    buffer_load_dwordx4 v5, s[12:15], s35 offen lds
    s_add_u32 m0, m0, 4096
    s_nop 0
    buffer_load_dwordx4 v6, s[12:15], s35 offen lds
    s_add_u32 m0, m0, 4096
    s_nop 0
    buffer_load_dwordx4 v7, s[12:15], s35 offen lds
    s_add_u32 s35, s35, 131072
    s_add_u32 m0, s40, s39
    s_nop 0
    buffer_load_dwordx4 v8, s[16:19], s36 offen sc1 lds
    buffer_load_dwordx4 v8, s[16:19], s36 offen offset:1024 sc1 lds
    s_add_u32 s36, s36, 8192
    s_add_u32 s40, s40, 24576
    s_cmp_eq_u32 s40, 147456
    s_cselect_b32 s40, 0, s40
    s_add_u32 m0, s40, s38
    s_nop 0
    buffer_load_dwordx4 v4, s[12:15], s35 offen lds
    s_add_u32 m0, m0, 4096
    s_nop 0
    buffer_load_dwordx4 v5, s[12:15], s35 offen lds
    s_add_u32 m0, m0, 4096
    s_nop 0
    buffer_load_dwordx4 v6, s[12:15], s35 offen lds
    s_add_u32 m0, m0, 4096
    s_nop 0
    buffer_load_dwordx4 v7, s[12:15], s35 offen lds
    s_add_u32 s35, s35, 131072
    s_add_u32 m0, s40, s39
    s_nop 0
    buffer_load_dwordx4 v8, s[16:19], s36 offen sc1 lds
    buffer_load_dwordx4 v8, s[16:19], s36 offen offset:1024 sc1 lds
    s_add_u32 s36, s36, 8192
    s_add_u32 s40, s40, 24576
    s_cmp_eq_u32 s40, 147456
    s_cselect_b32 s40, 0, s40
    s_mov_b32 s44, 10
k3pb_ploop0:
    s_waitcnt vmcnt(18)
    s_barrier
    s_add_u32 m0, s40, s38
    s_nop 0
    buffer_load_dwordx4 v4, s[12:15], s35 offen lds
    s_add_u32 m0, m0, 4096
    s_nop 0
    buffer_load_dwordx4 v5, s[12:15], s35 offen lds
    s_add_u32 m0, m0, 4096
    s_nop 0
    buffer_load_dwordx4 v6, s[12:15], s35 offen lds
    s_add_u32 m0, m0, 4096
    s_nop 0
    buffer_load_dwordx4 v7, s[12:15], s35 offen lds
    s_add_u32 s35, s35, 131072
    s_add_u32 m0, s40, s39
    s_nop 0
    buffer_load_dwordx4 v8, s[16:19], s36 offen sc1 lds
    buffer_load_dwordx4 v8, s[16:19], s36 offen offset:1024 sc1 lds
    s_add_u32 s36, s36, 8192
    s_add_u32 s40, s40, 24576
    s_cmp_eq_u32 s40, 147456
    s_cselect_b32 s40, 0, s40
    s_sub_u32 s44, s44, 1
    s_cmp_lg_u32 s44, 0
    s_cbranch_scc1 k3pb_ploop0
    s_mov_b32 s12, s6
    s_mov_b32 s13, s7
    s_mov_b32 s14, 0x200000
    s_mov_b32 s15, 0x00020000
    s_add_u32 s16, s26, 0x1c00000
    s_addc_u32 s17, s27, 0
    s_mov_b32 s18, 0x400000
    s_mov_b32 s19, 0x00020000
    s_mul_i32 s35, s3, 16384
    s_lshl_b32 s36, s32, 8
    s_add_u32 s35, s35, s36
    s_mul_i32 s36, s30, 1048576
    s_add_u32 s35, s35, s36
    s_lshl_b32 s36, s33, 19
    s_lshl_b32 s37, s30, 18
    s_add_u32 s36, s36, s37
    s_lshl_b32 s39, s3, 12
    s_add_u32 s36, s36, s39
    s_add_u32 s38, s38, 16384
    s_mov_b32 s44, 16
k3pb_ploop1:
    s_waitcnt vmcnt(18)
    s_barrier
    s_add_u32 m0, s40, s38
    s_nop 0
    buffer_load_dwordx4 v9, s[12:15], s35 offen lds
    s_add_u32 m0, m0, 4096
    s_nop 0
    buffer_load_dwordx4 v10, s[12:15], s35 offen lds
    s_add_u32 s35, s35, 65536
    s_add_u32 m0, s40, s39
    s_nop 0
    buffer_load_dwordx4 v8, s[16:19], s36 offen offset:0 sc1 lds
    buffer_load_dwordx4 v8, s[16:19], s36 offen offset:1024 sc1 lds
    buffer_load_dwordx4 v8, s[16:19], s36 offen offset:2048 sc1 lds
    buffer_load_dwordx4 v8, s[16:19], s36 offen offset:3072 sc1 lds
    s_add_u32 s36, s36, 16384
    s_add_u32 s40, s40, 24576
    s_cmp_eq_u32 s40, 147456
    s_cselect_b32 s40, 0, s40
    s_sub_u32 s44, s44, 1
    s_cmp_lg_u32 s44, 0
    s_cbranch_scc1 k3pb_ploop1
    s_waitcnt vmcnt(18)
    s_barrier
    s_waitcnt vmcnt(12)
    s_barrier
    s_waitcnt vmcnt(6)
    s_barrier
    s_waitcnt vmcnt(0)
    s_barrier
k2_done:
    s_endpgm
code_end:
.section .rodata,"a"
.p2align 6
.amdhsa_kernel k2_kernel
  .amdhsa_next_free_vgpr 256
  .amdhsa_next_free_sgpr 102
  .amdhsa_accum_offset 256
  .amdhsa_group_segment_fixed_size 0
  .amdhsa_kernarg_size 88
  .amdhsa_user_sgpr_count 2
  .amdhsa_user_sgpr_kernarg_segment_ptr 1
  .amdhsa_system_sgpr_workgroup_id_x 1
  .amdhsa_float_denorm_mode_32 3
.end_amdhsa_kernel
```
